```python
import torch

def _softmax(x, axis=-1):
    return torch.softmax(x, dim=axis)

def _gelu(x):
    return torch.nn.functional.gelu(x, approximate='tanh')

def _silu(x):
    return torch.nn.functional.silu(x)

def _sigmoid(x):
    return torch.sigmoid(x)

def _layernorm(x, axis=-1, eps=1e-05):
    m = x.mean(dim=axis, keepdim=True)
    v = x.var(dim=axis, keepdim=True, unbiased=False)
    return (x - m) / torch.sqrt(v + eps)

def _scatter_add(tgt, idx, src, axis=0):
    return tgt.clone().index_add_(axis, idx, src)

def _segment_sum(src, seg, n):
    out = torch.zeros((n,) + src.shape[1:], dtype=src.dtype)
    return out.index_add_(0, seg, src)

def _pad(x, pw):
    flat = tuple((v for pair in reversed(pw) for v in pair))
    return torch.nn.functional.pad(x, flat)
kernel_name = 'parallel_sum__memory_aug_recurrent_mem_tr__glu_gated_geglu__prompt'

def setup_inputs():

    _w = lambda a: (lambda t: t.to(torch.bfloat16) if t.is_floating_point() else t)(torch.as_tensor(a))

    def _A_setup():
        B, S, Dm = (1, 2048, 640)
        H, Dh = (32, 192)
        M, seg = (8, 32)
        seg = min(seg, S)
        S = S // seg * seg
        return {'x': _w((lambda *s: torch.randn(*s, dtype=torch.bfloat16) * 0.05)(B, S, Dm)), 'mem0': _w((lambda *s: torch.randn(*s, dtype=torch.bfloat16) * 0.2)(B, M, Dm)), 'Wq': _w((lambda *s: torch.randn(*s, dtype=torch.bfloat16) * 1.6)(Dm, H, Dh) * Dm ** (-0.5)), 'Wk': _w((lambda *s: torch.randn(*s, dtype=torch.bfloat16) * 1.6)(Dm, H, Dh) * Dm ** (-0.5)), 'Wv': _w((lambda *s: torch.randn(*s, dtype=torch.bfloat16) * 0.2)(Dm, H, Dh) * Dm ** (-0.5)), 'Wo': _w((lambda *s: torch.randn(*s, dtype=torch.bfloat16) * 0.2)(H, Dh, Dm) * (H * Dh) ** (-0.5)), 'seg_len': seg}
    _A_in = _A_setup()

    def _B_setup():
        B, S, Dm, Df = (1, 2048, 640, 1536)
        return {'x': _w((lambda *s: torch.randn(*s, dtype=torch.bfloat16) * 0.05)(B, S, Dm)), 'w_gate': _w((lambda *s: torch.randn(*s, dtype=torch.bfloat16) * 0.4)(Dm, Df) * Dm ** (-0.5)), 'w_up': _w((lambda *s: torch.randn(*s, dtype=torch.bfloat16) * 0.4)(Dm, Df) * Dm ** (-0.5)), 'w_down': _w((lambda *s: torch.randn(*s, dtype=torch.bfloat16) * 0.4)(Df, Dm) * Df ** (-0.5))}
    _B_in = _B_setup()
    return {'A_x': _A_in['x'], 'A_mem0': _A_in['mem0'], 'A_Wq': _A_in['Wq'], 'A_Wk': _A_in['Wk'], 'A_Wv': _A_in['Wv'], 'A_Wo': _A_in['Wo'], 'A_seg_len': _A_in['seg_len'], 'B_x': _B_in['x'], 'B_w_gate': _B_in['w_gate'], 'B_w_up': _B_in['w_up'], 'B_w_down': _B_in['w_down']}

def reference(A_x, A_mem0, A_Wq, A_Wk, A_Wv, A_Wo, A_seg_len, B_x, B_w_gate, B_w_up, B_w_down):

    def _A_ref(x, mem0, Wq, Wk, Wv, Wo, seg_len):
        B, S, Dm = x.shape
        H, Dh = (Wq.shape[1], Wq.shape[2])
        M = mem0.shape[1]
        scale = Dh ** (-0.5)
        n_seg = S // seg_len
        L = M + seg_len
        idx = torch.arange(L)
        mask = (idx[:, None] < M) | (idx[:, None] >= idx[None, :])
        mem = mem0
        outs = []
        for s in range(n_seg):
            xs = x[:, s * seg_len:(s + 1) * seg_len, :].clone()
            h = torch.concatenate([mem, xs], axis=1)
            q = torch.einsum('btd,dhe->bhte', h, Wq)
            k = torch.einsum('btd,dhe->bhte', h, Wk)
            v = torch.einsum('btd,dhe->bhte', h, Wv)
            scores = torch.einsum('bhqe,bhke->bhqk', q, k) * scale
            scores = torch.where(mask[None, None], scores, -1000000000.0)
            p = _softmax(scores, axis=-1)
            o = torch.einsum('bhqk,bhke->bhqe', p, v)
            o = torch.einsum('bhte,hed->btd', o, Wo)
            mem = o[:, :M, :].clone()
            outs.append(o[:, M:, :])
        return torch.concatenate(outs, axis=1)

    def _B_ref(x, w_gate, w_up, w_down):
        g = torch.einsum('bsd,df->bsf', x, w_gate)
        u = torch.einsum('bsd,df->bsf', x, w_up)
        h = _gelu(g) * u
        return torch.einsum('bsf,fd->bsd', h, w_down)
    x = A_x
    xn = _layernorm(x, axis=-1)
    return x + _A_ref(xn, A_mem0, A_Wq, A_Wk, A_Wv, A_Wo, A_seg_len) + _B_ref(xn, B_w_gate, B_w_up, B_w_down)
```

```asm
; @launch grid=(256,1,1) block=(256,1,1) lds=163840
.amdgcn_target "amdgcn-amd-amdhsa--gfx950"
.text
.globl parallel_sum__memory_aug_recurrent_mem_tr__glu_gated_geglu__prompt_kernel
.p2align 8
.type parallel_sum__memory_aug_recurrent_mem_tr__glu_gated_geglu__prompt_kernel,@function
parallel_sum__memory_aug_recurrent_mem_tr__glu_gated_geglu__prompt_kernel:
    s_cmp_lt_u32 s2, 256
    s_cbranch_scc1 go
    s_endpgm
go:
    s_getpc_b64 s[96:97]
pc0:
    s_lshr_b32 s98, s2, 3
    s_lshl_b32 s98, s98, 12
    v_lshlrev_b32 v2, 4, v0
    v_add_u32 v2, s98, v2
    s_mov_b32 s99, code_end-pc0-20
    v_min_u32 v2, s99, v2
    v_and_b32 v2, -4, v2
    global_load_dwordx4 v[8:11], v2, s[96:97]
    s_load_dwordx16 s[64:79], s[0:1], 0
    s_load_dwordx8 s[80:87], s[0:1], 64
    s_load_dwordx4 s[88:91], s[0:1], 96
ticket:
    v_lshrrev_b32 v2, 6, v0
    v_and_b32 v1, 63, v0
    v_readfirstlane_b32 s4, v2
    s_waitcnt lgkmcnt(0)
    s_mov_b32 s8, s90
    s_and_b32 s9, s91, 0xffff
    s_mov_b32 s10, 0x10000000
    s_mov_b32 s11, 0x20000
    s_cmp_lg_u32 s4, 0
    s_cbranch_scc1 ticket_rd
    s_getreg_b32 s32, hwreg(HW_REG_XCC_ID)
    s_mov_b32 s20, s88
    s_and_b32 s21, s89, 0xffff
    s_mov_b32 s22, 0x100
    s_mov_b32 s23, 0x20000
    s_mov_b64 exec, 1
    s_mov_b32 s37, 8
    s_mov_b32 s3, 256
ticket_try:
    s_and_b32 s32, s32, 7
    s_lshl_b32 s33, s32, 5
    v_mov_b32 v2, s33
    v_mov_b32 v3, 1
    buffer_atomic_add v3, v2, s[20:23], 0 offen sc0
    s_waitcnt vmcnt(0)
    v_readfirstlane_b32 s34, v3
    s_nop 3
    s_cmp_lt_u32 s34, 32
    s_cbranch_scc1 ticket_got
    s_add_u32 s32, s32, 1
    s_sub_u32 s37, s37, 1
    s_cmp_lg_u32 s37, 0
    s_cbranch_scc1 ticket_try
    s_branch ticket_wr
ticket_got:
    s_lshl_b32 s33, s32, 5
    s_add_u32 s33, s33, s34
    s_mov_b32 s36, 0
    s_cmp_ge_u32 s33, 0
    s_cmov_b32 s36, 0x0
    s_cmp_ge_u32 s33, 8
    s_cmov_b32 s36, 0x18
    s_cmp_ge_u32 s33, 16
    s_cmov_b32 s36, 0x30
    s_cmp_ge_u32 s33, 21
    s_cmov_b32 s36, 0x3f
    s_cmp_ge_u32 s33, 26
    s_cmov_b32 s36, 0xce
    s_cmp_ge_u32 s33, 28
    s_cmov_b32 s36, 0x7c
    s_cmp_ge_u32 s33, 32
    s_cmov_b32 s36, 0xffffffe8
    s_cmp_ge_u32 s33, 40
    s_cmov_b32 s36, 0x0
    s_cmp_ge_u32 s33, 48
    s_cmov_b32 s36, 0x15
    s_cmp_ge_u32 s33, 53
    s_cmov_b32 s36, 0x24
    s_cmp_ge_u32 s33, 58
    s_cmov_b32 s36, 0xb0
    s_cmp_ge_u32 s33, 60
    s_cmov_b32 s36, 0x60
    s_cmp_ge_u32 s33, 64
    s_cmov_b32 s36, 0xffffffd0
    s_cmp_ge_u32 s33, 72
    s_cmov_b32 s36, 0xffffffe8
    s_cmp_ge_u32 s33, 80
    s_cmov_b32 s36, 0xfffffffa
    s_cmp_ge_u32 s33, 85
    s_cmov_b32 s36, 0x9
    s_cmp_ge_u32 s33, 90
    s_cmov_b32 s36, 0x92
    s_cmp_ge_u32 s33, 92
    s_cmov_b32 s36, 0x44
    s_cmp_ge_u32 s33, 96
    s_cmov_b32 s36, 0xffffffb8
    s_cmp_ge_u32 s33, 104
    s_cmov_b32 s36, 0xffffffd0
    s_cmp_ge_u32 s33, 112
    s_cmov_b32 s36, 0xffffffdf
    s_cmp_ge_u32 s33, 117
    s_cmov_b32 s36, 0xffffffee
    s_cmp_ge_u32 s33, 122
    s_cmov_b32 s36, 0x74
    s_cmp_ge_u32 s33, 124
    s_cmov_b32 s36, 0x28
    s_cmp_ge_u32 s33, 128
    s_cmov_b32 s36, 0xffffffe8
    s_cmp_ge_u32 s33, 140
    s_cmov_b32 s36, 0x1c
    s_cmp_ge_u32 s33, 156
    s_cmov_b32 s36, 0x54
    s_cmp_ge_u32 s33, 160
    s_cmov_b32 s36, 0xffffffd4
    s_cmp_ge_u32 s33, 172
    s_cmov_b32 s36, 0xc
    s_cmp_ge_u32 s33, 188
    s_cmov_b32 s36, 0x38
    s_cmp_ge_u32 s33, 192
    s_cmov_b32 s36, 0xffffffc0
    s_cmp_ge_u32 s33, 204
    s_cmov_b32 s36, 0xfffffffc
    s_cmp_ge_u32 s33, 220
    s_cmov_b32 s36, 0x1c
    s_cmp_ge_u32 s33, 224
    s_cmov_b32 s36, 0xffffffac
    s_cmp_ge_u32 s33, 236
    s_cmov_b32 s36, 0xffffffec
    s_cmp_ge_u32 s33, 252
    s_cmov_b32 s36, 0x0
    s_add_u32 s3, s33, s36
ticket_wr:
    v_mov_b32 v3, s3
    v_mov_b32 v2, 0
    ds_write_b32 v2, v3
    s_waitcnt lgkmcnt(0)
    s_mov_b64 exec, -1
ticket_rd:
    s_barrier
    v_mov_b32 v2, 0
    ds_read_b32 v3, v2
    s_waitcnt vmcnt(0) lgkmcnt(0)
    v_readfirstlane_b32 s3, v3
    s_nop 3
    s_barrier
    s_cmp_gt_u32 s3, 255
    s_cbranch_scc1 code_end
    s_mov_b32 s53, 0
    s_mov_b32 s6, s3
    s_cmp_lt_u32 s3, 32
    s_cbranch_scc1 A_start
    s_sub_u32 s6, s3, 32
    s_cmp_lt_u32 s3, 64
    s_cbranch_scc1 V_start
    s_cmp_lt_u32 s3, 104
    s_cbranch_scc1 helper
    s_and_b32 s7, s3, 1
    s_sub_u32 s6, s3, 104
    s_lshr_b32 s6, s6, 1
    s_cmp_lt_u32 s3, 152
    s_cbranch_scc1 QK_start
    s_sub_u32 s6, s3, 152
    s_lshr_b32 s6, s6, 1
    s_cmp_lt_u32 s3, 168
    s_cbranch_scc1 helper
    s_sub_u32 s6, s3, 168
    s_lshr_b32 s6, s6, 1
    s_cmp_lt_u32 s3, 232
    s_cbranch_scc1 VO_start
    s_sub_u32 s6, s3, 232
    s_lshr_b32 s6, s6, 1
    s_branch FFN_start
helper:
    s_mov_b32 s24, s64
    s_and_b32 s25, s65, 0xffff
    s_mov_b32 s26, 0x280000
    s_mov_b32 s27, 0x20000
    s_mov_b32 s12, s66
    s_and_b32 s13, s67, 0xffff
    s_mov_b32 s14, 0x2800
    s_mov_b32 s15, 0x20000
    s_sub_u32 s54, s3, 64
    s_min_u32 s54, s54, 39
    v_mov_b32 v4, -1
    v_mov_b32 v5, -1
    v_mov_b32 v6, -1
    v_mov_b32 v7, -1
    s_mul_hi_u32 s33, s54, 0x55555556
    s_mul_i32 s34, s33, 3
    s_sub_u32 s34, s54, s34
    s_lshl_b32 s33, s33, 2
    s_add_u32 s33, s33, s4
    s_lshl_b32 s57, s34, 3
    s_add_u32 s57, s57, 8
    v_mov_b32 v2, 0
    v_mov_b32 v3, 1
    ds_write_b32 v2, v3 offset:64
    s_waitcnt lgkmcnt(0)
    s_barrier
    s_lshl_b32 s50, s34, 21
    s_lshl_b32 s33, s33, 15
    s_add_u32 s50, s50, s33
    s_add_u32 s50, s50, 0xa205f00
    s_add_u32 s51, s50, 8192
    v_and_b32 v14, 7, v1
    v_lshlrev_b32 v14, 4, v14
    s_mov_b32 s55, -1
    s_mov_b32 s56, -1
    s_sub_u32 s54, s3, 152
    s_cmp_ge_u32 s3, 152
    s_cbranch_scc1 prep_nv
    s_sub_u32 s54, s3, 48
    buffer_store_dwordx4 v[4:7], v14, s[8:11], s50 offen sc1
    buffer_store_dwordx4 v[4:7], v14, s[8:11], s51 offen sc1
    s_waitcnt vmcnt(0)
    s_memtime s[36:37]
    s_waitcnt lgkmcnt(0)
    buffer_load_dwordx4 v[8:11], v14, s[8:11], s50 offen sc1
    s_waitcnt vmcnt(0)
    s_memtime s[38:39]
    s_waitcnt lgkmcnt(0)
    buffer_load_dwordx4 v[8:11], v14, s[8:11], s51 offen sc1
    s_waitcnt vmcnt(0)
    s_memtime s[40:41]
    s_waitcnt lgkmcnt(0)
    s_sub_u32 s40, s40, s38
    s_sub_u32 s38, s38, s36
    s_min_u32 s55, s55, s38
    s_min_u32 s56, s56, s40
    buffer_store_dwordx4 v[4:7], v14, s[8:11], s51 offen sc1
    buffer_store_dwordx4 v[4:7], v14, s[8:11], s50 offen sc1
    s_waitcnt vmcnt(0)
    s_memtime s[36:37]
    s_waitcnt lgkmcnt(0)
    buffer_load_dwordx4 v[8:11], v14, s[8:11], s51 offen sc1
    s_waitcnt vmcnt(0)
    s_memtime s[38:39]
    s_waitcnt lgkmcnt(0)
    buffer_load_dwordx4 v[8:11], v14, s[8:11], s50 offen sc1
    s_waitcnt vmcnt(0)
    s_memtime s[40:41]
    s_waitcnt lgkmcnt(0)
    s_sub_u32 s40, s40, s38
    s_sub_u32 s38, s38, s36
    s_min_u32 s56, s56, s38
    s_min_u32 s55, s55, s40
prep_nv:
    v_lshrrev_b32 v2, 3, v0
    v_and_b32 v3, 7, v0
    v_mul_u32_u24 v12, 1280, v2
    v_lshl_add_u32 v12, v3, 4, v12
    v_lshlrev_b32 v13, 9, v3
    v_lshl_add_u32 v13, v2, 4, v13
    s_mov_b32 s48, s54
    s_mov_b32 s34, 0xffff0000
    s_mul_i32 s32, s48, 40960
    s_add_u32 s35, s32, 2293760
    buffer_load_dwordx4 v[16:19], v12, s[24:27], s32 offen offset:0
    buffer_load_dwordx4 v[20:23], v12, s[24:27], s32 offen offset:128
    buffer_load_dwordx4 v[24:27], v12, s[24:27], s32 offen offset:256
    buffer_load_dwordx4 v[28:31], v12, s[24:27], s32 offen offset:384
    buffer_load_dwordx4 v[32:35], v12, s[24:27], s32 offen offset:512
    buffer_load_dwordx4 v[36:39], v12, s[24:27], s32 offen offset:640
    buffer_load_dwordx4 v[40:43], v12, s[24:27], s32 offen offset:768
    buffer_load_dwordx4 v[44:47], v12, s[24:27], s32 offen offset:896
    buffer_load_dwordx4 v[48:51], v12, s[24:27], s32 offen offset:1024
    buffer_load_dwordx4 v[52:55], v12, s[24:27], s32 offen offset:1152
    buffer_load_dwordx4 v[144:147], v12, s[24:27], s35 offen offset:0
    buffer_load_dwordx4 v[148:151], v12, s[24:27], s35 offen offset:128
    buffer_load_dwordx4 v[152:155], v12, s[24:27], s35 offen offset:256
    buffer_load_dwordx4 v[156:159], v12, s[24:27], s35 offen offset:384
    buffer_load_dwordx4 v[160:163], v12, s[24:27], s35 offen offset:512
    buffer_load_dwordx4 v[164:167], v12, s[24:27], s35 offen offset:640
    buffer_load_dwordx4 v[168:171], v12, s[24:27], s35 offen offset:768
    buffer_load_dwordx4 v[172:175], v12, s[24:27], s35 offen offset:896
    buffer_load_dwordx4 v[176:179], v12, s[24:27], s35 offen offset:1024
    buffer_load_dwordx4 v[180:183], v12, s[24:27], s35 offen offset:1152
    v_lshlrev_b32 v15, 4, v0
    s_lshl_b32 s36, s54, 12
    s_add_u32 s36, s36, 0
    s_cmp_ge_u32 s36, 0
    s_cmov_b32 s37, 0xa208000
    s_cmp_ge_u32 s36, 98304
    s_cmov_b32 s37, 0xa3e8000
    s_cmp_ge_u32 s36, 1839104
    s_cmov_b32 s37, 0x40000000
    s_add_u32 s37, s37, s36
    buffer_store_dwordx4 v[4:7], v15, s[8:11], s37 offen sc1
    s_lshl_b32 s36, s54, 12
    s_add_u32 s36, s36, 229376
    s_cmp_ge_u32 s36, 229376
    s_cmov_b32 s37, 0xa7c8000
    s_cmp_ge_u32 s36, 1839104
    s_cmov_b32 s37, 0x40000000
    s_add_u32 s37, s37, s36
    buffer_store_dwordx4 v[4:7], v15, s[8:11], s37 offen sc1
    s_lshl_b32 s36, s54, 12
    s_add_u32 s36, s36, 458752
    s_cmp_ge_u32 s36, 229376
    s_cmov_b32 s37, 0xa7c8000
    s_cmp_ge_u32 s36, 528384
    s_cmov_b32 s37, 0xaf7f000
    s_cmp_ge_u32 s36, 1839104
    s_cmov_b32 s37, 0x40000000
    s_add_u32 s37, s37, s36
    buffer_store_dwordx4 v[4:7], v15, s[8:11], s37 offen sc1
    s_lshl_b32 s36, s54, 12
    s_add_u32 s36, s36, 688128
    s_cmp_ge_u32 s36, 528384
    s_cmov_b32 s37, 0xaf7f000
    s_cmp_ge_u32 s36, 1839104
    s_cmov_b32 s37, 0x40000000
    s_add_u32 s37, s37, s36
    buffer_store_dwordx4 v[4:7], v15, s[8:11], s37 offen sc1
    s_lshl_b32 s36, s54, 12
    s_add_u32 s36, s36, 917504
    s_cmp_ge_u32 s36, 528384
    s_cmov_b32 s37, 0xaf7f000
    s_cmp_ge_u32 s36, 1839104
    s_cmov_b32 s37, 0x40000000
    s_add_u32 s37, s37, s36
    buffer_store_dwordx4 v[4:7], v15, s[8:11], s37 offen sc1
    s_lshl_b32 s36, s54, 12
    s_add_u32 s36, s36, 1146880
    s_cmp_ge_u32 s36, 528384
    s_cmov_b32 s37, 0xaf7f000
    s_cmp_ge_u32 s36, 1839104
    s_cmov_b32 s37, 0x40000000
    s_add_u32 s37, s37, s36
    buffer_store_dwordx4 v[4:7], v15, s[8:11], s37 offen sc1
    s_lshl_b32 s36, s54, 12
    s_add_u32 s36, s36, 1376256
    s_cmp_ge_u32 s36, 528384
    s_cmov_b32 s37, 0xaf7f000
    s_cmp_ge_u32 s36, 1839104
    s_cmov_b32 s37, 0x40000000
    s_add_u32 s37, s37, s36
    buffer_store_dwordx4 v[4:7], v15, s[8:11], s37 offen sc1
    s_lshl_b32 s36, s54, 12
    s_add_u32 s36, s36, 1605632
    s_cmp_ge_u32 s36, 528384
    s_cmov_b32 s37, 0xaf7f000
    s_cmp_ge_u32 s36, 1839104
    s_cmov_b32 s37, 0x40000000
    s_add_u32 s37, s37, s36
    buffer_store_dwordx4 v[4:7], v15, s[8:11], s37 offen sc1
    s_lshl_b32 s36, s54, 12
    s_add_u32 s36, s36, 1835008
    s_cmp_ge_u32 s36, 528384
    s_cmov_b32 s37, 0xaf7f000
    s_cmp_ge_u32 s36, 1839104
    s_cmov_b32 s37, 0x40000000
    s_add_u32 s37, s37, s36
    buffer_store_dwordx4 v[4:7], v15, s[8:11], s37 offen sc1
    s_waitcnt vmcnt(0)
    s_nop 0
prep_ln:
    s_mul_i32 s33, s48, 40960
    v_lshlrev_b32 v64, 16, v16
    v_and_b32 v65, s34, v16
    v_lshlrev_b32 v66, 16, v17
    v_and_b32 v67, s34, v17
    v_lshlrev_b32 v68, 16, v18
    v_and_b32 v69, s34, v18
    v_lshlrev_b32 v70, 16, v19
    v_and_b32 v71, s34, v19
    v_lshlrev_b32 v72, 16, v20
    v_and_b32 v73, s34, v20
    v_lshlrev_b32 v74, 16, v21
    v_and_b32 v75, s34, v21
    v_lshlrev_b32 v76, 16, v22
    v_and_b32 v77, s34, v22
    v_lshlrev_b32 v78, 16, v23
    v_and_b32 v79, s34, v23
    v_lshlrev_b32 v80, 16, v24
    v_and_b32 v81, s34, v24
    v_lshlrev_b32 v82, 16, v25
    v_and_b32 v83, s34, v25
    v_lshlrev_b32 v84, 16, v26
    v_and_b32 v85, s34, v26
    v_lshlrev_b32 v86, 16, v27
    v_and_b32 v87, s34, v27
    v_lshlrev_b32 v88, 16, v28
    v_and_b32 v89, s34, v28
    v_lshlrev_b32 v90, 16, v29
    v_and_b32 v91, s34, v29
    v_lshlrev_b32 v92, 16, v30
    v_and_b32 v93, s34, v30
    v_lshlrev_b32 v94, 16, v31
    v_and_b32 v95, s34, v31
    v_lshlrev_b32 v96, 16, v32
    v_and_b32 v97, s34, v32
    v_lshlrev_b32 v98, 16, v33
    v_and_b32 v99, s34, v33
    v_lshlrev_b32 v100, 16, v34
    v_and_b32 v101, s34, v34
    v_lshlrev_b32 v102, 16, v35
    v_and_b32 v103, s34, v35
    v_lshlrev_b32 v104, 16, v36
    v_and_b32 v105, s34, v36
    v_lshlrev_b32 v106, 16, v37
    v_and_b32 v107, s34, v37
    v_lshlrev_b32 v108, 16, v38
    v_and_b32 v109, s34, v38
    v_lshlrev_b32 v110, 16, v39
    v_and_b32 v111, s34, v39
    v_lshlrev_b32 v112, 16, v40
    v_and_b32 v113, s34, v40
    v_lshlrev_b32 v114, 16, v41
    v_and_b32 v115, s34, v41
    v_lshlrev_b32 v116, 16, v42
    v_and_b32 v117, s34, v42
    v_lshlrev_b32 v118, 16, v43
    v_and_b32 v119, s34, v43
    v_lshlrev_b32 v120, 16, v44
    v_and_b32 v121, s34, v44
    v_lshlrev_b32 v122, 16, v45
    v_and_b32 v123, s34, v45
    v_lshlrev_b32 v124, 16, v46
    v_and_b32 v125, s34, v46
    v_lshlrev_b32 v126, 16, v47
    v_and_b32 v127, s34, v47
    v_lshlrev_b32 v128, 16, v48
    v_and_b32 v129, s34, v48
    v_lshlrev_b32 v130, 16, v49
    v_and_b32 v131, s34, v49
    v_lshlrev_b32 v132, 16, v50
    v_and_b32 v133, s34, v50
    v_lshlrev_b32 v134, 16, v51
    v_and_b32 v135, s34, v51
    v_lshlrev_b32 v136, 16, v52
    v_and_b32 v137, s34, v52
    v_lshlrev_b32 v138, 16, v53
    v_and_b32 v139, s34, v53
    v_lshlrev_b32 v140, 16, v54
    v_and_b32 v141, s34, v54
    v_lshlrev_b32 v142, 16, v55
    v_and_b32 v143, s34, v55
    v_add_f32 v56, v64, v68
    v_add_f32 v57, v65, v69
    v_add_f32 v58, v66, v70
    v_add_f32 v59, v67, v71
    v_add_f32 v56, v56, v72
    v_add_f32 v57, v57, v73
    v_add_f32 v58, v58, v74
    v_add_f32 v59, v59, v75
    v_add_f32 v56, v56, v76
    v_add_f32 v57, v57, v77
    v_add_f32 v58, v58, v78
    v_add_f32 v59, v59, v79
    v_add_f32 v56, v56, v80
    v_add_f32 v57, v57, v81
    v_add_f32 v58, v58, v82
    v_add_f32 v59, v59, v83
    v_add_f32 v56, v56, v84
    v_add_f32 v57, v57, v85
    v_add_f32 v58, v58, v86
    v_add_f32 v59, v59, v87
    v_add_f32 v56, v56, v88
    v_add_f32 v57, v57, v89
    v_add_f32 v58, v58, v90
    v_add_f32 v59, v59, v91
    v_add_f32 v56, v56, v92
    v_add_f32 v57, v57, v93
    v_add_f32 v58, v58, v94
    v_add_f32 v59, v59, v95
    v_add_f32 v56, v56, v96
    v_add_f32 v57, v57, v97
    v_add_f32 v58, v58, v98
    v_add_f32 v59, v59, v99
    v_add_f32 v56, v56, v100
    v_add_f32 v57, v57, v101
    v_add_f32 v58, v58, v102
    v_add_f32 v59, v59, v103
    v_add_f32 v56, v56, v104
    v_add_f32 v57, v57, v105
    v_add_f32 v58, v58, v106
    v_add_f32 v59, v59, v107
    v_add_f32 v56, v56, v108
    v_add_f32 v57, v57, v109
    v_add_f32 v58, v58, v110
    v_add_f32 v59, v59, v111
    v_add_f32 v56, v56, v112
    v_add_f32 v57, v57, v113
    v_add_f32 v58, v58, v114
    v_add_f32 v59, v59, v115
    v_add_f32 v56, v56, v116
    v_add_f32 v57, v57, v117
    v_add_f32 v58, v58, v118
    v_add_f32 v59, v59, v119
    v_add_f32 v56, v56, v120
    v_add_f32 v57, v57, v121
    v_add_f32 v58, v58, v122
    v_add_f32 v59, v59, v123
    v_add_f32 v56, v56, v124
    v_add_f32 v57, v57, v125
    v_add_f32 v58, v58, v126
    v_add_f32 v59, v59, v127
    v_add_f32 v56, v56, v128
    v_add_f32 v57, v57, v129
    v_add_f32 v58, v58, v130
    v_add_f32 v59, v59, v131
    v_add_f32 v56, v56, v132
    v_add_f32 v57, v57, v133
    v_add_f32 v58, v58, v134
    v_add_f32 v59, v59, v135
    v_add_f32 v56, v56, v136
    v_add_f32 v57, v57, v137
    v_add_f32 v58, v58, v138
    v_add_f32 v59, v59, v139
    v_add_f32 v56, v56, v140
    v_add_f32 v57, v57, v141
    v_add_f32 v58, v58, v142
    v_add_f32 v59, v59, v143
    v_add_f32 v56, v56, v57
    v_add_f32 v58, v58, v59
    v_add_f32 v56, v56, v58
    s_nop 1
    v_add_f32_dpp v56, v56, v56 quad_perm:[1,0,3,2] row_mask:0xf bank_mask:0xf
    s_nop 1
    v_add_f32_dpp v56, v56, v56 quad_perm:[2,3,0,1] row_mask:0xf bank_mask:0xf
    s_nop 1
    v_add_f32_dpp v56, v56, v56 row_half_mirror row_mask:0xf bank_mask:0xf
    v_mul_f32 v56, 0x3acccccd, v56
    v_mov_b32 v58, 0
    v_mov_b32 v59, 0
    v_mov_b32 v60, 0
    v_mov_b32 v61, 0
    v_sub_f32 v57, v64, v56
    v_fmac_f32 v58, v57, v57
    v_sub_f32 v57, v65, v56
    v_fmac_f32 v59, v57, v57
    v_sub_f32 v57, v66, v56
    v_fmac_f32 v60, v57, v57
    v_sub_f32 v57, v67, v56
    v_fmac_f32 v61, v57, v57
    v_sub_f32 v57, v68, v56
    v_fmac_f32 v58, v57, v57
    v_sub_f32 v57, v69, v56
    v_fmac_f32 v59, v57, v57
    v_sub_f32 v57, v70, v56
    v_fmac_f32 v60, v57, v57
    v_sub_f32 v57, v71, v56
    v_fmac_f32 v61, v57, v57
    v_sub_f32 v57, v72, v56
    v_fmac_f32 v58, v57, v57
    v_sub_f32 v57, v73, v56
    v_fmac_f32 v59, v57, v57
    v_sub_f32 v57, v74, v56
    v_fmac_f32 v60, v57, v57
    v_sub_f32 v57, v75, v56
    v_fmac_f32 v61, v57, v57
    v_sub_f32 v57, v76, v56
    v_fmac_f32 v58, v57, v57
    v_sub_f32 v57, v77, v56
    v_fmac_f32 v59, v57, v57
    v_sub_f32 v57, v78, v56
    v_fmac_f32 v60, v57, v57
    v_sub_f32 v57, v79, v56
    v_fmac_f32 v61, v57, v57
    v_sub_f32 v57, v80, v56
    v_fmac_f32 v58, v57, v57
    v_sub_f32 v57, v81, v56
    v_fmac_f32 v59, v57, v57
    v_sub_f32 v57, v82, v56
    v_fmac_f32 v60, v57, v57
    v_sub_f32 v57, v83, v56
    v_fmac_f32 v61, v57, v57
    v_sub_f32 v57, v84, v56
    v_fmac_f32 v58, v57, v57
    v_sub_f32 v57, v85, v56
    v_fmac_f32 v59, v57, v57
    v_sub_f32 v57, v86, v56
    v_fmac_f32 v60, v57, v57
    v_sub_f32 v57, v87, v56
    v_fmac_f32 v61, v57, v57
    v_sub_f32 v57, v88, v56
    v_fmac_f32 v58, v57, v57
    v_sub_f32 v57, v89, v56
    v_fmac_f32 v59, v57, v57
    v_sub_f32 v57, v90, v56
    v_fmac_f32 v60, v57, v57
    v_sub_f32 v57, v91, v56
    v_fmac_f32 v61, v57, v57
    v_sub_f32 v57, v92, v56
    v_fmac_f32 v58, v57, v57
    v_sub_f32 v57, v93, v56
    v_fmac_f32 v59, v57, v57
    v_sub_f32 v57, v94, v56
    v_fmac_f32 v60, v57, v57
    v_sub_f32 v57, v95, v56
    v_fmac_f32 v61, v57, v57
    v_sub_f32 v57, v96, v56
    v_fmac_f32 v58, v57, v57
    v_sub_f32 v57, v97, v56
    v_fmac_f32 v59, v57, v57
    v_sub_f32 v57, v98, v56
    v_fmac_f32 v60, v57, v57
    v_sub_f32 v57, v99, v56
    v_fmac_f32 v61, v57, v57
    v_sub_f32 v57, v100, v56
    v_fmac_f32 v58, v57, v57
    v_sub_f32 v57, v101, v56
    v_fmac_f32 v59, v57, v57
    v_sub_f32 v57, v102, v56
    v_fmac_f32 v60, v57, v57
    v_sub_f32 v57, v103, v56
    v_fmac_f32 v61, v57, v57
    v_sub_f32 v57, v104, v56
    v_fmac_f32 v58, v57, v57
    v_sub_f32 v57, v105, v56
    v_fmac_f32 v59, v57, v57
    v_sub_f32 v57, v106, v56
    v_fmac_f32 v60, v57, v57
    v_sub_f32 v57, v107, v56
    v_fmac_f32 v61, v57, v57
    v_sub_f32 v57, v108, v56
    v_fmac_f32 v58, v57, v57
    v_sub_f32 v57, v109, v56
    v_fmac_f32 v59, v57, v57
    v_sub_f32 v57, v110, v56
    v_fmac_f32 v60, v57, v57
    v_sub_f32 v57, v111, v56
    v_fmac_f32 v61, v57, v57
    v_sub_f32 v57, v112, v56
    v_fmac_f32 v58, v57, v57
    v_sub_f32 v57, v113, v56
    v_fmac_f32 v59, v57, v57
    v_sub_f32 v57, v114, v56
    v_fmac_f32 v60, v57, v57
    v_sub_f32 v57, v115, v56
    v_fmac_f32 v61, v57, v57
    v_sub_f32 v57, v116, v56
    v_fmac_f32 v58, v57, v57
    v_sub_f32 v57, v117, v56
    v_fmac_f32 v59, v57, v57
    v_sub_f32 v57, v118, v56
    v_fmac_f32 v60, v57, v57
    v_sub_f32 v57, v119, v56
    v_fmac_f32 v61, v57, v57
    v_sub_f32 v57, v120, v56
    v_fmac_f32 v58, v57, v57
    v_sub_f32 v57, v121, v56
    v_fmac_f32 v59, v57, v57
    v_sub_f32 v57, v122, v56
    v_fmac_f32 v60, v57, v57
    v_sub_f32 v57, v123, v56
    v_fmac_f32 v61, v57, v57
    v_sub_f32 v57, v124, v56
    v_fmac_f32 v58, v57, v57
    v_sub_f32 v57, v125, v56
    v_fmac_f32 v59, v57, v57
    v_sub_f32 v57, v126, v56
    v_fmac_f32 v60, v57, v57
    v_sub_f32 v57, v127, v56
    v_fmac_f32 v61, v57, v57
    v_sub_f32 v57, v128, v56
    v_fmac_f32 v58, v57, v57
    v_sub_f32 v57, v129, v56
    v_fmac_f32 v59, v57, v57
    v_sub_f32 v57, v130, v56
    v_fmac_f32 v60, v57, v57
    v_sub_f32 v57, v131, v56
    v_fmac_f32 v61, v57, v57
    v_sub_f32 v57, v132, v56
    v_fmac_f32 v58, v57, v57
    v_sub_f32 v57, v133, v56
    v_fmac_f32 v59, v57, v57
    v_sub_f32 v57, v134, v56
    v_fmac_f32 v60, v57, v57
    v_sub_f32 v57, v135, v56
    v_fmac_f32 v61, v57, v57
    v_sub_f32 v57, v136, v56
    v_fmac_f32 v58, v57, v57
    v_sub_f32 v57, v137, v56
    v_fmac_f32 v59, v57, v57
    v_sub_f32 v57, v138, v56
    v_fmac_f32 v60, v57, v57
    v_sub_f32 v57, v139, v56
    v_fmac_f32 v61, v57, v57
    v_sub_f32 v57, v140, v56
    v_fmac_f32 v58, v57, v57
    v_sub_f32 v57, v141, v56
    v_fmac_f32 v59, v57, v57
    v_sub_f32 v57, v142, v56
    v_fmac_f32 v60, v57, v57
    v_sub_f32 v57, v143, v56
    v_fmac_f32 v61, v57, v57
    v_add_f32 v58, v58, v59
    v_add_f32 v60, v60, v61
    v_add_f32 v58, v58, v60
    s_nop 1
    v_add_f32_dpp v58, v58, v58 quad_perm:[1,0,3,2] row_mask:0xf bank_mask:0xf
    s_nop 1
    v_add_f32_dpp v58, v58, v58 quad_perm:[2,3,0,1] row_mask:0xf bank_mask:0xf
    s_nop 1
    v_add_f32_dpp v58, v58, v58 row_half_mirror row_mask:0xf bank_mask:0xf
    v_mul_f32 v58, 0x3acccccd, v58
    v_cvt_pk_bf16_f32 v57, v56, v58
    v_lshlrev_b32 v56, 16, v57
    v_and_b32 v58, s34, v57
    v_add_f32 v58, 0x3727c5ac, v58
    v_cvt_pk_bf16_f32 v58, v58, v58
    v_lshlrev_b32 v58, 16, v58
    v_sqrt_f32 v58, v58
    s_nop 0
    v_cvt_pk_bf16_f32 v58, v58, v58
    v_lshlrev_b32 v58, 16, v58
    v_rcp_f32 v58, v58
    v_sub_f32 v59, v64, v56
    v_sub_f32 v60, v65, v56
    v_cvt_pk_bf16_f32 v59, v59, v60
    v_and_b32 v60, s34, v59
    v_lshlrev_b32 v59, 16, v59
    v_mul_f32 v59, v59, v58
    v_mul_f32 v60, v60, v58
    v_cvt_pk_bf16_f32 v16, v59, v60
    v_sub_f32 v59, v66, v56
    v_sub_f32 v60, v67, v56
    v_cvt_pk_bf16_f32 v59, v59, v60
    v_and_b32 v60, s34, v59
    v_lshlrev_b32 v59, 16, v59
    v_mul_f32 v59, v59, v58
    v_mul_f32 v60, v60, v58
    v_cvt_pk_bf16_f32 v17, v59, v60
    v_sub_f32 v59, v68, v56
    v_sub_f32 v60, v69, v56
    v_cvt_pk_bf16_f32 v59, v59, v60
    v_and_b32 v60, s34, v59
    v_lshlrev_b32 v59, 16, v59
    v_mul_f32 v59, v59, v58
    v_mul_f32 v60, v60, v58
    v_cvt_pk_bf16_f32 v18, v59, v60
    v_sub_f32 v59, v70, v56
    v_sub_f32 v60, v71, v56
    v_cvt_pk_bf16_f32 v59, v59, v60
    v_and_b32 v60, s34, v59
    v_lshlrev_b32 v59, 16, v59
    v_mul_f32 v59, v59, v58
    v_mul_f32 v60, v60, v58
    v_cvt_pk_bf16_f32 v19, v59, v60
    v_sub_f32 v59, v72, v56
    v_sub_f32 v60, v73, v56
    v_cvt_pk_bf16_f32 v59, v59, v60
    v_and_b32 v60, s34, v59
    v_lshlrev_b32 v59, 16, v59
    v_mul_f32 v59, v59, v58
    v_mul_f32 v60, v60, v58
    v_cvt_pk_bf16_f32 v20, v59, v60
    v_sub_f32 v59, v74, v56
    v_sub_f32 v60, v75, v56
    v_cvt_pk_bf16_f32 v59, v59, v60
    v_and_b32 v60, s34, v59
    v_lshlrev_b32 v59, 16, v59
    v_mul_f32 v59, v59, v58
    v_mul_f32 v60, v60, v58
    v_cvt_pk_bf16_f32 v21, v59, v60
    v_sub_f32 v59, v76, v56
    v_sub_f32 v60, v77, v56
    v_cvt_pk_bf16_f32 v59, v59, v60
    v_and_b32 v60, s34, v59
    v_lshlrev_b32 v59, 16, v59
    v_mul_f32 v59, v59, v58
    v_mul_f32 v60, v60, v58
    v_cvt_pk_bf16_f32 v22, v59, v60
    v_sub_f32 v59, v78, v56
    v_sub_f32 v60, v79, v56
    v_cvt_pk_bf16_f32 v59, v59, v60
    v_and_b32 v60, s34, v59
    v_lshlrev_b32 v59, 16, v59
    v_mul_f32 v59, v59, v58
    v_mul_f32 v60, v60, v58
    v_cvt_pk_bf16_f32 v23, v59, v60
    v_sub_f32 v59, v80, v56
    v_sub_f32 v60, v81, v56
    v_cvt_pk_bf16_f32 v59, v59, v60
    v_and_b32 v60, s34, v59
    v_lshlrev_b32 v59, 16, v59
    v_mul_f32 v59, v59, v58
    v_mul_f32 v60, v60, v58
    v_cvt_pk_bf16_f32 v24, v59, v60
    v_sub_f32 v59, v82, v56
    v_sub_f32 v60, v83, v56
    v_cvt_pk_bf16_f32 v59, v59, v60
    v_and_b32 v60, s34, v59
    v_lshlrev_b32 v59, 16, v59
    v_mul_f32 v59, v59, v58
    v_mul_f32 v60, v60, v58
    v_cvt_pk_bf16_f32 v25, v59, v60
    v_sub_f32 v59, v84, v56
    v_sub_f32 v60, v85, v56
    v_cvt_pk_bf16_f32 v59, v59, v60
    v_and_b32 v60, s34, v59
    v_lshlrev_b32 v59, 16, v59
    v_mul_f32 v59, v59, v58
    v_mul_f32 v60, v60, v58
    v_cvt_pk_bf16_f32 v26, v59, v60
    v_sub_f32 v59, v86, v56
    v_sub_f32 v60, v87, v56
    v_cvt_pk_bf16_f32 v59, v59, v60
    v_and_b32 v60, s34, v59
    v_lshlrev_b32 v59, 16, v59
    v_mul_f32 v59, v59, v58
    v_mul_f32 v60, v60, v58
    v_cvt_pk_bf16_f32 v27, v59, v60
    v_sub_f32 v59, v88, v56
    v_sub_f32 v60, v89, v56
    v_cvt_pk_bf16_f32 v59, v59, v60
    v_and_b32 v60, s34, v59
    v_lshlrev_b32 v59, 16, v59
    v_mul_f32 v59, v59, v58
    v_mul_f32 v60, v60, v58
    v_cvt_pk_bf16_f32 v28, v59, v60
    v_sub_f32 v59, v90, v56
    v_sub_f32 v60, v91, v56
    v_cvt_pk_bf16_f32 v59, v59, v60
    v_and_b32 v60, s34, v59
    v_lshlrev_b32 v59, 16, v59
    v_mul_f32 v59, v59, v58
    v_mul_f32 v60, v60, v58
    v_cvt_pk_bf16_f32 v29, v59, v60
    v_sub_f32 v59, v92, v56
    v_sub_f32 v60, v93, v56
    v_cvt_pk_bf16_f32 v59, v59, v60
    v_and_b32 v60, s34, v59
    v_lshlrev_b32 v59, 16, v59
    v_mul_f32 v59, v59, v58
    v_mul_f32 v60, v60, v58
    v_cvt_pk_bf16_f32 v30, v59, v60
    v_sub_f32 v59, v94, v56
    v_sub_f32 v60, v95, v56
    v_cvt_pk_bf16_f32 v59, v59, v60
    v_and_b32 v60, s34, v59
    v_lshlrev_b32 v59, 16, v59
    v_mul_f32 v59, v59, v58
    v_mul_f32 v60, v60, v58
    v_cvt_pk_bf16_f32 v31, v59, v60
    v_sub_f32 v59, v96, v56
    v_sub_f32 v60, v97, v56
    v_cvt_pk_bf16_f32 v59, v59, v60
    v_and_b32 v60, s34, v59
    v_lshlrev_b32 v59, 16, v59
    v_mul_f32 v59, v59, v58
    v_mul_f32 v60, v60, v58
    v_cvt_pk_bf16_f32 v32, v59, v60
    v_sub_f32 v59, v98, v56
    v_sub_f32 v60, v99, v56
    v_cvt_pk_bf16_f32 v59, v59, v60
    v_and_b32 v60, s34, v59
    v_lshlrev_b32 v59, 16, v59
    v_mul_f32 v59, v59, v58
    v_mul_f32 v60, v60, v58
    v_cvt_pk_bf16_f32 v33, v59, v60
    v_sub_f32 v59, v100, v56
    v_sub_f32 v60, v101, v56
    v_cvt_pk_bf16_f32 v59, v59, v60
    v_and_b32 v60, s34, v59
    v_lshlrev_b32 v59, 16, v59
    v_mul_f32 v59, v59, v58
    v_mul_f32 v60, v60, v58
    v_cvt_pk_bf16_f32 v34, v59, v60
    v_sub_f32 v59, v102, v56
    v_sub_f32 v60, v103, v56
    v_cvt_pk_bf16_f32 v59, v59, v60
    v_and_b32 v60, s34, v59
    v_lshlrev_b32 v59, 16, v59
    v_mul_f32 v59, v59, v58
    v_mul_f32 v60, v60, v58
    v_cvt_pk_bf16_f32 v35, v59, v60
    v_sub_f32 v59, v104, v56
    v_sub_f32 v60, v105, v56
    v_cvt_pk_bf16_f32 v59, v59, v60
    v_and_b32 v60, s34, v59
    v_lshlrev_b32 v59, 16, v59
    v_mul_f32 v59, v59, v58
    v_mul_f32 v60, v60, v58
    v_cvt_pk_bf16_f32 v36, v59, v60
    v_sub_f32 v59, v106, v56
    v_sub_f32 v60, v107, v56
    v_cvt_pk_bf16_f32 v59, v59, v60
    v_and_b32 v60, s34, v59
    v_lshlrev_b32 v59, 16, v59
    v_mul_f32 v59, v59, v58
    v_mul_f32 v60, v60, v58
    v_cvt_pk_bf16_f32 v37, v59, v60
    v_sub_f32 v59, v108, v56
    v_sub_f32 v60, v109, v56
    v_cvt_pk_bf16_f32 v59, v59, v60
    v_and_b32 v60, s34, v59
    v_lshlrev_b32 v59, 16, v59
    v_mul_f32 v59, v59, v58
    v_mul_f32 v60, v60, v58
    v_cvt_pk_bf16_f32 v38, v59, v60
    v_sub_f32 v59, v110, v56
    v_sub_f32 v60, v111, v56
    v_cvt_pk_bf16_f32 v59, v59, v60
    v_and_b32 v60, s34, v59
    v_lshlrev_b32 v59, 16, v59
    v_mul_f32 v59, v59, v58
    v_mul_f32 v60, v60, v58
    v_cvt_pk_bf16_f32 v39, v59, v60
    v_sub_f32 v59, v112, v56
    v_sub_f32 v60, v113, v56
    v_cvt_pk_bf16_f32 v59, v59, v60
    v_and_b32 v60, s34, v59
    v_lshlrev_b32 v59, 16, v59
    v_mul_f32 v59, v59, v58
    v_mul_f32 v60, v60, v58
    v_cvt_pk_bf16_f32 v40, v59, v60
    v_sub_f32 v59, v114, v56
    v_sub_f32 v60, v115, v56
    v_cvt_pk_bf16_f32 v59, v59, v60
    v_and_b32 v60, s34, v59
    v_lshlrev_b32 v59, 16, v59
    v_mul_f32 v59, v59, v58
    v_mul_f32 v60, v60, v58
    v_cvt_pk_bf16_f32 v41, v59, v60
    v_sub_f32 v59, v116, v56
    v_sub_f32 v60, v117, v56
    v_cvt_pk_bf16_f32 v59, v59, v60
    v_and_b32 v60, s34, v59
    v_lshlrev_b32 v59, 16, v59
    v_mul_f32 v59, v59, v58
    v_mul_f32 v60, v60, v58
    v_cvt_pk_bf16_f32 v42, v59, v60
    v_sub_f32 v59, v118, v56
    v_sub_f32 v60, v119, v56
    v_cvt_pk_bf16_f32 v59, v59, v60
    v_and_b32 v60, s34, v59
    v_lshlrev_b32 v59, 16, v59
    v_mul_f32 v59, v59, v58
    v_mul_f32 v60, v60, v58
    v_cvt_pk_bf16_f32 v43, v59, v60
    v_sub_f32 v59, v120, v56
    v_sub_f32 v60, v121, v56
    v_cvt_pk_bf16_f32 v59, v59, v60
    v_and_b32 v60, s34, v59
    v_lshlrev_b32 v59, 16, v59
    v_mul_f32 v59, v59, v58
    v_mul_f32 v60, v60, v58
    v_cvt_pk_bf16_f32 v44, v59, v60
    v_sub_f32 v59, v122, v56
    v_sub_f32 v60, v123, v56
    v_cvt_pk_bf16_f32 v59, v59, v60
    v_and_b32 v60, s34, v59
    v_lshlrev_b32 v59, 16, v59
    v_mul_f32 v59, v59, v58
    v_mul_f32 v60, v60, v58
    v_cvt_pk_bf16_f32 v45, v59, v60
    v_sub_f32 v59, v124, v56
    v_sub_f32 v60, v125, v56
    v_cvt_pk_bf16_f32 v59, v59, v60
    v_and_b32 v60, s34, v59
    v_lshlrev_b32 v59, 16, v59
    v_mul_f32 v59, v59, v58
    v_mul_f32 v60, v60, v58
    v_cvt_pk_bf16_f32 v46, v59, v60
    v_sub_f32 v59, v126, v56
    v_sub_f32 v60, v127, v56
    v_cvt_pk_bf16_f32 v59, v59, v60
    v_and_b32 v60, s34, v59
    v_lshlrev_b32 v59, 16, v59
    v_mul_f32 v59, v59, v58
    v_mul_f32 v60, v60, v58
    v_cvt_pk_bf16_f32 v47, v59, v60
    v_sub_f32 v59, v128, v56
    v_sub_f32 v60, v129, v56
    v_cvt_pk_bf16_f32 v59, v59, v60
    v_and_b32 v60, s34, v59
    v_lshlrev_b32 v59, 16, v59
    v_mul_f32 v59, v59, v58
    v_mul_f32 v60, v60, v58
    v_cvt_pk_bf16_f32 v48, v59, v60
    v_sub_f32 v59, v130, v56
    v_sub_f32 v60, v131, v56
    v_cvt_pk_bf16_f32 v59, v59, v60
    v_and_b32 v60, s34, v59
    v_lshlrev_b32 v59, 16, v59
    v_mul_f32 v59, v59, v58
    v_mul_f32 v60, v60, v58
    v_cvt_pk_bf16_f32 v49, v59, v60
    v_sub_f32 v59, v132, v56
    v_sub_f32 v60, v133, v56
    v_cvt_pk_bf16_f32 v59, v59, v60
    v_and_b32 v60, s34, v59
    v_lshlrev_b32 v59, 16, v59
    v_mul_f32 v59, v59, v58
    v_mul_f32 v60, v60, v58
    v_cvt_pk_bf16_f32 v50, v59, v60
    v_sub_f32 v59, v134, v56
    v_sub_f32 v60, v135, v56
    v_cvt_pk_bf16_f32 v59, v59, v60
    v_and_b32 v60, s34, v59
    v_lshlrev_b32 v59, 16, v59
    v_mul_f32 v59, v59, v58
    v_mul_f32 v60, v60, v58
    v_cvt_pk_bf16_f32 v51, v59, v60
    v_sub_f32 v59, v136, v56
    v_sub_f32 v60, v137, v56
    v_cvt_pk_bf16_f32 v59, v59, v60
    v_and_b32 v60, s34, v59
    v_lshlrev_b32 v59, 16, v59
    v_mul_f32 v59, v59, v58
    v_mul_f32 v60, v60, v58
    v_cvt_pk_bf16_f32 v52, v59, v60
    v_sub_f32 v59, v138, v56
    v_sub_f32 v60, v139, v56
    v_cvt_pk_bf16_f32 v59, v59, v60
    v_and_b32 v60, s34, v59
    v_lshlrev_b32 v59, 16, v59
    v_mul_f32 v59, v59, v58
    v_mul_f32 v60, v60, v58
    v_cvt_pk_bf16_f32 v53, v59, v60
    v_sub_f32 v59, v140, v56
    v_sub_f32 v60, v141, v56
    v_cvt_pk_bf16_f32 v59, v59, v60
    v_and_b32 v60, s34, v59
    v_lshlrev_b32 v59, 16, v59
    v_mul_f32 v59, v59, v58
    v_mul_f32 v60, v60, v58
    v_cvt_pk_bf16_f32 v54, v59, v60
    v_sub_f32 v59, v142, v56
    v_sub_f32 v60, v143, v56
    v_cvt_pk_bf16_f32 v59, v59, v60
    v_and_b32 v60, s34, v59
    v_lshlrev_b32 v59, 16, v59
    v_mul_f32 v59, v59, v58
    v_mul_f32 v60, v60, v58
    v_cvt_pk_bf16_f32 v55, v59, v60
    buffer_store_dwordx4 v[16:19], v13, s[8:11], s33 offen sc1
    s_add_u32 s33, s33, 4096
    buffer_store_dwordx4 v[20:23], v13, s[8:11], s33 offen sc1
    s_add_u32 s33, s33, 4096
    buffer_store_dwordx4 v[24:27], v13, s[8:11], s33 offen sc1
    s_add_u32 s33, s33, 4096
    buffer_store_dwordx4 v[28:31], v13, s[8:11], s33 offen sc1
    s_add_u32 s33, s33, 4096
    buffer_store_dwordx4 v[32:35], v13, s[8:11], s33 offen sc1
    s_add_u32 s33, s33, 4096
    buffer_store_dwordx4 v[36:39], v13, s[8:11], s33 offen sc1
    s_add_u32 s33, s33, 4096
    buffer_store_dwordx4 v[40:43], v13, s[8:11], s33 offen sc1
    s_add_u32 s33, s33, 4096
    buffer_store_dwordx4 v[44:47], v13, s[8:11], s33 offen sc1
    s_add_u32 s33, s33, 4096
    buffer_store_dwordx4 v[48:51], v13, s[8:11], s33 offen sc1
    s_add_u32 s33, s33, 4096
    buffer_store_dwordx4 v[52:55], v13, s[8:11], s33 offen sc1
    s_add_u32 s33, s33, 4096
    s_add_u32 s48, s48, 56
    s_cmp_ge_u32 s48, 64
    s_cbranch_scc1 prep_m0
    s_nop 1
    v_mov_b32 v16, v144
    v_mov_b32 v17, v145
    v_mov_b32 v18, v146
    v_mov_b32 v19, v147
    v_mov_b32 v20, v148
    v_mov_b32 v21, v149
    v_mov_b32 v22, v150
    v_mov_b32 v23, v151
    v_mov_b32 v24, v152
    v_mov_b32 v25, v153
    v_mov_b32 v26, v154
    v_mov_b32 v27, v155
    v_mov_b32 v28, v156
    v_mov_b32 v29, v157
    v_mov_b32 v30, v158
    v_mov_b32 v31, v159
    v_mov_b32 v32, v160
    v_mov_b32 v33, v161
    v_mov_b32 v34, v162
    v_mov_b32 v35, v163
    v_mov_b32 v36, v164
    v_mov_b32 v37, v165
    v_mov_b32 v38, v166
    v_mov_b32 v39, v167
    v_mov_b32 v40, v168
    v_mov_b32 v41, v169
    v_mov_b32 v42, v170
    v_mov_b32 v43, v171
    v_mov_b32 v44, v172
    v_mov_b32 v45, v173
    v_mov_b32 v46, v174
    v_mov_b32 v47, v175
    v_mov_b32 v48, v176
    v_mov_b32 v49, v177
    v_mov_b32 v50, v178
    v_mov_b32 v51, v179
    v_mov_b32 v52, v180
    v_mov_b32 v53, v181
    v_mov_b32 v54, v182
    v_mov_b32 v55, v183
    s_nop 1
    s_branch prep_ln
prep_m0:
    s_cmp_lg_u32 s54, 15
    s_cbranch_scc1 prep_v
    v_add_u32 v8, 0, v0
    v_and_b32 v9, 7, v8
    v_mul_u32_u24 v9, 1280, v9
    v_lshrrev_b32 v10, 3, v8
    v_lshl_add_u32 v9, v10, 4, v9
    v_lshlrev_b32 v60, 4, v8
    v_add_u32 v2, 16384, v60
    v_subrev_u32 v60, 2048, v60
    v_cmp_gt_u32 vcc, 128, v8
    s_nop 1
    v_cndmask_b32 v60, v60, v2, vcc
    v_mov_b32 v3, 0x40000000
    v_cmp_gt_u32 vcc, 640, v8
    s_nop 1
    v_cndmask_b32 v9, v3, v9, vcc
    v_cndmask_b32 v60, v3, v60, vcc
    buffer_load_dwordx4 v[64:67], v9, s[12:15], 0 offen
    v_add_u32 v8, 256, v0
    v_and_b32 v9, 7, v8
    v_mul_u32_u24 v9, 1280, v9
    v_lshrrev_b32 v10, 3, v8
    v_lshl_add_u32 v9, v10, 4, v9
    v_lshlrev_b32 v61, 4, v8
    v_add_u32 v2, 16384, v61
    v_subrev_u32 v61, 2048, v61
    v_cmp_gt_u32 vcc, 128, v8
    s_nop 1
    v_cndmask_b32 v61, v61, v2, vcc
    v_mov_b32 v3, 0x40000000
    v_cmp_gt_u32 vcc, 640, v8
    s_nop 1
    v_cndmask_b32 v9, v3, v9, vcc
    v_cndmask_b32 v61, v3, v61, vcc
    buffer_load_dwordx4 v[68:71], v9, s[12:15], 0 offen
    v_add_u32 v8, 512, v0
    v_and_b32 v9, 7, v8
    v_mul_u32_u24 v9, 1280, v9
    v_lshrrev_b32 v10, 3, v8
    v_lshl_add_u32 v9, v10, 4, v9
    v_lshlrev_b32 v62, 4, v8
    v_add_u32 v2, 16384, v62
    v_subrev_u32 v62, 2048, v62
    v_cmp_gt_u32 vcc, 128, v8
    s_nop 1
    v_cndmask_b32 v62, v62, v2, vcc
    v_mov_b32 v3, 0x40000000
    v_cmp_gt_u32 vcc, 640, v8
    s_nop 1
    v_cndmask_b32 v9, v3, v9, vcc
    v_cndmask_b32 v62, v3, v62, vcc
    buffer_load_dwordx4 v[72:75], v9, s[12:15], 0 offen
    s_mov_b32 s32, 0xa200000
    s_mov_b32 s33, 0xa202000
    s_waitcnt vmcnt(0)
    buffer_store_dwordx4 v[64:67], v60, s[8:11], s32 offen sc1
    buffer_store_dwordx4 v[64:67], v60, s[8:11], s33 offen sc1
    buffer_store_dwordx4 v[68:71], v61, s[8:11], s32 offen sc1
    buffer_store_dwordx4 v[68:71], v61, s[8:11], s33 offen sc1
    buffer_store_dwordx4 v[72:75], v62, s[8:11], s32 offen sc1
    buffer_store_dwordx4 v[72:75], v62, s[8:11], s33 offen sc1
    s_nop 1
prep_v:
    s_cmp_lt_u32 s55, s56
    s_cselect_b32 s35, 1, 0
    s_getreg_b32 s36, hwreg(HW_REG_XCC_ID)
    s_bfe_u32 s36, s36, 0x10002
    s_xor_b32 s35, s35, s36
    s_lshl_b32 s35, s35, s57
    s_cmp_ge_u32 s3, 152
    s_cmov_b32 s35, 0
    v_mov_b32 v9, s35
    v_cmp_eq_u32 vcc, 0, v1
    s_nop 1
    v_cndmask_b32 v9, 0, v9, vcc
    v_mov_b32 v2, 0
    ds_add_u32 v2, v9 offset:64
    s_waitcnt vmcnt(0) lgkmcnt(0)
    s_barrier
    s_mov_b32 s20, s88
    s_and_b32 s21, s89, 0xffff
    s_mov_b32 s22, 0x100
    s_mov_b32 s23, 0x20000
    ds_read_b32 v9, v2 offset:64
    v_mov_b32 v3, 0x40000000
    v_cmp_eq_u32 vcc, 0, v0
    s_nop 1
    v_cndmask_b32 v8, v3, v0, vcc
    s_waitcnt lgkmcnt(0)
    v_mov_b32 v10, v9
    buffer_atomic_add v10, v8, s[20:23], 0 offen offset:252 sc0
    s_waitcnt vmcnt(0)
    v_add_u32 v10, v10, v9
    v_and_b32 v9, 255, v10
    v_cmp_eq_u32 vcc, 56, v9
    s_nop 1
    v_cndmask_b32 v8, v3, v8, vcc
    buffer_store_dword v10, v8, s[20:23], 0 offen offset:60 sc1
    s_sub_u32 s6, s3, 64
    s_cmp_lt_u32 s3, 84
    s_cbranch_scc1 B_start
    s_sub_u32 s50, s3, 84
    s_lshl_b32 s50, s50, 1
    s_mov_b32 s48, 1
    s_cmp_lt_u32 s3, 104
    s_cbranch_scc1 T_start
    s_sub_u32 s32, s3, 152
    s_lshr_b32 s50, s32, 1
    s_mul_i32 s50, s50, 5
    s_and_b32 s48, s32, 1
    s_lshl_b32 s48, s48, 1
    s_branch T2_start
B_start:
    s_mov_b32 s28, s88
    s_and_b32 s29, s89, 0xffff
    s_mov_b32 s30, 0x100
    s_mov_b32 s31, 0x20000
    v_mov_b32 v2, 0
    buffer_load_dword v3, v2, s[28:31], 0 offen offset:60 sc1
    s_mov_b32 s52, 1048576
    s_branch prepw_ck_3
prepw_1:
    buffer_load_dword v3, v2, s[28:31], 0 offen offset:60 sc1
prepw_ck_3:
    s_waitcnt vmcnt(0)
    v_readfirstlane_b32 s32, v3
    s_nop 1
    s_and_b32 s33, s32, 255
    s_cmp_ge_u32 s33, 56
    s_cbranch_scc1 prepw_ok_2
    s_cmp_eq_u32 s52, 0
    s_cbranch_scc1 prepw_ok_2
    s_sub_u32 s52, s52, 1
    s_sleep 4
    s_branch prepw_1
prepw_ok_2:
    s_bfe_u32 s33, s32, 0x80008
    s_bfe_u32 s34, s32, 0x80018
    s_add_u32 s33, s33, s34
    s_bfe_u32 s34, s32, 0x80010
    s_sub_u32 s33, s33, s34
    s_cmp_ge_i32 s33, 28
    s_cselect_b32 s96, 0, 8192
    s_mov_b32 s98, s96
    s_xor_b32 s97, s96, 8192
    s_add_u32 s99, s96, 0xa20d000
    v_lshlrev_b32 v6, 4, v1
    v_lshrrev_b32 v2, 4, v1
    v_and_b32 v3, 7, v1
    v_bfe_u32 v4, v1, 3, 1
    s_lshl_b32 s32, s4, 14
    v_mul_u32_u24 v5, 640, v4
    v_lshl_add_u32 v5, v2, 7, v5
    v_lshl_add_u32 v5, v3, 4, v5
    v_add_u32 v7, s32, v5
    v_lshl_add_u32 v5, v4, 2, v2
    v_mul_u32_u24 v5, 640, v5
    v_lshl_add_u32 v5, v3, 4, v5
    v_add_u32 v5, 512, v5
    v_add_u32 v8, s32, v5
    s_lshl_b32 s32, s4, 11
    v_add_u32 v9, s32, v6
    s_lshl_b32 s32, s4, 13
    v_add_u32 v10, s32, v6
    s_lshl_b32 s32, s4, 7
    v_lshl_add_u32 v11, v3, 4, s32
    v_lshlrev_b32 v12, 4, v0
    s_lshl_b32 s32, s6, 7
    s_add_u32 s32, s32, 63488
    v_mov_b32 v16, s32
    v_lshlrev_b32 v5, 6, v2
    v_lshl_add_u32 v5, v3, 4, v5
    v_lshl_add_u32 v5, v4, 8, v5
    v_and_b32 v4, 16, v1
    v_mov_b32 v76, 0x40000000
    v_cmp_eq_u32 vcc, 0, v4
    s_nop 1
    v_cndmask_b32 v13, v76, v5, vcc
    v_mov_b32 v20, -1
    v_mov_b32 v21, -1
    v_mov_b32 v22, -1
    v_mov_b32 v23, -1
    v_mov_b32 v14, -1
    v_mov_b32 v15, 0
    v_mov_b32 v18, -1
    s_lshl_b32 s50, s6, 9
    s_sub_u32 s32, s50, 2048
    s_add_u32 s50, s50, 16384
    s_cmp_ge_u32 s6, 4
    s_cmov_b32 s50, s32
    s_add_u32 s50, s50, s96
    s_add_u32 s50, s50, 0xa208000
    v_min_u32 v17, 3, v1
    v_lshlrev_b32 v17, 7, v17
    s_mov_b32 s48, 0
    s_mov_b32 s52, 4194304
    ds_write_b32 v15, v15 offset:8192
    s_waitcnt lgkmcnt(0)
    s_barrier
    s_mul_i32 s32, s48, 2048
    s_add_u32 s32, s32, 0xa800400
bu_poll_4:
    buffer_load_dword v2, v11, s[8:11], s32 offen sc1
    s_waitcnt vmcnt(0)
    v_cmp_gt_i32 vcc, s48, v2
    s_cbranch_vccz bu_ok_5
    s_cmp_eq_u32 s52, 0
    s_cbranch_scc1 bu_ok_5
    s_sub_u32 s52, s52, 1
    s_sleep 1
    s_branch bu_poll_4
bu_ok_5:
    s_mul_i32 s64, s48, 1802240
    s_mul_i32 s65, s6, 90112
    s_add_u32 s64, s64, s65
    s_add_u32 s64, s64, 0x3400000
    s_add_u32 s65, s64, 4096
    s_add_u32 s66, s64, 45056
    s_add_u32 s67, s64, 49152
    buffer_load_dwordx4 v[100:103], v10, s[8:11], s64 offen offset:0 sc1
    buffer_load_dwordx4 v[104:107], v10, s[8:11], s66 offen offset:0 sc1
    buffer_load_dwordx4 v[108:111], v10, s[8:11], s64 offen offset:1024 sc1
    buffer_load_dwordx4 v[112:115], v10, s[8:11], s66 offen offset:1024 sc1
    buffer_load_dwordx4 v[116:119], v10, s[8:11], s64 offen offset:2048 sc1
    buffer_load_dwordx4 v[120:123], v10, s[8:11], s66 offen offset:2048 sc1
    buffer_load_dwordx4 v[124:127], v10, s[8:11], s64 offen offset:3072 sc1
    buffer_load_dwordx4 v[128:131], v10, s[8:11], s66 offen offset:3072 sc1
    buffer_load_dwordx4 v[132:135], v10, s[8:11], s65 offen offset:0 sc1
    buffer_load_dwordx4 v[136:139], v10, s[8:11], s67 offen offset:0 sc1
    buffer_load_dwordx4 v[140:143], v10, s[8:11], s65 offen offset:1024 sc1
    buffer_load_dwordx4 v[144:147], v10, s[8:11], s67 offen offset:1024 sc1
    buffer_load_dwordx4 v[148:151], v10, s[8:11], s65 offen offset:2048 sc1
    buffer_load_dwordx4 v[152:155], v10, s[8:11], s67 offen offset:2048 sc1
    buffer_load_dwordx4 v[156:159], v10, s[8:11], s65 offen offset:3072 sc1
    buffer_load_dwordx4 v[160:163], v10, s[8:11], s67 offen offset:3072 sc1
    v_min_u32 v4, 31, v1
    v_lshlrev_b32 v4, 7, v4
    s_add_u32 s40, s99, 30720
    buffer_load_dword v5, v4, s[8:11], s40 offen sc1
B_loop:
    s_cmp_lt_u32 s48, 32
    s_cselect_b32 s54, s97, s98
    s_lshl_b32 s47, s48, 16
    s_add_u32 s54, s54, s47
    s_add_u32 s54, s54, 0xa400000
    s_mul_hi_u32 s47, s48, 0x55555556
    s_mul_i32 s55, s48, 655360
    s_mul_i32 s46, s47, 131072
    s_add_u32 s55, s55, s46
    s_andn2_b32 s47, 1, s47
    s_lshl_b32 s47, s47, 13
    s_xor_b32 s47, s47, s96
    s_add_u32 s55, s55, s47
    s_add_u32 s55, s55, 0xb000000
    s_lshl_b32 s36, s6, 15
    s_add_u32 s55, s55, s36
    s_add_u32 s56, s55, 16384
    s_lshl_b32 s57, s48, 15
    s_add_u32 s57, s57, s50
    s_add_u32 s63, s48, 1
    s_mov_b32 s51, 0
    s_andn2_b32 s47, 1, s63
    s_lshl_b32 s47, s47, 9
    s_add_u32 s47, s47, s99
    buffer_load_dword v14, v17, s[8:11], s47 offen offset:0 sc1
    s_waitcnt vmcnt(0)
    s_cmp_lg_u32 s48, 0
    s_cbranch_scc1 B0_nr
    v_min_u32 v4, 31, v1
    v_lshlrev_b32 v4, 7, v4
    s_add_u32 s40, s99, 30720
    s_mov_b32 s41, 0
    v_cmp_gt_i32 vcc, 0, v5
    s_cbranch_vccz B0_ok
    s_nop 3
B0_poll_6:
    buffer_load_dword v2, v4, s[8:11], s40 offen sc1
    s_waitcnt vmcnt(0)
    v_cmp_gt_i32 vcc, s41, v2
    s_cbranch_vccz B0_ok_7
    s_cmp_eq_u32 s52, 0
    s_cbranch_scc1 B0_ok_7
    s_sub_u32 s52, s52, 1
    s_sleep 1
    s_branch B0_poll_6
B0_ok_7:
B0_ok:
    s_memrealtime s[44:45]
    s_waitcnt lgkmcnt(0)
    s_lshl_b32 s44, s44, 7
    s_mov_b32 s62, s44
    s_branch B_y1
B0_nr:
    s_andn2_b32 s47, 1, s63
    s_lshl_b32 s47, s47, 9
    s_add_u32 s47, s47, s99
    s_branch door_ck_10
door_ag_11:
    s_cmp_eq_u32 s52, 0
    s_cbranch_scc1 door_lt_12
    s_sub_u32 s52, s52, 1
    buffer_load_dword v14, v17, s[8:11], s47 offen offset:0 sc1
    s_sleep 4
door_ck_10:
    s_memrealtime s[44:45]
    v_readlane_b32 s62, v14, 0
    v_readlane_b32 s41, v14, 1
    v_readlane_b32 s42, v14, 2
    v_readlane_b32 s43, v14, 3
    s_sub_u32 s40, s41, s62
    s_and_b32 s40, s40, 0x8000007f
    s_cmp_eq_u32 s40, 0
    s_cmov_b32 s62, s41
    s_sub_u32 s40, s42, s62
    s_and_b32 s40, s40, 0x8000007f
    s_cmp_eq_u32 s40, 0
    s_cmov_b32 s62, s42
    s_sub_u32 s40, s43, s62
    s_and_b32 s40, s40, 0x8000007f
    s_cmp_eq_u32 s40, 0
    s_cmov_b32 s62, s43
    s_add_u32 s46, s62, 1
    s_and_b32 s46, s46, 127
    s_add_u32 s62, s62, 0xfffff880
    s_waitcnt lgkmcnt(0)
    s_lshl_b32 s44, s44, 7
    s_cmp_lt_u32 s46, s63
    s_cbranch_scc1 door_ag_11
    s_cmp_gt_u32 s46, s63
    s_cbranch_scc1 door_lt_12
    s_sub_u32 s45, s44, s62
    s_cmp_lt_i32 s45, 0xfffff200
    s_cbranch_scc1 door_ag_11
    s_cmp_ge_i32 s45, 0
    s_cbranch_scc1 door_ok_9
door_md_13:
    s_cmp_ge_i32 s45, 0xfffffb00
    s_cbranch_scc1 door_8
    s_sleep 1
    s_memrealtime s[44:45]
    s_waitcnt lgkmcnt(0)
    s_lshl_b32 s44, s44, 7
    s_sub_u32 s45, s44, s62
    s_branch door_md_13
door_8:
    s_memrealtime s[44:45]
    s_waitcnt lgkmcnt(0)
    s_lshl_b32 s44, s44, 7
    s_sub_u32 s45, s44, s62
    s_cmp_lt_i32 s45, 0
    s_cbranch_scc1 door_8
    s_branch door_ok_9
door_lt_12:
    s_mov_b32 s62, s44
door_ok_9:
    buffer_load_dwordx4 v[44:47], v9, s[8:11], s55 offen offset:0 sc1
    buffer_load_dwordx4 v[48:51], v9, s[8:11], s56 offen offset:0 sc1
    buffer_load_dwordx4 v[52:55], v9, s[8:11], s55 offen offset:1024 sc1
    buffer_load_dwordx4 v[56:59], v9, s[8:11], s56 offen offset:1024 sc1
    s_mov_b32 s59, s62
    s_andn2_b32 s47, 1, s63
    s_lshl_b32 s47, s47, 9
    s_add_u32 s47, s47, s99
    s_branch door_ck_16
door_ag_17:
    s_cmp_eq_u32 s52, 0
    s_cbranch_scc1 door_lt_18
    s_sub_u32 s52, s52, 1
    buffer_load_dword v14, v17, s[8:11], s47 offen offset:0 sc1
    s_sleep 4
door_ck_16:
    s_memrealtime s[44:45]
    v_readlane_b32 s62, v14, 0
    v_readlane_b32 s41, v14, 1
    v_readlane_b32 s42, v14, 2
    v_readlane_b32 s43, v14, 3
    s_sub_u32 s40, s41, s62
    s_and_b32 s40, s40, 0x8000007f
    s_cmp_eq_u32 s40, 0
    s_cmov_b32 s62, s41
    s_sub_u32 s40, s42, s62
    s_and_b32 s40, s40, 0x8000007f
    s_cmp_eq_u32 s40, 0
    s_cmov_b32 s62, s42
    s_sub_u32 s40, s43, s62
    s_and_b32 s40, s40, 0x8000007f
    s_cmp_eq_u32 s40, 0
    s_cmov_b32 s62, s43
    s_add_u32 s46, s62, 1
    s_and_b32 s46, s46, 127
    s_add_u32 s62, s62, 0x0
    s_waitcnt lgkmcnt(0)
    s_lshl_b32 s44, s44, 7
    s_cmp_lt_u32 s46, s63
    s_cbranch_scc1 door_ag_17
    s_cmp_gt_u32 s46, s63
    s_cbranch_scc1 door_lt_18
    s_sub_u32 s45, s44, s62
    s_cmp_lt_i32 s45, 0xfffff200
    s_cbranch_scc1 door_ag_17
    s_cmp_ge_i32 s45, 0
    s_cbranch_scc1 door_ok_15
door_md_19:
    s_cmp_ge_i32 s45, 0xfffffb00
    s_cbranch_scc1 door_14
    s_sleep 1
    s_memrealtime s[44:45]
    s_waitcnt lgkmcnt(0)
    s_lshl_b32 s44, s44, 7
    s_sub_u32 s45, s44, s62
    s_branch door_md_19
door_14:
    s_memrealtime s[44:45]
    s_waitcnt lgkmcnt(0)
    s_lshl_b32 s44, s44, 7
    s_sub_u32 s45, s44, s62
    s_cmp_lt_i32 s45, 0
    s_cbranch_scc1 door_14
    s_branch door_ok_15
door_lt_18:
    s_mov_b32 s62, s44
door_ok_15:
    s_sub_u32 s32, s62, s59
    s_cmp_le_u32 s32, 1920
    s_cbranch_scc1 B_y2
B_y1:
    ds_write_b32 v15, v16 offset:8192
    buffer_load_dwordx4 v[44:47], v9, s[8:11], s55 offen offset:0 sc1
    buffer_load_dwordx4 v[48:51], v9, s[8:11], s56 offen offset:0 sc1
    buffer_load_dwordx4 v[52:55], v9, s[8:11], s55 offen offset:1024 sc1
    buffer_load_dwordx4 v[56:59], v9, s[8:11], s56 offen offset:1024 sc1
B_y2:
B_pl:
    buffer_load_dwordx4 v[24:27], v7, s[8:11], s54 offen offset:0 sc1
    s_nop 9
    buffer_load_dwordx4 v[28:31], v7, s[8:11], s54 offen offset:1280 sc1
    s_nop 9
    buffer_load_dwordx4 v[32:35], v7, s[8:11], s54 offen offset:2560 sc1
    s_nop 9
    buffer_load_dwordx4 v[36:39], v7, s[8:11], s54 offen offset:3840 sc1
    s_nop 9
    buffer_load_dwordx4 v[40:43], v8, s[8:11], s54 offen sc1
    s_waitcnt vmcnt(5)
    v_max3_u32 v2, v44, v45, v46
    v_max3_u32 v2, v2, v47, v48
    v_max3_u32 v2, v2, v49, v50
    v_max3_u32 v2, v2, v51, v52
    v_max3_u32 v2, v2, v53, v54
    v_max3_u32 v2, v2, v55, v56
    v_max3_u32 v2, v2, v57, v58
    v_max_u32 v2, v2, v59
    s_waitcnt vmcnt(4)
    v_mfma_f32_16x16x32_bf16 v[60:63], v[100:103], v[24:27], 0
    v_max3_u32 v2, v2, v24, v25
    v_mfma_f32_16x16x32_bf16 v[64:67], v[108:111], v[24:27], 0
    v_max3_u32 v2, v2, v26, v27
    v_mfma_f32_16x16x32_bf16 v[68:71], v[104:107], v[24:27], 0
    v_mfma_f32_16x16x32_bf16 v[72:75], v[112:115], v[24:27], 0
    s_waitcnt vmcnt(3)
    v_mfma_f32_16x16x32_bf16 v[60:63], v[116:119], v[28:31], v[60:63]
    v_max3_u32 v2, v2, v28, v29
    v_mfma_f32_16x16x32_bf16 v[64:67], v[124:127], v[28:31], v[64:67]
    v_max3_u32 v2, v2, v30, v31
    v_mfma_f32_16x16x32_bf16 v[68:71], v[120:123], v[28:31], v[68:71]
    v_mfma_f32_16x16x32_bf16 v[72:75], v[128:131], v[28:31], v[72:75]
    s_waitcnt vmcnt(2)
    v_mfma_f32_16x16x32_bf16 v[60:63], v[132:135], v[32:35], v[60:63]
    v_max3_u32 v2, v2, v32, v33
    v_mfma_f32_16x16x32_bf16 v[64:67], v[140:143], v[32:35], v[64:67]
    v_max3_u32 v2, v2, v34, v35
    v_mfma_f32_16x16x32_bf16 v[68:71], v[136:139], v[32:35], v[68:71]
    v_mfma_f32_16x16x32_bf16 v[72:75], v[144:147], v[32:35], v[72:75]
    s_waitcnt vmcnt(1)
    v_mfma_f32_16x16x32_bf16 v[60:63], v[148:151], v[36:39], v[60:63]
    v_max3_u32 v2, v2, v36, v37
    v_mfma_f32_16x16x32_bf16 v[64:67], v[156:159], v[36:39], v[64:67]
    v_max3_u32 v2, v2, v38, v39
    v_mfma_f32_16x16x32_bf16 v[68:71], v[152:155], v[36:39], v[68:71]
    v_mfma_f32_16x16x32_bf16 v[72:75], v[160:163], v[36:39], v[72:75]
    s_waitcnt vmcnt(0)
    v_mfma_f32_16x16x32_bf16 v[60:63], v[44:47], v[40:43], v[60:63]
    v_max3_u32 v2, v2, v40, v41
    v_mfma_f32_16x16x32_bf16 v[64:67], v[52:55], v[40:43], v[64:67]
    v_max3_u32 v2, v2, v42, v43
    v_mfma_f32_16x16x32_bf16 v[68:71], v[48:51], v[40:43], v[68:71]
    v_mfma_f32_16x16x32_bf16 v[72:75], v[56:59], v[40:43], v[72:75]
    v_cmp_eq_u32 vcc, -1, v2
    s_cbranch_vccnz B_prt
B_pok:
    s_nop 2
    v_add_f32_dpp v76, v64, v60 row_ror:8 row_mask:0xf bank_mask:0x3
    v_add_f32_dpp v77, v65, v61 row_ror:8 row_mask:0xf bank_mask:0x3
    v_add_f32_dpp v78, v66, v62 row_ror:8 row_mask:0xf bank_mask:0x3
    v_add_f32_dpp v79, v67, v63 row_ror:8 row_mask:0xf bank_mask:0x3
    v_add_f32_dpp v76, v68, v72 row_ror:8 row_mask:0xf bank_mask:0xc
    v_add_f32_dpp v77, v69, v73 row_ror:8 row_mask:0xf bank_mask:0xc
    v_add_f32_dpp v78, v70, v74 row_ror:8 row_mask:0xf bank_mask:0xc
    v_add_f32_dpp v79, v71, v75 row_ror:8 row_mask:0xf bank_mask:0xc
    ds_write_b128 v12, v[76:79]
    s_cmp_lg_u32 s4, 0
    s_waitcnt lgkmcnt(0)
    s_barrier
    s_cbranch_scc1 B_hold
    ds_read_b128 v[80:83], v12 offset:1024
    ds_read_b128 v[84:87], v12 offset:2048
    ds_read_b128 v[88:91], v12 offset:3072
    s_waitcnt lgkmcnt(2)
    v_pk_add_f32 v[76:77], v[76:77], v[80:81]
    v_pk_add_f32 v[78:79], v[78:79], v[82:83]
    s_waitcnt lgkmcnt(0)
    v_pk_add_f32 v[84:85], v[84:85], v[88:89]
    v_pk_add_f32 v[86:87], v[86:87], v[90:91]
    v_pk_add_f32 v[76:77], v[76:77], v[84:85]
    v_pk_add_f32 v[78:79], v[78:79], v[86:87]
    v_cvt_pk_bf16_f32 v80, v76, v77
    v_cvt_pk_bf16_f32 v81, v78, v79
    s_nop 0
    v_permlane16_swap_b32 v80, v82
    v_permlane16_swap_b32 v81, v83
    buffer_store_dwordx4 v[80:83], v13, s[8:11], s57 offen sc1
    s_memrealtime s[44:45]
    ds_read_b32 v3, v15 offset:8192
    ds_write_b32 v15, v15 offset:8192
    s_waitcnt lgkmcnt(0)
    v_readfirstlane_b32 s51, v3
    s_waitcnt lgkmcnt(0)
    s_lshl_b32 s44, s44, 7
    s_sub_u32 s44, s44, s62
    s_add_u32 s44, s44, 127
    s_lshr_b32 s44, s44, 7
    s_cmp_eq_u32 s51, 0
    s_cselect_b32 s45, s99, 0x40000000
    s_cmp_eq_u32 s48, 0
    s_cmov_b32 s45, s99
    s_cmov_b32 s44, 0
    v_mov_b32 v2, s44
    buffer_store_dword v2, v16, s[8:11], s45 offen sc1
    s_nop 0
B_nx:
    s_cmp_ge_u32 s48, 62
    s_cbranch_scc1 B_end
    s_add_u32 s34, s48, 1
    s_min_u32 s34, s34, 63
    v_cmp_gt_i32 vcc, s34, v18
    s_cbranch_vccz uf_20
    s_mul_i32 s32, s34, 2048
    s_add_u32 s32, s32, 0xa800400
    s_nop 1
bu_poll_21:
    buffer_load_dword v2, v11, s[8:11], s32 offen sc1
    s_waitcnt vmcnt(0)
    v_cmp_gt_i32 vcc, s34, v2
    s_cbranch_vccz bu_ok_22
    s_cmp_eq_u32 s52, 0
    s_cbranch_scc1 bu_ok_22
    s_sub_u32 s52, s52, 1
    s_sleep 1
    s_branch bu_poll_21
bu_ok_22:
uf_20:
    s_mul_i32 s64, s34, 1802240
    s_mul_i32 s65, s6, 90112
    s_add_u32 s64, s64, s65
    s_add_u32 s64, s64, 0x3400000
    s_add_u32 s65, s64, 4096
    s_add_u32 s66, s64, 45056
    s_add_u32 s67, s64, 49152
    s_cmp_ge_u32 s48, 63
    s_cmov_b32 s64, 0x40000000
    s_cmov_b32 s65, 0x40000000
    s_cmov_b32 s66, 0x40000000
    s_cmov_b32 s67, 0x40000000
    s_add_u32 s35, s48, 2
    s_min_u32 s35, s35, 63
    s_mul_i32 s32, s35, 2048
    s_add_u32 s32, s32, 0xa800400
    buffer_load_dword v18, v11, s[8:11], s32 offen sc1
    buffer_load_dwordx4 v[100:103], v10, s[8:11], s64 offen offset:0 sc1
    buffer_load_dwordx4 v[104:107], v10, s[8:11], s66 offen offset:0 sc1
    buffer_load_dwordx4 v[108:111], v10, s[8:11], s64 offen offset:1024 sc1
    buffer_load_dwordx4 v[112:115], v10, s[8:11], s66 offen offset:1024 sc1
    buffer_load_dwordx4 v[116:119], v10, s[8:11], s64 offen offset:2048 sc1
    buffer_load_dwordx4 v[120:123], v10, s[8:11], s66 offen offset:2048 sc1
    buffer_load_dwordx4 v[124:127], v10, s[8:11], s64 offen offset:3072 sc1
    buffer_load_dwordx4 v[128:131], v10, s[8:11], s66 offen offset:3072 sc1
    buffer_load_dwordx4 v[132:135], v10, s[8:11], s65 offen offset:0 sc1
    buffer_load_dwordx4 v[136:139], v10, s[8:11], s67 offen offset:0 sc1
    buffer_load_dwordx4 v[140:143], v10, s[8:11], s65 offen offset:1024 sc1
    buffer_load_dwordx4 v[144:147], v10, s[8:11], s67 offen offset:1024 sc1
    buffer_load_dwordx4 v[148:151], v10, s[8:11], s65 offen offset:2048 sc1
    buffer_load_dwordx4 v[152:155], v10, s[8:11], s67 offen offset:2048 sc1
    buffer_load_dwordx4 v[156:159], v10, s[8:11], s65 offen offset:3072 sc1
    buffer_load_dwordx4 v[160:163], v10, s[8:11], s67 offen offset:3072 sc1
    v_xor_b32 v12, 4096, v12
    s_add_u32 s48, s48, 1
    s_nop 0
    s_branch B_loop
B_hold:
    s_sleep 3
    s_branch B_nx
B_prt:
    s_nop 7
    s_cmp_eq_u32 s52, 0
    s_cbranch_scc1 B_pok
    s_sub_u32 s52, s52, 1
    ds_write_b32 v15, v16 offset:8192
    s_sleep 0
    buffer_load_dwordx4 v[44:47], v9, s[8:11], s55 offen offset:0 sc1
    buffer_load_dwordx4 v[48:51], v9, s[8:11], s56 offen offset:0 sc1
    buffer_load_dwordx4 v[52:55], v9, s[8:11], s55 offen offset:1024 sc1
    buffer_load_dwordx4 v[56:59], v9, s[8:11], s56 offen offset:1024 sc1
    s_branch B_pl
B_end:
    s_endpgm
T_start:
    s_mov_b32 s28, s88
    s_and_b32 s29, s89, 0xffff
    s_mov_b32 s30, 0x100
    s_mov_b32 s31, 0x20000
    v_mov_b32 v2, 0
    buffer_load_dword v3, v2, s[28:31], 0 offen offset:60 sc1
    s_mov_b32 s52, 1048576
    s_branch prepw_ck_25
prepw_23:
    buffer_load_dword v3, v2, s[28:31], 0 offen offset:60 sc1
prepw_ck_25:
    s_waitcnt vmcnt(0)
    v_readfirstlane_b32 s32, v3
    s_nop 1
    s_and_b32 s33, s32, 255
    s_cmp_ge_u32 s33, 56
    s_cbranch_scc1 prepw_ok_24
    s_cmp_eq_u32 s52, 0
    s_cbranch_scc1 prepw_ok_24
    s_sub_u32 s52, s52, 1
    s_sleep 4
    s_branch prepw_23
prepw_ok_24:
    s_barrier
    v_mov_b32 v2, 0x40000000
    v_cmp_eq_u32 vcc, 0, v0
    s_nop 1
    v_cndmask_b32 v2, v2, v0, vcc
    v_mov_b32 v3, 1
    buffer_atomic_add v3, v2, s[28:31], 0 offen offset:248
    s_bfe_u32 s33, s32, 0x80008
    s_bfe_u32 s34, s32, 0x80018
    s_add_u32 s33, s33, s34
    s_bfe_u32 s34, s32, 0x80010
    s_sub_u32 s33, s33, s34
    s_cmp_ge_i32 s33, 28
    s_cselect_b32 s96, 0, 8192
    s_mov_b32 s98, s96
    s_xor_b32 s97, s96, 8192
    s_add_u32 s99, s96, 0xa20d000
    s_nop 4
    s_mov_b32 s24, s64
    s_and_b32 s25, s65, 0xffff
    s_mov_b32 s26, 0x280000
    s_mov_b32 s27, 0x20000
    s_mov_b32 s28, s86
    s_and_b32 s29, s87, 0xffff
    s_mov_b32 s30, 0x280000
    s_mov_b32 s31, 0x20000
    v_lshlrev_b32 v6, 4, v1
    v_lshrrev_b32 v2, 4, v1
    s_lshl_b32 s32, s4, 11
    v_add_u32 v9, s32, v6
    s_lshl_b32 s32, s4, 13
    v_add_u32 v10, s32, v6
    s_mul_i32 s32, s4, 3072
    s_add_u32 s32, s32, 32768
    v_add_u32 v16, s32, v6
    s_lshl_b32 s32, s4, 3
    v_add_u32 v4, s32, v1
    s_mul_i32 s32, s4, 3
    s_add_u32 s32, s32, 24
    v_min_u32 v5, 10, v1
    v_add_u32 v5, s32, v5
    v_cmp_gt_u32 vcc, 8, v1
    s_nop 1
    v_cndmask_b32 v5, v5, v4, vcc
    v_lshlrev_b32 v11, 4, v5
    v_lshlrev_b32 v12, 4, v0
    s_lshl_b32 s32, s4, 12
    v_add_u32 v20, s32, v6
    v_and_b32 v3, 15, v1
    s_mul_i32 s32, s4, 20480
    v_add_u32 v17, s32, v6
    v_mul_u32_u24 v4, 2560, v2
    v_lshl_add_u32 v4, v3, 4, v4
    v_add_u32 v4, 2048, v4
    v_add_u32 v18, s32, v4
    v_mul_u32_u24 v4, 1280, v3
    v_lshl_add_u32 v4, v2, 3, v4
    s_and_b32 s32, s4, 1
    s_mul_i32 s32, s32, 20480
    s_lshr_b32 s33, s4, 1
    s_lshl_b32 s33, s33, 5
    s_add_u32 s32, s32, s33
    v_add_u32 v19, s32, v4
    s_cmp_lt_u32 s4, 4
    s_cselect_b32 s32, 0, 0x40000000
    v_add_u32 v21, s32, v19
    v_lshlrev_b32 v4, 2, v2
    v_sub_u32 v4, v3, v4
    v_mov_b32 v5, 0x3f80
    v_mov_b32 v41, 0x3f800000
    v_cmp_eq_u32 vcc, 0, v4
    s_nop 1
    v_cndmask_b32 v24, 0, v5, vcc
    v_cmp_eq_u32 vcc, 1, v4
    s_nop 1
    v_cndmask_b32 v24, v24, v41, vcc
    v_mov_b32 v30, v24
    v_cmp_eq_u32 vcc, 2, v4
    s_nop 1
    v_cndmask_b32 v25, 0, v5, vcc
    v_cmp_eq_u32 vcc, 3, v4
    s_nop 1
    v_cndmask_b32 v25, v25, v41, vcc
    v_mov_b32 v31, v25
    v_mov_b32 v26, 0
    v_mov_b32 v27, 0
    v_mov_b32 v28, 0
    v_mov_b32 v29, 0
    v_mov_b32 v14, -1
    v_min_u32 v15, 3, v1
    v_lshlrev_b32 v15, 7, v15
    s_mov_b32 s52, 4194304
    s_mov_b32 s58, 0xffff0000
    s_mov_b32 s51, s48
    s_cmp_ge_u32 s51, 64
    s_cbranch_scc1 T_nu_26
    s_mul_i32 s32, s51, 2048
    s_add_u32 s32, s32, 0xa800400
T_poll_27:
    buffer_load_dword v2, v11, s[8:11], s32 offen sc1
    s_waitcnt vmcnt(0)
    v_cmp_gt_i32 vcc, s51, v2
    s_cbranch_vccz T_ok_28
    s_cmp_eq_u32 s52, 0
    s_cbranch_scc1 T_ok_28
    s_sub_u32 s52, s52, 1
    s_sleep 1
    s_branch T_poll_27
T_ok_28:
    s_mul_i32 s64, s51, 1802240
    s_mul_i32 s32, s50, 45056
    s_add_u32 s64, s64, s32
    s_add_u32 s64, s64, 0x3400000
    s_cmp_le_u32 s51, 2
    s_cbranch_scc1 T_w_29
    s_sub_u32 s63, s51, 2
    s_andn2_b32 s47, 1, s63
    s_lshl_b32 s47, s47, 9
    s_add_u32 s47, s47, s99
    s_branch door_ck_32
door_ag_33:
    s_cmp_eq_u32 s52, 0
    s_cbranch_scc1 door_lt_34
    s_sub_u32 s52, s52, 1
    buffer_load_dword v14, v15, s[8:11], s47 offen offset:4 sc1
    s_sleep 4
door_ck_32:
    s_memrealtime s[44:45]
    v_readlane_b32 s62, v14, 0
    v_readlane_b32 s41, v14, 1
    v_readlane_b32 s42, v14, 2
    v_readlane_b32 s43, v14, 3
    s_sub_u32 s40, s41, s62
    s_and_b32 s40, s40, 0x8000007f
    s_cmp_eq_u32 s40, 0
    s_cmov_b32 s62, s41
    s_sub_u32 s40, s42, s62
    s_and_b32 s40, s40, 0x8000007f
    s_cmp_eq_u32 s40, 0
    s_cmov_b32 s62, s42
    s_sub_u32 s40, s43, s62
    s_and_b32 s40, s40, 0x8000007f
    s_cmp_eq_u32 s40, 0
    s_cmov_b32 s62, s43
    s_add_u32 s46, s62, 1
    s_and_b32 s46, s46, 127
    s_add_u32 s62, s62, 0x1400
    s_waitcnt lgkmcnt(0)
    s_lshl_b32 s44, s44, 7
    s_cmp_lt_u32 s46, s63
    s_cbranch_scc1 door_ag_33
    s_cmp_gt_u32 s46, s63
    s_cbranch_scc1 door_lt_34
    s_sub_u32 s45, s44, s62
    s_cmp_lt_i32 s45, 0xfffff100
    s_cbranch_scc1 door_ag_33
    s_cmp_ge_i32 s45, 0
    s_cbranch_scc1 door_ok_31
door_md_35:
    s_cmp_ge_i32 s45, 0xfffffb00
    s_cbranch_scc1 door_30
    s_sleep 1
    s_memrealtime s[44:45]
    s_waitcnt lgkmcnt(0)
    s_lshl_b32 s44, s44, 7
    s_sub_u32 s45, s44, s62
    s_branch door_md_35
door_30:
    s_memrealtime s[44:45]
    s_waitcnt lgkmcnt(0)
    s_lshl_b32 s44, s44, 7
    s_sub_u32 s45, s44, s62
    s_cmp_lt_i32 s45, 0
    s_cbranch_scc1 door_30
    s_branch door_ok_31
door_lt_34:
    s_mov_b32 s62, s44
door_ok_31:
T_w_29:
    s_add_u32 s65, s64, 4096
    buffer_load_dwordx4 a[0:3], v10, s[8:11], s64 offen offset:0 sc1
    buffer_load_dwordx4 a[4:7], v10, s[8:11], s64 offen offset:1024 sc1
    buffer_load_dwordx4 a[8:11], v10, s[8:11], s64 offen offset:2048 sc1
    buffer_load_dwordx4 a[12:15], v10, s[8:11], s64 offen offset:3072 sc1
    buffer_load_dwordx4 a[16:19], v10, s[8:11], s65 offen offset:0 sc1
    buffer_load_dwordx4 a[20:23], v10, s[8:11], s65 offen offset:1024 sc1
    buffer_load_dwordx4 a[24:27], v10, s[8:11], s65 offen offset:2048 sc1
    buffer_load_dwordx4 a[28:31], v10, s[8:11], s65 offen offset:3072 sc1
    buffer_load_dwordx4 a[32:35], v16, s[8:11], s64 offen offset:0 sc1
    buffer_load_dwordx4 a[36:39], v16, s[8:11], s64 offen offset:1024 sc1
    buffer_load_dwordx4 a[40:43], v16, s[8:11], s64 offen offset:2048 sc1
    s_add_u32 s64, s64, 45056
    s_add_u32 s65, s64, 4096
    buffer_load_dwordx4 a[44:47], v10, s[8:11], s64 offen offset:0 sc1
    buffer_load_dwordx4 a[48:51], v10, s[8:11], s64 offen offset:1024 sc1
    buffer_load_dwordx4 a[52:55], v10, s[8:11], s64 offen offset:2048 sc1
    buffer_load_dwordx4 a[56:59], v10, s[8:11], s64 offen offset:3072 sc1
    buffer_load_dwordx4 a[60:63], v10, s[8:11], s65 offen offset:0 sc1
    buffer_load_dwordx4 a[64:67], v10, s[8:11], s65 offen offset:1024 sc1
    buffer_load_dwordx4 a[68:71], v10, s[8:11], s65 offen offset:2048 sc1
    buffer_load_dwordx4 a[72:75], v10, s[8:11], s65 offen offset:3072 sc1
    buffer_load_dwordx4 a[76:79], v16, s[8:11], s64 offen offset:0 sc1
    buffer_load_dwordx4 a[80:83], v16, s[8:11], s64 offen offset:1024 sc1
    buffer_load_dwordx4 a[84:87], v16, s[8:11], s64 offen offset:2048 sc1
T_nu_26:
    s_add_u32 s51, s51, 2
T_loop:
    s_cmp_ge_u32 s51, 64
    s_cbranch_scc1 T_nu_36
    s_mul_i32 s32, s51, 2048
    s_add_u32 s32, s32, 0xa800400
T_poll_37:
    buffer_load_dword v2, v11, s[8:11], s32 offen sc1
    s_waitcnt vmcnt(0)
    v_cmp_gt_i32 vcc, s51, v2
    s_cbranch_vccz T_ok_38
    s_cmp_eq_u32 s52, 0
    s_cbranch_scc1 T_ok_38
    s_sub_u32 s52, s52, 1
    s_sleep 1
    s_branch T_poll_37
T_ok_38:
    s_mul_i32 s64, s51, 1802240
    s_mul_i32 s32, s50, 45056
    s_add_u32 s64, s64, s32
    s_add_u32 s64, s64, 0x3400000
    s_cmp_le_u32 s51, 2
    s_cbranch_scc1 T_w_39
    s_sub_u32 s63, s51, 2
    s_andn2_b32 s47, 1, s63
    s_lshl_b32 s47, s47, 9
    s_add_u32 s47, s47, s99
    s_branch door_ck_42
door_ag_43:
    s_cmp_eq_u32 s52, 0
    s_cbranch_scc1 door_lt_44
    s_sub_u32 s52, s52, 1
    buffer_load_dword v14, v15, s[8:11], s47 offen offset:4 sc1
    s_sleep 4
door_ck_42:
    s_memrealtime s[44:45]
    v_readlane_b32 s62, v14, 0
    v_readlane_b32 s41, v14, 1
    v_readlane_b32 s42, v14, 2
    v_readlane_b32 s43, v14, 3
    s_sub_u32 s40, s41, s62
    s_and_b32 s40, s40, 0x8000007f
    s_cmp_eq_u32 s40, 0
    s_cmov_b32 s62, s41
    s_sub_u32 s40, s42, s62
    s_and_b32 s40, s40, 0x8000007f
    s_cmp_eq_u32 s40, 0
    s_cmov_b32 s62, s42
    s_sub_u32 s40, s43, s62
    s_and_b32 s40, s40, 0x8000007f
    s_cmp_eq_u32 s40, 0
    s_cmov_b32 s62, s43
    s_add_u32 s46, s62, 1
    s_and_b32 s46, s46, 127
    s_add_u32 s62, s62, 0x1400
    s_waitcnt lgkmcnt(0)
    s_lshl_b32 s44, s44, 7
    s_cmp_lt_u32 s46, s63
    s_cbranch_scc1 door_ag_43
    s_cmp_gt_u32 s46, s63
    s_cbranch_scc1 door_lt_44
    s_sub_u32 s45, s44, s62
    s_cmp_lt_i32 s45, 0xfffff100
    s_cbranch_scc1 door_ag_43
    s_cmp_ge_i32 s45, 0
    s_cbranch_scc1 door_ok_41
door_md_45:
    s_cmp_ge_i32 s45, 0xfffffb00
    s_cbranch_scc1 door_40
    s_sleep 1
    s_memrealtime s[44:45]
    s_waitcnt lgkmcnt(0)
    s_lshl_b32 s44, s44, 7
    s_sub_u32 s45, s44, s62
    s_branch door_md_45
door_40:
    s_memrealtime s[44:45]
    s_waitcnt lgkmcnt(0)
    s_lshl_b32 s44, s44, 7
    s_sub_u32 s45, s44, s62
    s_cmp_lt_i32 s45, 0
    s_cbranch_scc1 door_40
    s_branch door_ok_41
door_lt_44:
    s_mov_b32 s62, s44
door_ok_41:
T_w_39:
    s_add_u32 s65, s64, 4096
    buffer_load_dwordx4 a[88:91], v10, s[8:11], s64 offen offset:0 sc1
    buffer_load_dwordx4 a[92:95], v10, s[8:11], s64 offen offset:1024 sc1
    buffer_load_dwordx4 a[96:99], v10, s[8:11], s64 offen offset:2048 sc1
    buffer_load_dwordx4 a[100:103], v10, s[8:11], s64 offen offset:3072 sc1
    buffer_load_dwordx4 a[104:107], v10, s[8:11], s65 offen offset:0 sc1
    buffer_load_dwordx4 a[108:111], v10, s[8:11], s65 offen offset:1024 sc1
    buffer_load_dwordx4 a[112:115], v10, s[8:11], s65 offen offset:2048 sc1
    buffer_load_dwordx4 a[116:119], v10, s[8:11], s65 offen offset:3072 sc1
    buffer_load_dwordx4 a[120:123], v16, s[8:11], s64 offen offset:0 sc1
    buffer_load_dwordx4 a[124:127], v16, s[8:11], s64 offen offset:1024 sc1
    buffer_load_dwordx4 a[128:131], v16, s[8:11], s64 offen offset:2048 sc1
    s_add_u32 s64, s64, 45056
    s_add_u32 s65, s64, 4096
    buffer_load_dwordx4 a[132:135], v10, s[8:11], s64 offen offset:0 sc1
    buffer_load_dwordx4 a[136:139], v10, s[8:11], s64 offen offset:1024 sc1
    buffer_load_dwordx4 a[140:143], v10, s[8:11], s64 offen offset:2048 sc1
    buffer_load_dwordx4 a[144:147], v10, s[8:11], s64 offen offset:3072 sc1
    buffer_load_dwordx4 a[148:151], v10, s[8:11], s65 offen offset:0 sc1
    buffer_load_dwordx4 a[152:155], v10, s[8:11], s65 offen offset:1024 sc1
    buffer_load_dwordx4 a[156:159], v10, s[8:11], s65 offen offset:2048 sc1
    buffer_load_dwordx4 a[160:163], v10, s[8:11], s65 offen offset:3072 sc1
    buffer_load_dwordx4 a[164:167], v16, s[8:11], s64 offen offset:0 sc1
    buffer_load_dwordx4 a[168:171], v16, s[8:11], s64 offen offset:1024 sc1
    buffer_load_dwordx4 a[172:175], v16, s[8:11], s64 offen offset:2048 sc1
T_nu_36:
    s_add_u32 s51, s51, 2
    s_mul_i32 s57, s48, 40960
    s_lshl_b32 s32, s50, 5
    s_add_u32 s57, s57, s32
    buffer_load_dwordx2 v[32:33], v21, s[24:27], s57 offen offset:0
    s_mul_hi_u32 s47, s48, 0x55555556
    s_mul_i32 s55, s48, 655360
    s_mul_i32 s46, s47, 131072
    s_add_u32 s55, s55, s46
    s_andn2_b32 s47, 1, s47
    s_lshl_b32 s47, s47, 13
    s_xor_b32 s47, s47, s96
    s_add_u32 s55, s55, s47
    s_add_u32 s55, s55, 0xb000000
    s_lshl_b32 s36, s50, 14
    s_add_u32 s64, s55, s36
    s_add_u32 s65, s64, 16384
    s_mul_i32 s70, s48, 81920
    s_add_u32 s70, s70, 0xa821000
    s_add_u32 s71, s70, 2560
    s_add_u32 s72, s70, 5120
    s_add_u32 s73, s70, 7680
    s_add_u32 s74, s70, 10240
    s_add_u32 s75, s70, 12800
    s_add_u32 s76, s70, 15360
    s_add_u32 s77, s70, 17920
    s_waitcnt vmcnt(0)
    s_add_u32 s63, s48, 1
    s_andn2_b32 s47, 1, s63
    s_lshl_b32 s47, s47, 9
    s_add_u32 s47, s47, s99
    s_branch door_ck_48
door_ag_49:
    s_cmp_eq_u32 s52, 0
    s_cbranch_scc1 door_lt_50
    s_sub_u32 s52, s52, 1
    buffer_load_dword v14, v15, s[8:11], s47 offen offset:0 sc1
    s_sleep 4
door_ck_48:
    s_memrealtime s[44:45]
    v_readlane_b32 s62, v14, 0
    v_readlane_b32 s41, v14, 1
    v_readlane_b32 s42, v14, 2
    v_readlane_b32 s43, v14, 3
    s_sub_u32 s40, s41, s62
    s_and_b32 s40, s40, 0x8000007f
    s_cmp_eq_u32 s40, 0
    s_cmov_b32 s62, s41
    s_sub_u32 s40, s42, s62
    s_and_b32 s40, s40, 0x8000007f
    s_cmp_eq_u32 s40, 0
    s_cmov_b32 s62, s42
    s_sub_u32 s40, s43, s62
    s_and_b32 s40, s40, 0x8000007f
    s_cmp_eq_u32 s40, 0
    s_cmov_b32 s62, s43
    s_add_u32 s46, s62, 1
    s_and_b32 s46, s46, 127
    s_add_u32 s62, s62, 0xc80
    s_waitcnt lgkmcnt(0)
    s_lshl_b32 s44, s44, 7
    s_cmp_lt_u32 s46, s63
    s_cbranch_scc1 door_ag_49
    s_cmp_gt_u32 s46, s63
    s_cbranch_scc1 door_lt_50
    s_sub_u32 s45, s44, s62
    s_cmp_lt_i32 s45, 0xfffff100
    s_cbranch_scc1 door_ag_49
    s_cmp_ge_i32 s45, 0
    s_cbranch_scc1 door_ok_47
door_md_51:
    s_cmp_ge_i32 s45, 0xfffffb00
    s_cbranch_scc1 door_46
    s_sleep 1
    s_memrealtime s[44:45]
    s_waitcnt lgkmcnt(0)
    s_lshl_b32 s44, s44, 7
    s_sub_u32 s45, s44, s62
    s_branch door_md_51
door_46:
    s_memrealtime s[44:45]
    s_waitcnt lgkmcnt(0)
    s_lshl_b32 s44, s44, 7
    s_sub_u32 s45, s44, s62
    s_cmp_lt_i32 s45, 0
    s_cbranch_scc1 door_46
    s_branch door_ok_47
door_lt_50:
    s_mov_b32 s62, s44
door_ok_47:
T_c_54:
    buffer_load_dwordx4 v[64:67], v17, s[8:11], s70 offen offset:0 sc1
    buffer_load_dwordx4 v[68:71], v17, s[8:11], s70 offen offset:1024 sc1
    buffer_load_dwordx4 v[72:75], v17, s[8:11], s71 offen offset:0 sc1
    buffer_load_dwordx4 v[76:79], v17, s[8:11], s71 offen offset:1024 sc1
    buffer_load_dwordx4 v[80:83], v17, s[8:11], s72 offen offset:0 sc1
    buffer_load_dwordx4 v[84:87], v17, s[8:11], s72 offen offset:1024 sc1
    buffer_load_dwordx4 v[88:91], v17, s[8:11], s73 offen offset:0 sc1
    buffer_load_dwordx4 v[92:95], v17, s[8:11], s73 offen offset:1024 sc1
    buffer_load_dwordx4 v[96:99], v17, s[8:11], s74 offen offset:0 sc1
    buffer_load_dwordx4 v[100:103], v17, s[8:11], s74 offen offset:1024 sc1
    v_mov_b32 v2, 0
    buffer_load_dwordx4 v[104:107], v17, s[8:11], s75 offen offset:0 sc1
    v_mfma_f32_16x16x32_bf16 v[160:163], a[32:35], v[24:27], 0
    v_mfma_f32_16x16x32_bf16 v[168:171], a[76:79], v[24:27], 0
    buffer_load_dwordx4 v[108:111], v17, s[8:11], s75 offen offset:1024 sc1
    v_mfma_f32_16x16x32_bf16 v[164:167], a[32:35], v[28:31], 0
    v_mfma_f32_16x16x32_bf16 v[172:175], a[76:79], v[28:31], 0
    buffer_load_dwordx4 v[112:115], v17, s[8:11], s76 offen offset:0 sc1
    v_mfma_f32_16x16x32_bf16 v[160:163], a[36:39], v[24:27], v[160:163]
    v_mfma_f32_16x16x32_bf16 v[168:171], a[80:83], v[24:27], v[168:171]
    buffer_load_dwordx4 v[116:119], v17, s[8:11], s76 offen offset:1024 sc1
    v_mfma_f32_16x16x32_bf16 v[164:167], a[36:39], v[28:31], v[164:167]
    v_mfma_f32_16x16x32_bf16 v[172:175], a[80:83], v[28:31], v[172:175]
    buffer_load_dwordx4 v[120:123], v17, s[8:11], s77 offen offset:0 sc1
    v_mfma_f32_16x16x32_bf16 v[160:163], a[40:43], v[24:27], v[160:163]
    v_mfma_f32_16x16x32_bf16 v[168:171], a[84:87], v[24:27], v[168:171]
    buffer_load_dwordx4 v[124:127], v17, s[8:11], s77 offen offset:1024 sc1
    v_mfma_f32_16x16x32_bf16 v[164:167], a[40:43], v[28:31], v[164:167]
    v_mfma_f32_16x16x32_bf16 v[172:175], a[84:87], v[28:31], v[172:175]
    buffer_load_dwordx4 v[144:147], v9, s[8:11], s64 offen offset:0 sc1
    s_waitcnt vmcnt(16)
    v_mfma_f32_16x16x32_bf16 v[160:163], a[0:3], v[64:67], v[160:163]
    v_max3_u32 v2, v2, v64, v65
    v_max3_u32 v2, v2, v66, v67
    v_mfma_f32_16x16x32_bf16 v[168:171], a[44:47], v[64:67], v[168:171]
    buffer_load_dwordx4 v[148:151], v9, s[8:11], s65 offen offset:0 sc1
    s_waitcnt vmcnt(16)
    v_mfma_f32_16x16x32_bf16 v[164:167], a[0:3], v[68:71], v[164:167]
    v_max3_u32 v2, v2, v68, v69
    v_max3_u32 v2, v2, v70, v71
    v_mfma_f32_16x16x32_bf16 v[172:175], a[44:47], v[68:71], v[172:175]
    buffer_load_dwordx4 v[128:131], v18, s[8:11], s70 offen offset:0 sc1
    s_waitcnt vmcnt(16)
    v_mfma_f32_16x16x32_bf16 v[160:163], a[4:7], v[72:75], v[160:163]
    v_max3_u32 v2, v2, v72, v73
    v_max3_u32 v2, v2, v74, v75
    v_mfma_f32_16x16x32_bf16 v[168:171], a[48:51], v[72:75], v[168:171]
    buffer_load_dwordx4 v[132:135], v18, s[8:11], s70 offen offset:256 sc1
    s_waitcnt vmcnt(16)
    v_mfma_f32_16x16x32_bf16 v[164:167], a[4:7], v[76:79], v[164:167]
    v_max3_u32 v2, v2, v76, v77
    v_max3_u32 v2, v2, v78, v79
    v_mfma_f32_16x16x32_bf16 v[172:175], a[48:51], v[76:79], v[172:175]
    buffer_load_dwordx4 v[152:155], v9, s[8:11], s64 offen offset:1024 sc1
    s_waitcnt vmcnt(16)
    v_mfma_f32_16x16x32_bf16 v[160:163], a[8:11], v[80:83], v[160:163]
    v_max3_u32 v2, v2, v80, v81
    v_max3_u32 v2, v2, v82, v83
    v_mfma_f32_16x16x32_bf16 v[168:171], a[52:55], v[80:83], v[168:171]
    buffer_load_dwordx4 v[156:159], v9, s[8:11], s65 offen offset:1024 sc1
    s_waitcnt vmcnt(16)
    v_mfma_f32_16x16x32_bf16 v[164:167], a[8:11], v[84:87], v[164:167]
    v_max3_u32 v2, v2, v84, v85
    v_max3_u32 v2, v2, v86, v87
    v_mfma_f32_16x16x32_bf16 v[172:175], a[52:55], v[84:87], v[172:175]
    buffer_load_dwordx4 v[136:139], v18, s[8:11], s74 offen offset:0 sc1
    s_waitcnt vmcnt(16)
    v_mfma_f32_16x16x32_bf16 v[160:163], a[12:15], v[88:91], v[160:163]
    v_max3_u32 v2, v2, v88, v89
    v_max3_u32 v2, v2, v90, v91
    v_mfma_f32_16x16x32_bf16 v[168:171], a[56:59], v[88:91], v[168:171]
    buffer_load_dwordx4 v[140:143], v18, s[8:11], s74 offen offset:256 sc1
    s_waitcnt vmcnt(16)
    v_mfma_f32_16x16x32_bf16 v[164:167], a[12:15], v[92:95], v[164:167]
    v_max3_u32 v2, v2, v92, v93
    v_max3_u32 v2, v2, v94, v95
    v_mfma_f32_16x16x32_bf16 v[172:175], a[56:59], v[92:95], v[172:175]
    s_waitcnt vmcnt(15)
    v_mfma_f32_16x16x32_bf16 v[160:163], a[16:19], v[96:99], v[160:163]
    v_max3_u32 v2, v2, v96, v97
    v_max3_u32 v2, v2, v98, v99
    v_mfma_f32_16x16x32_bf16 v[168:171], a[60:63], v[96:99], v[168:171]
    s_waitcnt vmcnt(14)
    v_mfma_f32_16x16x32_bf16 v[164:167], a[16:19], v[100:103], v[164:167]
    v_max3_u32 v2, v2, v100, v101
    v_max3_u32 v2, v2, v102, v103
    v_mfma_f32_16x16x32_bf16 v[172:175], a[60:63], v[100:103], v[172:175]
    s_waitcnt vmcnt(13)
    v_mfma_f32_16x16x32_bf16 v[160:163], a[20:23], v[104:107], v[160:163]
    v_max3_u32 v2, v2, v104, v105
    v_max3_u32 v2, v2, v106, v107
    v_mfma_f32_16x16x32_bf16 v[168:171], a[64:67], v[104:107], v[168:171]
    s_waitcnt vmcnt(12)
    v_mfma_f32_16x16x32_bf16 v[164:167], a[20:23], v[108:111], v[164:167]
    v_max3_u32 v2, v2, v108, v109
    v_max3_u32 v2, v2, v110, v111
    v_mfma_f32_16x16x32_bf16 v[172:175], a[64:67], v[108:111], v[172:175]
    s_waitcnt vmcnt(11)
    v_mfma_f32_16x16x32_bf16 v[160:163], a[24:27], v[112:115], v[160:163]
    v_max3_u32 v2, v2, v112, v113
    v_max3_u32 v2, v2, v114, v115
    v_mfma_f32_16x16x32_bf16 v[168:171], a[68:71], v[112:115], v[168:171]
    s_waitcnt vmcnt(10)
    v_mfma_f32_16x16x32_bf16 v[164:167], a[24:27], v[116:119], v[164:167]
    v_max3_u32 v2, v2, v116, v117
    v_max3_u32 v2, v2, v118, v119
    v_mfma_f32_16x16x32_bf16 v[172:175], a[68:71], v[116:119], v[172:175]
    s_waitcnt vmcnt(9)
    v_mfma_f32_16x16x32_bf16 v[160:163], a[28:31], v[120:123], v[160:163]
    v_max3_u32 v2, v2, v120, v121
    v_max3_u32 v2, v2, v122, v123
    v_mfma_f32_16x16x32_bf16 v[168:171], a[72:75], v[120:123], v[168:171]
    s_waitcnt vmcnt(8)
    v_mfma_f32_16x16x32_bf16 v[164:167], a[28:31], v[124:127], v[164:167]
    v_max3_u32 v2, v2, v124, v125
    v_max3_u32 v2, v2, v126, v127
    v_mfma_f32_16x16x32_bf16 v[172:175], a[72:75], v[124:127], v[172:175]
    s_waitcnt vmcnt(5)
    v_mfma_f32_16x16x32_bf16 v[160:163], v[144:147], v[128:131], v[160:163]
    v_max3_u32 v2, v2, v128, v129
    v_max3_u32 v2, v2, v130, v131
    v_mfma_f32_16x16x32_bf16 v[168:171], v[148:151], v[128:131], v[168:171]
    v_max3_u32 v2, v2, v144, v145
    v_max3_u32 v2, v2, v146, v147
    s_waitcnt vmcnt(4)
    v_mfma_f32_16x16x32_bf16 v[164:167], v[144:147], v[132:135], v[164:167]
    v_max3_u32 v2, v2, v132, v133
    v_max3_u32 v2, v2, v134, v135
    v_mfma_f32_16x16x32_bf16 v[172:175], v[148:151], v[132:135], v[172:175]
    v_max3_u32 v2, v2, v148, v149
    v_max3_u32 v2, v2, v150, v151
    s_waitcnt vmcnt(1)
    v_mfma_f32_16x16x32_bf16 v[160:163], v[152:155], v[136:139], v[160:163]
    v_max3_u32 v2, v2, v136, v137
    v_max3_u32 v2, v2, v138, v139
    v_mfma_f32_16x16x32_bf16 v[168:171], v[156:159], v[136:139], v[168:171]
    v_max3_u32 v2, v2, v152, v153
    v_max3_u32 v2, v2, v154, v155
    s_waitcnt vmcnt(0)
    v_mfma_f32_16x16x32_bf16 v[164:167], v[152:155], v[140:143], v[164:167]
    v_max3_u32 v2, v2, v140, v141
    v_max3_u32 v2, v2, v142, v143
    v_mfma_f32_16x16x32_bf16 v[172:175], v[156:159], v[140:143], v[172:175]
    v_max3_u32 v2, v2, v156, v157
    v_max3_u32 v2, v2, v158, v159
    v_cmp_eq_u32 vcc, -1, v2
    s_cbranch_vccnz T_rt_53
T_ok_52:
    ds_write_b128 v12, v[160:163] offset:0
    ds_write_b128 v12, v[164:167] offset:4096
    ds_write_b128 v12, v[168:171] offset:8192
    s_nop 0
    ds_write_b128 v12, v[172:175] offset:12288
    s_waitcnt lgkmcnt(0)
    s_barrier
    ds_read_b128 v[48:51], v20 offset:0
    ds_read_b128 v[52:55], v20 offset:1024
    ds_read_b128 v[56:59], v20 offset:2048
    ds_read_b128 v[60:63], v20 offset:3072
    v_lshlrev_b32 v40, 16, v32
    v_and_b32 v41, s58, v32
    v_lshlrev_b32 v42, 16, v33
    v_and_b32 v43, s58, v33
    s_waitcnt lgkmcnt(3)
    v_pk_add_f32 v[40:41], v[40:41], v[48:49]
    v_pk_add_f32 v[42:43], v[42:43], v[50:51]
    s_waitcnt lgkmcnt(2)
    v_pk_add_f32 v[40:41], v[40:41], v[52:53]
    v_pk_add_f32 v[42:43], v[42:43], v[54:55]
    s_waitcnt lgkmcnt(1)
    v_pk_add_f32 v[40:41], v[40:41], v[56:57]
    v_pk_add_f32 v[42:43], v[42:43], v[58:59]
    s_waitcnt lgkmcnt(0)
    v_pk_add_f32 v[40:41], v[40:41], v[60:61]
    v_pk_add_f32 v[42:43], v[42:43], v[62:63]
    v_cvt_pk_bf16_f32 v44, v40, v41
    v_cvt_pk_bf16_f32 v45, v42, v43
    buffer_store_dwordx2 v[44:45], v21, s[28:31], s57 offen offset:0
    s_xor_b32 s32, s48, 41
    s_or_b32 s32, s32, s50
    s_or_b32 s32, s32, s4
    s_cbranch_scc1 T_z
    s_mov_b32 s40, s88
    s_and_b32 s41, s89, 0xffff
    s_mov_b32 s42, 0x100
    s_mov_b32 s43, 0x20000
    buffer_load_dword v3, v26, s[40:43], 0 offen offset:248 sc1
    s_waitcnt vmcnt(0)
    v_cmp_ne_u32 vcc, 60, v3
    s_cbranch_vccnz T_z
    buffer_store_dwordx4 v[26:29], v6, s[40:43], 0 offen sc1
T_z:
    v_xor_b32 v12, 0x10000, v12
    v_xor_b32 v20, 0x10000, v20
    s_add_u32 s48, s48, 2
    s_cmp_ge_u32 s48, 64
    s_cbranch_scc1 T_end
    s_cmp_ge_u32 s51, 64
    s_cbranch_scc1 T_nu_55
    s_mul_i32 s32, s51, 2048
    s_add_u32 s32, s32, 0xa800400
T_poll_56:
    buffer_load_dword v2, v11, s[8:11], s32 offen sc1
    s_waitcnt vmcnt(0)
    v_cmp_gt_i32 vcc, s51, v2
    s_cbranch_vccz T_ok_57
    s_cmp_eq_u32 s52, 0
    s_cbranch_scc1 T_ok_57
    s_sub_u32 s52, s52, 1
    s_sleep 1
    s_branch T_poll_56
T_ok_57:
    s_mul_i32 s64, s51, 1802240
    s_mul_i32 s32, s50, 45056
    s_add_u32 s64, s64, s32
    s_add_u32 s64, s64, 0x3400000
    s_cmp_le_u32 s51, 2
    s_cbranch_scc1 T_w_58
    s_sub_u32 s63, s51, 2
    s_andn2_b32 s47, 1, s63
    s_lshl_b32 s47, s47, 9
    s_add_u32 s47, s47, s99
    s_branch door_ck_61
door_ag_62:
    s_cmp_eq_u32 s52, 0
    s_cbranch_scc1 door_lt_63
    s_sub_u32 s52, s52, 1
    buffer_load_dword v14, v15, s[8:11], s47 offen offset:4 sc1
    s_sleep 4
door_ck_61:
    s_memrealtime s[44:45]
    v_readlane_b32 s62, v14, 0
    v_readlane_b32 s41, v14, 1
    v_readlane_b32 s42, v14, 2
    v_readlane_b32 s43, v14, 3
    s_sub_u32 s40, s41, s62
    s_and_b32 s40, s40, 0x8000007f
    s_cmp_eq_u32 s40, 0
    s_cmov_b32 s62, s41
    s_sub_u32 s40, s42, s62
    s_and_b32 s40, s40, 0x8000007f
    s_cmp_eq_u32 s40, 0
    s_cmov_b32 s62, s42
    s_sub_u32 s40, s43, s62
    s_and_b32 s40, s40, 0x8000007f
    s_cmp_eq_u32 s40, 0
    s_cmov_b32 s62, s43
    s_add_u32 s46, s62, 1
    s_and_b32 s46, s46, 127
    s_add_u32 s62, s62, 0x1400
    s_waitcnt lgkmcnt(0)
    s_lshl_b32 s44, s44, 7
    s_cmp_lt_u32 s46, s63
    s_cbranch_scc1 door_ag_62
    s_cmp_gt_u32 s46, s63
    s_cbranch_scc1 door_lt_63
    s_sub_u32 s45, s44, s62
    s_cmp_lt_i32 s45, 0xfffff100
    s_cbranch_scc1 door_ag_62
    s_cmp_ge_i32 s45, 0
    s_cbranch_scc1 door_ok_60
door_md_64:
    s_cmp_ge_i32 s45, 0xfffffb00
    s_cbranch_scc1 door_59
    s_sleep 1
    s_memrealtime s[44:45]
    s_waitcnt lgkmcnt(0)
    s_lshl_b32 s44, s44, 7
    s_sub_u32 s45, s44, s62
    s_branch door_md_64
door_59:
    s_memrealtime s[44:45]
    s_waitcnt lgkmcnt(0)
    s_lshl_b32 s44, s44, 7
    s_sub_u32 s45, s44, s62
    s_cmp_lt_i32 s45, 0
    s_cbranch_scc1 door_59
    s_branch door_ok_60
door_lt_63:
    s_mov_b32 s62, s44
door_ok_60:
T_w_58:
    s_add_u32 s65, s64, 4096
    buffer_load_dwordx4 a[0:3], v10, s[8:11], s64 offen offset:0 sc1
    buffer_load_dwordx4 a[4:7], v10, s[8:11], s64 offen offset:1024 sc1
    buffer_load_dwordx4 a[8:11], v10, s[8:11], s64 offen offset:2048 sc1
    buffer_load_dwordx4 a[12:15], v10, s[8:11], s64 offen offset:3072 sc1
    buffer_load_dwordx4 a[16:19], v10, s[8:11], s65 offen offset:0 sc1
    buffer_load_dwordx4 a[20:23], v10, s[8:11], s65 offen offset:1024 sc1
    buffer_load_dwordx4 a[24:27], v10, s[8:11], s65 offen offset:2048 sc1
    buffer_load_dwordx4 a[28:31], v10, s[8:11], s65 offen offset:3072 sc1
    buffer_load_dwordx4 a[32:35], v16, s[8:11], s64 offen offset:0 sc1
    buffer_load_dwordx4 a[36:39], v16, s[8:11], s64 offen offset:1024 sc1
    buffer_load_dwordx4 a[40:43], v16, s[8:11], s64 offen offset:2048 sc1
    s_add_u32 s64, s64, 45056
    s_add_u32 s65, s64, 4096
    buffer_load_dwordx4 a[44:47], v10, s[8:11], s64 offen offset:0 sc1
    buffer_load_dwordx4 a[48:51], v10, s[8:11], s64 offen offset:1024 sc1
    buffer_load_dwordx4 a[52:55], v10, s[8:11], s64 offen offset:2048 sc1
    buffer_load_dwordx4 a[56:59], v10, s[8:11], s64 offen offset:3072 sc1
    buffer_load_dwordx4 a[60:63], v10, s[8:11], s65 offen offset:0 sc1
    buffer_load_dwordx4 a[64:67], v10, s[8:11], s65 offen offset:1024 sc1
    buffer_load_dwordx4 a[68:71], v10, s[8:11], s65 offen offset:2048 sc1
    buffer_load_dwordx4 a[72:75], v10, s[8:11], s65 offen offset:3072 sc1
    buffer_load_dwordx4 a[76:79], v16, s[8:11], s64 offen offset:0 sc1
    buffer_load_dwordx4 a[80:83], v16, s[8:11], s64 offen offset:1024 sc1
    buffer_load_dwordx4 a[84:87], v16, s[8:11], s64 offen offset:2048 sc1
T_nu_55:
    s_add_u32 s51, s51, 2
    s_mul_i32 s57, s48, 40960
    s_lshl_b32 s32, s50, 5
    s_add_u32 s57, s57, s32
    buffer_load_dwordx2 v[32:33], v21, s[24:27], s57 offen offset:0
    s_mul_hi_u32 s47, s48, 0x55555556
    s_mul_i32 s55, s48, 655360
    s_mul_i32 s46, s47, 131072
    s_add_u32 s55, s55, s46
    s_andn2_b32 s47, 1, s47
    s_lshl_b32 s47, s47, 13
    s_xor_b32 s47, s47, s96
    s_add_u32 s55, s55, s47
    s_add_u32 s55, s55, 0xb000000
    s_lshl_b32 s36, s50, 14
    s_add_u32 s64, s55, s36
    s_add_u32 s65, s64, 16384
    s_mul_i32 s70, s48, 81920
    s_add_u32 s70, s70, 0xa821000
    s_add_u32 s71, s70, 2560
    s_add_u32 s72, s70, 5120
    s_add_u32 s73, s70, 7680
    s_add_u32 s74, s70, 10240
    s_add_u32 s75, s70, 12800
    s_add_u32 s76, s70, 15360
    s_add_u32 s77, s70, 17920
    s_waitcnt vmcnt(0)
    s_add_u32 s63, s48, 1
    s_andn2_b32 s47, 1, s63
    s_lshl_b32 s47, s47, 9
    s_add_u32 s47, s47, s99
    s_branch door_ck_67
door_ag_68:
    s_cmp_eq_u32 s52, 0
    s_cbranch_scc1 door_lt_69
    s_sub_u32 s52, s52, 1
    buffer_load_dword v14, v15, s[8:11], s47 offen offset:0 sc1
    s_sleep 4
door_ck_67:
    s_memrealtime s[44:45]
    v_readlane_b32 s62, v14, 0
    v_readlane_b32 s41, v14, 1
    v_readlane_b32 s42, v14, 2
    v_readlane_b32 s43, v14, 3
    s_sub_u32 s40, s41, s62
    s_and_b32 s40, s40, 0x8000007f
    s_cmp_eq_u32 s40, 0
    s_cmov_b32 s62, s41
    s_sub_u32 s40, s42, s62
    s_and_b32 s40, s40, 0x8000007f
    s_cmp_eq_u32 s40, 0
    s_cmov_b32 s62, s42
    s_sub_u32 s40, s43, s62
    s_and_b32 s40, s40, 0x8000007f
    s_cmp_eq_u32 s40, 0
    s_cmov_b32 s62, s43
    s_add_u32 s46, s62, 1
    s_and_b32 s46, s46, 127
    s_add_u32 s62, s62, 0xc80
    s_waitcnt lgkmcnt(0)
    s_lshl_b32 s44, s44, 7
    s_cmp_lt_u32 s46, s63
    s_cbranch_scc1 door_ag_68
    s_cmp_gt_u32 s46, s63
    s_cbranch_scc1 door_lt_69
    s_sub_u32 s45, s44, s62
    s_cmp_lt_i32 s45, 0xfffff100
    s_cbranch_scc1 door_ag_68
    s_cmp_ge_i32 s45, 0
    s_cbranch_scc1 door_ok_66
door_md_70:
    s_cmp_ge_i32 s45, 0xfffffb00
    s_cbranch_scc1 door_65
    s_sleep 1
    s_memrealtime s[44:45]
    s_waitcnt lgkmcnt(0)
    s_lshl_b32 s44, s44, 7
    s_sub_u32 s45, s44, s62
    s_branch door_md_70
door_65:
    s_memrealtime s[44:45]
    s_waitcnt lgkmcnt(0)
    s_lshl_b32 s44, s44, 7
    s_sub_u32 s45, s44, s62
    s_cmp_lt_i32 s45, 0
    s_cbranch_scc1 door_65
    s_branch door_ok_66
door_lt_69:
    s_mov_b32 s62, s44
door_ok_66:
T_c_73:
    buffer_load_dwordx4 v[64:67], v17, s[8:11], s70 offen offset:0 sc1
    buffer_load_dwordx4 v[68:71], v17, s[8:11], s70 offen offset:1024 sc1
    buffer_load_dwordx4 v[72:75], v17, s[8:11], s71 offen offset:0 sc1
    buffer_load_dwordx4 v[76:79], v17, s[8:11], s71 offen offset:1024 sc1
    buffer_load_dwordx4 v[80:83], v17, s[8:11], s72 offen offset:0 sc1
    buffer_load_dwordx4 v[84:87], v17, s[8:11], s72 offen offset:1024 sc1
    buffer_load_dwordx4 v[88:91], v17, s[8:11], s73 offen offset:0 sc1
    buffer_load_dwordx4 v[92:95], v17, s[8:11], s73 offen offset:1024 sc1
    buffer_load_dwordx4 v[96:99], v17, s[8:11], s74 offen offset:0 sc1
    buffer_load_dwordx4 v[100:103], v17, s[8:11], s74 offen offset:1024 sc1
    v_mov_b32 v2, 0
    buffer_load_dwordx4 v[104:107], v17, s[8:11], s75 offen offset:0 sc1
    v_mfma_f32_16x16x32_bf16 v[160:163], a[120:123], v[24:27], 0
    v_mfma_f32_16x16x32_bf16 v[168:171], a[164:167], v[24:27], 0
    buffer_load_dwordx4 v[108:111], v17, s[8:11], s75 offen offset:1024 sc1
    v_mfma_f32_16x16x32_bf16 v[164:167], a[120:123], v[28:31], 0
    v_mfma_f32_16x16x32_bf16 v[172:175], a[164:167], v[28:31], 0
    buffer_load_dwordx4 v[112:115], v17, s[8:11], s76 offen offset:0 sc1
    v_mfma_f32_16x16x32_bf16 v[160:163], a[124:127], v[24:27], v[160:163]
    v_mfma_f32_16x16x32_bf16 v[168:171], a[168:171], v[24:27], v[168:171]
    buffer_load_dwordx4 v[116:119], v17, s[8:11], s76 offen offset:1024 sc1
    v_mfma_f32_16x16x32_bf16 v[164:167], a[124:127], v[28:31], v[164:167]
    v_mfma_f32_16x16x32_bf16 v[172:175], a[168:171], v[28:31], v[172:175]
    buffer_load_dwordx4 v[120:123], v17, s[8:11], s77 offen offset:0 sc1
    v_mfma_f32_16x16x32_bf16 v[160:163], a[128:131], v[24:27], v[160:163]
    v_mfma_f32_16x16x32_bf16 v[168:171], a[172:175], v[24:27], v[168:171]
    buffer_load_dwordx4 v[124:127], v17, s[8:11], s77 offen offset:1024 sc1
    v_mfma_f32_16x16x32_bf16 v[164:167], a[128:131], v[28:31], v[164:167]
    v_mfma_f32_16x16x32_bf16 v[172:175], a[172:175], v[28:31], v[172:175]
    buffer_load_dwordx4 v[144:147], v9, s[8:11], s64 offen offset:0 sc1
    s_waitcnt vmcnt(16)
    v_mfma_f32_16x16x32_bf16 v[160:163], a[88:91], v[64:67], v[160:163]
    v_max3_u32 v2, v2, v64, v65
    v_max3_u32 v2, v2, v66, v67
    v_mfma_f32_16x16x32_bf16 v[168:171], a[132:135], v[64:67], v[168:171]
    buffer_load_dwordx4 v[148:151], v9, s[8:11], s65 offen offset:0 sc1
    s_waitcnt vmcnt(16)
    v_mfma_f32_16x16x32_bf16 v[164:167], a[88:91], v[68:71], v[164:167]
    v_max3_u32 v2, v2, v68, v69
    v_max3_u32 v2, v2, v70, v71
    v_mfma_f32_16x16x32_bf16 v[172:175], a[132:135], v[68:71], v[172:175]
    buffer_load_dwordx4 v[128:131], v18, s[8:11], s70 offen offset:0 sc1
    s_waitcnt vmcnt(16)
    v_mfma_f32_16x16x32_bf16 v[160:163], a[92:95], v[72:75], v[160:163]
    v_max3_u32 v2, v2, v72, v73
    v_max3_u32 v2, v2, v74, v75
    v_mfma_f32_16x16x32_bf16 v[168:171], a[136:139], v[72:75], v[168:171]
    buffer_load_dwordx4 v[132:135], v18, s[8:11], s70 offen offset:256 sc1
    s_waitcnt vmcnt(16)
    v_mfma_f32_16x16x32_bf16 v[164:167], a[92:95], v[76:79], v[164:167]
    v_max3_u32 v2, v2, v76, v77
    v_max3_u32 v2, v2, v78, v79
    v_mfma_f32_16x16x32_bf16 v[172:175], a[136:139], v[76:79], v[172:175]
    buffer_load_dwordx4 v[152:155], v9, s[8:11], s64 offen offset:1024 sc1
    s_waitcnt vmcnt(16)
    v_mfma_f32_16x16x32_bf16 v[160:163], a[96:99], v[80:83], v[160:163]
    v_max3_u32 v2, v2, v80, v81
    v_max3_u32 v2, v2, v82, v83
    v_mfma_f32_16x16x32_bf16 v[168:171], a[140:143], v[80:83], v[168:171]
    buffer_load_dwordx4 v[156:159], v9, s[8:11], s65 offen offset:1024 sc1
    s_waitcnt vmcnt(16)
    v_mfma_f32_16x16x32_bf16 v[164:167], a[96:99], v[84:87], v[164:167]
    v_max3_u32 v2, v2, v84, v85
    v_max3_u32 v2, v2, v86, v87
    v_mfma_f32_16x16x32_bf16 v[172:175], a[140:143], v[84:87], v[172:175]
    buffer_load_dwordx4 v[136:139], v18, s[8:11], s74 offen offset:0 sc1
    s_waitcnt vmcnt(16)
    v_mfma_f32_16x16x32_bf16 v[160:163], a[100:103], v[88:91], v[160:163]
    v_max3_u32 v2, v2, v88, v89
    v_max3_u32 v2, v2, v90, v91
    v_mfma_f32_16x16x32_bf16 v[168:171], a[144:147], v[88:91], v[168:171]
    buffer_load_dwordx4 v[140:143], v18, s[8:11], s74 offen offset:256 sc1
    s_waitcnt vmcnt(16)
    v_mfma_f32_16x16x32_bf16 v[164:167], a[100:103], v[92:95], v[164:167]
    v_max3_u32 v2, v2, v92, v93
    v_max3_u32 v2, v2, v94, v95
    v_mfma_f32_16x16x32_bf16 v[172:175], a[144:147], v[92:95], v[172:175]
    s_waitcnt vmcnt(15)
    v_mfma_f32_16x16x32_bf16 v[160:163], a[104:107], v[96:99], v[160:163]
    v_max3_u32 v2, v2, v96, v97
    v_max3_u32 v2, v2, v98, v99
    v_mfma_f32_16x16x32_bf16 v[168:171], a[148:151], v[96:99], v[168:171]
    s_waitcnt vmcnt(14)
    v_mfma_f32_16x16x32_bf16 v[164:167], a[104:107], v[100:103], v[164:167]
    v_max3_u32 v2, v2, v100, v101
    v_max3_u32 v2, v2, v102, v103
    v_mfma_f32_16x16x32_bf16 v[172:175], a[148:151], v[100:103], v[172:175]
    s_waitcnt vmcnt(13)
    v_mfma_f32_16x16x32_bf16 v[160:163], a[108:111], v[104:107], v[160:163]
    v_max3_u32 v2, v2, v104, v105
    v_max3_u32 v2, v2, v106, v107
    v_mfma_f32_16x16x32_bf16 v[168:171], a[152:155], v[104:107], v[168:171]
    s_waitcnt vmcnt(12)
    v_mfma_f32_16x16x32_bf16 v[164:167], a[108:111], v[108:111], v[164:167]
    v_max3_u32 v2, v2, v108, v109
    v_max3_u32 v2, v2, v110, v111
    v_mfma_f32_16x16x32_bf16 v[172:175], a[152:155], v[108:111], v[172:175]
    s_waitcnt vmcnt(11)
    v_mfma_f32_16x16x32_bf16 v[160:163], a[112:115], v[112:115], v[160:163]
    v_max3_u32 v2, v2, v112, v113
    v_max3_u32 v2, v2, v114, v115
    v_mfma_f32_16x16x32_bf16 v[168:171], a[156:159], v[112:115], v[168:171]
    s_waitcnt vmcnt(10)
    v_mfma_f32_16x16x32_bf16 v[164:167], a[112:115], v[116:119], v[164:167]
    v_max3_u32 v2, v2, v116, v117
    v_max3_u32 v2, v2, v118, v119
    v_mfma_f32_16x16x32_bf16 v[172:175], a[156:159], v[116:119], v[172:175]
    s_waitcnt vmcnt(9)
    v_mfma_f32_16x16x32_bf16 v[160:163], a[116:119], v[120:123], v[160:163]
    v_max3_u32 v2, v2, v120, v121
    v_max3_u32 v2, v2, v122, v123
    v_mfma_f32_16x16x32_bf16 v[168:171], a[160:163], v[120:123], v[168:171]
    s_waitcnt vmcnt(8)
    v_mfma_f32_16x16x32_bf16 v[164:167], a[116:119], v[124:127], v[164:167]
    v_max3_u32 v2, v2, v124, v125
    v_max3_u32 v2, v2, v126, v127
    v_mfma_f32_16x16x32_bf16 v[172:175], a[160:163], v[124:127], v[172:175]
    s_waitcnt vmcnt(5)
    v_mfma_f32_16x16x32_bf16 v[160:163], v[144:147], v[128:131], v[160:163]
    v_max3_u32 v2, v2, v128, v129
    v_max3_u32 v2, v2, v130, v131
    v_mfma_f32_16x16x32_bf16 v[168:171], v[148:151], v[128:131], v[168:171]
    v_max3_u32 v2, v2, v144, v145
    v_max3_u32 v2, v2, v146, v147
    s_waitcnt vmcnt(4)
    v_mfma_f32_16x16x32_bf16 v[164:167], v[144:147], v[132:135], v[164:167]
    v_max3_u32 v2, v2, v132, v133
    v_max3_u32 v2, v2, v134, v135
    v_mfma_f32_16x16x32_bf16 v[172:175], v[148:151], v[132:135], v[172:175]
    v_max3_u32 v2, v2, v148, v149
    v_max3_u32 v2, v2, v150, v151
    s_waitcnt vmcnt(1)
    v_mfma_f32_16x16x32_bf16 v[160:163], v[152:155], v[136:139], v[160:163]
    v_max3_u32 v2, v2, v136, v137
    v_max3_u32 v2, v2, v138, v139
    v_mfma_f32_16x16x32_bf16 v[168:171], v[156:159], v[136:139], v[168:171]
    v_max3_u32 v2, v2, v152, v153
    v_max3_u32 v2, v2, v154, v155
    s_waitcnt vmcnt(0)
    v_mfma_f32_16x16x32_bf16 v[164:167], v[152:155], v[140:143], v[164:167]
    v_max3_u32 v2, v2, v140, v141
    v_max3_u32 v2, v2, v142, v143
    v_mfma_f32_16x16x32_bf16 v[172:175], v[156:159], v[140:143], v[172:175]
    v_max3_u32 v2, v2, v156, v157
    v_max3_u32 v2, v2, v158, v159
    v_cmp_eq_u32 vcc, -1, v2
    s_cbranch_vccnz T_rt_72
T_ok_71:
    ds_write_b128 v12, v[160:163] offset:0
    ds_write_b128 v12, v[164:167] offset:4096
    ds_write_b128 v12, v[168:171] offset:8192
    s_nop 0
    ds_write_b128 v12, v[172:175] offset:12288
    s_waitcnt lgkmcnt(0)
    s_barrier
    ds_read_b128 v[48:51], v20 offset:0
    ds_read_b128 v[52:55], v20 offset:1024
    ds_read_b128 v[56:59], v20 offset:2048
    ds_read_b128 v[60:63], v20 offset:3072
    v_lshlrev_b32 v40, 16, v32
    v_and_b32 v41, s58, v32
    v_lshlrev_b32 v42, 16, v33
    v_and_b32 v43, s58, v33
    s_waitcnt lgkmcnt(3)
    v_pk_add_f32 v[40:41], v[40:41], v[48:49]
    v_pk_add_f32 v[42:43], v[42:43], v[50:51]
    s_waitcnt lgkmcnt(2)
    v_pk_add_f32 v[40:41], v[40:41], v[52:53]
    v_pk_add_f32 v[42:43], v[42:43], v[54:55]
    s_waitcnt lgkmcnt(1)
    v_pk_add_f32 v[40:41], v[40:41], v[56:57]
    v_pk_add_f32 v[42:43], v[42:43], v[58:59]
    s_waitcnt lgkmcnt(0)
    v_pk_add_f32 v[40:41], v[40:41], v[60:61]
    v_pk_add_f32 v[42:43], v[42:43], v[62:63]
    v_cvt_pk_bf16_f32 v44, v40, v41
    v_cvt_pk_bf16_f32 v45, v42, v43
    buffer_store_dwordx2 v[44:45], v21, s[28:31], s57 offen offset:0
    v_xor_b32 v12, 0x10000, v12
    v_xor_b32 v20, 0x10000, v20
    s_add_u32 s48, s48, 2
    s_cmp_ge_u32 s48, 64
    s_cbranch_scc1 T_end
    s_branch T_loop
T_end:
    s_endpgm
T_rt_53:
    s_nop 7
    s_cmp_eq_u32 s52, 0
    s_cbranch_scc1 T_ok_52
    s_sub_u32 s52, s52, 1
    s_sleep 16
    s_waitcnt vmcnt(0)
    s_branch T_c_54
T_rt_72:
    s_nop 7
    s_cmp_eq_u32 s52, 0
    s_cbranch_scc1 T_ok_71
    s_sub_u32 s52, s52, 1
    s_sleep 16
    s_waitcnt vmcnt(0)
    s_branch T_c_73
T2_start:
    s_mov_b32 s28, s88
    s_and_b32 s29, s89, 0xffff
    s_mov_b32 s30, 0x100
    s_mov_b32 s31, 0x20000
    v_mov_b32 v2, 0
    buffer_load_dword v3, v2, s[28:31], 0 offen offset:60 sc1
    s_mov_b32 s52, 1048576
    s_branch prepw_ck_76
prepw_74:
    buffer_load_dword v3, v2, s[28:31], 0 offen offset:60 sc1
prepw_ck_76:
    s_waitcnt vmcnt(0)
    v_readfirstlane_b32 s32, v3
    s_nop 1
    s_and_b32 s33, s32, 255
    s_cmp_ge_u32 s33, 56
    s_cbranch_scc1 prepw_ok_75
    s_cmp_eq_u32 s52, 0
    s_cbranch_scc1 prepw_ok_75
    s_sub_u32 s52, s52, 1
    s_sleep 4
    s_branch prepw_74
prepw_ok_75:
    s_barrier
    v_mov_b32 v2, 0x40000000
    v_cmp_eq_u32 vcc, 0, v0
    s_nop 1
    v_cndmask_b32 v2, v2, v0, vcc
    v_mov_b32 v3, 1
    buffer_atomic_add v3, v2, s[28:31], 0 offen offset:248
    s_bfe_u32 s33, s32, 0x80008
    s_bfe_u32 s34, s32, 0x80018
    s_add_u32 s33, s33, s34
    s_bfe_u32 s34, s32, 0x80010
    s_sub_u32 s33, s33, s34
    s_cmp_ge_i32 s33, 28
    s_cselect_b32 s96, 0, 8192
    s_mov_b32 s98, s96
    s_xor_b32 s97, s96, 8192
    s_add_u32 s99, s96, 0xa20d000
    s_nop 4
    s_mov_b32 s24, s64
    s_and_b32 s25, s65, 0xffff
    s_mov_b32 s26, 0x280000
    s_mov_b32 s27, 0x20000
    s_mov_b32 s28, s86
    s_and_b32 s29, s87, 0xffff
    s_mov_b32 s30, 0x280000
    s_mov_b32 s31, 0x20000
    v_lshlrev_b32 v6, 4, v1
    v_lshrrev_b32 v2, 4, v1
    s_lshl_b32 s32, s4, 11
    v_add_u32 v9, s32, v6
    s_lshl_b32 s32, s4, 13
    v_add_u32 v10, s32, v6
    s_mul_i32 s32, s4, 3072
    s_add_u32 s32, s32, 32768
    v_add_u32 v16, s32, v6
    s_lshl_b32 s32, s4, 3
    v_add_u32 v4, s32, v1
    s_mul_i32 s32, s4, 3
    s_add_u32 s32, s32, 24
    v_min_u32 v5, 10, v1
    v_add_u32 v5, s32, v5
    v_cmp_gt_u32 vcc, 8, v1
    s_nop 1
    v_cndmask_b32 v5, v5, v4, vcc
    v_lshlrev_b32 v11, 4, v5
    v_lshlrev_b32 v12, 4, v0
    s_lshl_b32 s32, s4, 12
    v_add_u32 v20, s32, v6
    v_and_b32 v3, 15, v1
    s_mul_i32 s32, s4, 20480
    v_add_u32 v17, s32, v6
    v_mul_u32_u24 v4, 2560, v2
    v_lshl_add_u32 v4, v3, 4, v4
    v_add_u32 v4, 2048, v4
    v_add_u32 v18, s32, v4
    v_mul_u32_u24 v4, 1280, v3
    v_lshl_add_u32 v4, v2, 3, v4
    s_and_b32 s32, s4, 1
    s_mul_i32 s32, s32, 20480
    s_lshr_b32 s33, s4, 1
    s_lshl_b32 s33, s33, 5
    s_add_u32 s32, s32, s33
    v_add_u32 v19, s32, v4
    s_cmp_lt_u32 s4, 2
    s_cselect_b32 s32, 0, 0x40000000
    v_add_u32 v21, s32, v19
    v_lshlrev_b32 v4, 2, v2
    v_sub_u32 v4, v3, v4
    v_mov_b32 v5, 0x3f80
    v_mov_b32 v41, 0x3f800000
    v_cmp_eq_u32 vcc, 0, v4
    s_nop 1
    v_cndmask_b32 v24, 0, v5, vcc
    v_cmp_eq_u32 vcc, 1, v4
    s_nop 1
    v_cndmask_b32 v24, v24, v41, vcc
    v_mov_b32 v30, v24
    v_cmp_eq_u32 vcc, 2, v4
    s_nop 1
    v_cndmask_b32 v25, 0, v5, vcc
    v_cmp_eq_u32 vcc, 3, v4
    s_nop 1
    v_cndmask_b32 v25, v25, v41, vcc
    v_mov_b32 v31, v25
    v_mov_b32 v26, 0
    v_mov_b32 v27, 0
    v_mov_b32 v28, 0
    v_mov_b32 v29, 0
    v_mov_b32 v14, -1
    v_min_u32 v15, 3, v1
    v_lshlrev_b32 v15, 7, v15
    s_mov_b32 s52, 4194304
    s_mov_b32 s58, 0xffff0000
    s_mov_b32 s51, s48
T2_loop:
    s_cmp_ge_u32 s51, 64
    s_cbranch_scc1 T2_nu_77
    s_mul_i32 s32, s51, 2048
    s_add_u32 s32, s32, 0xa800400
T2_poll_78:
    buffer_load_dword v2, v11, s[8:11], s32 offen sc1
    s_waitcnt vmcnt(0)
    v_cmp_gt_i32 vcc, s51, v2
    s_cbranch_vccz T2_ok_79
    s_cmp_eq_u32 s52, 0
    s_cbranch_scc1 T2_ok_79
    s_sub_u32 s52, s52, 1
    s_sleep 1
    s_branch T2_poll_78
T2_ok_79:
    s_mul_i32 s64, s51, 1802240
    s_mul_i32 s32, s50, 45056
    s_add_u32 s64, s64, s32
    s_add_u32 s64, s64, 0x3400000
    s_add_u32 s65, s64, 4096
    buffer_load_dwordx4 a[0:3], v10, s[8:11], s64 offen offset:0 sc1
    buffer_load_dwordx4 a[4:7], v10, s[8:11], s64 offen offset:1024 sc1
    buffer_load_dwordx4 a[8:11], v10, s[8:11], s64 offen offset:2048 sc1
    buffer_load_dwordx4 a[12:15], v10, s[8:11], s64 offen offset:3072 sc1
    buffer_load_dwordx4 a[16:19], v10, s[8:11], s65 offen offset:0 sc1
    buffer_load_dwordx4 a[20:23], v10, s[8:11], s65 offen offset:1024 sc1
    buffer_load_dwordx4 a[24:27], v10, s[8:11], s65 offen offset:2048 sc1
    buffer_load_dwordx4 a[28:31], v10, s[8:11], s65 offen offset:3072 sc1
    buffer_load_dwordx4 a[32:35], v16, s[8:11], s64 offen offset:0 sc1
    buffer_load_dwordx4 a[36:39], v16, s[8:11], s64 offen offset:1024 sc1
    buffer_load_dwordx4 a[40:43], v16, s[8:11], s64 offen offset:2048 sc1
    s_add_u32 s64, s64, 45056
    s_add_u32 s65, s64, 4096
    buffer_load_dwordx4 a[44:47], v10, s[8:11], s64 offen offset:0 sc1
    buffer_load_dwordx4 a[48:51], v10, s[8:11], s64 offen offset:1024 sc1
    buffer_load_dwordx4 a[52:55], v10, s[8:11], s64 offen offset:2048 sc1
    buffer_load_dwordx4 a[56:59], v10, s[8:11], s64 offen offset:3072 sc1
    buffer_load_dwordx4 a[60:63], v10, s[8:11], s65 offen offset:0 sc1
    buffer_load_dwordx4 a[64:67], v10, s[8:11], s65 offen offset:1024 sc1
    buffer_load_dwordx4 a[68:71], v10, s[8:11], s65 offen offset:2048 sc1
    buffer_load_dwordx4 a[72:75], v10, s[8:11], s65 offen offset:3072 sc1
    buffer_load_dwordx4 a[76:79], v16, s[8:11], s64 offen offset:0 sc1
    buffer_load_dwordx4 a[80:83], v16, s[8:11], s64 offen offset:1024 sc1
    buffer_load_dwordx4 a[84:87], v16, s[8:11], s64 offen offset:2048 sc1
    s_add_u32 s64, s64, 45056
    s_add_u32 s65, s64, 4096
    buffer_load_dwordx4 a[88:91], v10, s[8:11], s64 offen offset:0 sc1
    buffer_load_dwordx4 a[92:95], v10, s[8:11], s64 offen offset:1024 sc1
    buffer_load_dwordx4 a[96:99], v10, s[8:11], s64 offen offset:2048 sc1
    buffer_load_dwordx4 a[100:103], v10, s[8:11], s64 offen offset:3072 sc1
    buffer_load_dwordx4 a[104:107], v10, s[8:11], s65 offen offset:0 sc1
    buffer_load_dwordx4 a[108:111], v10, s[8:11], s65 offen offset:1024 sc1
    buffer_load_dwordx4 a[112:115], v10, s[8:11], s65 offen offset:2048 sc1
    buffer_load_dwordx4 a[116:119], v10, s[8:11], s65 offen offset:3072 sc1
    buffer_load_dwordx4 a[120:123], v16, s[8:11], s64 offen offset:0 sc1
    buffer_load_dwordx4 a[124:127], v16, s[8:11], s64 offen offset:1024 sc1
    buffer_load_dwordx4 a[128:131], v16, s[8:11], s64 offen offset:2048 sc1
    s_add_u32 s64, s64, 45056
    s_add_u32 s65, s64, 4096
    buffer_load_dwordx4 a[132:135], v10, s[8:11], s64 offen offset:0 sc1
    buffer_load_dwordx4 a[136:139], v10, s[8:11], s64 offen offset:1024 sc1
    buffer_load_dwordx4 a[140:143], v10, s[8:11], s64 offen offset:2048 sc1
    buffer_load_dwordx4 a[144:147], v10, s[8:11], s64 offen offset:3072 sc1
    buffer_load_dwordx4 a[148:151], v10, s[8:11], s65 offen offset:0 sc1
    buffer_load_dwordx4 a[152:155], v10, s[8:11], s65 offen offset:1024 sc1
    buffer_load_dwordx4 a[156:159], v10, s[8:11], s65 offen offset:2048 sc1
    buffer_load_dwordx4 a[160:163], v10, s[8:11], s65 offen offset:3072 sc1
    buffer_load_dwordx4 a[164:167], v16, s[8:11], s64 offen offset:0 sc1
    buffer_load_dwordx4 a[168:171], v16, s[8:11], s64 offen offset:1024 sc1
    buffer_load_dwordx4 a[172:175], v16, s[8:11], s64 offen offset:2048 sc1
    s_add_u32 s64, s64, 45056
    s_add_u32 s65, s64, 4096
    buffer_load_dwordx4 a[176:179], v10, s[8:11], s64 offen offset:0 sc1
    buffer_load_dwordx4 a[180:183], v10, s[8:11], s64 offen offset:1024 sc1
    buffer_load_dwordx4 a[184:187], v10, s[8:11], s64 offen offset:2048 sc1
    buffer_load_dwordx4 a[188:191], v10, s[8:11], s64 offen offset:3072 sc1
    buffer_load_dwordx4 a[192:195], v10, s[8:11], s65 offen offset:0 sc1
    buffer_load_dwordx4 a[196:199], v10, s[8:11], s65 offen offset:1024 sc1
    buffer_load_dwordx4 a[200:203], v10, s[8:11], s65 offen offset:2048 sc1
    buffer_load_dwordx4 a[204:207], v10, s[8:11], s65 offen offset:3072 sc1
    buffer_load_dwordx4 a[208:211], v16, s[8:11], s64 offen offset:0 sc1
    buffer_load_dwordx4 a[212:215], v16, s[8:11], s64 offen offset:1024 sc1
    buffer_load_dwordx4 a[216:219], v16, s[8:11], s64 offen offset:2048 sc1
T2_nu_77:
    s_add_u32 s51, s51, 4
    s_mul_i32 s57, s48, 40960
    s_lshl_b32 s32, s50, 5
    s_add_u32 s57, s57, s32
    buffer_load_dwordx2 v[32:33], v19, s[24:27], s57 offen offset:0
    buffer_load_dwordx2 v[34:35], v19, s[24:27], s57 offen offset:64
    buffer_load_dwordx2 v[36:37], v21, s[24:27], s57 offen offset:128
    s_mul_hi_u32 s47, s48, 0x55555556
    s_mul_i32 s55, s48, 655360
    s_mul_i32 s46, s47, 131072
    s_add_u32 s55, s55, s46
    s_andn2_b32 s47, 1, s47
    s_lshl_b32 s47, s47, 13
    s_xor_b32 s47, s47, s96
    s_add_u32 s55, s55, s47
    s_add_u32 s55, s55, 0xb000000
    s_lshl_b32 s36, s50, 14
    s_add_u32 s64, s55, s36
    s_add_u32 s65, s64, 16384
    s_add_u32 s66, s64, 32768
    s_add_u32 s67, s64, 49152
    s_add_u32 s68, s64, 65536
    s_mul_i32 s70, s48, 81920
    s_add_u32 s70, s70, 0xa821000
    s_add_u32 s71, s70, 2560
    s_add_u32 s72, s70, 5120
    s_add_u32 s73, s70, 7680
    s_add_u32 s74, s70, 10240
    s_add_u32 s75, s70, 12800
    s_add_u32 s76, s70, 15360
    s_add_u32 s77, s70, 17920
    s_waitcnt vmcnt(0)
    s_add_u32 s63, s48, 1
    s_andn2_b32 s47, 1, s63
    s_lshl_b32 s47, s47, 9
    s_add_u32 s47, s47, s99
    s_branch door_ck_82
door_ag_83:
    s_cmp_eq_u32 s52, 0
    s_cbranch_scc1 door_lt_84
    s_sub_u32 s52, s52, 1
    buffer_load_dword v14, v15, s[8:11], s47 offen offset:0 sc1
    s_sleep 4
door_ck_82:
    s_memrealtime s[44:45]
    v_readlane_b32 s62, v14, 0
    v_readlane_b32 s41, v14, 1
    v_readlane_b32 s42, v14, 2
    v_readlane_b32 s43, v14, 3
    s_sub_u32 s40, s41, s62
    s_and_b32 s40, s40, 0x8000007f
    s_cmp_eq_u32 s40, 0
    s_cmov_b32 s62, s41
    s_sub_u32 s40, s42, s62
    s_and_b32 s40, s40, 0x8000007f
    s_cmp_eq_u32 s40, 0
    s_cmov_b32 s62, s42
    s_sub_u32 s40, s43, s62
    s_and_b32 s40, s40, 0x8000007f
    s_cmp_eq_u32 s40, 0
    s_cmov_b32 s62, s43
    s_add_u32 s46, s62, 1
    s_and_b32 s46, s46, 127
    s_add_u32 s62, s62, 0xc80
    s_waitcnt lgkmcnt(0)
    s_lshl_b32 s44, s44, 7
    s_cmp_lt_u32 s46, s63
    s_cbranch_scc1 door_ag_83
    s_cmp_gt_u32 s46, s63
    s_cbranch_scc1 door_lt_84
    s_sub_u32 s45, s44, s62
    s_cmp_lt_i32 s45, 0xfffff100
    s_cbranch_scc1 door_ag_83
    s_cmp_ge_i32 s45, 0
    s_cbranch_scc1 door_ok_81
door_md_85:
    s_cmp_ge_i32 s45, 0xfffffb00
    s_cbranch_scc1 door_80
    s_sleep 1
    s_memrealtime s[44:45]
    s_waitcnt lgkmcnt(0)
    s_lshl_b32 s44, s44, 7
    s_sub_u32 s45, s44, s62
    s_branch door_md_85
door_80:
    s_memrealtime s[44:45]
    s_waitcnt lgkmcnt(0)
    s_lshl_b32 s44, s44, 7
    s_sub_u32 s45, s44, s62
    s_cmp_lt_i32 s45, 0
    s_cbranch_scc1 door_80
    s_branch door_ok_81
door_lt_84:
    s_mov_b32 s62, s44
door_ok_81:
T2_c_88:
    buffer_load_dwordx4 v[64:67], v17, s[8:11], s70 offen offset:0 sc1
    buffer_load_dwordx4 v[68:71], v17, s[8:11], s70 offen offset:1024 sc1
    buffer_load_dwordx4 v[72:75], v17, s[8:11], s71 offen offset:0 sc1
    buffer_load_dwordx4 v[76:79], v17, s[8:11], s71 offen offset:1024 sc1
    buffer_load_dwordx4 v[80:83], v17, s[8:11], s72 offen offset:0 sc1
    buffer_load_dwordx4 v[84:87], v17, s[8:11], s72 offen offset:1024 sc1
    buffer_load_dwordx4 v[88:91], v17, s[8:11], s73 offen offset:0 sc1
    buffer_load_dwordx4 v[92:95], v17, s[8:11], s73 offen offset:1024 sc1
    buffer_load_dwordx4 v[96:99], v17, s[8:11], s74 offen offset:0 sc1
    buffer_load_dwordx4 v[100:103], v17, s[8:11], s74 offen offset:1024 sc1
    v_mov_b32 v2, 0
    buffer_load_dwordx4 v[104:107], v17, s[8:11], s75 offen offset:0 sc1
    buffer_load_dwordx4 v[108:111], v17, s[8:11], s75 offen offset:1024 sc1
    v_mfma_f32_16x16x32_bf16 v[184:187], a[32:35], v[24:27], 0
    v_mfma_f32_16x16x32_bf16 v[192:195], a[76:79], v[24:27], 0
    v_mfma_f32_16x16x32_bf16 v[200:203], a[120:123], v[24:27], 0
    v_mfma_f32_16x16x32_bf16 v[208:211], a[164:167], v[24:27], 0
    v_mfma_f32_16x16x32_bf16 v[216:219], a[208:211], v[24:27], 0
    buffer_load_dwordx4 v[112:115], v17, s[8:11], s76 offen offset:0 sc1
    buffer_load_dwordx4 v[116:119], v17, s[8:11], s76 offen offset:1024 sc1
    v_mfma_f32_16x16x32_bf16 v[188:191], a[32:35], v[28:31], 0
    v_mfma_f32_16x16x32_bf16 v[196:199], a[76:79], v[28:31], 0
    v_mfma_f32_16x16x32_bf16 v[204:207], a[120:123], v[28:31], 0
    v_mfma_f32_16x16x32_bf16 v[212:215], a[164:167], v[28:31], 0
    v_mfma_f32_16x16x32_bf16 v[220:223], a[208:211], v[28:31], 0
    buffer_load_dwordx4 v[120:123], v17, s[8:11], s77 offen offset:0 sc1
    buffer_load_dwordx4 v[124:127], v17, s[8:11], s77 offen offset:1024 sc1
    v_mfma_f32_16x16x32_bf16 v[184:187], a[36:39], v[24:27], v[184:187]
    v_mfma_f32_16x16x32_bf16 v[192:195], a[80:83], v[24:27], v[192:195]
    v_mfma_f32_16x16x32_bf16 v[200:203], a[124:127], v[24:27], v[200:203]
    v_mfma_f32_16x16x32_bf16 v[208:211], a[168:171], v[24:27], v[208:211]
    v_mfma_f32_16x16x32_bf16 v[216:219], a[212:215], v[24:27], v[216:219]
    buffer_load_dwordx4 v[144:147], v9, s[8:11], s64 offen offset:0 sc1
    buffer_load_dwordx4 v[148:151], v9, s[8:11], s65 offen offset:0 sc1
    v_mfma_f32_16x16x32_bf16 v[188:191], a[36:39], v[28:31], v[188:191]
    v_mfma_f32_16x16x32_bf16 v[196:199], a[80:83], v[28:31], v[196:199]
    v_mfma_f32_16x16x32_bf16 v[204:207], a[124:127], v[28:31], v[204:207]
    v_mfma_f32_16x16x32_bf16 v[212:215], a[168:171], v[28:31], v[212:215]
    v_mfma_f32_16x16x32_bf16 v[220:223], a[212:215], v[28:31], v[220:223]
    buffer_load_dwordx4 v[152:155], v9, s[8:11], s66 offen offset:0 sc1
    buffer_load_dwordx4 v[156:159], v9, s[8:11], s67 offen offset:0 sc1
    v_mfma_f32_16x16x32_bf16 v[184:187], a[40:43], v[24:27], v[184:187]
    v_mfma_f32_16x16x32_bf16 v[192:195], a[84:87], v[24:27], v[192:195]
    v_mfma_f32_16x16x32_bf16 v[200:203], a[128:131], v[24:27], v[200:203]
    v_mfma_f32_16x16x32_bf16 v[208:211], a[172:175], v[24:27], v[208:211]
    v_mfma_f32_16x16x32_bf16 v[216:219], a[216:219], v[24:27], v[216:219]
    buffer_load_dwordx4 v[160:163], v9, s[8:11], s68 offen offset:0 sc1
    buffer_load_dwordx4 v[128:131], v18, s[8:11], s70 offen offset:0 sc1
    v_mfma_f32_16x16x32_bf16 v[188:191], a[40:43], v[28:31], v[188:191]
    v_mfma_f32_16x16x32_bf16 v[196:199], a[84:87], v[28:31], v[196:199]
    v_mfma_f32_16x16x32_bf16 v[204:207], a[128:131], v[28:31], v[204:207]
    v_mfma_f32_16x16x32_bf16 v[212:215], a[172:175], v[28:31], v[212:215]
    v_mfma_f32_16x16x32_bf16 v[220:223], a[216:219], v[28:31], v[220:223]
    buffer_load_dwordx4 v[132:135], v18, s[8:11], s70 offen offset:256 sc1
    buffer_load_dwordx4 v[164:167], v9, s[8:11], s64 offen offset:1024 sc1
    s_waitcnt vmcnt(23)
    v_mfma_f32_16x16x32_bf16 v[184:187], a[0:3], v[64:67], v[184:187]
    v_max3_u32 v2, v2, v64, v65
    v_max3_u32 v2, v2, v66, v67
    v_mfma_f32_16x16x32_bf16 v[192:195], a[44:47], v[64:67], v[192:195]
    v_mfma_f32_16x16x32_bf16 v[200:203], a[88:91], v[64:67], v[200:203]
    v_mfma_f32_16x16x32_bf16 v[208:211], a[132:135], v[64:67], v[208:211]
    v_mfma_f32_16x16x32_bf16 v[216:219], a[176:179], v[64:67], v[216:219]
    buffer_load_dwordx4 v[168:171], v9, s[8:11], s65 offen offset:1024 sc1
    buffer_load_dwordx4 v[172:175], v9, s[8:11], s66 offen offset:1024 sc1
    s_waitcnt vmcnt(24)
    v_mfma_f32_16x16x32_bf16 v[188:191], a[0:3], v[68:71], v[188:191]
    v_max3_u32 v2, v2, v68, v69
    v_max3_u32 v2, v2, v70, v71
    v_mfma_f32_16x16x32_bf16 v[196:199], a[44:47], v[68:71], v[196:199]
    v_mfma_f32_16x16x32_bf16 v[204:207], a[88:91], v[68:71], v[204:207]
    v_mfma_f32_16x16x32_bf16 v[212:215], a[132:135], v[68:71], v[212:215]
    v_mfma_f32_16x16x32_bf16 v[220:223], a[176:179], v[68:71], v[220:223]
    buffer_load_dwordx4 v[176:179], v9, s[8:11], s67 offen offset:1024 sc1
    buffer_load_dwordx4 v[180:183], v9, s[8:11], s68 offen offset:1024 sc1
    s_waitcnt vmcnt(25)
    v_mfma_f32_16x16x32_bf16 v[184:187], a[4:7], v[72:75], v[184:187]
    v_max3_u32 v2, v2, v72, v73
    v_max3_u32 v2, v2, v74, v75
    v_mfma_f32_16x16x32_bf16 v[192:195], a[48:51], v[72:75], v[192:195]
    v_mfma_f32_16x16x32_bf16 v[200:203], a[92:95], v[72:75], v[200:203]
    v_mfma_f32_16x16x32_bf16 v[208:211], a[136:139], v[72:75], v[208:211]
    v_mfma_f32_16x16x32_bf16 v[216:219], a[180:183], v[72:75], v[216:219]
    buffer_load_dwordx4 v[136:139], v18, s[8:11], s74 offen offset:0 sc1
    buffer_load_dwordx4 v[140:143], v18, s[8:11], s74 offen offset:256 sc1
    s_waitcnt vmcnt(26)
    v_mfma_f32_16x16x32_bf16 v[188:191], a[4:7], v[76:79], v[188:191]
    v_max3_u32 v2, v2, v76, v77
    v_max3_u32 v2, v2, v78, v79
    v_mfma_f32_16x16x32_bf16 v[196:199], a[48:51], v[76:79], v[196:199]
    v_mfma_f32_16x16x32_bf16 v[204:207], a[92:95], v[76:79], v[204:207]
    v_mfma_f32_16x16x32_bf16 v[212:215], a[136:139], v[76:79], v[212:215]
    v_mfma_f32_16x16x32_bf16 v[220:223], a[180:183], v[76:79], v[220:223]
    s_waitcnt vmcnt(25)
    v_mfma_f32_16x16x32_bf16 v[184:187], a[8:11], v[80:83], v[184:187]
    v_max3_u32 v2, v2, v80, v81
    v_max3_u32 v2, v2, v82, v83
    v_mfma_f32_16x16x32_bf16 v[192:195], a[52:55], v[80:83], v[192:195]
    v_mfma_f32_16x16x32_bf16 v[200:203], a[96:99], v[80:83], v[200:203]
    v_mfma_f32_16x16x32_bf16 v[208:211], a[140:143], v[80:83], v[208:211]
    v_mfma_f32_16x16x32_bf16 v[216:219], a[184:187], v[80:83], v[216:219]
    s_waitcnt vmcnt(24)
    v_mfma_f32_16x16x32_bf16 v[188:191], a[8:11], v[84:87], v[188:191]
    v_max3_u32 v2, v2, v84, v85
    v_max3_u32 v2, v2, v86, v87
    v_mfma_f32_16x16x32_bf16 v[196:199], a[52:55], v[84:87], v[196:199]
    v_mfma_f32_16x16x32_bf16 v[204:207], a[96:99], v[84:87], v[204:207]
    v_mfma_f32_16x16x32_bf16 v[212:215], a[140:143], v[84:87], v[212:215]
    v_mfma_f32_16x16x32_bf16 v[220:223], a[184:187], v[84:87], v[220:223]
    s_waitcnt vmcnt(23)
    v_mfma_f32_16x16x32_bf16 v[184:187], a[12:15], v[88:91], v[184:187]
    v_max3_u32 v2, v2, v88, v89
    v_max3_u32 v2, v2, v90, v91
    v_mfma_f32_16x16x32_bf16 v[192:195], a[56:59], v[88:91], v[192:195]
    v_mfma_f32_16x16x32_bf16 v[200:203], a[100:103], v[88:91], v[200:203]
    v_mfma_f32_16x16x32_bf16 v[208:211], a[144:147], v[88:91], v[208:211]
    v_mfma_f32_16x16x32_bf16 v[216:219], a[188:191], v[88:91], v[216:219]
    s_waitcnt vmcnt(22)
    v_mfma_f32_16x16x32_bf16 v[188:191], a[12:15], v[92:95], v[188:191]
    v_max3_u32 v2, v2, v92, v93
    v_max3_u32 v2, v2, v94, v95
    v_mfma_f32_16x16x32_bf16 v[196:199], a[56:59], v[92:95], v[196:199]
    v_mfma_f32_16x16x32_bf16 v[204:207], a[100:103], v[92:95], v[204:207]
    v_mfma_f32_16x16x32_bf16 v[212:215], a[144:147], v[92:95], v[212:215]
    v_mfma_f32_16x16x32_bf16 v[220:223], a[188:191], v[92:95], v[220:223]
    s_waitcnt vmcnt(21)
    v_mfma_f32_16x16x32_bf16 v[184:187], a[16:19], v[96:99], v[184:187]
    v_max3_u32 v2, v2, v96, v97
    v_max3_u32 v2, v2, v98, v99
    v_mfma_f32_16x16x32_bf16 v[192:195], a[60:63], v[96:99], v[192:195]
    v_mfma_f32_16x16x32_bf16 v[200:203], a[104:107], v[96:99], v[200:203]
    v_mfma_f32_16x16x32_bf16 v[208:211], a[148:151], v[96:99], v[208:211]
    v_mfma_f32_16x16x32_bf16 v[216:219], a[192:195], v[96:99], v[216:219]
    s_waitcnt vmcnt(20)
    v_mfma_f32_16x16x32_bf16 v[188:191], a[16:19], v[100:103], v[188:191]
    v_max3_u32 v2, v2, v100, v101
    v_max3_u32 v2, v2, v102, v103
    v_mfma_f32_16x16x32_bf16 v[196:199], a[60:63], v[100:103], v[196:199]
    v_mfma_f32_16x16x32_bf16 v[204:207], a[104:107], v[100:103], v[204:207]
    v_mfma_f32_16x16x32_bf16 v[212:215], a[148:151], v[100:103], v[212:215]
    v_mfma_f32_16x16x32_bf16 v[220:223], a[192:195], v[100:103], v[220:223]
    s_waitcnt vmcnt(19)
    v_mfma_f32_16x16x32_bf16 v[184:187], a[20:23], v[104:107], v[184:187]
    v_max3_u32 v2, v2, v104, v105
    v_max3_u32 v2, v2, v106, v107
    v_mfma_f32_16x16x32_bf16 v[192:195], a[64:67], v[104:107], v[192:195]
    v_mfma_f32_16x16x32_bf16 v[200:203], a[108:111], v[104:107], v[200:203]
    v_mfma_f32_16x16x32_bf16 v[208:211], a[152:155], v[104:107], v[208:211]
    v_mfma_f32_16x16x32_bf16 v[216:219], a[196:199], v[104:107], v[216:219]
    s_waitcnt vmcnt(18)
    v_mfma_f32_16x16x32_bf16 v[188:191], a[20:23], v[108:111], v[188:191]
    v_max3_u32 v2, v2, v108, v109
    v_max3_u32 v2, v2, v110, v111
    v_mfma_f32_16x16x32_bf16 v[196:199], a[64:67], v[108:111], v[196:199]
    v_mfma_f32_16x16x32_bf16 v[204:207], a[108:111], v[108:111], v[204:207]
    v_mfma_f32_16x16x32_bf16 v[212:215], a[152:155], v[108:111], v[212:215]
    v_mfma_f32_16x16x32_bf16 v[220:223], a[196:199], v[108:111], v[220:223]
    s_waitcnt vmcnt(17)
    v_mfma_f32_16x16x32_bf16 v[184:187], a[24:27], v[112:115], v[184:187]
    v_max3_u32 v2, v2, v112, v113
    v_max3_u32 v2, v2, v114, v115
    v_mfma_f32_16x16x32_bf16 v[192:195], a[68:71], v[112:115], v[192:195]
    v_mfma_f32_16x16x32_bf16 v[200:203], a[112:115], v[112:115], v[200:203]
    v_mfma_f32_16x16x32_bf16 v[208:211], a[156:159], v[112:115], v[208:211]
    v_mfma_f32_16x16x32_bf16 v[216:219], a[200:203], v[112:115], v[216:219]
    s_waitcnt vmcnt(16)
    v_mfma_f32_16x16x32_bf16 v[188:191], a[24:27], v[116:119], v[188:191]
    v_max3_u32 v2, v2, v116, v117
    v_max3_u32 v2, v2, v118, v119
    v_mfma_f32_16x16x32_bf16 v[196:199], a[68:71], v[116:119], v[196:199]
    v_mfma_f32_16x16x32_bf16 v[204:207], a[112:115], v[116:119], v[204:207]
    v_mfma_f32_16x16x32_bf16 v[212:215], a[156:159], v[116:119], v[212:215]
    v_mfma_f32_16x16x32_bf16 v[220:223], a[200:203], v[116:119], v[220:223]
    s_waitcnt vmcnt(15)
    v_mfma_f32_16x16x32_bf16 v[184:187], a[28:31], v[120:123], v[184:187]
    v_max3_u32 v2, v2, v120, v121
    v_max3_u32 v2, v2, v122, v123
    v_mfma_f32_16x16x32_bf16 v[192:195], a[72:75], v[120:123], v[192:195]
    v_mfma_f32_16x16x32_bf16 v[200:203], a[116:119], v[120:123], v[200:203]
    v_mfma_f32_16x16x32_bf16 v[208:211], a[160:163], v[120:123], v[208:211]
    v_mfma_f32_16x16x32_bf16 v[216:219], a[204:207], v[120:123], v[216:219]
    s_waitcnt vmcnt(14)
    v_mfma_f32_16x16x32_bf16 v[188:191], a[28:31], v[124:127], v[188:191]
    v_max3_u32 v2, v2, v124, v125
    v_max3_u32 v2, v2, v126, v127
    v_mfma_f32_16x16x32_bf16 v[196:199], a[72:75], v[124:127], v[196:199]
    v_mfma_f32_16x16x32_bf16 v[204:207], a[116:119], v[124:127], v[204:207]
    v_mfma_f32_16x16x32_bf16 v[212:215], a[160:163], v[124:127], v[212:215]
    v_mfma_f32_16x16x32_bf16 v[220:223], a[204:207], v[124:127], v[220:223]
    s_waitcnt vmcnt(8)
    v_mfma_f32_16x16x32_bf16 v[184:187], v[144:147], v[128:131], v[184:187]
    v_max3_u32 v2, v2, v128, v129
    v_max3_u32 v2, v2, v130, v131
    v_mfma_f32_16x16x32_bf16 v[192:195], v[148:151], v[128:131], v[192:195]
    v_max3_u32 v2, v2, v144, v145
    v_max3_u32 v2, v2, v146, v147
    v_mfma_f32_16x16x32_bf16 v[200:203], v[152:155], v[128:131], v[200:203]
    v_max3_u32 v2, v2, v148, v149
    v_max3_u32 v2, v2, v150, v151
    v_mfma_f32_16x16x32_bf16 v[208:211], v[156:159], v[128:131], v[208:211]
    v_max3_u32 v2, v2, v152, v153
    v_mfma_f32_16x16x32_bf16 v[216:219], v[160:163], v[128:131], v[216:219]
    s_waitcnt vmcnt(7)
    v_mfma_f32_16x16x32_bf16 v[188:191], v[144:147], v[132:135], v[188:191]
    v_max3_u32 v2, v2, v132, v133
    v_max3_u32 v2, v2, v134, v135
    v_mfma_f32_16x16x32_bf16 v[196:199], v[148:151], v[132:135], v[196:199]
    v_max3_u32 v2, v2, v154, v155
    v_max3_u32 v2, v2, v156, v157
    v_mfma_f32_16x16x32_bf16 v[204:207], v[152:155], v[132:135], v[204:207]
    v_max3_u32 v2, v2, v158, v159
    v_max3_u32 v2, v2, v160, v161
    v_mfma_f32_16x16x32_bf16 v[212:215], v[156:159], v[132:135], v[212:215]
    v_max3_u32 v2, v2, v162, v163
    v_mfma_f32_16x16x32_bf16 v[220:223], v[160:163], v[132:135], v[220:223]
    s_waitcnt vmcnt(1)
    v_mfma_f32_16x16x32_bf16 v[184:187], v[164:167], v[136:139], v[184:187]
    v_max3_u32 v2, v2, v136, v137
    v_max3_u32 v2, v2, v138, v139
    v_mfma_f32_16x16x32_bf16 v[192:195], v[168:171], v[136:139], v[192:195]
    v_max3_u32 v2, v2, v164, v165
    v_max3_u32 v2, v2, v166, v167
    v_mfma_f32_16x16x32_bf16 v[200:203], v[172:175], v[136:139], v[200:203]
    v_max3_u32 v2, v2, v168, v169
    v_max3_u32 v2, v2, v170, v171
    v_mfma_f32_16x16x32_bf16 v[208:211], v[176:179], v[136:139], v[208:211]
    v_max3_u32 v2, v2, v172, v173
    v_mfma_f32_16x16x32_bf16 v[216:219], v[180:183], v[136:139], v[216:219]
    s_waitcnt vmcnt(0)
    v_mfma_f32_16x16x32_bf16 v[188:191], v[164:167], v[140:143], v[188:191]
    v_max3_u32 v2, v2, v140, v141
    v_max3_u32 v2, v2, v142, v143
    v_mfma_f32_16x16x32_bf16 v[196:199], v[168:171], v[140:143], v[196:199]
    v_max3_u32 v2, v2, v174, v175
    v_max3_u32 v2, v2, v176, v177
    v_mfma_f32_16x16x32_bf16 v[204:207], v[172:175], v[140:143], v[204:207]
    v_max3_u32 v2, v2, v178, v179
    v_max3_u32 v2, v2, v180, v181
    v_mfma_f32_16x16x32_bf16 v[212:215], v[176:179], v[140:143], v[212:215]
    v_max3_u32 v2, v2, v182, v183
    v_mfma_f32_16x16x32_bf16 v[220:223], v[180:183], v[140:143], v[220:223]
    v_cmp_eq_u32 vcc, -1, v2
    s_cbranch_vccnz T2_rt_87
T2_ok_86:
    ds_write_b128 v12, v[184:187] offset:0
    ds_write_b128 v12, v[188:191] offset:4096
    ds_write_b128 v12, v[192:195] offset:8192
    ds_write_b128 v12, v[196:199] offset:12288
    ds_write_b128 v12, v[200:203] offset:16384
    ds_write_b128 v12, v[204:207] offset:20480
    ds_write_b128 v12, v[208:211] offset:24576
    ds_write_b128 v12, v[212:215] offset:28672
    ds_write_b128 v12, v[216:219] offset:32768
    ds_write_b128 v12, v[220:223] offset:36864
    s_waitcnt lgkmcnt(0)
    s_barrier
    ds_read_b128 v[48:51], v20 offset:0
    ds_read_b128 v[52:55], v20 offset:1024
    ds_read_b128 v[56:59], v20 offset:2048
    ds_read_b128 v[60:63], v20 offset:3072
    v_lshlrev_b32 v40, 16, v32
    v_and_b32 v41, s58, v32
    v_lshlrev_b32 v42, 16, v33
    v_and_b32 v43, s58, v33
    s_waitcnt lgkmcnt(3)
    v_pk_add_f32 v[40:41], v[40:41], v[48:49]
    v_pk_add_f32 v[42:43], v[42:43], v[50:51]
    s_waitcnt lgkmcnt(2)
    v_pk_add_f32 v[40:41], v[40:41], v[52:53]
    v_pk_add_f32 v[42:43], v[42:43], v[54:55]
    s_waitcnt lgkmcnt(1)
    v_pk_add_f32 v[40:41], v[40:41], v[56:57]
    v_pk_add_f32 v[42:43], v[42:43], v[58:59]
    s_waitcnt lgkmcnt(0)
    v_pk_add_f32 v[40:41], v[40:41], v[60:61]
    v_pk_add_f32 v[42:43], v[42:43], v[62:63]
    v_cvt_pk_bf16_f32 v44, v40, v41
    v_cvt_pk_bf16_f32 v45, v42, v43
    buffer_store_dwordx2 v[44:45], v19, s[28:31], s57 offen offset:0
    ds_read_b128 v[48:51], v20 offset:16384
    ds_read_b128 v[52:55], v20 offset:17408
    ds_read_b128 v[56:59], v20 offset:18432
    ds_read_b128 v[60:63], v20 offset:19456
    v_lshlrev_b32 v40, 16, v34
    v_and_b32 v41, s58, v34
    v_lshlrev_b32 v42, 16, v35
    v_and_b32 v43, s58, v35
    s_waitcnt lgkmcnt(3)
    v_pk_add_f32 v[40:41], v[40:41], v[48:49]
    v_pk_add_f32 v[42:43], v[42:43], v[50:51]
    s_waitcnt lgkmcnt(2)
    v_pk_add_f32 v[40:41], v[40:41], v[52:53]
    v_pk_add_f32 v[42:43], v[42:43], v[54:55]
    s_waitcnt lgkmcnt(1)
    v_pk_add_f32 v[40:41], v[40:41], v[56:57]
    v_pk_add_f32 v[42:43], v[42:43], v[58:59]
    s_waitcnt lgkmcnt(0)
    v_pk_add_f32 v[40:41], v[40:41], v[60:61]
    v_pk_add_f32 v[42:43], v[42:43], v[62:63]
    v_cvt_pk_bf16_f32 v46, v40, v41
    v_cvt_pk_bf16_f32 v47, v42, v43
    buffer_store_dwordx2 v[46:47], v19, s[28:31], s57 offen offset:64
    ds_read_b128 v[48:51], v20 offset:32768
    ds_read_b128 v[52:55], v20 offset:33792
    ds_read_b128 v[56:59], v20 offset:34816
    ds_read_b128 v[60:63], v20 offset:35840
    v_lshlrev_b32 v40, 16, v36
    v_and_b32 v41, s58, v36
    v_lshlrev_b32 v42, 16, v37
    v_and_b32 v43, s58, v37
    s_waitcnt lgkmcnt(3)
    v_pk_add_f32 v[40:41], v[40:41], v[48:49]
    v_pk_add_f32 v[42:43], v[42:43], v[50:51]
    s_waitcnt lgkmcnt(2)
    v_pk_add_f32 v[40:41], v[40:41], v[52:53]
    v_pk_add_f32 v[42:43], v[42:43], v[54:55]
    s_waitcnt lgkmcnt(1)
    v_pk_add_f32 v[40:41], v[40:41], v[56:57]
    v_pk_add_f32 v[42:43], v[42:43], v[58:59]
    s_waitcnt lgkmcnt(0)
    v_pk_add_f32 v[40:41], v[40:41], v[60:61]
    v_pk_add_f32 v[42:43], v[42:43], v[62:63]
    v_cvt_pk_bf16_f32 v44, v40, v41
    v_cvt_pk_bf16_f32 v45, v42, v43
    buffer_store_dwordx2 v[44:45], v21, s[28:31], s57 offen offset:128
    v_xor_b32 v12, 0x10000, v12
    v_xor_b32 v20, 0x10000, v20
    s_add_u32 s48, s48, 4
    s_cmp_ge_u32 s48, 64
    s_cbranch_scc1 T2_end
    s_branch T2_loop
T2_end:
    s_endpgm
T2_rt_87:
    s_nop 7
    s_cmp_eq_u32 s52, 0
    s_cbranch_scc1 T2_ok_86
    s_sub_u32 s52, s52, 1
    s_sleep 16
    s_waitcnt vmcnt(0)
    s_branch T2_c_88
A_start:
    s_mov_b32 s12, s68
    s_and_b32 s13, s69, 0xffff
    s_mov_b32 s14, 0x780000
    s_mov_b32 s15, 0x20000
    s_mov_b32 s16, s70
    s_and_b32 s17, s71, 0xffff
    s_mov_b32 s18, 0x780000
    s_mov_b32 s19, 0x20000
    s_mul_i32 s50, s6, 384
    s_lshl_b32 s54, s4, 10
    v_lshrrev_b32 v2, 5, v1
    v_lshlrev_b32 v2, 10, v2
    v_bfe_u32 v3, v1, 2, 3
    v_lshl_add_u32 v2, v3, 7, v2
    v_and_b32 v4, 3, v1
    v_lshl_add_u32 v2, v4, 3, v2
    v_lshrrev_b32 v3, 1, v3
    s_mul_i32 s32, s4, 1
    s_add_u32 s32, s32, 0
    s_lshr_b32 s33, s32, 2
    s_mul_i32 s33, s33, 8192
    v_add_u32 v4, s32, v3
    v_and_b32 v4, 3, v4
    v_lshl_add_u32 v4, v4, 5, v2
    v_add_u32 v6, s33, v4
    v_lshrrev_b32 v2, 3, v1
    v_bfe_u32 v3, v1, 1, 2
    v_lshrrev_b32 v4, 1, v2
    v_sub_u32 v3, v3, v4
    v_and_b32 v3, 3, v3
    v_and_b32 v4, 1, v1
    v_lshl_add_u32 v3, v3, 1, v4
    v_lshrrev_b32 v4, 2, v2
    v_lshlrev_b32 v4, 2, v4
    v_bfe_u32 v5, v2, 1, 1
    v_lshl_add_u32 v4, v5, 3, v4
    v_and_b32 v5, 1, v2
    v_add_u32 v4, v4, v5
    s_and_b32 s32, s4, 1
    s_lshl_b32 s32, s32, 4
    s_lshr_b32 s33, s4, 1
    s_lshl_b32 s33, s33, 1
    s_add_u32 s32, s32, s33
    v_add_u32 v4, s32, v4
    v_mul_u32_u24 v4, 12288, v4
    v_lshl_add_u32 v20, v3, 4, v4
    s_mul_i32 s32, s4, 24576
    s_add_u32 s32, s32, 65536
    v_lshl_add_u32 v7, v1, 4, s32
    s_cmp_eq_u32 s4, 0
    s_cbranch_scc1 A_ld_w0
    s_cmp_eq_u32 s4, 1
    s_cbranch_scc1 A_ld_w1
    s_cmp_eq_u32 s4, 2
    s_cbranch_scc1 A_ld_w2
    s_add_u32 m0, s54, 0
    s_add_u32 s32, s50, 0
    buffer_load_dwordx4 v20, s[12:15], s32 offen lds
    s_add_u32 m0, s54, 4096
    s_add_u32 s32, s50, 393216
    buffer_load_dwordx4 v20, s[12:15], s32 offen lds
    s_add_u32 m0, s54, 8192
    s_add_u32 s32, s50, 128
    buffer_load_dwordx4 v20, s[12:15], s32 offen lds
    s_add_u32 m0, s54, 12288
    s_add_u32 s32, s50, 393344
    buffer_load_dwordx4 v20, s[12:15], s32 offen lds
    s_add_u32 m0, s54, 16384
    s_add_u32 s32, s50, 256
    buffer_load_dwordx4 v20, s[12:15], s32 offen lds
    s_add_u32 m0, s54, 20480
    s_add_u32 s32, s50, 393472
    buffer_load_dwordx4 v20, s[12:15], s32 offen lds
    s_add_u32 m0, s54, 24576
    s_add_u32 s32, s50, 0
    buffer_load_dwordx4 v20, s[16:19], s32 offen lds
    s_add_u32 m0, s54, 28672
    s_add_u32 s32, s50, 393216
    buffer_load_dwordx4 v20, s[16:19], s32 offen lds
    s_add_u32 m0, s54, 32768
    s_add_u32 s32, s50, 128
    buffer_load_dwordx4 v20, s[16:19], s32 offen lds
    s_add_u32 m0, s54, 36864
    s_add_u32 s32, s50, 393344
    buffer_load_dwordx4 v20, s[16:19], s32 offen lds
    s_add_u32 m0, s54, 40960
    s_add_u32 s32, s50, 256
    buffer_load_dwordx4 v20, s[16:19], s32 offen lds
    s_add_u32 m0, s54, 45056
    s_add_u32 s32, s50, 393472
    buffer_load_dwordx4 v20, s[16:19], s32 offen lds
    s_add_u32 m0, s54, 49152
    s_add_u32 s32, s50, 786432
    buffer_load_dwordx4 v20, s[12:15], s32 offen lds
    s_add_u32 m0, s54, 53248
    s_add_u32 s32, s50, 1179648
    buffer_load_dwordx4 v20, s[12:15], s32 offen lds
    s_add_u32 m0, s54, 57344
    s_add_u32 s32, s50, 786560
    buffer_load_dwordx4 v20, s[12:15], s32 offen lds
    s_add_u32 m0, s54, 61440
    s_add_u32 s32, s50, 1179776
    buffer_load_dwordx4 v20, s[12:15], s32 offen lds
    s_add_u32 m0, s54, 65536
    s_add_u32 s32, s50, 786688
    buffer_load_dwordx4 v20, s[12:15], s32 offen lds
    s_add_u32 m0, s54, 69632
    s_add_u32 s32, s50, 1179904
    buffer_load_dwordx4 v20, s[12:15], s32 offen lds
    s_add_u32 m0, s54, 73728
    s_add_u32 s32, s50, 786432
    buffer_load_dwordx4 v20, s[16:19], s32 offen lds
    s_add_u32 m0, s54, 77824
    s_add_u32 s32, s50, 1179648
    buffer_load_dwordx4 v20, s[16:19], s32 offen lds
    s_add_u32 m0, s54, 81920
    s_add_u32 s32, s50, 786560
    buffer_load_dwordx4 v20, s[16:19], s32 offen lds
    s_add_u32 m0, s54, 86016
    s_add_u32 s32, s50, 1179776
    buffer_load_dwordx4 v20, s[16:19], s32 offen lds
    s_add_u32 m0, s54, 90112
    s_add_u32 s32, s50, 786688
    buffer_load_dwordx4 v20, s[16:19], s32 offen lds
    s_add_u32 m0, s54, 94208
    s_add_u32 s32, s50, 1179904
    buffer_load_dwordx4 v20, s[16:19], s32 offen lds
    s_add_u32 m0, s54, 98304
    s_add_u32 s32, s50, 1572864
    buffer_load_dwordx4 v20, s[12:15], s32 offen lds
    s_add_u32 m0, s54, 102400
    s_add_u32 s32, s50, 1966080
    buffer_load_dwordx4 v20, s[12:15], s32 offen lds
    s_add_u32 m0, s54, 106496
    s_add_u32 s32, s50, 1572992
    buffer_load_dwordx4 v20, s[12:15], s32 offen lds
    s_add_u32 m0, s54, 110592
    s_add_u32 s32, s50, 1966208
    buffer_load_dwordx4 v20, s[12:15], s32 offen lds
    s_add_u32 m0, s54, 114688
    s_add_u32 s32, s50, 1573120
    buffer_load_dwordx4 v20, s[12:15], s32 offen lds
    s_add_u32 m0, s54, 118784
    s_add_u32 s32, s50, 1966336
    buffer_load_dwordx4 v20, s[12:15], s32 offen lds
    s_add_u32 m0, s54, 122880
    s_add_u32 s32, s50, 1572864
    buffer_load_dwordx4 v20, s[16:19], s32 offen lds
    s_add_u32 m0, s54, 126976
    s_add_u32 s32, s50, 1966080
    buffer_load_dwordx4 v20, s[16:19], s32 offen lds
    s_add_u32 m0, s54, 131072
    s_add_u32 s32, s50, 1572992
    buffer_load_dwordx4 v20, s[16:19], s32 offen lds
    s_add_u32 m0, s54, 135168
    s_add_u32 s32, s50, 1966208
    buffer_load_dwordx4 v20, s[16:19], s32 offen lds
    s_add_u32 m0, s54, 139264
    s_add_u32 s32, s50, 1573120
    buffer_load_dwordx4 v20, s[16:19], s32 offen lds
    s_add_u32 m0, s54, 143360
    s_add_u32 s32, s50, 1966336
    buffer_load_dwordx4 v20, s[16:19], s32 offen lds
    s_waitcnt vmcnt(30)
    s_barrier
    ds_read_b64_tr_b16 a[96:97], v6 offset:0
    ds_read_b64_tr_b16 a[98:99], v6 offset:2048
    ds_read_b64_tr_b16 a[100:101], v6 offset:4096
    ds_read_b64_tr_b16 a[102:103], v6 offset:6144
    ds_read_b64_tr_b16 a[112:113], v6 offset:8192
    ds_read_b64_tr_b16 a[114:115], v6 offset:10240
    ds_read_b64_tr_b16 a[116:117], v6 offset:12288
    ds_read_b64_tr_b16 a[118:119], v6 offset:14336
    ds_read_b64_tr_b16 a[128:129], v6 offset:16384
    ds_read_b64_tr_b16 a[130:131], v6 offset:18432
    ds_read_b64_tr_b16 a[132:133], v6 offset:20480
    ds_read_b64_tr_b16 a[134:135], v6 offset:22528
    s_waitcnt lgkmcnt(4)
    s_waitcnt lgkmcnt(0)
    s_waitcnt vmcnt(24)
    s_barrier
    s_add_u32 m0, s54, 0
    s_add_u32 s32, s50, 2359296
    buffer_load_dwordx4 v20, s[12:15], s32 offen lds
    s_add_u32 m0, s54, 4096
    s_add_u32 s32, s50, 2752512
    buffer_load_dwordx4 v20, s[12:15], s32 offen lds
    s_add_u32 m0, s54, 8192
    s_add_u32 s32, s50, 2359424
    buffer_load_dwordx4 v20, s[12:15], s32 offen lds
    s_add_u32 m0, s54, 12288
    s_add_u32 s32, s50, 2752640
    buffer_load_dwordx4 v20, s[12:15], s32 offen lds
    s_add_u32 m0, s54, 16384
    s_add_u32 s32, s50, 2359552
    buffer_load_dwordx4 v20, s[12:15], s32 offen lds
    s_add_u32 m0, s54, 20480
    s_add_u32 s32, s50, 2752768
    buffer_load_dwordx4 v20, s[12:15], s32 offen lds
    ds_read_b64_tr_b16 a[104:105], v6 offset:24576
    ds_read_b64_tr_b16 a[106:107], v6 offset:26624
    ds_read_b64_tr_b16 a[108:109], v6 offset:28672
    ds_read_b64_tr_b16 a[110:111], v6 offset:30720
    ds_read_b64_tr_b16 a[120:121], v6 offset:32768
    ds_read_b64_tr_b16 a[122:123], v6 offset:34816
    ds_read_b64_tr_b16 a[124:125], v6 offset:36864
    ds_read_b64_tr_b16 a[126:127], v6 offset:38912
    ds_read_b64_tr_b16 a[136:137], v6 offset:40960
    ds_read_b64_tr_b16 a[138:139], v6 offset:43008
    ds_read_b64_tr_b16 a[140:141], v6 offset:45056
    ds_read_b64_tr_b16 a[142:143], v6 offset:47104
    s_waitcnt lgkmcnt(4)
    s_waitcnt lgkmcnt(0)
    s_waitcnt vmcnt(24)
    s_barrier
    s_add_u32 m0, s54, 24576
    s_add_u32 s32, s50, 2359296
    buffer_load_dwordx4 v20, s[16:19], s32 offen lds
    s_add_u32 m0, s54, 28672
    s_add_u32 s32, s50, 2752512
    buffer_load_dwordx4 v20, s[16:19], s32 offen lds
    s_add_u32 m0, s54, 32768
    s_add_u32 s32, s50, 2359424
    buffer_load_dwordx4 v20, s[16:19], s32 offen lds
    s_add_u32 m0, s54, 36864
    s_add_u32 s32, s50, 2752640
    buffer_load_dwordx4 v20, s[16:19], s32 offen lds
    s_add_u32 m0, s54, 40960
    s_add_u32 s32, s50, 2359552
    buffer_load_dwordx4 v20, s[16:19], s32 offen lds
    s_add_u32 m0, s54, 45056
    s_add_u32 s32, s50, 2752768
    buffer_load_dwordx4 v20, s[16:19], s32 offen lds
    ds_read_b64_tr_b16 a[144:145], v6 offset:49152
    ds_read_b64_tr_b16 a[146:147], v6 offset:51200
    ds_read_b64_tr_b16 a[148:149], v6 offset:53248
    ds_read_b64_tr_b16 a[150:151], v6 offset:55296
    ds_read_b64_tr_b16 a[160:161], v6 offset:57344
    ds_read_b64_tr_b16 a[162:163], v6 offset:59392
    ds_read_b64_tr_b16 a[164:165], v6 offset:61440
    ds_read_b64_tr_b16 a[166:167], v6 offset:63488
    v_add_u32 v9, 0x10000, v6
    ds_read_b64_tr_b16 a[176:177], v9 offset:0
    ds_read_b64_tr_b16 a[178:179], v9 offset:2048
    ds_read_b64_tr_b16 a[180:181], v9 offset:4096
    ds_read_b64_tr_b16 a[182:183], v9 offset:6144
    s_waitcnt lgkmcnt(4)
    s_waitcnt lgkmcnt(0)
    s_waitcnt vmcnt(24)
    s_barrier
    s_add_u32 m0, s54, 49152
    s_add_u32 s32, s50, 3145728
    buffer_load_dwordx4 v20, s[12:15], s32 offen lds
    s_add_u32 m0, s54, 53248
    s_add_u32 s32, s50, 3538944
    buffer_load_dwordx4 v20, s[12:15], s32 offen lds
    s_add_u32 m0, s54, 57344
    s_add_u32 s32, s50, 3145856
    buffer_load_dwordx4 v20, s[12:15], s32 offen lds
    s_add_u32 m0, s54, 61440
    s_add_u32 s32, s50, 3539072
    buffer_load_dwordx4 v20, s[12:15], s32 offen lds
    s_add_u32 m0, s54, 65536
    s_add_u32 s32, s50, 3145984
    buffer_load_dwordx4 v20, s[12:15], s32 offen lds
    s_add_u32 m0, s54, 69632
    s_add_u32 s32, s50, 3539200
    buffer_load_dwordx4 v20, s[12:15], s32 offen lds
    v_add_u32 v10, 0x10000, v6
    ds_read_b64_tr_b16 a[152:153], v10 offset:8192
    ds_read_b64_tr_b16 a[154:155], v10 offset:10240
    ds_read_b64_tr_b16 a[156:157], v10 offset:12288
    ds_read_b64_tr_b16 a[158:159], v10 offset:14336
    ds_read_b64_tr_b16 a[168:169], v10 offset:16384
    ds_read_b64_tr_b16 a[170:171], v10 offset:18432
    ds_read_b64_tr_b16 a[172:173], v10 offset:20480
    ds_read_b64_tr_b16 a[174:175], v10 offset:22528
    ds_read_b64_tr_b16 a[184:185], v10 offset:24576
    ds_read_b64_tr_b16 a[186:187], v10 offset:26624
    ds_read_b64_tr_b16 a[188:189], v10 offset:28672
    ds_read_b64_tr_b16 a[190:191], v10 offset:30720
    s_waitcnt lgkmcnt(4)
    s_waitcnt lgkmcnt(0)
    s_waitcnt vmcnt(24)
    s_barrier
    s_add_u32 m0, s54, 73728
    s_add_u32 s32, s50, 3145728
    buffer_load_dwordx4 v20, s[16:19], s32 offen lds
    s_add_u32 m0, s54, 77824
    s_add_u32 s32, s50, 3538944
    buffer_load_dwordx4 v20, s[16:19], s32 offen lds
    s_add_u32 m0, s54, 81920
    s_add_u32 s32, s50, 3145856
    buffer_load_dwordx4 v20, s[16:19], s32 offen lds
    s_add_u32 m0, s54, 86016
    s_add_u32 s32, s50, 3539072
    buffer_load_dwordx4 v20, s[16:19], s32 offen lds
    s_add_u32 m0, s54, 90112
    s_add_u32 s32, s50, 3145984
    buffer_load_dwordx4 v20, s[16:19], s32 offen lds
    s_add_u32 m0, s54, 94208
    s_add_u32 s32, s50, 3539200
    buffer_load_dwordx4 v20, s[16:19], s32 offen lds
    v_add_u32 v9, 0x18000, v6
    ds_read_b64_tr_b16 v[24:25], v9 offset:0
    ds_read_b64_tr_b16 v[26:27], v9 offset:2048
    ds_read_b64_tr_b16 v[28:29], v9 offset:4096
    ds_read_b64_tr_b16 v[30:31], v9 offset:6144
    ds_read_b64_tr_b16 v[40:41], v9 offset:8192
    ds_read_b64_tr_b16 v[42:43], v9 offset:10240
    ds_read_b64_tr_b16 v[44:45], v9 offset:12288
    ds_read_b64_tr_b16 v[46:47], v9 offset:14336
    ds_read_b64_tr_b16 v[56:57], v9 offset:16384
    ds_read_b64_tr_b16 v[58:59], v9 offset:18432
    ds_read_b64_tr_b16 v[60:61], v9 offset:20480
    ds_read_b64_tr_b16 v[62:63], v9 offset:22528
    s_waitcnt lgkmcnt(4)
    s_waitcnt lgkmcnt(0)
    s_waitcnt vmcnt(24)
    s_barrier
    s_add_u32 m0, s54, 98304
    s_add_u32 s32, s50, 3932160
    buffer_load_dwordx4 v20, s[12:15], s32 offen lds
    s_add_u32 m0, s54, 102400
    s_add_u32 s32, s50, 4325376
    buffer_load_dwordx4 v20, s[12:15], s32 offen lds
    s_add_u32 m0, s54, 106496
    s_add_u32 s32, s50, 3932288
    buffer_load_dwordx4 v20, s[12:15], s32 offen lds
    s_add_u32 m0, s54, 110592
    s_add_u32 s32, s50, 4325504
    buffer_load_dwordx4 v20, s[12:15], s32 offen lds
    s_add_u32 m0, s54, 114688
    s_add_u32 s32, s50, 3932416
    buffer_load_dwordx4 v20, s[12:15], s32 offen lds
    s_add_u32 m0, s54, 118784
    s_add_u32 s32, s50, 4325632
    buffer_load_dwordx4 v20, s[12:15], s32 offen lds
    v_add_u32 v10, 0x18000, v6
    ds_read_b64_tr_b16 v[32:33], v10 offset:24576
    ds_read_b64_tr_b16 v[34:35], v10 offset:26624
    ds_read_b64_tr_b16 v[36:37], v10 offset:28672
    ds_read_b64_tr_b16 v[38:39], v10 offset:30720
    v_add_u32 v9, 0x20000, v6
    ds_read_b64_tr_b16 v[48:49], v9 offset:0
    ds_read_b64_tr_b16 v[50:51], v9 offset:2048
    ds_read_b64_tr_b16 v[52:53], v9 offset:4096
    ds_read_b64_tr_b16 v[54:55], v9 offset:6144
    ds_read_b64_tr_b16 v[64:65], v9 offset:8192
    ds_read_b64_tr_b16 v[66:67], v9 offset:10240
    ds_read_b64_tr_b16 v[68:69], v9 offset:12288
    ds_read_b64_tr_b16 v[70:71], v9 offset:14336
    s_waitcnt lgkmcnt(4)
    s_waitcnt lgkmcnt(0)
    s_waitcnt vmcnt(24)
    s_barrier
    s_add_u32 m0, s54, 122880
    s_add_u32 s32, s50, 3932160
    buffer_load_dwordx4 v20, s[16:19], s32 offen lds
    s_add_u32 m0, s54, 126976
    s_add_u32 s32, s50, 4325376
    buffer_load_dwordx4 v20, s[16:19], s32 offen lds
    s_add_u32 m0, s54, 131072
    s_add_u32 s32, s50, 3932288
    buffer_load_dwordx4 v20, s[16:19], s32 offen lds
    s_add_u32 m0, s54, 135168
    s_add_u32 s32, s50, 4325504
    buffer_load_dwordx4 v20, s[16:19], s32 offen lds
    s_add_u32 m0, s54, 139264
    s_add_u32 s32, s50, 3932416
    buffer_load_dwordx4 v20, s[16:19], s32 offen lds
    s_add_u32 m0, s54, 143360
    s_add_u32 s32, s50, 4325632
    buffer_load_dwordx4 v20, s[16:19], s32 offen lds
    ds_read_b64_tr_b16 a[240:241], v6 offset:0
    ds_read_b64_tr_b16 a[242:243], v6 offset:2048
    ds_read_b64_tr_b16 a[244:245], v6 offset:4096
    ds_read_b64_tr_b16 a[246:247], v6 offset:6144
    ds_read_b64_tr_b16 v[128:129], v6 offset:8192
    ds_read_b64_tr_b16 v[130:131], v6 offset:10240
    ds_read_b64_tr_b16 v[132:133], v6 offset:12288
    ds_read_b64_tr_b16 v[134:135], v6 offset:14336
    ds_read_b64_tr_b16 v[144:145], v6 offset:16384
    ds_read_b64_tr_b16 v[146:147], v6 offset:18432
    ds_read_b64_tr_b16 v[148:149], v6 offset:20480
    ds_read_b64_tr_b16 v[150:151], v6 offset:22528
    s_waitcnt lgkmcnt(4)
    s_waitcnt lgkmcnt(0)
    s_waitcnt vmcnt(24)
    s_barrier
    s_add_u32 m0, s54, 0
    s_add_u32 s32, s50, 4718592
    buffer_load_dwordx4 v20, s[12:15], s32 offen lds
    s_add_u32 m0, s54, 4096
    s_add_u32 s32, s50, 5111808
    buffer_load_dwordx4 v20, s[12:15], s32 offen lds
    s_add_u32 m0, s54, 8192
    s_add_u32 s32, s50, 4718720
    buffer_load_dwordx4 v20, s[12:15], s32 offen lds
    s_add_u32 m0, s54, 12288
    s_add_u32 s32, s50, 5111936
    buffer_load_dwordx4 v20, s[12:15], s32 offen lds
    s_add_u32 m0, s54, 16384
    s_add_u32 s32, s50, 4718848
    buffer_load_dwordx4 v20, s[12:15], s32 offen lds
    s_add_u32 m0, s54, 20480
    s_add_u32 s32, s50, 5112064
    buffer_load_dwordx4 v20, s[12:15], s32 offen lds
    ds_read_b64_tr_b16 a[248:249], v6 offset:24576
    ds_read_b64_tr_b16 a[250:251], v6 offset:26624
    ds_read_b64_tr_b16 a[252:253], v6 offset:28672
    ds_read_b64_tr_b16 a[254:255], v6 offset:30720
    ds_read_b64_tr_b16 v[136:137], v6 offset:32768
    ds_read_b64_tr_b16 v[138:139], v6 offset:34816
    ds_read_b64_tr_b16 v[140:141], v6 offset:36864
    ds_read_b64_tr_b16 v[142:143], v6 offset:38912
    ds_read_b64_tr_b16 v[152:153], v6 offset:40960
    ds_read_b64_tr_b16 v[154:155], v6 offset:43008
    ds_read_b64_tr_b16 v[156:157], v6 offset:45056
    ds_read_b64_tr_b16 v[158:159], v6 offset:47104
    s_waitcnt lgkmcnt(4)
    s_waitcnt lgkmcnt(0)
    s_waitcnt vmcnt(24)
    s_barrier
    s_add_u32 m0, s54, 24576
    s_add_u32 s32, s50, 4718592
    buffer_load_dwordx4 v20, s[16:19], s32 offen lds
    s_add_u32 m0, s54, 28672
    s_add_u32 s32, s50, 5111808
    buffer_load_dwordx4 v20, s[16:19], s32 offen lds
    s_add_u32 m0, s54, 32768
    s_add_u32 s32, s50, 4718720
    buffer_load_dwordx4 v20, s[16:19], s32 offen lds
    s_add_u32 m0, s54, 36864
    s_add_u32 s32, s50, 5111936
    buffer_load_dwordx4 v20, s[16:19], s32 offen lds
    s_add_u32 m0, s54, 40960
    s_add_u32 s32, s50, 4718848
    buffer_load_dwordx4 v20, s[16:19], s32 offen lds
    s_add_u32 m0, s54, 45056
    s_add_u32 s32, s50, 5112064
    buffer_load_dwordx4 v20, s[16:19], s32 offen lds
    ds_read_b64_tr_b16 a[192:193], v6 offset:49152
    ds_read_b64_tr_b16 a[194:195], v6 offset:51200
    ds_read_b64_tr_b16 a[196:197], v6 offset:53248
    ds_read_b64_tr_b16 a[198:199], v6 offset:55296
    ds_read_b64_tr_b16 a[208:209], v6 offset:57344
    ds_read_b64_tr_b16 a[210:211], v6 offset:59392
    ds_read_b64_tr_b16 a[212:213], v6 offset:61440
    ds_read_b64_tr_b16 a[214:215], v6 offset:63488
    v_add_u32 v10, 0x10000, v6
    ds_read_b64_tr_b16 a[224:225], v10 offset:0
    ds_read_b64_tr_b16 a[226:227], v10 offset:2048
    ds_read_b64_tr_b16 a[228:229], v10 offset:4096
    ds_read_b64_tr_b16 a[230:231], v10 offset:6144
    s_waitcnt lgkmcnt(4)
    s_waitcnt lgkmcnt(0)
    s_waitcnt vmcnt(24)
    s_barrier
    s_add_u32 m0, s54, 49152
    s_add_u32 s32, s50, 5505024
    buffer_load_dwordx4 v20, s[12:15], s32 offen lds
    s_add_u32 m0, s54, 53248
    s_add_u32 s32, s50, 5898240
    buffer_load_dwordx4 v20, s[12:15], s32 offen lds
    s_add_u32 m0, s54, 57344
    s_add_u32 s32, s50, 5505152
    buffer_load_dwordx4 v20, s[12:15], s32 offen lds
    s_add_u32 m0, s54, 61440
    s_add_u32 s32, s50, 5898368
    buffer_load_dwordx4 v20, s[12:15], s32 offen lds
    s_add_u32 m0, s54, 65536
    s_add_u32 s32, s50, 5505280
    buffer_load_dwordx4 v20, s[12:15], s32 offen lds
    s_add_u32 m0, s54, 69632
    s_add_u32 s32, s50, 5898496
    buffer_load_dwordx4 v20, s[12:15], s32 offen lds
    v_add_u32 v9, 0x10000, v6
    ds_read_b64_tr_b16 a[200:201], v9 offset:8192
    ds_read_b64_tr_b16 a[202:203], v9 offset:10240
    ds_read_b64_tr_b16 a[204:205], v9 offset:12288
    ds_read_b64_tr_b16 a[206:207], v9 offset:14336
    ds_read_b64_tr_b16 a[216:217], v9 offset:16384
    ds_read_b64_tr_b16 a[218:219], v9 offset:18432
    ds_read_b64_tr_b16 a[220:221], v9 offset:20480
    ds_read_b64_tr_b16 a[222:223], v9 offset:22528
    ds_read_b64_tr_b16 a[232:233], v9 offset:24576
    ds_read_b64_tr_b16 a[234:235], v9 offset:26624
    ds_read_b64_tr_b16 a[236:237], v9 offset:28672
    ds_read_b64_tr_b16 a[238:239], v9 offset:30720
    s_waitcnt lgkmcnt(4)
    s_waitcnt lgkmcnt(0)
    s_waitcnt vmcnt(24)
    s_barrier
    s_add_u32 m0, s54, 73728
    s_add_u32 s32, s50, 5505024
    buffer_load_dwordx4 v20, s[16:19], s32 offen lds
    s_add_u32 m0, s54, 77824
    s_add_u32 s32, s50, 5898240
    buffer_load_dwordx4 v20, s[16:19], s32 offen lds
    s_add_u32 m0, s54, 81920
    s_add_u32 s32, s50, 5505152
    buffer_load_dwordx4 v20, s[16:19], s32 offen lds
    s_add_u32 m0, s54, 86016
    s_add_u32 s32, s50, 5898368
    buffer_load_dwordx4 v20, s[16:19], s32 offen lds
    s_add_u32 m0, s54, 90112
    s_add_u32 s32, s50, 5505280
    buffer_load_dwordx4 v20, s[16:19], s32 offen lds
    s_add_u32 m0, s54, 94208
    s_add_u32 s32, s50, 5898496
    buffer_load_dwordx4 v20, s[16:19], s32 offen lds
    v_add_u32 v10, 0x18000, v6
    ds_read_b64_tr_b16 a[0:1], v10 offset:0
    ds_read_b64_tr_b16 a[2:3], v10 offset:2048
    ds_read_b64_tr_b16 a[4:5], v10 offset:4096
    ds_read_b64_tr_b16 a[6:7], v10 offset:6144
    ds_read_b64_tr_b16 a[16:17], v10 offset:8192
    ds_read_b64_tr_b16 a[18:19], v10 offset:10240
    ds_read_b64_tr_b16 a[20:21], v10 offset:12288
    ds_read_b64_tr_b16 a[22:23], v10 offset:14336
    ds_read_b64_tr_b16 a[32:33], v10 offset:16384
    ds_read_b64_tr_b16 a[34:35], v10 offset:18432
    ds_read_b64_tr_b16 a[36:37], v10 offset:20480
    ds_read_b64_tr_b16 a[38:39], v10 offset:22528
    s_waitcnt lgkmcnt(4)
    s_waitcnt lgkmcnt(0)
    s_waitcnt vmcnt(24)
    s_barrier
    s_add_u32 m0, s54, 98304
    s_add_u32 s32, s50, 6291456
    buffer_load_dwordx4 v20, s[12:15], s32 offen lds
    s_add_u32 m0, s54, 102400
    s_add_u32 s32, s50, 6684672
    buffer_load_dwordx4 v20, s[12:15], s32 offen lds
    s_add_u32 m0, s54, 106496
    s_add_u32 s32, s50, 6291584
    buffer_load_dwordx4 v20, s[12:15], s32 offen lds
    s_add_u32 m0, s54, 110592
    s_add_u32 s32, s50, 6684800
    buffer_load_dwordx4 v20, s[12:15], s32 offen lds
    s_add_u32 m0, s54, 114688
    s_add_u32 s32, s50, 6291712
    buffer_load_dwordx4 v20, s[12:15], s32 offen lds
    s_add_u32 m0, s54, 118784
    s_add_u32 s32, s50, 6684928
    buffer_load_dwordx4 v20, s[12:15], s32 offen lds
    v_add_u32 v9, 0x18000, v6
    ds_read_b64_tr_b16 a[8:9], v9 offset:24576
    ds_read_b64_tr_b16 a[10:11], v9 offset:26624
    ds_read_b64_tr_b16 a[12:13], v9 offset:28672
    ds_read_b64_tr_b16 a[14:15], v9 offset:30720
    v_add_u32 v10, 0x20000, v6
    ds_read_b64_tr_b16 a[24:25], v10 offset:0
    ds_read_b64_tr_b16 a[26:27], v10 offset:2048
    ds_read_b64_tr_b16 a[28:29], v10 offset:4096
    ds_read_b64_tr_b16 a[30:31], v10 offset:6144
    ds_read_b64_tr_b16 a[40:41], v10 offset:8192
    ds_read_b64_tr_b16 a[42:43], v10 offset:10240
    ds_read_b64_tr_b16 a[44:45], v10 offset:12288
    ds_read_b64_tr_b16 a[46:47], v10 offset:14336
    s_waitcnt lgkmcnt(4)
    s_waitcnt lgkmcnt(0)
    s_waitcnt vmcnt(24)
    s_barrier
    s_add_u32 m0, s54, 122880
    s_add_u32 s32, s50, 6291456
    buffer_load_dwordx4 v20, s[16:19], s32 offen lds
    s_add_u32 m0, s54, 126976
    s_add_u32 s32, s50, 6684672
    buffer_load_dwordx4 v20, s[16:19], s32 offen lds
    s_add_u32 m0, s54, 131072
    s_add_u32 s32, s50, 6291584
    buffer_load_dwordx4 v20, s[16:19], s32 offen lds
    s_add_u32 m0, s54, 135168
    s_add_u32 s32, s50, 6684800
    buffer_load_dwordx4 v20, s[16:19], s32 offen lds
    s_add_u32 m0, s54, 139264
    s_add_u32 s32, s50, 6291712
    buffer_load_dwordx4 v20, s[16:19], s32 offen lds
    s_add_u32 m0, s54, 143360
    s_add_u32 s32, s50, 6684928
    buffer_load_dwordx4 v20, s[16:19], s32 offen lds
    ds_read_b64_tr_b16 v[72:73], v6 offset:0
    ds_read_b64_tr_b16 v[74:75], v6 offset:2048
    ds_read_b64_tr_b16 v[76:77], v6 offset:4096
    ds_read_b64_tr_b16 v[78:79], v6 offset:6144
    ds_read_b64_tr_b16 v[88:89], v6 offset:8192
    ds_read_b64_tr_b16 v[90:91], v6 offset:10240
    ds_read_b64_tr_b16 v[92:93], v6 offset:12288
    ds_read_b64_tr_b16 v[94:95], v6 offset:14336
    ds_read_b64_tr_b16 v[104:105], v6 offset:16384
    ds_read_b64_tr_b16 v[106:107], v6 offset:18432
    ds_read_b64_tr_b16 v[108:109], v6 offset:20480
    ds_read_b64_tr_b16 v[110:111], v6 offset:22528
    s_waitcnt lgkmcnt(4)
    s_waitcnt lgkmcnt(0)
    s_waitcnt vmcnt(24)
    s_barrier
    s_add_u32 m0, s54, 0
    s_add_u32 s32, s50, 7077888
    buffer_load_dwordx4 v20, s[12:15], s32 offen lds
    s_add_u32 m0, s54, 4096
    s_add_u32 s32, s50, 7471104
    buffer_load_dwordx4 v20, s[12:15], s32 offen lds
    s_add_u32 m0, s54, 8192
    s_add_u32 s32, s50, 7078016
    buffer_load_dwordx4 v20, s[12:15], s32 offen lds
    s_add_u32 m0, s54, 12288
    s_add_u32 s32, s50, 7471232
    buffer_load_dwordx4 v20, s[12:15], s32 offen lds
    s_add_u32 m0, s54, 16384
    s_add_u32 s32, s50, 7078144
    buffer_load_dwordx4 v20, s[12:15], s32 offen lds
    s_add_u32 m0, s54, 20480
    s_add_u32 s32, s50, 7471360
    buffer_load_dwordx4 v20, s[12:15], s32 offen lds
    ds_read_b64_tr_b16 v[80:81], v6 offset:24576
    ds_read_b64_tr_b16 v[82:83], v6 offset:26624
    ds_read_b64_tr_b16 v[84:85], v6 offset:28672
    ds_read_b64_tr_b16 v[86:87], v6 offset:30720
    ds_read_b64_tr_b16 v[96:97], v6 offset:32768
    ds_read_b64_tr_b16 v[98:99], v6 offset:34816
    ds_read_b64_tr_b16 v[100:101], v6 offset:36864
    ds_read_b64_tr_b16 v[102:103], v6 offset:38912
    ds_read_b64_tr_b16 v[112:113], v6 offset:40960
    ds_read_b64_tr_b16 v[114:115], v6 offset:43008
    ds_read_b64_tr_b16 v[116:117], v6 offset:45056
    ds_read_b64_tr_b16 v[118:119], v6 offset:47104
    s_waitcnt lgkmcnt(4)
    s_waitcnt lgkmcnt(0)
    s_waitcnt vmcnt(24)
    s_barrier
    s_add_u32 m0, s54, 24576
    s_add_u32 s32, s50, 7077888
    buffer_load_dwordx4 v20, s[16:19], s32 offen lds
    s_add_u32 m0, s54, 28672
    s_add_u32 s32, s50, 7471104
    buffer_load_dwordx4 v20, s[16:19], s32 offen lds
    s_add_u32 m0, s54, 32768
    s_add_u32 s32, s50, 7078016
    buffer_load_dwordx4 v20, s[16:19], s32 offen lds
    s_add_u32 m0, s54, 36864
    s_add_u32 s32, s50, 7471232
    buffer_load_dwordx4 v20, s[16:19], s32 offen lds
    s_add_u32 m0, s54, 40960
    s_add_u32 s32, s50, 7078144
    buffer_load_dwordx4 v20, s[16:19], s32 offen lds
    s_add_u32 m0, s54, 45056
    s_add_u32 s32, s50, 7471360
    buffer_load_dwordx4 v20, s[16:19], s32 offen lds
    s_mov_b32 s28, s88
    s_and_b32 s29, s89, 0xffff
    s_mov_b32 s30, 0x100
    s_mov_b32 s31, 0x20000
    v_mov_b32 v2, 0
    buffer_load_dword v3, v2, s[28:31], 0 offen offset:60 sc1
    ds_read_b64_tr_b16 v[208:209], v6 offset:49152
    ds_read_b64_tr_b16 v[210:211], v6 offset:51200
    ds_read_b64_tr_b16 v[212:213], v6 offset:53248
    ds_read_b64_tr_b16 v[214:215], v6 offset:55296
    ds_read_b64_tr_b16 v[224:225], v6 offset:57344
    ds_read_b64_tr_b16 v[226:227], v6 offset:59392
    ds_read_b64_tr_b16 v[228:229], v6 offset:61440
    ds_read_b64_tr_b16 v[230:231], v6 offset:63488
    v_add_u32 v9, 0x10000, v6
    ds_read_b64_tr_b16 v[240:241], v9 offset:0
    ds_read_b64_tr_b16 v[242:243], v9 offset:2048
    ds_read_b64_tr_b16 v[244:245], v9 offset:4096
    ds_read_b64_tr_b16 v[246:247], v9 offset:6144
    s_waitcnt lgkmcnt(4)
    s_waitcnt lgkmcnt(0)
    s_waitcnt vmcnt(25)
    s_barrier
    v_add_u32 v10, 0x10000, v6
    ds_read_b64_tr_b16 v[216:217], v10 offset:8192
    ds_read_b64_tr_b16 v[218:219], v10 offset:10240
    ds_read_b64_tr_b16 v[220:221], v10 offset:12288
    ds_read_b64_tr_b16 v[222:223], v10 offset:14336
    ds_read_b64_tr_b16 v[232:233], v10 offset:16384
    ds_read_b64_tr_b16 v[234:235], v10 offset:18432
    ds_read_b64_tr_b16 v[236:237], v10 offset:20480
    ds_read_b64_tr_b16 v[238:239], v10 offset:22528
    ds_read_b64_tr_b16 v[248:249], v10 offset:24576
    ds_read_b64_tr_b16 v[250:251], v10 offset:26624
    ds_read_b64_tr_b16 v[252:253], v10 offset:28672
    ds_read_b64_tr_b16 v[254:255], v10 offset:30720
    s_waitcnt lgkmcnt(4)
    s_waitcnt lgkmcnt(0)
    s_waitcnt vmcnt(19)
    s_barrier
    v_add_u32 v9, 0x18000, v6
    ds_read_b64_tr_b16 v[160:161], v9 offset:0
    ds_read_b64_tr_b16 v[162:163], v9 offset:2048
    ds_read_b64_tr_b16 v[164:165], v9 offset:4096
    ds_read_b64_tr_b16 v[166:167], v9 offset:6144
    ds_read_b64_tr_b16 v[176:177], v9 offset:8192
    ds_read_b64_tr_b16 v[178:179], v9 offset:10240
    ds_read_b64_tr_b16 v[180:181], v9 offset:12288
    ds_read_b64_tr_b16 v[182:183], v9 offset:14336
    ds_read_b64_tr_b16 v[192:193], v9 offset:16384
    ds_read_b64_tr_b16 v[194:195], v9 offset:18432
    ds_read_b64_tr_b16 v[196:197], v9 offset:20480
    ds_read_b64_tr_b16 v[198:199], v9 offset:22528
    s_waitcnt lgkmcnt(4)
    s_waitcnt lgkmcnt(0)
    s_waitcnt vmcnt(13)
    s_barrier
    v_add_u32 v10, 0x18000, v6
    ds_read_b64_tr_b16 v[168:169], v10 offset:24576
    ds_read_b64_tr_b16 v[170:171], v10 offset:26624
    ds_read_b64_tr_b16 v[172:173], v10 offset:28672
    ds_read_b64_tr_b16 v[174:175], v10 offset:30720
    v_add_u32 v9, 0x20000, v6
    ds_read_b64_tr_b16 v[184:185], v9 offset:0
    ds_read_b64_tr_b16 v[186:187], v9 offset:2048
    ds_read_b64_tr_b16 v[188:189], v9 offset:4096
    ds_read_b64_tr_b16 v[190:191], v9 offset:6144
    ds_read_b64_tr_b16 v[200:201], v9 offset:8192
    ds_read_b64_tr_b16 v[202:203], v9 offset:10240
    ds_read_b64_tr_b16 v[204:205], v9 offset:12288
    ds_read_b64_tr_b16 v[206:207], v9 offset:14336
    s_waitcnt lgkmcnt(4)
    s_waitcnt lgkmcnt(0)
    s_waitcnt vmcnt(7)
    s_barrier
    ds_read_b64_tr_b16 a[48:49], v6 offset:0
    ds_read_b64_tr_b16 a[50:51], v6 offset:2048
    ds_read_b64_tr_b16 a[52:53], v6 offset:4096
    ds_read_b64_tr_b16 a[54:55], v6 offset:6144
    ds_read_b64_tr_b16 a[64:65], v6 offset:8192
    ds_read_b64_tr_b16 a[66:67], v6 offset:10240
    ds_read_b64_tr_b16 a[68:69], v6 offset:12288
    ds_read_b64_tr_b16 a[70:71], v6 offset:14336
    ds_read_b64_tr_b16 a[80:81], v6 offset:16384
    ds_read_b64_tr_b16 a[82:83], v6 offset:18432
    ds_read_b64_tr_b16 a[84:85], v6 offset:20480
    ds_read_b64_tr_b16 a[86:87], v6 offset:22528
    s_waitcnt lgkmcnt(4)
    s_waitcnt lgkmcnt(0)
    s_waitcnt vmcnt(1)
    s_barrier
    ds_read_b64_tr_b16 a[56:57], v6 offset:24576
    ds_read_b64_tr_b16 a[58:59], v6 offset:26624
    ds_read_b64_tr_b16 a[60:61], v6 offset:28672
    ds_read_b64_tr_b16 a[62:63], v6 offset:30720
    ds_read_b64_tr_b16 a[72:73], v6 offset:32768
    ds_read_b64_tr_b16 a[74:75], v6 offset:34816
    ds_read_b64_tr_b16 a[76:77], v6 offset:36864
    ds_read_b64_tr_b16 a[78:79], v6 offset:38912
    ds_read_b64_tr_b16 a[88:89], v6 offset:40960
    ds_read_b64_tr_b16 a[90:91], v6 offset:43008
    ds_read_b64_tr_b16 a[92:93], v6 offset:45056
    ds_read_b64_tr_b16 a[94:95], v6 offset:47104
    s_waitcnt lgkmcnt(4)
    s_waitcnt lgkmcnt(0)
    s_barrier
    s_branch A_ld_wx
A_ld_w0:
    s_add_u32 m0, s54, 0
    s_add_u32 s32, s50, 0
    buffer_load_dwordx4 v20, s[12:15], s32 offen lds
    s_add_u32 m0, s54, 4096
    s_add_u32 s32, s50, 393216
    buffer_load_dwordx4 v20, s[12:15], s32 offen lds
    s_add_u32 m0, s54, 8192
    s_add_u32 s32, s50, 128
    buffer_load_dwordx4 v20, s[12:15], s32 offen lds
    s_add_u32 m0, s54, 12288
    s_add_u32 s32, s50, 393344
    buffer_load_dwordx4 v20, s[12:15], s32 offen lds
    s_add_u32 m0, s54, 16384
    s_add_u32 s32, s50, 256
    buffer_load_dwordx4 v20, s[12:15], s32 offen lds
    s_add_u32 m0, s54, 20480
    s_add_u32 s32, s50, 393472
    buffer_load_dwordx4 v20, s[12:15], s32 offen lds
    s_add_u32 m0, s54, 24576
    s_add_u32 s32, s50, 0
    buffer_load_dwordx4 v20, s[16:19], s32 offen lds
    s_add_u32 m0, s54, 28672
    s_add_u32 s32, s50, 393216
    buffer_load_dwordx4 v20, s[16:19], s32 offen lds
    s_add_u32 m0, s54, 32768
    s_add_u32 s32, s50, 128
    buffer_load_dwordx4 v20, s[16:19], s32 offen lds
    s_add_u32 m0, s54, 36864
    s_add_u32 s32, s50, 393344
    buffer_load_dwordx4 v20, s[16:19], s32 offen lds
    s_add_u32 m0, s54, 40960
    s_add_u32 s32, s50, 256
    buffer_load_dwordx4 v20, s[16:19], s32 offen lds
    s_add_u32 m0, s54, 45056
    s_add_u32 s32, s50, 393472
    buffer_load_dwordx4 v20, s[16:19], s32 offen lds
    s_add_u32 m0, s54, 49152
    s_add_u32 s32, s50, 786432
    buffer_load_dwordx4 v20, s[12:15], s32 offen lds
    s_add_u32 m0, s54, 53248
    s_add_u32 s32, s50, 1179648
    buffer_load_dwordx4 v20, s[12:15], s32 offen lds
    s_add_u32 m0, s54, 57344
    s_add_u32 s32, s50, 786560
    buffer_load_dwordx4 v20, s[12:15], s32 offen lds
    s_add_u32 m0, s54, 61440
    s_add_u32 s32, s50, 1179776
    buffer_load_dwordx4 v20, s[12:15], s32 offen lds
    s_add_u32 m0, s54, 65536
    s_add_u32 s32, s50, 786688
    buffer_load_dwordx4 v20, s[12:15], s32 offen lds
    s_add_u32 m0, s54, 69632
    s_add_u32 s32, s50, 1179904
    buffer_load_dwordx4 v20, s[12:15], s32 offen lds
    s_add_u32 m0, s54, 73728
    s_add_u32 s32, s50, 786432
    buffer_load_dwordx4 v20, s[16:19], s32 offen lds
    s_add_u32 m0, s54, 77824
    s_add_u32 s32, s50, 1179648
    buffer_load_dwordx4 v20, s[16:19], s32 offen lds
    s_add_u32 m0, s54, 81920
    s_add_u32 s32, s50, 786560
    buffer_load_dwordx4 v20, s[16:19], s32 offen lds
    s_add_u32 m0, s54, 86016
    s_add_u32 s32, s50, 1179776
    buffer_load_dwordx4 v20, s[16:19], s32 offen lds
    s_add_u32 m0, s54, 90112
    s_add_u32 s32, s50, 786688
    buffer_load_dwordx4 v20, s[16:19], s32 offen lds
    s_add_u32 m0, s54, 94208
    s_add_u32 s32, s50, 1179904
    buffer_load_dwordx4 v20, s[16:19], s32 offen lds
    s_add_u32 m0, s54, 98304
    s_add_u32 s32, s50, 1572864
    buffer_load_dwordx4 v20, s[12:15], s32 offen lds
    s_add_u32 m0, s54, 102400
    s_add_u32 s32, s50, 1966080
    buffer_load_dwordx4 v20, s[12:15], s32 offen lds
    s_add_u32 m0, s54, 106496
    s_add_u32 s32, s50, 1572992
    buffer_load_dwordx4 v20, s[12:15], s32 offen lds
    s_add_u32 m0, s54, 110592
    s_add_u32 s32, s50, 1966208
    buffer_load_dwordx4 v20, s[12:15], s32 offen lds
    s_add_u32 m0, s54, 114688
    s_add_u32 s32, s50, 1573120
    buffer_load_dwordx4 v20, s[12:15], s32 offen lds
    s_add_u32 m0, s54, 118784
    s_add_u32 s32, s50, 1966336
    buffer_load_dwordx4 v20, s[12:15], s32 offen lds
    s_add_u32 m0, s54, 122880
    s_add_u32 s32, s50, 1572864
    buffer_load_dwordx4 v20, s[16:19], s32 offen lds
    s_add_u32 m0, s54, 126976
    s_add_u32 s32, s50, 1966080
    buffer_load_dwordx4 v20, s[16:19], s32 offen lds
    s_add_u32 m0, s54, 131072
    s_add_u32 s32, s50, 1572992
    buffer_load_dwordx4 v20, s[16:19], s32 offen lds
    s_add_u32 m0, s54, 135168
    s_add_u32 s32, s50, 1966208
    buffer_load_dwordx4 v20, s[16:19], s32 offen lds
    s_add_u32 m0, s54, 139264
    s_add_u32 s32, s50, 1573120
    buffer_load_dwordx4 v20, s[16:19], s32 offen lds
    s_add_u32 m0, s54, 143360
    s_add_u32 s32, s50, 1966336
    buffer_load_dwordx4 v20, s[16:19], s32 offen lds
    s_waitcnt vmcnt(30)
    s_barrier
    ds_read_b64_tr_b16 a[96:97], v6 offset:0
    ds_read_b64_tr_b16 a[98:99], v6 offset:2048
    ds_read_b64_tr_b16 a[100:101], v6 offset:4096
    ds_read_b64_tr_b16 a[102:103], v6 offset:6144
    ds_read_b64_tr_b16 a[112:113], v6 offset:8192
    ds_read_b64_tr_b16 a[114:115], v6 offset:10240
    ds_read_b64_tr_b16 a[116:117], v6 offset:12288
    ds_read_b64_tr_b16 a[118:119], v6 offset:14336
    ds_read_b64_tr_b16 a[128:129], v6 offset:16384
    ds_read_b64_tr_b16 a[130:131], v6 offset:18432
    ds_read_b64_tr_b16 a[132:133], v6 offset:20480
    ds_read_b64_tr_b16 a[134:135], v6 offset:22528
    s_waitcnt lgkmcnt(4)
    s_waitcnt lgkmcnt(0)
    s_waitcnt vmcnt(24)
    s_barrier
    s_add_u32 m0, s54, 0
    s_add_u32 s32, s50, 2359296
    buffer_load_dwordx4 v20, s[12:15], s32 offen lds
    s_add_u32 m0, s54, 4096
    s_add_u32 s32, s50, 2752512
    buffer_load_dwordx4 v20, s[12:15], s32 offen lds
    s_add_u32 m0, s54, 8192
    s_add_u32 s32, s50, 2359424
    buffer_load_dwordx4 v20, s[12:15], s32 offen lds
    s_add_u32 m0, s54, 12288
    s_add_u32 s32, s50, 2752640
    buffer_load_dwordx4 v20, s[12:15], s32 offen lds
    s_add_u32 m0, s54, 16384
    s_add_u32 s32, s50, 2359552
    buffer_load_dwordx4 v20, s[12:15], s32 offen lds
    s_add_u32 m0, s54, 20480
    s_add_u32 s32, s50, 2752768
    buffer_load_dwordx4 v20, s[12:15], s32 offen lds
    ds_read_b64_tr_b16 a[104:105], v6 offset:24576
    ds_read_b64_tr_b16 a[106:107], v6 offset:26624
    ds_read_b64_tr_b16 a[108:109], v6 offset:28672
    ds_read_b64_tr_b16 a[110:111], v6 offset:30720
    ds_read_b64_tr_b16 a[120:121], v6 offset:32768
    ds_read_b64_tr_b16 a[122:123], v6 offset:34816
    ds_read_b64_tr_b16 a[124:125], v6 offset:36864
    ds_read_b64_tr_b16 a[126:127], v6 offset:38912
    ds_read_b64_tr_b16 a[136:137], v6 offset:40960
    ds_read_b64_tr_b16 a[138:139], v6 offset:43008
    ds_read_b64_tr_b16 a[140:141], v6 offset:45056
    ds_read_b64_tr_b16 a[142:143], v6 offset:47104
    s_waitcnt lgkmcnt(4)
    s_waitcnt lgkmcnt(0)
    s_waitcnt vmcnt(24)
    s_barrier
    s_add_u32 m0, s54, 24576
    s_add_u32 s32, s50, 2359296
    buffer_load_dwordx4 v20, s[16:19], s32 offen lds
    s_add_u32 m0, s54, 28672
    s_add_u32 s32, s50, 2752512
    buffer_load_dwordx4 v20, s[16:19], s32 offen lds
    s_add_u32 m0, s54, 32768
    s_add_u32 s32, s50, 2359424
    buffer_load_dwordx4 v20, s[16:19], s32 offen lds
    s_add_u32 m0, s54, 36864
    s_add_u32 s32, s50, 2752640
    buffer_load_dwordx4 v20, s[16:19], s32 offen lds
    s_add_u32 m0, s54, 40960
    s_add_u32 s32, s50, 2359552
    buffer_load_dwordx4 v20, s[16:19], s32 offen lds
    s_add_u32 m0, s54, 45056
    s_add_u32 s32, s50, 2752768
    buffer_load_dwordx4 v20, s[16:19], s32 offen lds
    ds_read_b64_tr_b16 a[144:145], v6 offset:49152
    ds_read_b64_tr_b16 a[146:147], v6 offset:51200
    ds_read_b64_tr_b16 a[148:149], v6 offset:53248
    ds_read_b64_tr_b16 a[150:151], v6 offset:55296
    ds_read_b64_tr_b16 a[160:161], v6 offset:57344
    ds_read_b64_tr_b16 a[162:163], v6 offset:59392
    ds_read_b64_tr_b16 a[164:165], v6 offset:61440
    ds_read_b64_tr_b16 a[166:167], v6 offset:63488
    v_add_u32 v10, 0x10000, v6
    ds_read_b64_tr_b16 a[176:177], v10 offset:0
    ds_read_b64_tr_b16 a[178:179], v10 offset:2048
    ds_read_b64_tr_b16 a[180:181], v10 offset:4096
    ds_read_b64_tr_b16 a[182:183], v10 offset:6144
    s_waitcnt lgkmcnt(4)
    s_waitcnt lgkmcnt(0)
    s_waitcnt vmcnt(24)
    s_barrier
    s_add_u32 m0, s54, 49152
    s_add_u32 s32, s50, 3145728
    buffer_load_dwordx4 v20, s[12:15], s32 offen lds
    s_add_u32 m0, s54, 53248
    s_add_u32 s32, s50, 3538944
    buffer_load_dwordx4 v20, s[12:15], s32 offen lds
    s_add_u32 m0, s54, 57344
    s_add_u32 s32, s50, 3145856
    buffer_load_dwordx4 v20, s[12:15], s32 offen lds
    s_add_u32 m0, s54, 61440
    s_add_u32 s32, s50, 3539072
    buffer_load_dwordx4 v20, s[12:15], s32 offen lds
    s_add_u32 m0, s54, 65536
    s_add_u32 s32, s50, 3145984
    buffer_load_dwordx4 v20, s[12:15], s32 offen lds
    s_add_u32 m0, s54, 69632
    s_add_u32 s32, s50, 3539200
    buffer_load_dwordx4 v20, s[12:15], s32 offen lds
    v_add_u32 v9, 0x10000, v6
    ds_read_b64_tr_b16 a[152:153], v9 offset:8192
    ds_read_b64_tr_b16 a[154:155], v9 offset:10240
    ds_read_b64_tr_b16 a[156:157], v9 offset:12288
    ds_read_b64_tr_b16 a[158:159], v9 offset:14336
    ds_read_b64_tr_b16 a[168:169], v9 offset:16384
    ds_read_b64_tr_b16 a[170:171], v9 offset:18432
    ds_read_b64_tr_b16 a[172:173], v9 offset:20480
    ds_read_b64_tr_b16 a[174:175], v9 offset:22528
    ds_read_b64_tr_b16 a[184:185], v9 offset:24576
    ds_read_b64_tr_b16 a[186:187], v9 offset:26624
    ds_read_b64_tr_b16 a[188:189], v9 offset:28672
    ds_read_b64_tr_b16 a[190:191], v9 offset:30720
    s_waitcnt lgkmcnt(4)
    s_waitcnt lgkmcnt(0)
    s_waitcnt vmcnt(24)
    s_barrier
    s_add_u32 m0, s54, 73728
    s_add_u32 s32, s50, 3145728
    buffer_load_dwordx4 v20, s[16:19], s32 offen lds
    s_add_u32 m0, s54, 77824
    s_add_u32 s32, s50, 3538944
    buffer_load_dwordx4 v20, s[16:19], s32 offen lds
    s_add_u32 m0, s54, 81920
    s_add_u32 s32, s50, 3145856
    buffer_load_dwordx4 v20, s[16:19], s32 offen lds
    s_add_u32 m0, s54, 86016
    s_add_u32 s32, s50, 3539072
    buffer_load_dwordx4 v20, s[16:19], s32 offen lds
    s_add_u32 m0, s54, 90112
    s_add_u32 s32, s50, 3145984
    buffer_load_dwordx4 v20, s[16:19], s32 offen lds
    s_add_u32 m0, s54, 94208
    s_add_u32 s32, s50, 3539200
    buffer_load_dwordx4 v20, s[16:19], s32 offen lds
    v_add_u32 v10, 0x18000, v6
    ds_read_b64_tr_b16 a[0:1], v10 offset:0
    ds_read_b64_tr_b16 a[2:3], v10 offset:2048
    ds_read_b64_tr_b16 a[4:5], v10 offset:4096
    ds_read_b64_tr_b16 a[6:7], v10 offset:6144
    ds_read_b64_tr_b16 a[16:17], v10 offset:8192
    ds_read_b64_tr_b16 a[18:19], v10 offset:10240
    ds_read_b64_tr_b16 a[20:21], v10 offset:12288
    ds_read_b64_tr_b16 a[22:23], v10 offset:14336
    ds_read_b64_tr_b16 a[32:33], v10 offset:16384
    ds_read_b64_tr_b16 a[34:35], v10 offset:18432
    ds_read_b64_tr_b16 a[36:37], v10 offset:20480
    ds_read_b64_tr_b16 a[38:39], v10 offset:22528
    s_waitcnt lgkmcnt(4)
    s_waitcnt lgkmcnt(0)
    s_waitcnt vmcnt(24)
    s_barrier
    s_add_u32 m0, s54, 98304
    s_add_u32 s32, s50, 3932160
    buffer_load_dwordx4 v20, s[12:15], s32 offen lds
    s_add_u32 m0, s54, 102400
    s_add_u32 s32, s50, 4325376
    buffer_load_dwordx4 v20, s[12:15], s32 offen lds
    s_add_u32 m0, s54, 106496
    s_add_u32 s32, s50, 3932288
    buffer_load_dwordx4 v20, s[12:15], s32 offen lds
    s_add_u32 m0, s54, 110592
    s_add_u32 s32, s50, 4325504
    buffer_load_dwordx4 v20, s[12:15], s32 offen lds
    s_add_u32 m0, s54, 114688
    s_add_u32 s32, s50, 3932416
    buffer_load_dwordx4 v20, s[12:15], s32 offen lds
    s_add_u32 m0, s54, 118784
    s_add_u32 s32, s50, 4325632
    buffer_load_dwordx4 v20, s[12:15], s32 offen lds
    v_add_u32 v9, 0x18000, v6
    ds_read_b64_tr_b16 a[8:9], v9 offset:24576
    ds_read_b64_tr_b16 a[10:11], v9 offset:26624
    ds_read_b64_tr_b16 a[12:13], v9 offset:28672
    ds_read_b64_tr_b16 a[14:15], v9 offset:30720
    v_add_u32 v10, 0x20000, v6
    ds_read_b64_tr_b16 a[24:25], v10 offset:0
    ds_read_b64_tr_b16 a[26:27], v10 offset:2048
    ds_read_b64_tr_b16 a[28:29], v10 offset:4096
    ds_read_b64_tr_b16 a[30:31], v10 offset:6144
    ds_read_b64_tr_b16 a[40:41], v10 offset:8192
    ds_read_b64_tr_b16 a[42:43], v10 offset:10240
    ds_read_b64_tr_b16 a[44:45], v10 offset:12288
    ds_read_b64_tr_b16 a[46:47], v10 offset:14336
    s_waitcnt lgkmcnt(4)
    s_waitcnt lgkmcnt(0)
    s_waitcnt vmcnt(24)
    s_barrier
    s_add_u32 m0, s54, 122880
    s_add_u32 s32, s50, 3932160
    buffer_load_dwordx4 v20, s[16:19], s32 offen lds
    s_add_u32 m0, s54, 126976
    s_add_u32 s32, s50, 4325376
    buffer_load_dwordx4 v20, s[16:19], s32 offen lds
    s_add_u32 m0, s54, 131072
    s_add_u32 s32, s50, 3932288
    buffer_load_dwordx4 v20, s[16:19], s32 offen lds
    s_add_u32 m0, s54, 135168
    s_add_u32 s32, s50, 4325504
    buffer_load_dwordx4 v20, s[16:19], s32 offen lds
    s_add_u32 m0, s54, 139264
    s_add_u32 s32, s50, 3932416
    buffer_load_dwordx4 v20, s[16:19], s32 offen lds
    s_add_u32 m0, s54, 143360
    s_add_u32 s32, s50, 4325632
    buffer_load_dwordx4 v20, s[16:19], s32 offen lds
    ds_read_b64_tr_b16 a[192:193], v6 offset:0
    ds_read_b64_tr_b16 a[194:195], v6 offset:2048
    ds_read_b64_tr_b16 a[196:197], v6 offset:4096
    ds_read_b64_tr_b16 a[198:199], v6 offset:6144
    ds_read_b64_tr_b16 a[208:209], v6 offset:8192
    ds_read_b64_tr_b16 a[210:211], v6 offset:10240
    ds_read_b64_tr_b16 a[212:213], v6 offset:12288
    ds_read_b64_tr_b16 a[214:215], v6 offset:14336
    ds_read_b64_tr_b16 a[224:225], v6 offset:16384
    ds_read_b64_tr_b16 a[226:227], v6 offset:18432
    ds_read_b64_tr_b16 a[228:229], v6 offset:20480
    ds_read_b64_tr_b16 a[230:231], v6 offset:22528
    s_waitcnt lgkmcnt(4)
    s_waitcnt lgkmcnt(0)
    s_waitcnt vmcnt(24)
    s_barrier
    s_add_u32 m0, s54, 0
    s_add_u32 s32, s50, 4718592
    buffer_load_dwordx4 v20, s[12:15], s32 offen lds
    s_add_u32 m0, s54, 4096
    s_add_u32 s32, s50, 5111808
    buffer_load_dwordx4 v20, s[12:15], s32 offen lds
    s_add_u32 m0, s54, 8192
    s_add_u32 s32, s50, 4718720
    buffer_load_dwordx4 v20, s[12:15], s32 offen lds
    s_add_u32 m0, s54, 12288
    s_add_u32 s32, s50, 5111936
    buffer_load_dwordx4 v20, s[12:15], s32 offen lds
    s_add_u32 m0, s54, 16384
    s_add_u32 s32, s50, 4718848
    buffer_load_dwordx4 v20, s[12:15], s32 offen lds
    s_add_u32 m0, s54, 20480
    s_add_u32 s32, s50, 5112064
    buffer_load_dwordx4 v20, s[12:15], s32 offen lds
    ds_read_b64_tr_b16 a[200:201], v6 offset:24576
    ds_read_b64_tr_b16 a[202:203], v6 offset:26624
    ds_read_b64_tr_b16 a[204:205], v6 offset:28672
    ds_read_b64_tr_b16 a[206:207], v6 offset:30720
    ds_read_b64_tr_b16 a[216:217], v6 offset:32768
    ds_read_b64_tr_b16 a[218:219], v6 offset:34816
    ds_read_b64_tr_b16 a[220:221], v6 offset:36864
    ds_read_b64_tr_b16 a[222:223], v6 offset:38912
    ds_read_b64_tr_b16 a[232:233], v6 offset:40960
    ds_read_b64_tr_b16 a[234:235], v6 offset:43008
    ds_read_b64_tr_b16 a[236:237], v6 offset:45056
    ds_read_b64_tr_b16 a[238:239], v6 offset:47104
    s_waitcnt lgkmcnt(4)
    s_waitcnt lgkmcnt(0)
    s_waitcnt vmcnt(24)
    s_barrier
    s_add_u32 m0, s54, 24576
    s_add_u32 s32, s50, 4718592
    buffer_load_dwordx4 v20, s[16:19], s32 offen lds
    s_add_u32 m0, s54, 28672
    s_add_u32 s32, s50, 5111808
    buffer_load_dwordx4 v20, s[16:19], s32 offen lds
    s_add_u32 m0, s54, 32768
    s_add_u32 s32, s50, 4718720
    buffer_load_dwordx4 v20, s[16:19], s32 offen lds
    s_add_u32 m0, s54, 36864
    s_add_u32 s32, s50, 5111936
    buffer_load_dwordx4 v20, s[16:19], s32 offen lds
    s_add_u32 m0, s54, 40960
    s_add_u32 s32, s50, 4718848
    buffer_load_dwordx4 v20, s[16:19], s32 offen lds
    s_add_u32 m0, s54, 45056
    s_add_u32 s32, s50, 5112064
    buffer_load_dwordx4 v20, s[16:19], s32 offen lds
    ds_read_b64_tr_b16 a[240:241], v6 offset:49152
    ds_read_b64_tr_b16 a[242:243], v6 offset:51200
    ds_read_b64_tr_b16 a[244:245], v6 offset:53248
    ds_read_b64_tr_b16 a[246:247], v6 offset:55296
    ds_read_b64_tr_b16 v[128:129], v6 offset:57344
    ds_read_b64_tr_b16 v[130:131], v6 offset:59392
    ds_read_b64_tr_b16 v[132:133], v6 offset:61440
    ds_read_b64_tr_b16 v[134:135], v6 offset:63488
    v_add_u32 v9, 0x10000, v6
    ds_read_b64_tr_b16 v[144:145], v9 offset:0
    ds_read_b64_tr_b16 v[146:147], v9 offset:2048
    ds_read_b64_tr_b16 v[148:149], v9 offset:4096
    ds_read_b64_tr_b16 v[150:151], v9 offset:6144
    s_waitcnt lgkmcnt(4)
    s_waitcnt lgkmcnt(0)
    s_waitcnt vmcnt(24)
    s_barrier
    s_add_u32 m0, s54, 49152
    s_add_u32 s32, s50, 5505024
    buffer_load_dwordx4 v20, s[12:15], s32 offen lds
    s_add_u32 m0, s54, 53248
    s_add_u32 s32, s50, 5898240
    buffer_load_dwordx4 v20, s[12:15], s32 offen lds
    s_add_u32 m0, s54, 57344
    s_add_u32 s32, s50, 5505152
    buffer_load_dwordx4 v20, s[12:15], s32 offen lds
    s_add_u32 m0, s54, 61440
    s_add_u32 s32, s50, 5898368
    buffer_load_dwordx4 v20, s[12:15], s32 offen lds
    s_add_u32 m0, s54, 65536
    s_add_u32 s32, s50, 5505280
    buffer_load_dwordx4 v20, s[12:15], s32 offen lds
    s_add_u32 m0, s54, 69632
    s_add_u32 s32, s50, 5898496
    buffer_load_dwordx4 v20, s[12:15], s32 offen lds
    v_add_u32 v10, 0x10000, v6
    ds_read_b64_tr_b16 a[248:249], v10 offset:8192
    ds_read_b64_tr_b16 a[250:251], v10 offset:10240
    ds_read_b64_tr_b16 a[252:253], v10 offset:12288
    ds_read_b64_tr_b16 a[254:255], v10 offset:14336
    ds_read_b64_tr_b16 v[136:137], v10 offset:16384
    ds_read_b64_tr_b16 v[138:139], v10 offset:18432
    ds_read_b64_tr_b16 v[140:141], v10 offset:20480
    ds_read_b64_tr_b16 v[142:143], v10 offset:22528
    ds_read_b64_tr_b16 v[152:153], v10 offset:24576
    ds_read_b64_tr_b16 v[154:155], v10 offset:26624
    ds_read_b64_tr_b16 v[156:157], v10 offset:28672
    ds_read_b64_tr_b16 v[158:159], v10 offset:30720
    s_waitcnt lgkmcnt(4)
    s_waitcnt lgkmcnt(0)
    s_waitcnt vmcnt(24)
    s_barrier
    s_add_u32 m0, s54, 73728
    s_add_u32 s32, s50, 5505024
    buffer_load_dwordx4 v20, s[16:19], s32 offen lds
    s_add_u32 m0, s54, 77824
    s_add_u32 s32, s50, 5898240
    buffer_load_dwordx4 v20, s[16:19], s32 offen lds
    s_add_u32 m0, s54, 81920
    s_add_u32 s32, s50, 5505152
    buffer_load_dwordx4 v20, s[16:19], s32 offen lds
    s_add_u32 m0, s54, 86016
    s_add_u32 s32, s50, 5898368
    buffer_load_dwordx4 v20, s[16:19], s32 offen lds
    s_add_u32 m0, s54, 90112
    s_add_u32 s32, s50, 5505280
    buffer_load_dwordx4 v20, s[16:19], s32 offen lds
    s_add_u32 m0, s54, 94208
    s_add_u32 s32, s50, 5898496
    buffer_load_dwordx4 v20, s[16:19], s32 offen lds
    v_add_u32 v9, 0x18000, v6
    ds_read_b64_tr_b16 v[24:25], v9 offset:0
    ds_read_b64_tr_b16 v[26:27], v9 offset:2048
    ds_read_b64_tr_b16 v[28:29], v9 offset:4096
    ds_read_b64_tr_b16 v[30:31], v9 offset:6144
    ds_read_b64_tr_b16 v[40:41], v9 offset:8192
    ds_read_b64_tr_b16 v[42:43], v9 offset:10240
    ds_read_b64_tr_b16 v[44:45], v9 offset:12288
    ds_read_b64_tr_b16 v[46:47], v9 offset:14336
    ds_read_b64_tr_b16 v[56:57], v9 offset:16384
    ds_read_b64_tr_b16 v[58:59], v9 offset:18432
    ds_read_b64_tr_b16 v[60:61], v9 offset:20480
    ds_read_b64_tr_b16 v[62:63], v9 offset:22528
    s_waitcnt lgkmcnt(4)
    s_waitcnt lgkmcnt(0)
    s_waitcnt vmcnt(24)
    s_barrier
    s_add_u32 m0, s54, 98304
    s_add_u32 s32, s50, 6291456
    buffer_load_dwordx4 v20, s[12:15], s32 offen lds
    s_add_u32 m0, s54, 102400
    s_add_u32 s32, s50, 6684672
    buffer_load_dwordx4 v20, s[12:15], s32 offen lds
    s_add_u32 m0, s54, 106496
    s_add_u32 s32, s50, 6291584
    buffer_load_dwordx4 v20, s[12:15], s32 offen lds
    s_add_u32 m0, s54, 110592
    s_add_u32 s32, s50, 6684800
    buffer_load_dwordx4 v20, s[12:15], s32 offen lds
    s_add_u32 m0, s54, 114688
    s_add_u32 s32, s50, 6291712
    buffer_load_dwordx4 v20, s[12:15], s32 offen lds
    s_add_u32 m0, s54, 118784
    s_add_u32 s32, s50, 6684928
    buffer_load_dwordx4 v20, s[12:15], s32 offen lds
    v_add_u32 v10, 0x18000, v6
    ds_read_b64_tr_b16 v[32:33], v10 offset:24576
    ds_read_b64_tr_b16 v[34:35], v10 offset:26624
    ds_read_b64_tr_b16 v[36:37], v10 offset:28672
    ds_read_b64_tr_b16 v[38:39], v10 offset:30720
    v_add_u32 v9, 0x20000, v6
    ds_read_b64_tr_b16 v[48:49], v9 offset:0
    ds_read_b64_tr_b16 v[50:51], v9 offset:2048
    ds_read_b64_tr_b16 v[52:53], v9 offset:4096
    ds_read_b64_tr_b16 v[54:55], v9 offset:6144
    ds_read_b64_tr_b16 v[64:65], v9 offset:8192
    ds_read_b64_tr_b16 v[66:67], v9 offset:10240
    ds_read_b64_tr_b16 v[68:69], v9 offset:12288
    ds_read_b64_tr_b16 v[70:71], v9 offset:14336
    s_waitcnt lgkmcnt(4)
    s_waitcnt lgkmcnt(0)
    s_waitcnt vmcnt(24)
    s_barrier
    s_add_u32 m0, s54, 122880
    s_add_u32 s32, s50, 6291456
    buffer_load_dwordx4 v20, s[16:19], s32 offen lds
    s_add_u32 m0, s54, 126976
    s_add_u32 s32, s50, 6684672
    buffer_load_dwordx4 v20, s[16:19], s32 offen lds
    s_add_u32 m0, s54, 131072
    s_add_u32 s32, s50, 6291584
    buffer_load_dwordx4 v20, s[16:19], s32 offen lds
    s_add_u32 m0, s54, 135168
    s_add_u32 s32, s50, 6684800
    buffer_load_dwordx4 v20, s[16:19], s32 offen lds
    s_add_u32 m0, s54, 139264
    s_add_u32 s32, s50, 6291712
    buffer_load_dwordx4 v20, s[16:19], s32 offen lds
    s_add_u32 m0, s54, 143360
    s_add_u32 s32, s50, 6684928
    buffer_load_dwordx4 v20, s[16:19], s32 offen lds
    ds_read_b64_tr_b16 a[48:49], v6 offset:0
    ds_read_b64_tr_b16 a[50:51], v6 offset:2048
    ds_read_b64_tr_b16 a[52:53], v6 offset:4096
    ds_read_b64_tr_b16 a[54:55], v6 offset:6144
    ds_read_b64_tr_b16 a[64:65], v6 offset:8192
    ds_read_b64_tr_b16 a[66:67], v6 offset:10240
    ds_read_b64_tr_b16 a[68:69], v6 offset:12288
    ds_read_b64_tr_b16 a[70:71], v6 offset:14336
    ds_read_b64_tr_b16 a[80:81], v6 offset:16384
    ds_read_b64_tr_b16 a[82:83], v6 offset:18432
    ds_read_b64_tr_b16 a[84:85], v6 offset:20480
    ds_read_b64_tr_b16 a[86:87], v6 offset:22528
    s_waitcnt lgkmcnt(4)
    s_waitcnt lgkmcnt(0)
    s_waitcnt vmcnt(24)
    s_barrier
    s_add_u32 m0, s54, 0
    s_add_u32 s32, s50, 7077888
    buffer_load_dwordx4 v20, s[12:15], s32 offen lds
    s_add_u32 m0, s54, 4096
    s_add_u32 s32, s50, 7471104
    buffer_load_dwordx4 v20, s[12:15], s32 offen lds
    s_add_u32 m0, s54, 8192
    s_add_u32 s32, s50, 7078016
    buffer_load_dwordx4 v20, s[12:15], s32 offen lds
    s_add_u32 m0, s54, 12288
    s_add_u32 s32, s50, 7471232
    buffer_load_dwordx4 v20, s[12:15], s32 offen lds
    s_add_u32 m0, s54, 16384
    s_add_u32 s32, s50, 7078144
    buffer_load_dwordx4 v20, s[12:15], s32 offen lds
    s_add_u32 m0, s54, 20480
    s_add_u32 s32, s50, 7471360
    buffer_load_dwordx4 v20, s[12:15], s32 offen lds
    ds_read_b64_tr_b16 a[56:57], v6 offset:24576
    ds_read_b64_tr_b16 a[58:59], v6 offset:26624
    ds_read_b64_tr_b16 a[60:61], v6 offset:28672
    ds_read_b64_tr_b16 a[62:63], v6 offset:30720
    ds_read_b64_tr_b16 a[72:73], v6 offset:32768
    ds_read_b64_tr_b16 a[74:75], v6 offset:34816
    ds_read_b64_tr_b16 a[76:77], v6 offset:36864
    ds_read_b64_tr_b16 a[78:79], v6 offset:38912
    ds_read_b64_tr_b16 a[88:89], v6 offset:40960
    ds_read_b64_tr_b16 a[90:91], v6 offset:43008
    ds_read_b64_tr_b16 a[92:93], v6 offset:45056
    ds_read_b64_tr_b16 a[94:95], v6 offset:47104
    s_waitcnt lgkmcnt(4)
    s_waitcnt lgkmcnt(0)
    s_waitcnt vmcnt(24)
    s_barrier
    s_add_u32 m0, s54, 24576
    s_add_u32 s32, s50, 7077888
    buffer_load_dwordx4 v20, s[16:19], s32 offen lds
    s_add_u32 m0, s54, 28672
    s_add_u32 s32, s50, 7471104
    buffer_load_dwordx4 v20, s[16:19], s32 offen lds
    s_add_u32 m0, s54, 32768
    s_add_u32 s32, s50, 7078016
    buffer_load_dwordx4 v20, s[16:19], s32 offen lds
    s_add_u32 m0, s54, 36864
    s_add_u32 s32, s50, 7471232
    buffer_load_dwordx4 v20, s[16:19], s32 offen lds
    s_add_u32 m0, s54, 40960
    s_add_u32 s32, s50, 7078144
    buffer_load_dwordx4 v20, s[16:19], s32 offen lds
    s_add_u32 m0, s54, 45056
    s_add_u32 s32, s50, 7471360
    buffer_load_dwordx4 v20, s[16:19], s32 offen lds
    s_mov_b32 s28, s88
    s_and_b32 s29, s89, 0xffff
    s_mov_b32 s30, 0x100
    s_mov_b32 s31, 0x20000
    v_mov_b32 v2, 0
    buffer_load_dword v3, v2, s[28:31], 0 offen offset:60 sc1
    ds_read_b64_tr_b16 v[160:161], v6 offset:49152
    ds_read_b64_tr_b16 v[162:163], v6 offset:51200
    ds_read_b64_tr_b16 v[164:165], v6 offset:53248
    ds_read_b64_tr_b16 v[166:167], v6 offset:55296
    ds_read_b64_tr_b16 v[176:177], v6 offset:57344
    ds_read_b64_tr_b16 v[178:179], v6 offset:59392
    ds_read_b64_tr_b16 v[180:181], v6 offset:61440
    ds_read_b64_tr_b16 v[182:183], v6 offset:63488
    v_add_u32 v10, 0x10000, v6
    ds_read_b64_tr_b16 v[192:193], v10 offset:0
    ds_read_b64_tr_b16 v[194:195], v10 offset:2048
    ds_read_b64_tr_b16 v[196:197], v10 offset:4096
    ds_read_b64_tr_b16 v[198:199], v10 offset:6144
    s_waitcnt lgkmcnt(4)
    s_waitcnt lgkmcnt(0)
    s_waitcnt vmcnt(25)
    s_barrier
    v_add_u32 v9, 0x10000, v6
    ds_read_b64_tr_b16 v[168:169], v9 offset:8192
    ds_read_b64_tr_b16 v[170:171], v9 offset:10240
    ds_read_b64_tr_b16 v[172:173], v9 offset:12288
    ds_read_b64_tr_b16 v[174:175], v9 offset:14336
    ds_read_b64_tr_b16 v[184:185], v9 offset:16384
    ds_read_b64_tr_b16 v[186:187], v9 offset:18432
    ds_read_b64_tr_b16 v[188:189], v9 offset:20480
    ds_read_b64_tr_b16 v[190:191], v9 offset:22528
    ds_read_b64_tr_b16 v[200:201], v9 offset:24576
    ds_read_b64_tr_b16 v[202:203], v9 offset:26624
    ds_read_b64_tr_b16 v[204:205], v9 offset:28672
    ds_read_b64_tr_b16 v[206:207], v9 offset:30720
    s_waitcnt lgkmcnt(4)
    s_waitcnt lgkmcnt(0)
    s_waitcnt vmcnt(19)
    s_barrier
    v_add_u32 v10, 0x18000, v6
    ds_read_b64_tr_b16 v[208:209], v10 offset:0
    ds_read_b64_tr_b16 v[210:211], v10 offset:2048
    ds_read_b64_tr_b16 v[212:213], v10 offset:4096
    ds_read_b64_tr_b16 v[214:215], v10 offset:6144
    ds_read_b64_tr_b16 v[224:225], v10 offset:8192
    ds_read_b64_tr_b16 v[226:227], v10 offset:10240
    ds_read_b64_tr_b16 v[228:229], v10 offset:12288
    ds_read_b64_tr_b16 v[230:231], v10 offset:14336
    ds_read_b64_tr_b16 v[240:241], v10 offset:16384
    ds_read_b64_tr_b16 v[242:243], v10 offset:18432
    ds_read_b64_tr_b16 v[244:245], v10 offset:20480
    ds_read_b64_tr_b16 v[246:247], v10 offset:22528
    s_waitcnt lgkmcnt(4)
    s_waitcnt lgkmcnt(0)
    s_waitcnt vmcnt(13)
    s_barrier
    v_add_u32 v9, 0x18000, v6
    ds_read_b64_tr_b16 v[216:217], v9 offset:24576
    ds_read_b64_tr_b16 v[218:219], v9 offset:26624
    ds_read_b64_tr_b16 v[220:221], v9 offset:28672
    ds_read_b64_tr_b16 v[222:223], v9 offset:30720
    v_add_u32 v10, 0x20000, v6
    ds_read_b64_tr_b16 v[232:233], v10 offset:0
    ds_read_b64_tr_b16 v[234:235], v10 offset:2048
    ds_read_b64_tr_b16 v[236:237], v10 offset:4096
    ds_read_b64_tr_b16 v[238:239], v10 offset:6144
    ds_read_b64_tr_b16 v[248:249], v10 offset:8192
    ds_read_b64_tr_b16 v[250:251], v10 offset:10240
    ds_read_b64_tr_b16 v[252:253], v10 offset:12288
    ds_read_b64_tr_b16 v[254:255], v10 offset:14336
    s_waitcnt lgkmcnt(4)
    s_waitcnt lgkmcnt(0)
    s_waitcnt vmcnt(7)
    s_barrier
    ds_read_b64_tr_b16 v[72:73], v6 offset:0
    ds_read_b64_tr_b16 v[74:75], v6 offset:2048
    ds_read_b64_tr_b16 v[76:77], v6 offset:4096
    ds_read_b64_tr_b16 v[78:79], v6 offset:6144
    ds_read_b64_tr_b16 v[88:89], v6 offset:8192
    ds_read_b64_tr_b16 v[90:91], v6 offset:10240
    ds_read_b64_tr_b16 v[92:93], v6 offset:12288
    ds_read_b64_tr_b16 v[94:95], v6 offset:14336
    ds_read_b64_tr_b16 v[104:105], v6 offset:16384
    ds_read_b64_tr_b16 v[106:107], v6 offset:18432
    ds_read_b64_tr_b16 v[108:109], v6 offset:20480
    ds_read_b64_tr_b16 v[110:111], v6 offset:22528
    s_waitcnt lgkmcnt(4)
    s_waitcnt lgkmcnt(0)
    s_waitcnt vmcnt(1)
    s_barrier
    ds_read_b64_tr_b16 v[80:81], v6 offset:24576
    ds_read_b64_tr_b16 v[82:83], v6 offset:26624
    ds_read_b64_tr_b16 v[84:85], v6 offset:28672
    ds_read_b64_tr_b16 v[86:87], v6 offset:30720
    ds_read_b64_tr_b16 v[96:97], v6 offset:32768
    ds_read_b64_tr_b16 v[98:99], v6 offset:34816
    ds_read_b64_tr_b16 v[100:101], v6 offset:36864
    ds_read_b64_tr_b16 v[102:103], v6 offset:38912
    ds_read_b64_tr_b16 v[112:113], v6 offset:40960
    ds_read_b64_tr_b16 v[114:115], v6 offset:43008
    ds_read_b64_tr_b16 v[116:117], v6 offset:45056
    ds_read_b64_tr_b16 v[118:119], v6 offset:47104
    s_waitcnt lgkmcnt(4)
    s_waitcnt lgkmcnt(0)
    s_barrier
    s_branch A_ld_wx
A_ld_w1:
    s_add_u32 m0, s54, 0
    s_add_u32 s32, s50, 0
    buffer_load_dwordx4 v20, s[12:15], s32 offen lds
    s_add_u32 m0, s54, 4096
    s_add_u32 s32, s50, 393216
    buffer_load_dwordx4 v20, s[12:15], s32 offen lds
    s_add_u32 m0, s54, 8192
    s_add_u32 s32, s50, 128
    buffer_load_dwordx4 v20, s[12:15], s32 offen lds
    s_add_u32 m0, s54, 12288
    s_add_u32 s32, s50, 393344
    buffer_load_dwordx4 v20, s[12:15], s32 offen lds
    s_add_u32 m0, s54, 16384
    s_add_u32 s32, s50, 256
    buffer_load_dwordx4 v20, s[12:15], s32 offen lds
    s_add_u32 m0, s54, 20480
    s_add_u32 s32, s50, 393472
    buffer_load_dwordx4 v20, s[12:15], s32 offen lds
    s_add_u32 m0, s54, 24576
    s_add_u32 s32, s50, 0
    buffer_load_dwordx4 v20, s[16:19], s32 offen lds
    s_add_u32 m0, s54, 28672
    s_add_u32 s32, s50, 393216
    buffer_load_dwordx4 v20, s[16:19], s32 offen lds
    s_add_u32 m0, s54, 32768
    s_add_u32 s32, s50, 128
    buffer_load_dwordx4 v20, s[16:19], s32 offen lds
    s_add_u32 m0, s54, 36864
    s_add_u32 s32, s50, 393344
    buffer_load_dwordx4 v20, s[16:19], s32 offen lds
    s_add_u32 m0, s54, 40960
    s_add_u32 s32, s50, 256
    buffer_load_dwordx4 v20, s[16:19], s32 offen lds
    s_add_u32 m0, s54, 45056
    s_add_u32 s32, s50, 393472
    buffer_load_dwordx4 v20, s[16:19], s32 offen lds
    s_add_u32 m0, s54, 49152
    s_add_u32 s32, s50, 786432
    buffer_load_dwordx4 v20, s[12:15], s32 offen lds
    s_add_u32 m0, s54, 53248
    s_add_u32 s32, s50, 1179648
    buffer_load_dwordx4 v20, s[12:15], s32 offen lds
    s_add_u32 m0, s54, 57344
    s_add_u32 s32, s50, 786560
    buffer_load_dwordx4 v20, s[12:15], s32 offen lds
    s_add_u32 m0, s54, 61440
    s_add_u32 s32, s50, 1179776
    buffer_load_dwordx4 v20, s[12:15], s32 offen lds
    s_add_u32 m0, s54, 65536
    s_add_u32 s32, s50, 786688
    buffer_load_dwordx4 v20, s[12:15], s32 offen lds
    s_add_u32 m0, s54, 69632
    s_add_u32 s32, s50, 1179904
    buffer_load_dwordx4 v20, s[12:15], s32 offen lds
    s_add_u32 m0, s54, 73728
    s_add_u32 s32, s50, 786432
    buffer_load_dwordx4 v20, s[16:19], s32 offen lds
    s_add_u32 m0, s54, 77824
    s_add_u32 s32, s50, 1179648
    buffer_load_dwordx4 v20, s[16:19], s32 offen lds
    s_add_u32 m0, s54, 81920
    s_add_u32 s32, s50, 786560
    buffer_load_dwordx4 v20, s[16:19], s32 offen lds
    s_add_u32 m0, s54, 86016
    s_add_u32 s32, s50, 1179776
    buffer_load_dwordx4 v20, s[16:19], s32 offen lds
    s_add_u32 m0, s54, 90112
    s_add_u32 s32, s50, 786688
    buffer_load_dwordx4 v20, s[16:19], s32 offen lds
    s_add_u32 m0, s54, 94208
    s_add_u32 s32, s50, 1179904
    buffer_load_dwordx4 v20, s[16:19], s32 offen lds
    s_add_u32 m0, s54, 98304
    s_add_u32 s32, s50, 1572864
    buffer_load_dwordx4 v20, s[12:15], s32 offen lds
    s_add_u32 m0, s54, 102400
    s_add_u32 s32, s50, 1966080
    buffer_load_dwordx4 v20, s[12:15], s32 offen lds
    s_add_u32 m0, s54, 106496
    s_add_u32 s32, s50, 1572992
    buffer_load_dwordx4 v20, s[12:15], s32 offen lds
    s_add_u32 m0, s54, 110592
    s_add_u32 s32, s50, 1966208
    buffer_load_dwordx4 v20, s[12:15], s32 offen lds
    s_add_u32 m0, s54, 114688
    s_add_u32 s32, s50, 1573120
    buffer_load_dwordx4 v20, s[12:15], s32 offen lds
    s_add_u32 m0, s54, 118784
    s_add_u32 s32, s50, 1966336
    buffer_load_dwordx4 v20, s[12:15], s32 offen lds
    s_add_u32 m0, s54, 122880
    s_add_u32 s32, s50, 1572864
    buffer_load_dwordx4 v20, s[16:19], s32 offen lds
    s_add_u32 m0, s54, 126976
    s_add_u32 s32, s50, 1966080
    buffer_load_dwordx4 v20, s[16:19], s32 offen lds
    s_add_u32 m0, s54, 131072
    s_add_u32 s32, s50, 1572992
    buffer_load_dwordx4 v20, s[16:19], s32 offen lds
    s_add_u32 m0, s54, 135168
    s_add_u32 s32, s50, 1966208
    buffer_load_dwordx4 v20, s[16:19], s32 offen lds
    s_add_u32 m0, s54, 139264
    s_add_u32 s32, s50, 1573120
    buffer_load_dwordx4 v20, s[16:19], s32 offen lds
    s_add_u32 m0, s54, 143360
    s_add_u32 s32, s50, 1966336
    buffer_load_dwordx4 v20, s[16:19], s32 offen lds
    s_waitcnt vmcnt(30)
    s_barrier
    ds_read_b64_tr_b16 a[96:97], v6 offset:0
    ds_read_b64_tr_b16 a[98:99], v6 offset:2048
    ds_read_b64_tr_b16 a[100:101], v6 offset:4096
    ds_read_b64_tr_b16 a[102:103], v6 offset:6144
    ds_read_b64_tr_b16 a[112:113], v6 offset:8192
    ds_read_b64_tr_b16 a[114:115], v6 offset:10240
    ds_read_b64_tr_b16 a[116:117], v6 offset:12288
    ds_read_b64_tr_b16 a[118:119], v6 offset:14336
    ds_read_b64_tr_b16 a[128:129], v6 offset:16384
    ds_read_b64_tr_b16 a[130:131], v6 offset:18432
    ds_read_b64_tr_b16 a[132:133], v6 offset:20480
    ds_read_b64_tr_b16 a[134:135], v6 offset:22528
    s_waitcnt lgkmcnt(4)
    s_waitcnt lgkmcnt(0)
    s_waitcnt vmcnt(24)
    s_barrier
    s_add_u32 m0, s54, 0
    s_add_u32 s32, s50, 2359296
    buffer_load_dwordx4 v20, s[12:15], s32 offen lds
    s_add_u32 m0, s54, 4096
    s_add_u32 s32, s50, 2752512
    buffer_load_dwordx4 v20, s[12:15], s32 offen lds
    s_add_u32 m0, s54, 8192
    s_add_u32 s32, s50, 2359424
    buffer_load_dwordx4 v20, s[12:15], s32 offen lds
    s_add_u32 m0, s54, 12288
    s_add_u32 s32, s50, 2752640
    buffer_load_dwordx4 v20, s[12:15], s32 offen lds
    s_add_u32 m0, s54, 16384
    s_add_u32 s32, s50, 2359552
    buffer_load_dwordx4 v20, s[12:15], s32 offen lds
    s_add_u32 m0, s54, 20480
    s_add_u32 s32, s50, 2752768
    buffer_load_dwordx4 v20, s[12:15], s32 offen lds
    ds_read_b64_tr_b16 a[104:105], v6 offset:24576
    ds_read_b64_tr_b16 a[106:107], v6 offset:26624
    ds_read_b64_tr_b16 a[108:109], v6 offset:28672
    ds_read_b64_tr_b16 a[110:111], v6 offset:30720
    ds_read_b64_tr_b16 a[120:121], v6 offset:32768
    ds_read_b64_tr_b16 a[122:123], v6 offset:34816
    ds_read_b64_tr_b16 a[124:125], v6 offset:36864
    ds_read_b64_tr_b16 a[126:127], v6 offset:38912
    ds_read_b64_tr_b16 a[136:137], v6 offset:40960
    ds_read_b64_tr_b16 a[138:139], v6 offset:43008
    ds_read_b64_tr_b16 a[140:141], v6 offset:45056
    ds_read_b64_tr_b16 a[142:143], v6 offset:47104
    s_waitcnt lgkmcnt(4)
    s_waitcnt lgkmcnt(0)
    s_waitcnt vmcnt(24)
    s_barrier
    s_add_u32 m0, s54, 24576
    s_add_u32 s32, s50, 2359296
    buffer_load_dwordx4 v20, s[16:19], s32 offen lds
    s_add_u32 m0, s54, 28672
    s_add_u32 s32, s50, 2752512
    buffer_load_dwordx4 v20, s[16:19], s32 offen lds
    s_add_u32 m0, s54, 32768
    s_add_u32 s32, s50, 2359424
    buffer_load_dwordx4 v20, s[16:19], s32 offen lds
    s_add_u32 m0, s54, 36864
    s_add_u32 s32, s50, 2752640
    buffer_load_dwordx4 v20, s[16:19], s32 offen lds
    s_add_u32 m0, s54, 40960
    s_add_u32 s32, s50, 2359552
    buffer_load_dwordx4 v20, s[16:19], s32 offen lds
    s_add_u32 m0, s54, 45056
    s_add_u32 s32, s50, 2752768
    buffer_load_dwordx4 v20, s[16:19], s32 offen lds
    ds_read_b64_tr_b16 a[144:145], v6 offset:49152
    ds_read_b64_tr_b16 a[146:147], v6 offset:51200
    ds_read_b64_tr_b16 a[148:149], v6 offset:53248
    ds_read_b64_tr_b16 a[150:151], v6 offset:55296
    ds_read_b64_tr_b16 a[160:161], v6 offset:57344
    ds_read_b64_tr_b16 a[162:163], v6 offset:59392
    ds_read_b64_tr_b16 a[164:165], v6 offset:61440
    ds_read_b64_tr_b16 a[166:167], v6 offset:63488
    v_add_u32 v9, 0x10000, v6
    ds_read_b64_tr_b16 a[176:177], v9 offset:0
    ds_read_b64_tr_b16 a[178:179], v9 offset:2048
    ds_read_b64_tr_b16 a[180:181], v9 offset:4096
    ds_read_b64_tr_b16 a[182:183], v9 offset:6144
    s_waitcnt lgkmcnt(4)
    s_waitcnt lgkmcnt(0)
    s_waitcnt vmcnt(24)
    s_barrier
    s_add_u32 m0, s54, 49152
    s_add_u32 s32, s50, 3145728
    buffer_load_dwordx4 v20, s[12:15], s32 offen lds
    s_add_u32 m0, s54, 53248
    s_add_u32 s32, s50, 3538944
    buffer_load_dwordx4 v20, s[12:15], s32 offen lds
    s_add_u32 m0, s54, 57344
    s_add_u32 s32, s50, 3145856
    buffer_load_dwordx4 v20, s[12:15], s32 offen lds
    s_add_u32 m0, s54, 61440
    s_add_u32 s32, s50, 3539072
    buffer_load_dwordx4 v20, s[12:15], s32 offen lds
    s_add_u32 m0, s54, 65536
    s_add_u32 s32, s50, 3145984
    buffer_load_dwordx4 v20, s[12:15], s32 offen lds
    s_add_u32 m0, s54, 69632
    s_add_u32 s32, s50, 3539200
    buffer_load_dwordx4 v20, s[12:15], s32 offen lds
    v_add_u32 v10, 0x10000, v6
    ds_read_b64_tr_b16 a[152:153], v10 offset:8192
    ds_read_b64_tr_b16 a[154:155], v10 offset:10240
    ds_read_b64_tr_b16 a[156:157], v10 offset:12288
    ds_read_b64_tr_b16 a[158:159], v10 offset:14336
    ds_read_b64_tr_b16 a[168:169], v10 offset:16384
    ds_read_b64_tr_b16 a[170:171], v10 offset:18432
    ds_read_b64_tr_b16 a[172:173], v10 offset:20480
    ds_read_b64_tr_b16 a[174:175], v10 offset:22528
    ds_read_b64_tr_b16 a[184:185], v10 offset:24576
    ds_read_b64_tr_b16 a[186:187], v10 offset:26624
    ds_read_b64_tr_b16 a[188:189], v10 offset:28672
    ds_read_b64_tr_b16 a[190:191], v10 offset:30720
    s_waitcnt lgkmcnt(4)
    s_waitcnt lgkmcnt(0)
    s_waitcnt vmcnt(24)
    s_barrier
    s_add_u32 m0, s54, 73728
    s_add_u32 s32, s50, 3145728
    buffer_load_dwordx4 v20, s[16:19], s32 offen lds
    s_add_u32 m0, s54, 77824
    s_add_u32 s32, s50, 3538944
    buffer_load_dwordx4 v20, s[16:19], s32 offen lds
    s_add_u32 m0, s54, 81920
    s_add_u32 s32, s50, 3145856
    buffer_load_dwordx4 v20, s[16:19], s32 offen lds
    s_add_u32 m0, s54, 86016
    s_add_u32 s32, s50, 3539072
    buffer_load_dwordx4 v20, s[16:19], s32 offen lds
    s_add_u32 m0, s54, 90112
    s_add_u32 s32, s50, 3145984
    buffer_load_dwordx4 v20, s[16:19], s32 offen lds
    s_add_u32 m0, s54, 94208
    s_add_u32 s32, s50, 3539200
    buffer_load_dwordx4 v20, s[16:19], s32 offen lds
    v_add_u32 v9, 0x18000, v6
    ds_read_b64_tr_b16 a[192:193], v9 offset:0
    ds_read_b64_tr_b16 a[194:195], v9 offset:2048
    ds_read_b64_tr_b16 a[196:197], v9 offset:4096
    ds_read_b64_tr_b16 a[198:199], v9 offset:6144
    ds_read_b64_tr_b16 a[208:209], v9 offset:8192
    ds_read_b64_tr_b16 a[210:211], v9 offset:10240
    ds_read_b64_tr_b16 a[212:213], v9 offset:12288
    ds_read_b64_tr_b16 a[214:215], v9 offset:14336
    ds_read_b64_tr_b16 a[224:225], v9 offset:16384
    ds_read_b64_tr_b16 a[226:227], v9 offset:18432
    ds_read_b64_tr_b16 a[228:229], v9 offset:20480
    ds_read_b64_tr_b16 a[230:231], v9 offset:22528
    s_waitcnt lgkmcnt(4)
    s_waitcnt lgkmcnt(0)
    s_waitcnt vmcnt(24)
    s_barrier
    s_add_u32 m0, s54, 98304
    s_add_u32 s32, s50, 3932160
    buffer_load_dwordx4 v20, s[12:15], s32 offen lds
    s_add_u32 m0, s54, 102400
    s_add_u32 s32, s50, 4325376
    buffer_load_dwordx4 v20, s[12:15], s32 offen lds
    s_add_u32 m0, s54, 106496
    s_add_u32 s32, s50, 3932288
    buffer_load_dwordx4 v20, s[12:15], s32 offen lds
    s_add_u32 m0, s54, 110592
    s_add_u32 s32, s50, 4325504
    buffer_load_dwordx4 v20, s[12:15], s32 offen lds
    s_add_u32 m0, s54, 114688
    s_add_u32 s32, s50, 3932416
    buffer_load_dwordx4 v20, s[12:15], s32 offen lds
    s_add_u32 m0, s54, 118784
    s_add_u32 s32, s50, 4325632
    buffer_load_dwordx4 v20, s[12:15], s32 offen lds
    v_add_u32 v10, 0x18000, v6
    ds_read_b64_tr_b16 a[200:201], v10 offset:24576
    ds_read_b64_tr_b16 a[202:203], v10 offset:26624
    ds_read_b64_tr_b16 a[204:205], v10 offset:28672
    ds_read_b64_tr_b16 a[206:207], v10 offset:30720
    v_add_u32 v9, 0x20000, v6
    ds_read_b64_tr_b16 a[216:217], v9 offset:0
    ds_read_b64_tr_b16 a[218:219], v9 offset:2048
    ds_read_b64_tr_b16 a[220:221], v9 offset:4096
    ds_read_b64_tr_b16 a[222:223], v9 offset:6144
    ds_read_b64_tr_b16 a[232:233], v9 offset:8192
    ds_read_b64_tr_b16 a[234:235], v9 offset:10240
    ds_read_b64_tr_b16 a[236:237], v9 offset:12288
    ds_read_b64_tr_b16 a[238:239], v9 offset:14336
    s_waitcnt lgkmcnt(4)
    s_waitcnt lgkmcnt(0)
    s_waitcnt vmcnt(24)
    s_barrier
    s_add_u32 m0, s54, 122880
    s_add_u32 s32, s50, 3932160
    buffer_load_dwordx4 v20, s[16:19], s32 offen lds
    s_add_u32 m0, s54, 126976
    s_add_u32 s32, s50, 4325376
    buffer_load_dwordx4 v20, s[16:19], s32 offen lds
    s_add_u32 m0, s54, 131072
    s_add_u32 s32, s50, 3932288
    buffer_load_dwordx4 v20, s[16:19], s32 offen lds
    s_add_u32 m0, s54, 135168
    s_add_u32 s32, s50, 4325504
    buffer_load_dwordx4 v20, s[16:19], s32 offen lds
    s_add_u32 m0, s54, 139264
    s_add_u32 s32, s50, 3932416
    buffer_load_dwordx4 v20, s[16:19], s32 offen lds
    s_add_u32 m0, s54, 143360
    s_add_u32 s32, s50, 4325632
    buffer_load_dwordx4 v20, s[16:19], s32 offen lds
    ds_read_b64_tr_b16 a[0:1], v6 offset:0
    ds_read_b64_tr_b16 a[2:3], v6 offset:2048
    ds_read_b64_tr_b16 a[4:5], v6 offset:4096
    ds_read_b64_tr_b16 a[6:7], v6 offset:6144
    ds_read_b64_tr_b16 a[16:17], v6 offset:8192
    ds_read_b64_tr_b16 a[18:19], v6 offset:10240
    ds_read_b64_tr_b16 a[20:21], v6 offset:12288
    ds_read_b64_tr_b16 a[22:23], v6 offset:14336
    ds_read_b64_tr_b16 a[32:33], v6 offset:16384
    ds_read_b64_tr_b16 a[34:35], v6 offset:18432
    ds_read_b64_tr_b16 a[36:37], v6 offset:20480
    ds_read_b64_tr_b16 a[38:39], v6 offset:22528
    s_waitcnt lgkmcnt(4)
    s_waitcnt lgkmcnt(0)
    s_waitcnt vmcnt(24)
    s_barrier
    s_add_u32 m0, s54, 0
    s_add_u32 s32, s50, 4718592
    buffer_load_dwordx4 v20, s[12:15], s32 offen lds
    s_add_u32 m0, s54, 4096
    s_add_u32 s32, s50, 5111808
    buffer_load_dwordx4 v20, s[12:15], s32 offen lds
    s_add_u32 m0, s54, 8192
    s_add_u32 s32, s50, 4718720
    buffer_load_dwordx4 v20, s[12:15], s32 offen lds
    s_add_u32 m0, s54, 12288
    s_add_u32 s32, s50, 5111936
    buffer_load_dwordx4 v20, s[12:15], s32 offen lds
    s_add_u32 m0, s54, 16384
    s_add_u32 s32, s50, 4718848
    buffer_load_dwordx4 v20, s[12:15], s32 offen lds
    s_add_u32 m0, s54, 20480
    s_add_u32 s32, s50, 5112064
    buffer_load_dwordx4 v20, s[12:15], s32 offen lds
    ds_read_b64_tr_b16 a[8:9], v6 offset:24576
    ds_read_b64_tr_b16 a[10:11], v6 offset:26624
    ds_read_b64_tr_b16 a[12:13], v6 offset:28672
    ds_read_b64_tr_b16 a[14:15], v6 offset:30720
    ds_read_b64_tr_b16 a[24:25], v6 offset:32768
    ds_read_b64_tr_b16 a[26:27], v6 offset:34816
    ds_read_b64_tr_b16 a[28:29], v6 offset:36864
    ds_read_b64_tr_b16 a[30:31], v6 offset:38912
    ds_read_b64_tr_b16 a[40:41], v6 offset:40960
    ds_read_b64_tr_b16 a[42:43], v6 offset:43008
    ds_read_b64_tr_b16 a[44:45], v6 offset:45056
    ds_read_b64_tr_b16 a[46:47], v6 offset:47104
    s_waitcnt lgkmcnt(4)
    s_waitcnt lgkmcnt(0)
    s_waitcnt vmcnt(24)
    s_barrier
    s_add_u32 m0, s54, 24576
    s_add_u32 s32, s50, 4718592
    buffer_load_dwordx4 v20, s[16:19], s32 offen lds
    s_add_u32 m0, s54, 28672
    s_add_u32 s32, s50, 5111808
    buffer_load_dwordx4 v20, s[16:19], s32 offen lds
    s_add_u32 m0, s54, 32768
    s_add_u32 s32, s50, 4718720
    buffer_load_dwordx4 v20, s[16:19], s32 offen lds
    s_add_u32 m0, s54, 36864
    s_add_u32 s32, s50, 5111936
    buffer_load_dwordx4 v20, s[16:19], s32 offen lds
    s_add_u32 m0, s54, 40960
    s_add_u32 s32, s50, 4718848
    buffer_load_dwordx4 v20, s[16:19], s32 offen lds
    s_add_u32 m0, s54, 45056
    s_add_u32 s32, s50, 5112064
    buffer_load_dwordx4 v20, s[16:19], s32 offen lds
    ds_read_b64_tr_b16 v[24:25], v6 offset:49152
    ds_read_b64_tr_b16 v[26:27], v6 offset:51200
    ds_read_b64_tr_b16 v[28:29], v6 offset:53248
    ds_read_b64_tr_b16 v[30:31], v6 offset:55296
    ds_read_b64_tr_b16 v[40:41], v6 offset:57344
    ds_read_b64_tr_b16 v[42:43], v6 offset:59392
    ds_read_b64_tr_b16 v[44:45], v6 offset:61440
    ds_read_b64_tr_b16 v[46:47], v6 offset:63488
    v_add_u32 v10, 0x10000, v6
    ds_read_b64_tr_b16 v[56:57], v10 offset:0
    ds_read_b64_tr_b16 v[58:59], v10 offset:2048
    ds_read_b64_tr_b16 v[60:61], v10 offset:4096
    ds_read_b64_tr_b16 v[62:63], v10 offset:6144
    s_waitcnt lgkmcnt(4)
    s_waitcnt lgkmcnt(0)
    s_waitcnt vmcnt(24)
    s_barrier
    s_add_u32 m0, s54, 49152
    s_add_u32 s32, s50, 5505024
    buffer_load_dwordx4 v20, s[12:15], s32 offen lds
    s_add_u32 m0, s54, 53248
    s_add_u32 s32, s50, 5898240
    buffer_load_dwordx4 v20, s[12:15], s32 offen lds
    s_add_u32 m0, s54, 57344
    s_add_u32 s32, s50, 5505152
    buffer_load_dwordx4 v20, s[12:15], s32 offen lds
    s_add_u32 m0, s54, 61440
    s_add_u32 s32, s50, 5898368
    buffer_load_dwordx4 v20, s[12:15], s32 offen lds
    s_add_u32 m0, s54, 65536
    s_add_u32 s32, s50, 5505280
    buffer_load_dwordx4 v20, s[12:15], s32 offen lds
    s_add_u32 m0, s54, 69632
    s_add_u32 s32, s50, 5898496
    buffer_load_dwordx4 v20, s[12:15], s32 offen lds
    v_add_u32 v9, 0x10000, v6
    ds_read_b64_tr_b16 v[32:33], v9 offset:8192
    ds_read_b64_tr_b16 v[34:35], v9 offset:10240
    ds_read_b64_tr_b16 v[36:37], v9 offset:12288
    ds_read_b64_tr_b16 v[38:39], v9 offset:14336
    ds_read_b64_tr_b16 v[48:49], v9 offset:16384
    ds_read_b64_tr_b16 v[50:51], v9 offset:18432
    ds_read_b64_tr_b16 v[52:53], v9 offset:20480
    ds_read_b64_tr_b16 v[54:55], v9 offset:22528
    ds_read_b64_tr_b16 v[64:65], v9 offset:24576
    ds_read_b64_tr_b16 v[66:67], v9 offset:26624
    ds_read_b64_tr_b16 v[68:69], v9 offset:28672
    ds_read_b64_tr_b16 v[70:71], v9 offset:30720
    s_waitcnt lgkmcnt(4)
    s_waitcnt lgkmcnt(0)
    s_waitcnt vmcnt(24)
    s_barrier
    s_add_u32 m0, s54, 73728
    s_add_u32 s32, s50, 5505024
    buffer_load_dwordx4 v20, s[16:19], s32 offen lds
    s_add_u32 m0, s54, 77824
    s_add_u32 s32, s50, 5898240
    buffer_load_dwordx4 v20, s[16:19], s32 offen lds
    s_add_u32 m0, s54, 81920
    s_add_u32 s32, s50, 5505152
    buffer_load_dwordx4 v20, s[16:19], s32 offen lds
    s_add_u32 m0, s54, 86016
    s_add_u32 s32, s50, 5898368
    buffer_load_dwordx4 v20, s[16:19], s32 offen lds
    s_add_u32 m0, s54, 90112
    s_add_u32 s32, s50, 5505280
    buffer_load_dwordx4 v20, s[16:19], s32 offen lds
    s_add_u32 m0, s54, 94208
    s_add_u32 s32, s50, 5898496
    buffer_load_dwordx4 v20, s[16:19], s32 offen lds
    v_add_u32 v10, 0x18000, v6
    ds_read_b64_tr_b16 a[240:241], v10 offset:0
    ds_read_b64_tr_b16 a[242:243], v10 offset:2048
    ds_read_b64_tr_b16 a[244:245], v10 offset:4096
    ds_read_b64_tr_b16 a[246:247], v10 offset:6144
    ds_read_b64_tr_b16 v[128:129], v10 offset:8192
    ds_read_b64_tr_b16 v[130:131], v10 offset:10240
    ds_read_b64_tr_b16 v[132:133], v10 offset:12288
    ds_read_b64_tr_b16 v[134:135], v10 offset:14336
    ds_read_b64_tr_b16 v[144:145], v10 offset:16384
    ds_read_b64_tr_b16 v[146:147], v10 offset:18432
    ds_read_b64_tr_b16 v[148:149], v10 offset:20480
    ds_read_b64_tr_b16 v[150:151], v10 offset:22528
    s_waitcnt lgkmcnt(4)
    s_waitcnt lgkmcnt(0)
    s_waitcnt vmcnt(24)
    s_barrier
    s_add_u32 m0, s54, 98304
    s_add_u32 s32, s50, 6291456
    buffer_load_dwordx4 v20, s[12:15], s32 offen lds
    s_add_u32 m0, s54, 102400
    s_add_u32 s32, s50, 6684672
    buffer_load_dwordx4 v20, s[12:15], s32 offen lds
    s_add_u32 m0, s54, 106496
    s_add_u32 s32, s50, 6291584
    buffer_load_dwordx4 v20, s[12:15], s32 offen lds
    s_add_u32 m0, s54, 110592
    s_add_u32 s32, s50, 6684800
    buffer_load_dwordx4 v20, s[12:15], s32 offen lds
    s_add_u32 m0, s54, 114688
    s_add_u32 s32, s50, 6291712
    buffer_load_dwordx4 v20, s[12:15], s32 offen lds
    s_add_u32 m0, s54, 118784
    s_add_u32 s32, s50, 6684928
    buffer_load_dwordx4 v20, s[12:15], s32 offen lds
    v_add_u32 v9, 0x18000, v6
    ds_read_b64_tr_b16 a[248:249], v9 offset:24576
    ds_read_b64_tr_b16 a[250:251], v9 offset:26624
    ds_read_b64_tr_b16 a[252:253], v9 offset:28672
    ds_read_b64_tr_b16 a[254:255], v9 offset:30720
    v_add_u32 v10, 0x20000, v6
    ds_read_b64_tr_b16 v[136:137], v10 offset:0
    ds_read_b64_tr_b16 v[138:139], v10 offset:2048
    ds_read_b64_tr_b16 v[140:141], v10 offset:4096
    ds_read_b64_tr_b16 v[142:143], v10 offset:6144
    ds_read_b64_tr_b16 v[152:153], v10 offset:8192
    ds_read_b64_tr_b16 v[154:155], v10 offset:10240
    ds_read_b64_tr_b16 v[156:157], v10 offset:12288
    ds_read_b64_tr_b16 v[158:159], v10 offset:14336
    s_waitcnt lgkmcnt(4)
    s_waitcnt lgkmcnt(0)
    s_waitcnt vmcnt(24)
    s_barrier
    s_add_u32 m0, s54, 122880
    s_add_u32 s32, s50, 6291456
    buffer_load_dwordx4 v20, s[16:19], s32 offen lds
    s_add_u32 m0, s54, 126976
    s_add_u32 s32, s50, 6684672
    buffer_load_dwordx4 v20, s[16:19], s32 offen lds
    s_add_u32 m0, s54, 131072
    s_add_u32 s32, s50, 6291584
    buffer_load_dwordx4 v20, s[16:19], s32 offen lds
    s_add_u32 m0, s54, 135168
    s_add_u32 s32, s50, 6684800
    buffer_load_dwordx4 v20, s[16:19], s32 offen lds
    s_add_u32 m0, s54, 139264
    s_add_u32 s32, s50, 6291712
    buffer_load_dwordx4 v20, s[16:19], s32 offen lds
    s_add_u32 m0, s54, 143360
    s_add_u32 s32, s50, 6684928
    buffer_load_dwordx4 v20, s[16:19], s32 offen lds
    ds_read_b64_tr_b16 v[160:161], v6 offset:0
    ds_read_b64_tr_b16 v[162:163], v6 offset:2048
    ds_read_b64_tr_b16 v[164:165], v6 offset:4096
    ds_read_b64_tr_b16 v[166:167], v6 offset:6144
    ds_read_b64_tr_b16 v[176:177], v6 offset:8192
    ds_read_b64_tr_b16 v[178:179], v6 offset:10240
    ds_read_b64_tr_b16 v[180:181], v6 offset:12288
    ds_read_b64_tr_b16 v[182:183], v6 offset:14336
    ds_read_b64_tr_b16 v[192:193], v6 offset:16384
    ds_read_b64_tr_b16 v[194:195], v6 offset:18432
    ds_read_b64_tr_b16 v[196:197], v6 offset:20480
    ds_read_b64_tr_b16 v[198:199], v6 offset:22528
    s_waitcnt lgkmcnt(4)
    s_waitcnt lgkmcnt(0)
    s_waitcnt vmcnt(24)
    s_barrier
    s_add_u32 m0, s54, 0
    s_add_u32 s32, s50, 7077888
    buffer_load_dwordx4 v20, s[12:15], s32 offen lds
    s_add_u32 m0, s54, 4096
    s_add_u32 s32, s50, 7471104
    buffer_load_dwordx4 v20, s[12:15], s32 offen lds
    s_add_u32 m0, s54, 8192
    s_add_u32 s32, s50, 7078016
    buffer_load_dwordx4 v20, s[12:15], s32 offen lds
    s_add_u32 m0, s54, 12288
    s_add_u32 s32, s50, 7471232
    buffer_load_dwordx4 v20, s[12:15], s32 offen lds
    s_add_u32 m0, s54, 16384
    s_add_u32 s32, s50, 7078144
    buffer_load_dwordx4 v20, s[12:15], s32 offen lds
    s_add_u32 m0, s54, 20480
    s_add_u32 s32, s50, 7471360
    buffer_load_dwordx4 v20, s[12:15], s32 offen lds
    ds_read_b64_tr_b16 v[168:169], v6 offset:24576
    ds_read_b64_tr_b16 v[170:171], v6 offset:26624
    ds_read_b64_tr_b16 v[172:173], v6 offset:28672
    ds_read_b64_tr_b16 v[174:175], v6 offset:30720
    ds_read_b64_tr_b16 v[184:185], v6 offset:32768
    ds_read_b64_tr_b16 v[186:187], v6 offset:34816
    ds_read_b64_tr_b16 v[188:189], v6 offset:36864
    ds_read_b64_tr_b16 v[190:191], v6 offset:38912
    ds_read_b64_tr_b16 v[200:201], v6 offset:40960
    ds_read_b64_tr_b16 v[202:203], v6 offset:43008
    ds_read_b64_tr_b16 v[204:205], v6 offset:45056
    ds_read_b64_tr_b16 v[206:207], v6 offset:47104
    s_waitcnt lgkmcnt(4)
    s_waitcnt lgkmcnt(0)
    s_waitcnt vmcnt(24)
    s_barrier
    s_add_u32 m0, s54, 24576
    s_add_u32 s32, s50, 7077888
    buffer_load_dwordx4 v20, s[16:19], s32 offen lds
    s_add_u32 m0, s54, 28672
    s_add_u32 s32, s50, 7471104
    buffer_load_dwordx4 v20, s[16:19], s32 offen lds
    s_add_u32 m0, s54, 32768
    s_add_u32 s32, s50, 7078016
    buffer_load_dwordx4 v20, s[16:19], s32 offen lds
    s_add_u32 m0, s54, 36864
    s_add_u32 s32, s50, 7471232
    buffer_load_dwordx4 v20, s[16:19], s32 offen lds
    s_add_u32 m0, s54, 40960
    s_add_u32 s32, s50, 7078144
    buffer_load_dwordx4 v20, s[16:19], s32 offen lds
    s_add_u32 m0, s54, 45056
    s_add_u32 s32, s50, 7471360
    buffer_load_dwordx4 v20, s[16:19], s32 offen lds
    s_mov_b32 s28, s88
    s_and_b32 s29, s89, 0xffff
    s_mov_b32 s30, 0x100
    s_mov_b32 s31, 0x20000
    v_mov_b32 v2, 0
    buffer_load_dword v3, v2, s[28:31], 0 offen offset:60 sc1
    ds_read_b64_tr_b16 a[48:49], v6 offset:49152
    ds_read_b64_tr_b16 a[50:51], v6 offset:51200
    ds_read_b64_tr_b16 a[52:53], v6 offset:53248
    ds_read_b64_tr_b16 a[54:55], v6 offset:55296
    ds_read_b64_tr_b16 a[64:65], v6 offset:57344
    ds_read_b64_tr_b16 a[66:67], v6 offset:59392
    ds_read_b64_tr_b16 a[68:69], v6 offset:61440
    ds_read_b64_tr_b16 a[70:71], v6 offset:63488
    v_add_u32 v9, 0x10000, v6
    ds_read_b64_tr_b16 a[80:81], v9 offset:0
    ds_read_b64_tr_b16 a[82:83], v9 offset:2048
    ds_read_b64_tr_b16 a[84:85], v9 offset:4096
    ds_read_b64_tr_b16 a[86:87], v9 offset:6144
    s_waitcnt lgkmcnt(4)
    s_waitcnt lgkmcnt(0)
    s_waitcnt vmcnt(25)
    s_barrier
    v_add_u32 v10, 0x10000, v6
    ds_read_b64_tr_b16 a[56:57], v10 offset:8192
    ds_read_b64_tr_b16 a[58:59], v10 offset:10240
    ds_read_b64_tr_b16 a[60:61], v10 offset:12288
    ds_read_b64_tr_b16 a[62:63], v10 offset:14336
    ds_read_b64_tr_b16 a[72:73], v10 offset:16384
    ds_read_b64_tr_b16 a[74:75], v10 offset:18432
    ds_read_b64_tr_b16 a[76:77], v10 offset:20480
    ds_read_b64_tr_b16 a[78:79], v10 offset:22528
    ds_read_b64_tr_b16 a[88:89], v10 offset:24576
    ds_read_b64_tr_b16 a[90:91], v10 offset:26624
    ds_read_b64_tr_b16 a[92:93], v10 offset:28672
    ds_read_b64_tr_b16 a[94:95], v10 offset:30720
    s_waitcnt lgkmcnt(4)
    s_waitcnt lgkmcnt(0)
    s_waitcnt vmcnt(19)
    s_barrier
    v_add_u32 v9, 0x18000, v6
    ds_read_b64_tr_b16 v[72:73], v9 offset:0
    ds_read_b64_tr_b16 v[74:75], v9 offset:2048
    ds_read_b64_tr_b16 v[76:77], v9 offset:4096
    ds_read_b64_tr_b16 v[78:79], v9 offset:6144
    ds_read_b64_tr_b16 v[88:89], v9 offset:8192
    ds_read_b64_tr_b16 v[90:91], v9 offset:10240
    ds_read_b64_tr_b16 v[92:93], v9 offset:12288
    ds_read_b64_tr_b16 v[94:95], v9 offset:14336
    ds_read_b64_tr_b16 v[104:105], v9 offset:16384
    ds_read_b64_tr_b16 v[106:107], v9 offset:18432
    ds_read_b64_tr_b16 v[108:109], v9 offset:20480
    ds_read_b64_tr_b16 v[110:111], v9 offset:22528
    s_waitcnt lgkmcnt(4)
    s_waitcnt lgkmcnt(0)
    s_waitcnt vmcnt(13)
    s_barrier
    v_add_u32 v10, 0x18000, v6
    ds_read_b64_tr_b16 v[80:81], v10 offset:24576
    ds_read_b64_tr_b16 v[82:83], v10 offset:26624
    ds_read_b64_tr_b16 v[84:85], v10 offset:28672
    ds_read_b64_tr_b16 v[86:87], v10 offset:30720
    v_add_u32 v9, 0x20000, v6
    ds_read_b64_tr_b16 v[96:97], v9 offset:0
    ds_read_b64_tr_b16 v[98:99], v9 offset:2048
    ds_read_b64_tr_b16 v[100:101], v9 offset:4096
    ds_read_b64_tr_b16 v[102:103], v9 offset:6144
    ds_read_b64_tr_b16 v[112:113], v9 offset:8192
    ds_read_b64_tr_b16 v[114:115], v9 offset:10240
    ds_read_b64_tr_b16 v[116:117], v9 offset:12288
    ds_read_b64_tr_b16 v[118:119], v9 offset:14336
    s_waitcnt lgkmcnt(4)
    s_waitcnt lgkmcnt(0)
    s_waitcnt vmcnt(7)
    s_barrier
    ds_read_b64_tr_b16 v[208:209], v6 offset:0
    ds_read_b64_tr_b16 v[210:211], v6 offset:2048
    ds_read_b64_tr_b16 v[212:213], v6 offset:4096
    ds_read_b64_tr_b16 v[214:215], v6 offset:6144
    ds_read_b64_tr_b16 v[224:225], v6 offset:8192
    ds_read_b64_tr_b16 v[226:227], v6 offset:10240
    ds_read_b64_tr_b16 v[228:229], v6 offset:12288
    ds_read_b64_tr_b16 v[230:231], v6 offset:14336
    ds_read_b64_tr_b16 v[240:241], v6 offset:16384
    ds_read_b64_tr_b16 v[242:243], v6 offset:18432
    ds_read_b64_tr_b16 v[244:245], v6 offset:20480
    ds_read_b64_tr_b16 v[246:247], v6 offset:22528
    s_waitcnt lgkmcnt(4)
    s_waitcnt lgkmcnt(0)
    s_waitcnt vmcnt(1)
    s_barrier
    ds_read_b64_tr_b16 v[216:217], v6 offset:24576
    ds_read_b64_tr_b16 v[218:219], v6 offset:26624
    ds_read_b64_tr_b16 v[220:221], v6 offset:28672
    ds_read_b64_tr_b16 v[222:223], v6 offset:30720
    ds_read_b64_tr_b16 v[232:233], v6 offset:32768
    ds_read_b64_tr_b16 v[234:235], v6 offset:34816
    ds_read_b64_tr_b16 v[236:237], v6 offset:36864
    ds_read_b64_tr_b16 v[238:239], v6 offset:38912
    ds_read_b64_tr_b16 v[248:249], v6 offset:40960
    ds_read_b64_tr_b16 v[250:251], v6 offset:43008
    ds_read_b64_tr_b16 v[252:253], v6 offset:45056
    ds_read_b64_tr_b16 v[254:255], v6 offset:47104
    s_waitcnt lgkmcnt(4)
    s_waitcnt lgkmcnt(0)
    s_barrier
    s_branch A_ld_wx
A_ld_w2:
    s_add_u32 m0, s54, 0
    s_add_u32 s32, s50, 0
    buffer_load_dwordx4 v20, s[12:15], s32 offen lds
    s_add_u32 m0, s54, 4096
    s_add_u32 s32, s50, 393216
    buffer_load_dwordx4 v20, s[12:15], s32 offen lds
    s_add_u32 m0, s54, 8192
    s_add_u32 s32, s50, 128
    buffer_load_dwordx4 v20, s[12:15], s32 offen lds
    s_add_u32 m0, s54, 12288
    s_add_u32 s32, s50, 393344
    buffer_load_dwordx4 v20, s[12:15], s32 offen lds
    s_add_u32 m0, s54, 16384
    s_add_u32 s32, s50, 256
    buffer_load_dwordx4 v20, s[12:15], s32 offen lds
    s_add_u32 m0, s54, 20480
    s_add_u32 s32, s50, 393472
    buffer_load_dwordx4 v20, s[12:15], s32 offen lds
    s_add_u32 m0, s54, 24576
    s_add_u32 s32, s50, 0
    buffer_load_dwordx4 v20, s[16:19], s32 offen lds
    s_add_u32 m0, s54, 28672
    s_add_u32 s32, s50, 393216
    buffer_load_dwordx4 v20, s[16:19], s32 offen lds
    s_add_u32 m0, s54, 32768
    s_add_u32 s32, s50, 128
    buffer_load_dwordx4 v20, s[16:19], s32 offen lds
    s_add_u32 m0, s54, 36864
    s_add_u32 s32, s50, 393344
    buffer_load_dwordx4 v20, s[16:19], s32 offen lds
    s_add_u32 m0, s54, 40960
    s_add_u32 s32, s50, 256
    buffer_load_dwordx4 v20, s[16:19], s32 offen lds
    s_add_u32 m0, s54, 45056
    s_add_u32 s32, s50, 393472
    buffer_load_dwordx4 v20, s[16:19], s32 offen lds
    s_add_u32 m0, s54, 49152
    s_add_u32 s32, s50, 786432
    buffer_load_dwordx4 v20, s[12:15], s32 offen lds
    s_add_u32 m0, s54, 53248
    s_add_u32 s32, s50, 1179648
    buffer_load_dwordx4 v20, s[12:15], s32 offen lds
    s_add_u32 m0, s54, 57344
    s_add_u32 s32, s50, 786560
    buffer_load_dwordx4 v20, s[12:15], s32 offen lds
    s_add_u32 m0, s54, 61440
    s_add_u32 s32, s50, 1179776
    buffer_load_dwordx4 v20, s[12:15], s32 offen lds
    s_add_u32 m0, s54, 65536
    s_add_u32 s32, s50, 786688
    buffer_load_dwordx4 v20, s[12:15], s32 offen lds
    s_add_u32 m0, s54, 69632
    s_add_u32 s32, s50, 1179904
    buffer_load_dwordx4 v20, s[12:15], s32 offen lds
    s_add_u32 m0, s54, 73728
    s_add_u32 s32, s50, 786432
    buffer_load_dwordx4 v20, s[16:19], s32 offen lds
    s_add_u32 m0, s54, 77824
    s_add_u32 s32, s50, 1179648
    buffer_load_dwordx4 v20, s[16:19], s32 offen lds
    s_add_u32 m0, s54, 81920
    s_add_u32 s32, s50, 786560
    buffer_load_dwordx4 v20, s[16:19], s32 offen lds
    s_add_u32 m0, s54, 86016
    s_add_u32 s32, s50, 1179776
    buffer_load_dwordx4 v20, s[16:19], s32 offen lds
    s_add_u32 m0, s54, 90112
    s_add_u32 s32, s50, 786688
    buffer_load_dwordx4 v20, s[16:19], s32 offen lds
    s_add_u32 m0, s54, 94208
    s_add_u32 s32, s50, 1179904
    buffer_load_dwordx4 v20, s[16:19], s32 offen lds
    s_add_u32 m0, s54, 98304
    s_add_u32 s32, s50, 1572864
    buffer_load_dwordx4 v20, s[12:15], s32 offen lds
    s_add_u32 m0, s54, 102400
    s_add_u32 s32, s50, 1966080
    buffer_load_dwordx4 v20, s[12:15], s32 offen lds
    s_add_u32 m0, s54, 106496
    s_add_u32 s32, s50, 1572992
    buffer_load_dwordx4 v20, s[12:15], s32 offen lds
    s_add_u32 m0, s54, 110592
    s_add_u32 s32, s50, 1966208
    buffer_load_dwordx4 v20, s[12:15], s32 offen lds
    s_add_u32 m0, s54, 114688
    s_add_u32 s32, s50, 1573120
    buffer_load_dwordx4 v20, s[12:15], s32 offen lds
    s_add_u32 m0, s54, 118784
    s_add_u32 s32, s50, 1966336
    buffer_load_dwordx4 v20, s[12:15], s32 offen lds
    s_add_u32 m0, s54, 122880
    s_add_u32 s32, s50, 1572864
    buffer_load_dwordx4 v20, s[16:19], s32 offen lds
    s_add_u32 m0, s54, 126976
    s_add_u32 s32, s50, 1966080
    buffer_load_dwordx4 v20, s[16:19], s32 offen lds
    s_add_u32 m0, s54, 131072
    s_add_u32 s32, s50, 1572992
    buffer_load_dwordx4 v20, s[16:19], s32 offen lds
    s_add_u32 m0, s54, 135168
    s_add_u32 s32, s50, 1966208
    buffer_load_dwordx4 v20, s[16:19], s32 offen lds
    s_add_u32 m0, s54, 139264
    s_add_u32 s32, s50, 1573120
    buffer_load_dwordx4 v20, s[16:19], s32 offen lds
    s_add_u32 m0, s54, 143360
    s_add_u32 s32, s50, 1966336
    buffer_load_dwordx4 v20, s[16:19], s32 offen lds
    s_waitcnt vmcnt(30)
    s_barrier
    ds_read_b64_tr_b16 a[96:97], v6 offset:0
    ds_read_b64_tr_b16 a[98:99], v6 offset:2048
    ds_read_b64_tr_b16 a[100:101], v6 offset:4096
    ds_read_b64_tr_b16 a[102:103], v6 offset:6144
    ds_read_b64_tr_b16 a[112:113], v6 offset:8192
    ds_read_b64_tr_b16 a[114:115], v6 offset:10240
    ds_read_b64_tr_b16 a[116:117], v6 offset:12288
    ds_read_b64_tr_b16 a[118:119], v6 offset:14336
    ds_read_b64_tr_b16 a[128:129], v6 offset:16384
    ds_read_b64_tr_b16 a[130:131], v6 offset:18432
    ds_read_b64_tr_b16 a[132:133], v6 offset:20480
    ds_read_b64_tr_b16 a[134:135], v6 offset:22528
    s_waitcnt lgkmcnt(4)
    s_waitcnt lgkmcnt(0)
    s_waitcnt vmcnt(24)
    s_barrier
    s_add_u32 m0, s54, 0
    s_add_u32 s32, s50, 2359296
    buffer_load_dwordx4 v20, s[12:15], s32 offen lds
    s_add_u32 m0, s54, 4096
    s_add_u32 s32, s50, 2752512
    buffer_load_dwordx4 v20, s[12:15], s32 offen lds
    s_add_u32 m0, s54, 8192
    s_add_u32 s32, s50, 2359424
    buffer_load_dwordx4 v20, s[12:15], s32 offen lds
    s_add_u32 m0, s54, 12288
    s_add_u32 s32, s50, 2752640
    buffer_load_dwordx4 v20, s[12:15], s32 offen lds
    s_add_u32 m0, s54, 16384
    s_add_u32 s32, s50, 2359552
    buffer_load_dwordx4 v20, s[12:15], s32 offen lds
    s_add_u32 m0, s54, 20480
    s_add_u32 s32, s50, 2752768
    buffer_load_dwordx4 v20, s[12:15], s32 offen lds
    ds_read_b64_tr_b16 a[104:105], v6 offset:24576
    ds_read_b64_tr_b16 a[106:107], v6 offset:26624
    ds_read_b64_tr_b16 a[108:109], v6 offset:28672
    ds_read_b64_tr_b16 a[110:111], v6 offset:30720
    ds_read_b64_tr_b16 a[120:121], v6 offset:32768
    ds_read_b64_tr_b16 a[122:123], v6 offset:34816
    ds_read_b64_tr_b16 a[124:125], v6 offset:36864
    ds_read_b64_tr_b16 a[126:127], v6 offset:38912
    ds_read_b64_tr_b16 a[136:137], v6 offset:40960
    ds_read_b64_tr_b16 a[138:139], v6 offset:43008
    ds_read_b64_tr_b16 a[140:141], v6 offset:45056
    ds_read_b64_tr_b16 a[142:143], v6 offset:47104
    s_waitcnt lgkmcnt(4)
    s_waitcnt lgkmcnt(0)
    s_waitcnt vmcnt(24)
    s_barrier
    s_add_u32 m0, s54, 24576
    s_add_u32 s32, s50, 2359296
    buffer_load_dwordx4 v20, s[16:19], s32 offen lds
    s_add_u32 m0, s54, 28672
    s_add_u32 s32, s50, 2752512
    buffer_load_dwordx4 v20, s[16:19], s32 offen lds
    s_add_u32 m0, s54, 32768
    s_add_u32 s32, s50, 2359424
    buffer_load_dwordx4 v20, s[16:19], s32 offen lds
    s_add_u32 m0, s54, 36864
    s_add_u32 s32, s50, 2752640
    buffer_load_dwordx4 v20, s[16:19], s32 offen lds
    s_add_u32 m0, s54, 40960
    s_add_u32 s32, s50, 2359552
    buffer_load_dwordx4 v20, s[16:19], s32 offen lds
    s_add_u32 m0, s54, 45056
    s_add_u32 s32, s50, 2752768
    buffer_load_dwordx4 v20, s[16:19], s32 offen lds
    ds_read_b64_tr_b16 a[144:145], v6 offset:49152
    ds_read_b64_tr_b16 a[146:147], v6 offset:51200
    ds_read_b64_tr_b16 a[148:149], v6 offset:53248
    ds_read_b64_tr_b16 a[150:151], v6 offset:55296
    ds_read_b64_tr_b16 a[160:161], v6 offset:57344
    ds_read_b64_tr_b16 a[162:163], v6 offset:59392
    ds_read_b64_tr_b16 a[164:165], v6 offset:61440
    ds_read_b64_tr_b16 a[166:167], v6 offset:63488
    v_add_u32 v10, 0x10000, v6
    ds_read_b64_tr_b16 a[176:177], v10 offset:0
    ds_read_b64_tr_b16 a[178:179], v10 offset:2048
    ds_read_b64_tr_b16 a[180:181], v10 offset:4096
    ds_read_b64_tr_b16 a[182:183], v10 offset:6144
    s_waitcnt lgkmcnt(4)
    s_waitcnt lgkmcnt(0)
    s_waitcnt vmcnt(24)
    s_barrier
    s_add_u32 m0, s54, 49152
    s_add_u32 s32, s50, 3145728
    buffer_load_dwordx4 v20, s[12:15], s32 offen lds
    s_add_u32 m0, s54, 53248
    s_add_u32 s32, s50, 3538944
    buffer_load_dwordx4 v20, s[12:15], s32 offen lds
    s_add_u32 m0, s54, 57344
    s_add_u32 s32, s50, 3145856
    buffer_load_dwordx4 v20, s[12:15], s32 offen lds
    s_add_u32 m0, s54, 61440
    s_add_u32 s32, s50, 3539072
    buffer_load_dwordx4 v20, s[12:15], s32 offen lds
    s_add_u32 m0, s54, 65536
    s_add_u32 s32, s50, 3145984
    buffer_load_dwordx4 v20, s[12:15], s32 offen lds
    s_add_u32 m0, s54, 69632
    s_add_u32 s32, s50, 3539200
    buffer_load_dwordx4 v20, s[12:15], s32 offen lds
    v_add_u32 v9, 0x10000, v6
    ds_read_b64_tr_b16 a[152:153], v9 offset:8192
    ds_read_b64_tr_b16 a[154:155], v9 offset:10240
    ds_read_b64_tr_b16 a[156:157], v9 offset:12288
    ds_read_b64_tr_b16 a[158:159], v9 offset:14336
    ds_read_b64_tr_b16 a[168:169], v9 offset:16384
    ds_read_b64_tr_b16 a[170:171], v9 offset:18432
    ds_read_b64_tr_b16 a[172:173], v9 offset:20480
    ds_read_b64_tr_b16 a[174:175], v9 offset:22528
    ds_read_b64_tr_b16 a[184:185], v9 offset:24576
    ds_read_b64_tr_b16 a[186:187], v9 offset:26624
    ds_read_b64_tr_b16 a[188:189], v9 offset:28672
    ds_read_b64_tr_b16 a[190:191], v9 offset:30720
    s_waitcnt lgkmcnt(4)
    s_waitcnt lgkmcnt(0)
    s_waitcnt vmcnt(24)
    s_barrier
    s_add_u32 m0, s54, 73728
    s_add_u32 s32, s50, 3145728
    buffer_load_dwordx4 v20, s[16:19], s32 offen lds
    s_add_u32 m0, s54, 77824
    s_add_u32 s32, s50, 3538944
    buffer_load_dwordx4 v20, s[16:19], s32 offen lds
    s_add_u32 m0, s54, 81920
    s_add_u32 s32, s50, 3145856
    buffer_load_dwordx4 v20, s[16:19], s32 offen lds
    s_add_u32 m0, s54, 86016
    s_add_u32 s32, s50, 3539072
    buffer_load_dwordx4 v20, s[16:19], s32 offen lds
    s_add_u32 m0, s54, 90112
    s_add_u32 s32, s50, 3145984
    buffer_load_dwordx4 v20, s[16:19], s32 offen lds
    s_add_u32 m0, s54, 94208
    s_add_u32 s32, s50, 3539200
    buffer_load_dwordx4 v20, s[16:19], s32 offen lds
    v_add_u32 v10, 0x18000, v6
    ds_read_b64_tr_b16 a[240:241], v10 offset:0
    ds_read_b64_tr_b16 a[242:243], v10 offset:2048
    ds_read_b64_tr_b16 a[244:245], v10 offset:4096
    ds_read_b64_tr_b16 a[246:247], v10 offset:6144
    ds_read_b64_tr_b16 v[128:129], v10 offset:8192
    ds_read_b64_tr_b16 v[130:131], v10 offset:10240
    ds_read_b64_tr_b16 v[132:133], v10 offset:12288
    ds_read_b64_tr_b16 v[134:135], v10 offset:14336
    ds_read_b64_tr_b16 v[144:145], v10 offset:16384
    ds_read_b64_tr_b16 v[146:147], v10 offset:18432
    ds_read_b64_tr_b16 v[148:149], v10 offset:20480
    ds_read_b64_tr_b16 v[150:151], v10 offset:22528
    s_waitcnt lgkmcnt(4)
    s_waitcnt lgkmcnt(0)
    s_waitcnt vmcnt(24)
    s_barrier
    s_add_u32 m0, s54, 98304
    s_add_u32 s32, s50, 3932160
    buffer_load_dwordx4 v20, s[12:15], s32 offen lds
    s_add_u32 m0, s54, 102400
    s_add_u32 s32, s50, 4325376
    buffer_load_dwordx4 v20, s[12:15], s32 offen lds
    s_add_u32 m0, s54, 106496
    s_add_u32 s32, s50, 3932288
    buffer_load_dwordx4 v20, s[12:15], s32 offen lds
    s_add_u32 m0, s54, 110592
    s_add_u32 s32, s50, 4325504
    buffer_load_dwordx4 v20, s[12:15], s32 offen lds
    s_add_u32 m0, s54, 114688
    s_add_u32 s32, s50, 3932416
    buffer_load_dwordx4 v20, s[12:15], s32 offen lds
    s_add_u32 m0, s54, 118784
    s_add_u32 s32, s50, 4325632
    buffer_load_dwordx4 v20, s[12:15], s32 offen lds
    v_add_u32 v9, 0x18000, v6
    ds_read_b64_tr_b16 a[248:249], v9 offset:24576
    ds_read_b64_tr_b16 a[250:251], v9 offset:26624
    ds_read_b64_tr_b16 a[252:253], v9 offset:28672
    ds_read_b64_tr_b16 a[254:255], v9 offset:30720
    v_add_u32 v10, 0x20000, v6
    ds_read_b64_tr_b16 v[136:137], v10 offset:0
    ds_read_b64_tr_b16 v[138:139], v10 offset:2048
    ds_read_b64_tr_b16 v[140:141], v10 offset:4096
    ds_read_b64_tr_b16 v[142:143], v10 offset:6144
    ds_read_b64_tr_b16 v[152:153], v10 offset:8192
    ds_read_b64_tr_b16 v[154:155], v10 offset:10240
    ds_read_b64_tr_b16 v[156:157], v10 offset:12288
    ds_read_b64_tr_b16 v[158:159], v10 offset:14336
    s_waitcnt lgkmcnt(4)
    s_waitcnt lgkmcnt(0)
    s_waitcnt vmcnt(24)
    s_barrier
    s_add_u32 m0, s54, 122880
    s_add_u32 s32, s50, 3932160
    buffer_load_dwordx4 v20, s[16:19], s32 offen lds
    s_add_u32 m0, s54, 126976
    s_add_u32 s32, s50, 4325376
    buffer_load_dwordx4 v20, s[16:19], s32 offen lds
    s_add_u32 m0, s54, 131072
    s_add_u32 s32, s50, 3932288
    buffer_load_dwordx4 v20, s[16:19], s32 offen lds
    s_add_u32 m0, s54, 135168
    s_add_u32 s32, s50, 4325504
    buffer_load_dwordx4 v20, s[16:19], s32 offen lds
    s_add_u32 m0, s54, 139264
    s_add_u32 s32, s50, 3932416
    buffer_load_dwordx4 v20, s[16:19], s32 offen lds
    s_add_u32 m0, s54, 143360
    s_add_u32 s32, s50, 4325632
    buffer_load_dwordx4 v20, s[16:19], s32 offen lds
    ds_read_b64_tr_b16 v[24:25], v6 offset:0
    ds_read_b64_tr_b16 v[26:27], v6 offset:2048
    ds_read_b64_tr_b16 v[28:29], v6 offset:4096
    ds_read_b64_tr_b16 v[30:31], v6 offset:6144
    ds_read_b64_tr_b16 v[40:41], v6 offset:8192
    ds_read_b64_tr_b16 v[42:43], v6 offset:10240
    ds_read_b64_tr_b16 v[44:45], v6 offset:12288
    ds_read_b64_tr_b16 v[46:47], v6 offset:14336
    ds_read_b64_tr_b16 v[56:57], v6 offset:16384
    ds_read_b64_tr_b16 v[58:59], v6 offset:18432
    ds_read_b64_tr_b16 v[60:61], v6 offset:20480
    ds_read_b64_tr_b16 v[62:63], v6 offset:22528
    s_waitcnt lgkmcnt(4)
    s_waitcnt lgkmcnt(0)
    s_waitcnt vmcnt(24)
    s_barrier
    s_add_u32 m0, s54, 0
    s_add_u32 s32, s50, 4718592
    buffer_load_dwordx4 v20, s[12:15], s32 offen lds
    s_add_u32 m0, s54, 4096
    s_add_u32 s32, s50, 5111808
    buffer_load_dwordx4 v20, s[12:15], s32 offen lds
    s_add_u32 m0, s54, 8192
    s_add_u32 s32, s50, 4718720
    buffer_load_dwordx4 v20, s[12:15], s32 offen lds
    s_add_u32 m0, s54, 12288
    s_add_u32 s32, s50, 5111936
    buffer_load_dwordx4 v20, s[12:15], s32 offen lds
    s_add_u32 m0, s54, 16384
    s_add_u32 s32, s50, 4718848
    buffer_load_dwordx4 v20, s[12:15], s32 offen lds
    s_add_u32 m0, s54, 20480
    s_add_u32 s32, s50, 5112064
    buffer_load_dwordx4 v20, s[12:15], s32 offen lds
    ds_read_b64_tr_b16 v[32:33], v6 offset:24576
    ds_read_b64_tr_b16 v[34:35], v6 offset:26624
    ds_read_b64_tr_b16 v[36:37], v6 offset:28672
    ds_read_b64_tr_b16 v[38:39], v6 offset:30720
    ds_read_b64_tr_b16 v[48:49], v6 offset:32768
    ds_read_b64_tr_b16 v[50:51], v6 offset:34816
    ds_read_b64_tr_b16 v[52:53], v6 offset:36864
    ds_read_b64_tr_b16 v[54:55], v6 offset:38912
    ds_read_b64_tr_b16 v[64:65], v6 offset:40960
    ds_read_b64_tr_b16 v[66:67], v6 offset:43008
    ds_read_b64_tr_b16 v[68:69], v6 offset:45056
    ds_read_b64_tr_b16 v[70:71], v6 offset:47104
    s_waitcnt lgkmcnt(4)
    s_waitcnt lgkmcnt(0)
    s_waitcnt vmcnt(24)
    s_barrier
    s_add_u32 m0, s54, 24576
    s_add_u32 s32, s50, 4718592
    buffer_load_dwordx4 v20, s[16:19], s32 offen lds
    s_add_u32 m0, s54, 28672
    s_add_u32 s32, s50, 5111808
    buffer_load_dwordx4 v20, s[16:19], s32 offen lds
    s_add_u32 m0, s54, 32768
    s_add_u32 s32, s50, 4718720
    buffer_load_dwordx4 v20, s[16:19], s32 offen lds
    s_add_u32 m0, s54, 36864
    s_add_u32 s32, s50, 5111936
    buffer_load_dwordx4 v20, s[16:19], s32 offen lds
    s_add_u32 m0, s54, 40960
    s_add_u32 s32, s50, 4718848
    buffer_load_dwordx4 v20, s[16:19], s32 offen lds
    s_add_u32 m0, s54, 45056
    s_add_u32 s32, s50, 5112064
    buffer_load_dwordx4 v20, s[16:19], s32 offen lds
    ds_read_b64_tr_b16 a[0:1], v6 offset:49152
    ds_read_b64_tr_b16 a[2:3], v6 offset:51200
    ds_read_b64_tr_b16 a[4:5], v6 offset:53248
    ds_read_b64_tr_b16 a[6:7], v6 offset:55296
    ds_read_b64_tr_b16 a[16:17], v6 offset:57344
    ds_read_b64_tr_b16 a[18:19], v6 offset:59392
    ds_read_b64_tr_b16 a[20:21], v6 offset:61440
    ds_read_b64_tr_b16 a[22:23], v6 offset:63488
    v_add_u32 v9, 0x10000, v6
    ds_read_b64_tr_b16 a[32:33], v9 offset:0
    ds_read_b64_tr_b16 a[34:35], v9 offset:2048
    ds_read_b64_tr_b16 a[36:37], v9 offset:4096
    ds_read_b64_tr_b16 a[38:39], v9 offset:6144
    s_waitcnt lgkmcnt(4)
    s_waitcnt lgkmcnt(0)
    s_waitcnt vmcnt(24)
    s_barrier
    s_add_u32 m0, s54, 49152
    s_add_u32 s32, s50, 5505024
    buffer_load_dwordx4 v20, s[12:15], s32 offen lds
    s_add_u32 m0, s54, 53248
    s_add_u32 s32, s50, 5898240
    buffer_load_dwordx4 v20, s[12:15], s32 offen lds
    s_add_u32 m0, s54, 57344
    s_add_u32 s32, s50, 5505152
    buffer_load_dwordx4 v20, s[12:15], s32 offen lds
    s_add_u32 m0, s54, 61440
    s_add_u32 s32, s50, 5898368
    buffer_load_dwordx4 v20, s[12:15], s32 offen lds
    s_add_u32 m0, s54, 65536
    s_add_u32 s32, s50, 5505280
    buffer_load_dwordx4 v20, s[12:15], s32 offen lds
    s_add_u32 m0, s54, 69632
    s_add_u32 s32, s50, 5898496
    buffer_load_dwordx4 v20, s[12:15], s32 offen lds
    v_add_u32 v10, 0x10000, v6
    ds_read_b64_tr_b16 a[8:9], v10 offset:8192
    ds_read_b64_tr_b16 a[10:11], v10 offset:10240
    ds_read_b64_tr_b16 a[12:13], v10 offset:12288
    ds_read_b64_tr_b16 a[14:15], v10 offset:14336
    ds_read_b64_tr_b16 a[24:25], v10 offset:16384
    ds_read_b64_tr_b16 a[26:27], v10 offset:18432
    ds_read_b64_tr_b16 a[28:29], v10 offset:20480
    ds_read_b64_tr_b16 a[30:31], v10 offset:22528
    ds_read_b64_tr_b16 a[40:41], v10 offset:24576
    ds_read_b64_tr_b16 a[42:43], v10 offset:26624
    ds_read_b64_tr_b16 a[44:45], v10 offset:28672
    ds_read_b64_tr_b16 a[46:47], v10 offset:30720
    s_waitcnt lgkmcnt(4)
    s_waitcnt lgkmcnt(0)
    s_waitcnt vmcnt(24)
    s_barrier
    s_add_u32 m0, s54, 73728
    s_add_u32 s32, s50, 5505024
    buffer_load_dwordx4 v20, s[16:19], s32 offen lds
    s_add_u32 m0, s54, 77824
    s_add_u32 s32, s50, 5898240
    buffer_load_dwordx4 v20, s[16:19], s32 offen lds
    s_add_u32 m0, s54, 81920
    s_add_u32 s32, s50, 5505152
    buffer_load_dwordx4 v20, s[16:19], s32 offen lds
    s_add_u32 m0, s54, 86016
    s_add_u32 s32, s50, 5898368
    buffer_load_dwordx4 v20, s[16:19], s32 offen lds
    s_add_u32 m0, s54, 90112
    s_add_u32 s32, s50, 5505280
    buffer_load_dwordx4 v20, s[16:19], s32 offen lds
    s_add_u32 m0, s54, 94208
    s_add_u32 s32, s50, 5898496
    buffer_load_dwordx4 v20, s[16:19], s32 offen lds
    v_add_u32 v9, 0x18000, v6
    ds_read_b64_tr_b16 a[192:193], v9 offset:0
    ds_read_b64_tr_b16 a[194:195], v9 offset:2048
    ds_read_b64_tr_b16 a[196:197], v9 offset:4096
    ds_read_b64_tr_b16 a[198:199], v9 offset:6144
    ds_read_b64_tr_b16 a[208:209], v9 offset:8192
    ds_read_b64_tr_b16 a[210:211], v9 offset:10240
    ds_read_b64_tr_b16 a[212:213], v9 offset:12288
    ds_read_b64_tr_b16 a[214:215], v9 offset:14336
    ds_read_b64_tr_b16 a[224:225], v9 offset:16384
    ds_read_b64_tr_b16 a[226:227], v9 offset:18432
    ds_read_b64_tr_b16 a[228:229], v9 offset:20480
    ds_read_b64_tr_b16 a[230:231], v9 offset:22528
    s_waitcnt lgkmcnt(4)
    s_waitcnt lgkmcnt(0)
    s_waitcnt vmcnt(24)
    s_barrier
    s_add_u32 m0, s54, 98304
    s_add_u32 s32, s50, 6291456
    buffer_load_dwordx4 v20, s[12:15], s32 offen lds
    s_add_u32 m0, s54, 102400
    s_add_u32 s32, s50, 6684672
    buffer_load_dwordx4 v20, s[12:15], s32 offen lds
    s_add_u32 m0, s54, 106496
    s_add_u32 s32, s50, 6291584
    buffer_load_dwordx4 v20, s[12:15], s32 offen lds
    s_add_u32 m0, s54, 110592
    s_add_u32 s32, s50, 6684800
    buffer_load_dwordx4 v20, s[12:15], s32 offen lds
    s_add_u32 m0, s54, 114688
    s_add_u32 s32, s50, 6291712
    buffer_load_dwordx4 v20, s[12:15], s32 offen lds
    s_add_u32 m0, s54, 118784
    s_add_u32 s32, s50, 6684928
    buffer_load_dwordx4 v20, s[12:15], s32 offen lds
    v_add_u32 v10, 0x18000, v6
    ds_read_b64_tr_b16 a[200:201], v10 offset:24576
    ds_read_b64_tr_b16 a[202:203], v10 offset:26624
    ds_read_b64_tr_b16 a[204:205], v10 offset:28672
    ds_read_b64_tr_b16 a[206:207], v10 offset:30720
    v_add_u32 v9, 0x20000, v6
    ds_read_b64_tr_b16 a[216:217], v9 offset:0
    ds_read_b64_tr_b16 a[218:219], v9 offset:2048
    ds_read_b64_tr_b16 a[220:221], v9 offset:4096
    ds_read_b64_tr_b16 a[222:223], v9 offset:6144
    ds_read_b64_tr_b16 a[232:233], v9 offset:8192
    ds_read_b64_tr_b16 a[234:235], v9 offset:10240
    ds_read_b64_tr_b16 a[236:237], v9 offset:12288
    ds_read_b64_tr_b16 a[238:239], v9 offset:14336
    s_waitcnt lgkmcnt(4)
    s_waitcnt lgkmcnt(0)
    s_waitcnt vmcnt(24)
    s_barrier
    s_add_u32 m0, s54, 122880
    s_add_u32 s32, s50, 6291456
    buffer_load_dwordx4 v20, s[16:19], s32 offen lds
    s_add_u32 m0, s54, 126976
    s_add_u32 s32, s50, 6684672
    buffer_load_dwordx4 v20, s[16:19], s32 offen lds
    s_add_u32 m0, s54, 131072
    s_add_u32 s32, s50, 6291584
    buffer_load_dwordx4 v20, s[16:19], s32 offen lds
    s_add_u32 m0, s54, 135168
    s_add_u32 s32, s50, 6684800
    buffer_load_dwordx4 v20, s[16:19], s32 offen lds
    s_add_u32 m0, s54, 139264
    s_add_u32 s32, s50, 6291712
    buffer_load_dwordx4 v20, s[16:19], s32 offen lds
    s_add_u32 m0, s54, 143360
    s_add_u32 s32, s50, 6684928
    buffer_load_dwordx4 v20, s[16:19], s32 offen lds
    ds_read_b64_tr_b16 v[208:209], v6 offset:0
    ds_read_b64_tr_b16 v[210:211], v6 offset:2048
    ds_read_b64_tr_b16 v[212:213], v6 offset:4096
    ds_read_b64_tr_b16 v[214:215], v6 offset:6144
    ds_read_b64_tr_b16 v[224:225], v6 offset:8192
    ds_read_b64_tr_b16 v[226:227], v6 offset:10240
    ds_read_b64_tr_b16 v[228:229], v6 offset:12288
    ds_read_b64_tr_b16 v[230:231], v6 offset:14336
    ds_read_b64_tr_b16 v[240:241], v6 offset:16384
    ds_read_b64_tr_b16 v[242:243], v6 offset:18432
    ds_read_b64_tr_b16 v[244:245], v6 offset:20480
    ds_read_b64_tr_b16 v[246:247], v6 offset:22528
    s_waitcnt lgkmcnt(4)
    s_waitcnt lgkmcnt(0)
    s_waitcnt vmcnt(24)
    s_barrier
    s_add_u32 m0, s54, 0
    s_add_u32 s32, s50, 7077888
    buffer_load_dwordx4 v20, s[12:15], s32 offen lds
    s_add_u32 m0, s54, 4096
    s_add_u32 s32, s50, 7471104
    buffer_load_dwordx4 v20, s[12:15], s32 offen lds
    s_add_u32 m0, s54, 8192
    s_add_u32 s32, s50, 7078016
    buffer_load_dwordx4 v20, s[12:15], s32 offen lds
    s_add_u32 m0, s54, 12288
    s_add_u32 s32, s50, 7471232
    buffer_load_dwordx4 v20, s[12:15], s32 offen lds
    s_add_u32 m0, s54, 16384
    s_add_u32 s32, s50, 7078144
    buffer_load_dwordx4 v20, s[12:15], s32 offen lds
    s_add_u32 m0, s54, 20480
    s_add_u32 s32, s50, 7471360
    buffer_load_dwordx4 v20, s[12:15], s32 offen lds
    ds_read_b64_tr_b16 v[216:217], v6 offset:24576
    ds_read_b64_tr_b16 v[218:219], v6 offset:26624
    ds_read_b64_tr_b16 v[220:221], v6 offset:28672
    ds_read_b64_tr_b16 v[222:223], v6 offset:30720
    ds_read_b64_tr_b16 v[232:233], v6 offset:32768
    ds_read_b64_tr_b16 v[234:235], v6 offset:34816
    ds_read_b64_tr_b16 v[236:237], v6 offset:36864
    ds_read_b64_tr_b16 v[238:239], v6 offset:38912
    ds_read_b64_tr_b16 v[248:249], v6 offset:40960
    ds_read_b64_tr_b16 v[250:251], v6 offset:43008
    ds_read_b64_tr_b16 v[252:253], v6 offset:45056
    ds_read_b64_tr_b16 v[254:255], v6 offset:47104
    s_waitcnt lgkmcnt(4)
    s_waitcnt lgkmcnt(0)
    s_waitcnt vmcnt(24)
    s_barrier
    s_add_u32 m0, s54, 24576
    s_add_u32 s32, s50, 7077888
    buffer_load_dwordx4 v20, s[16:19], s32 offen lds
    s_add_u32 m0, s54, 28672
    s_add_u32 s32, s50, 7471104
    buffer_load_dwordx4 v20, s[16:19], s32 offen lds
    s_add_u32 m0, s54, 32768
    s_add_u32 s32, s50, 7078016
    buffer_load_dwordx4 v20, s[16:19], s32 offen lds
    s_add_u32 m0, s54, 36864
    s_add_u32 s32, s50, 7471232
    buffer_load_dwordx4 v20, s[16:19], s32 offen lds
    s_add_u32 m0, s54, 40960
    s_add_u32 s32, s50, 7078144
    buffer_load_dwordx4 v20, s[16:19], s32 offen lds
    s_add_u32 m0, s54, 45056
    s_add_u32 s32, s50, 7471360
    buffer_load_dwordx4 v20, s[16:19], s32 offen lds
    s_mov_b32 s28, s88
    s_and_b32 s29, s89, 0xffff
    s_mov_b32 s30, 0x100
    s_mov_b32 s31, 0x20000
    v_mov_b32 v2, 0
    buffer_load_dword v3, v2, s[28:31], 0 offen offset:60 sc1
    ds_read_b64_tr_b16 v[72:73], v6 offset:49152
    ds_read_b64_tr_b16 v[74:75], v6 offset:51200
    ds_read_b64_tr_b16 v[76:77], v6 offset:53248
    ds_read_b64_tr_b16 v[78:79], v6 offset:55296
    ds_read_b64_tr_b16 v[88:89], v6 offset:57344
    ds_read_b64_tr_b16 v[90:91], v6 offset:59392
    ds_read_b64_tr_b16 v[92:93], v6 offset:61440
    ds_read_b64_tr_b16 v[94:95], v6 offset:63488
    v_add_u32 v10, 0x10000, v6
    ds_read_b64_tr_b16 v[104:105], v10 offset:0
    ds_read_b64_tr_b16 v[106:107], v10 offset:2048
    ds_read_b64_tr_b16 v[108:109], v10 offset:4096
    ds_read_b64_tr_b16 v[110:111], v10 offset:6144
    s_waitcnt lgkmcnt(4)
    s_waitcnt lgkmcnt(0)
    s_waitcnt vmcnt(25)
    s_barrier
    v_add_u32 v9, 0x10000, v6
    ds_read_b64_tr_b16 v[80:81], v9 offset:8192
    ds_read_b64_tr_b16 v[82:83], v9 offset:10240
    ds_read_b64_tr_b16 v[84:85], v9 offset:12288
    ds_read_b64_tr_b16 v[86:87], v9 offset:14336
    ds_read_b64_tr_b16 v[96:97], v9 offset:16384
    ds_read_b64_tr_b16 v[98:99], v9 offset:18432
    ds_read_b64_tr_b16 v[100:101], v9 offset:20480
    ds_read_b64_tr_b16 v[102:103], v9 offset:22528
    ds_read_b64_tr_b16 v[112:113], v9 offset:24576
    ds_read_b64_tr_b16 v[114:115], v9 offset:26624
    ds_read_b64_tr_b16 v[116:117], v9 offset:28672
    ds_read_b64_tr_b16 v[118:119], v9 offset:30720
    s_waitcnt lgkmcnt(4)
    s_waitcnt lgkmcnt(0)
    s_waitcnt vmcnt(19)
    s_barrier
    v_add_u32 v10, 0x18000, v6
    ds_read_b64_tr_b16 a[48:49], v10 offset:0
    ds_read_b64_tr_b16 a[50:51], v10 offset:2048
    ds_read_b64_tr_b16 a[52:53], v10 offset:4096
    ds_read_b64_tr_b16 a[54:55], v10 offset:6144
    ds_read_b64_tr_b16 a[64:65], v10 offset:8192
    ds_read_b64_tr_b16 a[66:67], v10 offset:10240
    ds_read_b64_tr_b16 a[68:69], v10 offset:12288
    ds_read_b64_tr_b16 a[70:71], v10 offset:14336
    ds_read_b64_tr_b16 a[80:81], v10 offset:16384
    ds_read_b64_tr_b16 a[82:83], v10 offset:18432
    ds_read_b64_tr_b16 a[84:85], v10 offset:20480
    ds_read_b64_tr_b16 a[86:87], v10 offset:22528
    s_waitcnt lgkmcnt(4)
    s_waitcnt lgkmcnt(0)
    s_waitcnt vmcnt(13)
    s_barrier
    v_add_u32 v9, 0x18000, v6
    ds_read_b64_tr_b16 a[56:57], v9 offset:24576
    ds_read_b64_tr_b16 a[58:59], v9 offset:26624
    ds_read_b64_tr_b16 a[60:61], v9 offset:28672
    ds_read_b64_tr_b16 a[62:63], v9 offset:30720
    v_add_u32 v10, 0x20000, v6
    ds_read_b64_tr_b16 a[72:73], v10 offset:0
    ds_read_b64_tr_b16 a[74:75], v10 offset:2048
    ds_read_b64_tr_b16 a[76:77], v10 offset:4096
    ds_read_b64_tr_b16 a[78:79], v10 offset:6144
    ds_read_b64_tr_b16 a[88:89], v10 offset:8192
    ds_read_b64_tr_b16 a[90:91], v10 offset:10240
    ds_read_b64_tr_b16 a[92:93], v10 offset:12288
    ds_read_b64_tr_b16 a[94:95], v10 offset:14336
    s_waitcnt lgkmcnt(4)
    s_waitcnt lgkmcnt(0)
    s_waitcnt vmcnt(7)
    s_barrier
    ds_read_b64_tr_b16 v[160:161], v6 offset:0
    ds_read_b64_tr_b16 v[162:163], v6 offset:2048
    ds_read_b64_tr_b16 v[164:165], v6 offset:4096
    ds_read_b64_tr_b16 v[166:167], v6 offset:6144
    ds_read_b64_tr_b16 v[176:177], v6 offset:8192
    ds_read_b64_tr_b16 v[178:179], v6 offset:10240
    ds_read_b64_tr_b16 v[180:181], v6 offset:12288
    ds_read_b64_tr_b16 v[182:183], v6 offset:14336
    ds_read_b64_tr_b16 v[192:193], v6 offset:16384
    ds_read_b64_tr_b16 v[194:195], v6 offset:18432
    ds_read_b64_tr_b16 v[196:197], v6 offset:20480
    ds_read_b64_tr_b16 v[198:199], v6 offset:22528
    s_waitcnt lgkmcnt(4)
    s_waitcnt lgkmcnt(0)
    s_waitcnt vmcnt(1)
    s_barrier
    ds_read_b64_tr_b16 v[168:169], v6 offset:24576
    ds_read_b64_tr_b16 v[170:171], v6 offset:26624
    ds_read_b64_tr_b16 v[172:173], v6 offset:28672
    ds_read_b64_tr_b16 v[174:175], v6 offset:30720
    ds_read_b64_tr_b16 v[184:185], v6 offset:32768
    ds_read_b64_tr_b16 v[186:187], v6 offset:34816
    ds_read_b64_tr_b16 v[188:189], v6 offset:36864
    ds_read_b64_tr_b16 v[190:191], v6 offset:38912
    ds_read_b64_tr_b16 v[200:201], v6 offset:40960
    ds_read_b64_tr_b16 v[202:203], v6 offset:43008
    ds_read_b64_tr_b16 v[204:205], v6 offset:45056
    ds_read_b64_tr_b16 v[206:207], v6 offset:47104
    s_waitcnt lgkmcnt(4)
    s_waitcnt lgkmcnt(0)
    s_barrier
A_ld_wx:
    ds_write_b128 v7, v[24:27] offset:0
    ds_write_b128 v7, v[28:31] offset:1024
    ds_write_b128 v7, v[32:35] offset:2048
    ds_write_b128 v7, v[36:39] offset:3072
    ds_write_b128 v7, v[40:43] offset:4096
    ds_write_b128 v7, v[44:47] offset:5120
    ds_write_b128 v7, v[48:51] offset:6144
    ds_write_b128 v7, v[52:55] offset:7168
    ds_write_b128 v7, v[56:59] offset:8192
    ds_write_b128 v7, v[60:63] offset:9216
    ds_write_b128 v7, v[64:67] offset:10240
    ds_write_b128 v7, v[68:71] offset:11264
    s_waitcnt lgkmcnt(4)
    ds_write_b128 v7, v[72:75] offset:12288
    ds_write_b128 v7, v[76:79] offset:13312
    ds_write_b128 v7, v[80:83] offset:14336
    ds_write_b128 v7, v[84:87] offset:15360
    ds_write_b128 v7, v[88:91] offset:16384
    ds_write_b128 v7, v[92:95] offset:17408
    ds_write_b128 v7, v[96:99] offset:18432
    ds_write_b128 v7, v[100:103] offset:19456
    s_waitcnt lgkmcnt(4)
    ds_write_b128 v7, v[104:107] offset:20480
    ds_write_b128 v7, v[108:111] offset:21504
    ds_write_b128 v7, v[112:115] offset:22528
    ds_write_b128 v7, v[116:119] offset:23552
    s_waitcnt lgkmcnt(0)
    s_mov_b32 s52, 1048576
    s_branch prepw_ck_91
prepw_89:
    buffer_load_dword v3, v2, s[28:31], 0 offen offset:60 sc1
prepw_ck_91:
    s_waitcnt vmcnt(0)
    v_readfirstlane_b32 s32, v3
    s_nop 1
    s_and_b32 s33, s32, 255
    s_cmp_ge_u32 s33, 56
    s_cbranch_scc1 prepw_ok_90
    s_cmp_eq_u32 s52, 0
    s_cbranch_scc1 prepw_ok_90
    s_sub_u32 s52, s52, 1
    s_sleep 4
    s_branch prepw_89
prepw_ok_90:
    s_bfe_u32 s33, s32, 0x80008
    s_bfe_u32 s34, s32, 0x80018
    s_add_u32 s33, s33, s34
    s_bfe_u32 s34, s32, 0x80010
    s_sub_u32 s33, s33, s34
    s_cmp_ge_i32 s33, 28
    s_cselect_b32 s96, 0, 8192
    s_mov_b32 s98, s96
    s_xor_b32 s97, s96, 8192
    s_add_u32 s99, s96, 0xa20d000
    v_lshlrev_b32 v13, 4, v0
    v_lshlrev_b32 v12, 4, v1
    v_and_b32 v2, 8, v1
    v_mov_b32 v3, 0x4444
    v_mov_b32 v4, 0xeeee
    v_cmp_eq_u32 vcc, 0, v2
    s_nop 1
    v_cndmask_b32 v11, v4, v3, vcc
    v_lshrrev_b32 v2, 4, v1
    v_and_b32 v3, 15, v1
    v_lshlrev_b32 v4, 5, v3
    v_lshl_add_u32 v4, v2, 3, v4
    s_lshl_b32 s32, s4, 9
    v_add_u32 v15, s32, v4
    v_lshlrev_b32 v16, 3, v1
    v_add_u32 v19, 16384, v12
    s_lshl_b32 s33, s6, 4
    s_add_u32 s33, s33, s99
    s_and_b32 s32, s6, 7
    s_cselect_b32 s5, 0x40000000, s33
    s_cmp_eq_u32 s6, 0
    s_cselect_b32 s7, s99, 0x40000000
    v_mov_b32 v4, 0x40000000
    v_mov_b32 v5, s5
    v_cmp_eq_u32 vcc, 192, v0
    s_nop 1
    v_cndmask_b32 v8, v4, v5, vcc
    v_min_u32 v9, 3, v1
    v_lshlrev_b32 v9, 7, v9
    s_xor_b32 s51, s4, 3
    s_or_b32 s51, s51, s6
    v_mov_b32 v10, 0
    v_mov_b32 v6, -1
    s_mov_b32 s100, 138
    s_mov_b32 s101, 70
    v_cmp_le_u32 s[60:61], 2, v2
    s_sub_u32 s32, s4, 1
    s_lshl_b32 s32, s32, 4
    v_add_u32 v4, s32, v3
    v_lshl_add_u32 v5, v2, 2, 0
    v_cmp_le_u32 s[64:65], v5, v4
    v_add_u32 v5, 16, v5
    v_cmp_le_u32 s[72:73], v5, v4
    v_lshl_add_u32 v5, v2, 2, 1
    v_cmp_le_u32 s[66:67], v5, v4
    v_add_u32 v5, 16, v5
    v_cmp_le_u32 s[74:75], v5, v4
    v_lshl_add_u32 v5, v2, 2, 2
    v_cmp_le_u32 s[68:69], v5, v4
    v_add_u32 v5, 16, v5
    v_cmp_le_u32 s[76:77], v5, v4
    v_lshl_add_u32 v5, v2, 2, 3
    v_cmp_le_u32 s[70:71], v5, v4
    v_add_u32 v5, 16, v5
    v_cmp_le_u32 s[78:79], v5, v4
    v_mov_b32 v20, 0x40000000
    s_cmp_eq_u32 s4, 0
    s_cbranch_scc0 A_c1
    v_lshlrev_b32 v4, 7, v2
    v_lshl_add_u32 v4, v3, 4, v4
    v_cmp_gt_u32 vcc, 8, v3
    s_nop 1
    v_cndmask_b32 v17, v20, v4, vcc
    v_lshlrev_b32 v4, 4, v3
    v_add_u32 v4, 512, v4
    v_cndmask_b32 v4, v20, v4, vcc
    v_cmp_eq_u32 vcc, 2, v2
    s_nop 1
    v_cndmask_b32 v18, v20, v4, vcc
    v_mov_b32 v4, 0xff61b1e6
    v_cndmask_b32 v20, v4, 0, s[60:61]
    v_cndmask_b32 v21, v4, 0, s[60:61]
    v_cndmask_b32 v22, v4, 0, s[60:61]
    v_cndmask_b32 v23, v4, 0, s[60:61]
    s_nop 1
    s_branch A_c2
A_c1:
    s_lshl_b32 s33, s32, 6
    v_add_u32 v17, s33, v12
    s_lshl_b32 s33, s32, 4
    s_add_u32 s33, s33, 2048
    v_lshlrev_b32 v4, 4, v3
    v_add_u32 v4, s33, v4
    v_cmp_eq_u32 vcc, 2, v2
    s_nop 1
    v_cndmask_b32 v18, v20, v4, vcc
    v_mov_b32 v20, 0
    v_and_b32 v2, 31, v1
    v_lshlrev_b32 v2, 7, v2
    v_lshrrev_b32 v3, 5, v1
    v_lshl_add_u32 v2, v3, 15, v2
    v_add_u32 v21, 30720, v2
    s_nop 1
A_c2:
    s_mov_b32 s48, 0
    s_mov_b32 s52, 4194304
    s_mov_b32 s58, 0x3dd53b95
    s_mov_b32 s59, 0x3dd53b95
    s_memrealtime s[44:45]
    s_waitcnt lgkmcnt(0)
    s_mov_b32 s49, s44
    s_mov_b32 s55, 16384
    s_lshr_b32 s57, s6, 3
    s_lshl_b32 s57, s57, 14
    s_and_b32 s32, s6, 7
    s_mul_i32 s32, s32, 640
    s_add_u32 s57, s57, s32
    s_mul_i32 s33, s6, 6
    v_and_b32 v2, 1, v1
    v_mul_u32_u24 v2, 5, v2
    v_add_u32 v2, s33, v2
    v_lshrrev_b32 v2, 3, v2
    v_lshlrev_b32 v2, 4, v2
    v_and_b32 v5, 2, v1
    v_lshl_add_u32 v2, v5, 8, v2
    s_mul_i32 s32, s48, 2048
    s_add_u32 s32, s32, 0xa800000
kq_poll_92:
    buffer_load_dword v3, v2, s[8:11], s32 offen sc1
    s_waitcnt vmcnt(0)
    v_cmp_gt_i32 vcc, s48, v3
    s_cbranch_vccz kq_ok_93
    s_cmp_eq_u32 s52, 0
    s_cbranch_scc1 kq_ok_93
    s_sub_u32 s52, s52, 1
    s_sleep 1
    s_branch kq_poll_92
kq_ok_93:
    s_cmp_lg_u32 s4, 3
    s_cbranch_scc1 A_k1
    s_sub_u32 s79, s49, 1000
    s_lshl_b32 s79, s79, 7
    s_mul_i32 s32, s48, 393216
    s_mul_i32 s33, s6, 12288
    s_add_u32 s32, s32, s33
    s_add_u32 m0, s55, 0
    s_add_u32 s33, s32, 0x1c00000
    buffer_load_dwordx4 v12, s[8:11], s33 offen offset:0 sc1 lds
    buffer_load_dwordx4 v12, s[8:11], s33 offen offset:1024 sc1 lds
    buffer_load_dwordx4 v12, s[8:11], s33 offen offset:2048 sc1 lds
    buffer_load_dwordx4 v12, s[8:11], s33 offen offset:3072 sc1 lds
    s_add_u32 m0, s55, 4096
    s_add_u32 s33, s32, 0x1c01000
    buffer_load_dwordx4 v12, s[8:11], s33 offen offset:0 sc1 lds
    buffer_load_dwordx4 v12, s[8:11], s33 offen offset:1024 sc1 lds
    buffer_load_dwordx4 v12, s[8:11], s33 offen offset:2048 sc1 lds
    buffer_load_dwordx4 v12, s[8:11], s33 offen offset:3072 sc1 lds
    s_add_u32 m0, s55, 8192
    s_add_u32 s33, s32, 0x1c02000
    buffer_load_dwordx4 v12, s[8:11], s33 offen offset:0 sc1 lds
    buffer_load_dwordx4 v12, s[8:11], s33 offen offset:1024 sc1 lds
    buffer_load_dwordx4 v12, s[8:11], s33 offen offset:2048 sc1 lds
    buffer_load_dwordx4 v12, s[8:11], s33 offen offset:3072 sc1 lds
A_k1:
    s_cmp_lg_u32 s4, 0
    s_cbranch_scc1 A_k0
    s_mul_i32 s32, s48, 393216
    s_mul_i32 s33, s6, 12288
    s_add_u32 s32, s32, s33
    s_add_u32 m0, s55, 12288
    s_add_u32 s33, s32, 0x400000
    buffer_load_dwordx4 v12, s[8:11], s33 offen offset:0 sc1 lds
    buffer_load_dwordx4 v12, s[8:11], s33 offen offset:1024 sc1 lds
    buffer_load_dwordx4 v12, s[8:11], s33 offen offset:2048 sc1 lds
    buffer_load_dwordx4 v12, s[8:11], s33 offen offset:3072 sc1 lds
    s_add_u32 m0, s55, 16384
    s_add_u32 s33, s32, 0x401000
    buffer_load_dwordx4 v12, s[8:11], s33 offen offset:0 sc1 lds
    buffer_load_dwordx4 v12, s[8:11], s33 offen offset:1024 sc1 lds
    buffer_load_dwordx4 v12, s[8:11], s33 offen offset:2048 sc1 lds
    buffer_load_dwordx4 v12, s[8:11], s33 offen offset:3072 sc1 lds
    s_add_u32 m0, s55, 20480
    s_add_u32 s33, s32, 0x402000
    buffer_load_dwordx4 v12, s[8:11], s33 offen offset:0 sc1 lds
    buffer_load_dwordx4 v12, s[8:11], s33 offen offset:1024 sc1 lds
    buffer_load_dwordx4 v12, s[8:11], s33 offen offset:2048 sc1 lds
    buffer_load_dwordx4 v12, s[8:11], s33 offen offset:3072 sc1 lds
A_k0:
    v_mov_b32 v14, -1
    v_and_b32 v0, 15, v1
    s_lshl_b32 s32, s4, 7
    v_lshl_add_u32 v0, v0, 3, s32
    ds_write_b32 v0, v10 offset:8192
    ds_write_b32 v0, v10 offset:8704
    s_waitcnt lgkmcnt(0)
    s_barrier
    s_mov_b32 s28, 1
    s_mov_b32 s29, 1
A_loop:
    ds_read_b128 v[96:99], v7 offset:0
    ds_read_b128 v[100:103], v7 offset:1024
    ds_read_b128 v[104:107], v7 offset:2048
    ds_read_b128 v[108:111], v7 offset:3072
    ds_read_b128 v[112:115], v7 offset:12288
    ds_read_b128 v[116:119], v7 offset:13312
    ds_read_b128 v[120:123], v7 offset:14336
    ds_read_b128 v[124:127], v7 offset:15360
    v_mov_b32 v72, 0
    v_mov_b32 v73, 0
    v_mov_b32 v74, 0
    v_mov_b32 v75, 0
    v_mov_b32 v76, 0
    v_mov_b32 v77, 0
    v_mov_b32 v78, 0
    v_mov_b32 v79, 0
    v_mov_b32 v80, 0
    v_mov_b32 v81, 0
    v_mov_b32 v82, 0
    v_mov_b32 v83, 0
    v_mov_b32 v84, 0
    v_mov_b32 v85, 0
    v_mov_b32 v86, 0
    v_mov_b32 v87, 0
    v_mov_b32 v88, 0
    v_mov_b32 v89, 0
    v_mov_b32 v90, 0
    v_mov_b32 v91, 0
    v_mov_b32 v92, 0
    v_mov_b32 v93, 0
    v_mov_b32 v94, 0
    v_mov_b32 v95, 0
    v_xor_b32 v64, 1024, v13
    v_xor_b32 v65, 2048, v13
    v_xor_b32 v66, 3072, v13
    s_xor_b32 s55, s55, 57344
    s_cmp_lt_u32 s48, 32
    s_cselect_b32 s56, s97, s98
    s_lshl_b32 s47, s48, 16
    s_add_u32 s56, s56, s47
    s_add_u32 s56, s56, 0xa400000
    s_add_u32 s56, s56, s57
    s_lshl_b32 s32, s48, 15
    s_add_u32 s32, s32, s96
    s_add_u32 s32, s32, 0xa200000
    s_add_u32 s33, s32, 4096
    s_add_u32 s34, s32, 16384
    s_mov_b32 s63, s48
    buffer_load_dword v3, v10, s[8:11], s99 offen offset:1024 sc1
    s_andn2_b32 s47, 1, s63
    s_lshl_b32 s47, s47, 9
    s_add_u32 s47, s47, s99
    buffer_load_dword v6, v9, s[8:11], s47 offen offset:4 sc1
    s_waitcnt vmcnt(0) lgkmcnt(0)
    v_readfirstlane_b32 s29, v3
    s_mov_b32 s50, 0
    s_and_b32 s29, s29, 0xffff
    s_min_u32 s29, s29, 170
    s_sub_u32 s29, s29, 71
    s_max_i32 s29, s29, 56
    s_min_i32 s29, s29, 75
    s_lshl_b32 s29, s29, 7
    s_cmp_lg_u32 s48, 1
    s_cbranch_scc1 A1_nr
    v_min_u32 v4, 19, v1
    v_lshlrev_b32 v4, 7, v4
    s_add_u32 s40, s99, 63488
    s_mov_b32 s41, 0
A1_poll_94:
    buffer_load_dword v2, v4, s[8:11], s40 offen sc1
    s_waitcnt vmcnt(0)
    v_cmp_gt_i32 vcc, s41, v2
    s_cbranch_vccz A1_ok_95
    s_cmp_eq_u32 s52, 0
    s_cbranch_scc1 A1_ok_95
    s_sub_u32 s52, s52, 1
    s_sleep 1
    s_branch A1_poll_94
A1_ok_95:
    s_memrealtime s[44:45]
    s_waitcnt lgkmcnt(0)
    s_lshl_b32 s44, s44, 7
    s_mov_b32 s62, s44
    s_branch A_go
A1_nr:
    s_andn2_b32 s47, 1, s63
    s_lshl_b32 s47, s47, 9
    s_add_u32 s47, s47, s99
    s_memrealtime s[44:45]
    s_waitcnt lgkmcnt(0)
    s_lshl_b32 s44, s44, 7
    s_cmp_eq_u32 s63, 0
    s_cbranch_scc1 door_lt_100
    s_branch door_ck_98
door_ag_99:
    s_cmp_eq_u32 s52, 0
    s_cbranch_scc1 door_lt_100
    s_sub_u32 s52, s52, 1
    buffer_load_dword v6, v9, s[8:11], s47 offen offset:4 sc1
    s_sleep 4
door_ck_98:
    s_memrealtime s[44:45]
    v_readlane_b32 s62, v6, 0
    v_readlane_b32 s41, v6, 1
    v_readlane_b32 s42, v6, 2
    v_readlane_b32 s43, v6, 3
    s_sub_u32 s40, s41, s62
    s_and_b32 s40, s40, 0x8000007f
    s_cmp_eq_u32 s40, 0
    s_cmov_b32 s62, s41
    s_sub_u32 s40, s42, s62
    s_and_b32 s40, s40, 0x8000007f
    s_cmp_eq_u32 s40, 0
    s_cmov_b32 s62, s42
    s_sub_u32 s40, s43, s62
    s_and_b32 s40, s40, 0x8000007f
    s_cmp_eq_u32 s40, 0
    s_cmov_b32 s62, s43
    s_add_u32 s46, s62, 1
    s_and_b32 s46, s46, 127
    s_add_u32 s62, s62, 0x0
    s_waitcnt lgkmcnt(0)
    s_lshl_b32 s44, s44, 7
    s_cmp_lt_u32 s46, s63
    s_cbranch_scc1 door_ag_99
    s_cmp_gt_u32 s46, s63
    s_cbranch_scc1 door_lt_100
    s_sub_u32 s45, s44, s62
    s_cmp_lt_i32 s45, 0xfffff200
    s_cbranch_scc1 door_ag_99
    s_cmp_ge_i32 s45, 0
    s_cbranch_scc1 door_ok_97
door_md_101:
    s_cmp_ge_i32 s45, 0xfffffb00
    s_cbranch_scc1 door_96
    s_sleep 1
    s_memrealtime s[44:45]
    s_waitcnt lgkmcnt(0)
    s_lshl_b32 s44, s44, 7
    s_sub_u32 s45, s44, s62
    s_branch door_md_101
door_96:
    s_memrealtime s[44:45]
    s_waitcnt lgkmcnt(0)
    s_lshl_b32 s44, s44, 7
    s_sub_u32 s45, s44, s62
    s_cmp_lt_i32 s45, 0
    s_cbranch_scc1 door_96
    s_branch door_ok_97
door_lt_100:
    s_mov_b32 s62, s44
door_ok_97:
A_go:
    s_cmp_lg_u32 s51, 0
    s_cbranch_scc1 A_re_ret
    s_sub_u32 s36, s44, s79
    s_add_u32 s36, s36, 768
    s_cmp_gt_u32 s36, 2048
    s_cbranch_scc1 A_re
A_re_ret:
    s_add_u32 s63, s48, 1
    buffer_load_dwordx4 v[24:27], v13, s[8:11], s32 offen sc1
    s_nop 13
    buffer_load_dwordx4 v[28:31], v13, s[8:11], s33 offen sc1
    s_nop 13
    buffer_load_dwordx4 v[32:35], v12, s[8:11], s34 offen
    s_nop 13
    buffer_load_dwordx4 v[36:39], v12, s[8:11], s34 offen offset:1024
A_ml_102:
    s_waitcnt vmcnt(3)
    ds_write_b128 v13, v[24:27]
    v_smfmac_f32_16x16x64_bf16 v[72:75], v[24:27], a[0:7], v11
    v_max3_u32 v2, v24, v25, v26
    v_smfmac_f32_16x16x64_bf16 v[76:79], v[24:27], a[8:15], v11
    v_max_u32 v2, v2, v27
    v_smfmac_f32_16x16x64_bf16 v[80:83], v[24:27], a[16:23], v11
    v_smfmac_f32_16x16x64_bf16 v[84:87], v[24:27], a[24:31], v11
    v_smfmac_f32_16x16x64_bf16 v[88:91], v[24:27], a[32:39], v11
    v_smfmac_f32_16x16x64_bf16 v[92:95], v[24:27], a[40:47], v11
    s_waitcnt vmcnt(2)
    ds_write_b128 v13, v[28:31] offset:4096
    v_smfmac_f32_16x16x64_bf16 v[72:75], v[28:31], a[48:55], v11
    v_max3_u32 v2, v2, v28, v29
    v_smfmac_f32_16x16x64_bf16 v[76:79], v[28:31], a[56:63], v11
    v_max3_u32 v2, v2, v30, v31
    v_smfmac_f32_16x16x64_bf16 v[80:83], v[28:31], a[64:71], v11
    v_cmp_eq_u32 vcc, -1, v2
    v_smfmac_f32_16x16x64_bf16 v[84:87], v[28:31], a[72:79], v11
    s_cbranch_vccnz A_mrt_104
A_mok_103:
    s_waitcnt vmcnt(1)
    v_smfmac_f32_16x16x64_bf16 v[72:75], v[32:35], a[96:103], v11
    v_max3_u32 v2, v32, v33, v34
    v_smfmac_f32_16x16x64_bf16 v[76:79], v[32:35], a[104:111], v11
    v_max_u32 v2, v2, v35
    s_waitcnt lgkmcnt(0)
    s_barrier
    s_memrealtime s[44:45]
    ds_read_b128 v[40:43], v64 offset:0
    v_smfmac_f32_16x16x64_bf16 v[80:83], v[32:35], a[112:119], v11
    ds_read_b128 v[44:47], v65 offset:0
    v_smfmac_f32_16x16x64_bf16 v[84:87], v[32:35], a[120:127], v11
    ds_read_b128 v[48:51], v66 offset:0
    s_waitcnt vmcnt(0)
    v_smfmac_f32_16x16x64_bf16 v[72:75], v[36:39], a[144:151], v11
    ds_read_b128 v[52:55], v64 offset:4096
    v_max3_u32 v2, v2, v36, v37
    v_smfmac_f32_16x16x64_bf16 v[76:79], v[36:39], a[152:159], v11
    ds_read_b128 v[56:59], v65 offset:4096
    v_max3_u32 v2, v2, v38, v39
    v_smfmac_f32_16x16x64_bf16 v[80:83], v[36:39], a[160:167], v11
    ds_read_b128 v[60:63], v66 offset:4096
    v_cmp_eq_u32 vcc, -1, v2
    v_smfmac_f32_16x16x64_bf16 v[84:87], v[36:39], a[168:175], v11
    s_cbranch_vccnz A_crt_107
A_cok_106:
    s_waitcnt lgkmcnt(5)
    v_smfmac_f32_16x16x64_bf16 v[72:75], v[40:43], a[192:199], v11
    v_smfmac_f32_16x16x64_bf16 v[76:79], v[40:43], a[200:207], v11
    s_waitcnt lgkmcnt(4)
    v_smfmac_f32_16x16x64_bf16 v[72:75], v[44:47], a[240:247], v11
    v_smfmac_f32_16x16x64_bf16 v[76:79], v[44:47], a[248:255], v11
    s_waitcnt lgkmcnt(3)
    v_smfmac_f32_16x16x64_bf16 v[72:75], v[48:51], v[96:103], v11
    s_waitcnt lgkmcnt(0)
    s_lshl_b32 s45, s44, 7
    s_sub_u32 s45, s45, s62
    s_cmp_gt_i32 s45, s29
    s_cbranch_scc1 A_post
A_post_ret:
    v_smfmac_f32_16x16x64_bf16 v[76:79], v[48:51], v[104:111], v11
    v_smfmac_f32_16x16x64_bf16 v[72:75], v[52:55], v[160:167], v11
    ds_read_b128 v[96:99], v7 offset:4096
    v_smfmac_f32_16x16x64_bf16 v[76:79], v[52:55], v[168:175], v11
    ds_read_b128 v[100:103], v7 offset:5120
    v_smfmac_f32_16x16x64_bf16 v[72:75], v[56:59], v[208:215], v11
    ds_read_b128 v[104:107], v7 offset:6144
    v_smfmac_f32_16x16x64_bf16 v[76:79], v[56:59], v[216:223], v11
    ds_read_b128 v[108:111], v7 offset:7168
    v_smfmac_f32_16x16x64_bf16 v[72:75], v[60:63], v[112:119], v11
    ds_read_b128 v[64:67], v19 offset:0
    v_smfmac_f32_16x16x64_bf16 v[76:79], v[60:63], v[120:127], v11
    ds_read_b128 v[68:71], v19 offset:6144
    v_smfmac_f32_16x16x64_bf16 v[80:83], v[40:43], a[208:215], v11
    ds_read_b128 v[24:27], v19 offset:1024
    v_smfmac_f32_16x16x64_bf16 v[84:87], v[40:43], a[216:223], v11
    ds_read_b128 v[112:115], v7 offset:16384
    v_smfmac_f32_16x16x64_bf16 v[80:83], v[44:47], v[128:135], v11
    ds_read_b128 v[116:119], v7 offset:17408
    v_smfmac_f32_16x16x64_bf16 v[84:87], v[44:47], v[136:143], v11
    ds_read_b128 v[120:123], v7 offset:18432
    v_permlane32_swap_b32 v72, v76
    s_waitcnt lgkmcnt(8)
    v_smfmac_f32_16x16x64_bf16 v[80:83], v[48:51], v[96:103], v11
    ds_read_b128 v[124:127], v7 offset:19456
    v_permlane32_swap_b32 v73, v77
    s_waitcnt lgkmcnt(7)
    v_smfmac_f32_16x16x64_bf16 v[84:87], v[48:51], v[104:111], v11
    v_permlane32_swap_b32 v74, v78
    v_smfmac_f32_16x16x64_bf16 v[80:83], v[52:55], v[176:183], v11
    ds_read_b128 v[96:99], v7 offset:8192
    v_permlane32_swap_b32 v75, v79
    v_smfmac_f32_16x16x64_bf16 v[84:87], v[52:55], v[184:191], v11
    ds_read_b128 v[100:103], v7 offset:9216
    v_add_f32 v72, v72, v76
    v_smfmac_f32_16x16x64_bf16 v[80:83], v[56:59], v[224:231], v11
    ds_read_b128 v[104:107], v7 offset:10240
    v_add_f32 v73, v73, v77
    v_add_f32 v74, v74, v78
    v_smfmac_f32_16x16x64_bf16 v[84:87], v[56:59], v[232:239], v11
    ds_read_b128 v[108:111], v7 offset:11264
    v_add_f32 v75, v75, v79
    v_cvt_pk_bf16_f32 v76, v72, v73
    s_waitcnt lgkmcnt(6)
    v_smfmac_f32_16x16x64_bf16 v[80:83], v[60:63], v[112:119], v11
    v_cvt_pk_bf16_f32 v77, v74, v75
    s_waitcnt lgkmcnt(4)
    v_smfmac_f32_16x16x64_bf16 v[84:87], v[60:63], v[120:127], v11
    ds_write_b64 v15, v[76:77] offset:10240
    v_smfmac_f32_16x16x64_bf16 v[88:91], v[28:31], a[80:87], v11
    ds_read_b128 v[112:115], v7 offset:20480
    v_smfmac_f32_16x16x64_bf16 v[92:95], v[28:31], a[88:95], v11
    ds_read_b128 v[116:119], v7 offset:21504
    v_smfmac_f32_16x16x64_bf16 v[88:91], v[32:35], a[128:135], v11
    ds_read_b128 v[120:123], v7 offset:22528
    v_smfmac_f32_16x16x64_bf16 v[92:95], v[32:35], a[136:143], v11
    ds_read_b128 v[124:127], v7 offset:23552
    v_permlane32_swap_b32 v80, v84
    v_smfmac_f32_16x16x64_bf16 v[88:91], v[36:39], a[176:183], v11
    ds_read_b128 v[28:31], v19 offset:7168
    v_permlane32_swap_b32 v81, v85
    v_permlane32_swap_b32 v82, v86
    v_smfmac_f32_16x16x64_bf16 v[92:95], v[36:39], a[184:191], v11
    ds_read_b128 v[32:35], v19 offset:2048
    v_permlane32_swap_b32 v83, v87
    v_add_f32 v80, v80, v84
    v_smfmac_f32_16x16x64_bf16 v[88:91], v[40:43], a[224:231], v11
    v_add_f32 v81, v81, v85
    v_add_f32 v82, v82, v86
    v_smfmac_f32_16x16x64_bf16 v[92:95], v[40:43], a[232:239], v11
    ds_read_b128 v[36:39], v19 offset:8192
    v_add_f32 v83, v83, v87
    v_cvt_pk_bf16_f32 v84, v80, v81
    v_smfmac_f32_16x16x64_bf16 v[88:91], v[44:47], v[144:151], v11
    v_cvt_pk_bf16_f32 v85, v82, v83
    v_smfmac_f32_16x16x64_bf16 v[92:95], v[44:47], v[152:159], v11
    ds_write_b64 v15, v[84:85] offset:12288
    s_waitcnt lgkmcnt(11)
    v_smfmac_f32_16x16x64_bf16 v[88:91], v[48:51], v[96:103], v11
    ds_read_b128 v[40:43], v19 offset:3072
    s_waitcnt lgkmcnt(10)
    v_smfmac_f32_16x16x64_bf16 v[92:95], v[48:51], v[104:111], v11
    ds_read_b128 v[44:47], v19 offset:9216
    v_smfmac_f32_16x16x64_bf16 v[88:91], v[52:55], v[192:199], v11
    v_smfmac_f32_16x16x64_bf16 v[92:95], v[52:55], v[200:207], v11
    s_waitcnt lgkmcnt(2)
    s_barrier
    ds_read_b64_tr_b16 v[96:97], v16 offset:10240
    v_smfmac_f32_16x16x64_bf16 v[88:91], v[56:59], v[240:247], v11
    ds_read_b64_tr_b16 v[98:99], v16 offset:10752
    v_smfmac_f32_16x16x64_bf16 v[92:95], v[56:59], v[248:255], v11
    ds_read_b64_tr_b16 v[100:101], v16 offset:11264
    v_smfmac_f32_16x16x64_bf16 v[88:91], v[60:63], v[112:119], v11
    ds_read_b64_tr_b16 v[102:103], v16 offset:11776
    v_smfmac_f32_16x16x64_bf16 v[92:95], v[60:63], v[120:127], v11
    ds_read_b64_tr_b16 v[104:105], v16 offset:12288
    s_waitcnt lgkmcnt(3)
    v_mfma_f32_16x16x32_bf16 v[76:79], v[64:67], v[96:99], 0
    ds_read_b64_tr_b16 v[106:107], v16 offset:12800
    v_mfma_f32_16x16x32_bf16 v[80:83], v[68:71], v[96:99], 0
    ds_read_b64_tr_b16 v[108:109], v16 offset:13312
    v_mfma_f32_16x16x32_bf16 v[72:75], v[96:99], v[96:99], v[20:23]
    s_nop 0
    v_permlane32_swap_b32 v88, v92
    v_permlane32_swap_b32 v89, v93
    v_permlane32_swap_b32 v90, v94
    v_permlane32_swap_b32 v91, v95
    v_add_f32 v88, v88, v92
    v_add_f32 v89, v89, v93
    v_add_f32 v90, v90, v94
    v_add_f32 v91, v91, v95
    v_cvt_pk_bf16_f32 v92, v88, v89
    v_cvt_pk_bf16_f32 v93, v90, v91
    ds_write_b64 v15, v[92:93] offset:14336
    s_waitcnt lgkmcnt(4)
    v_mfma_f32_16x16x32_bf16 v[76:79], v[24:27], v[100:103], v[76:79]
    ds_read_b64_tr_b16 v[110:111], v16 offset:13824
    v_mfma_f32_16x16x32_bf16 v[80:83], v[28:31], v[100:103], v[80:83]
    ds_read_b128 v[48:51], v19 offset:4096
    v_mfma_f32_16x16x32_bf16 v[72:75], v[100:103], v[100:103], v[72:75]
    ds_read_b128 v[52:55], v19 offset:10240
    s_waitcnt lgkmcnt(5)
    v_mfma_f32_16x16x32_bf16 v[76:79], v[32:35], v[104:107], v[76:79]
    ds_read_b128 v[56:59], v19 offset:5120
    s_waitcnt lgkmcnt(4)
    s_barrier
    ds_read_b64_tr_b16 v[112:113], v16 offset:14336
    ds_read_b64_tr_b16 v[114:115], v16 offset:14848
    s_cmp_lg_u32 s4, 0
    s_cbranch_scc1 A_w123
    v_mfma_f32_16x16x32_bf16 v[80:83], v[36:39], v[104:107], v[80:83]
    ds_read_b64_tr_b16 v[116:117], v16 offset:15360
    v_mfma_f32_16x16x32_bf16 v[72:75], v[104:107], v[104:107], v[72:75]
    ds_read_b64_tr_b16 v[118:119], v16 offset:15872
    s_waitcnt lgkmcnt(7)
    v_mfma_f32_16x16x32_bf16 v[76:79], v[40:43], v[108:111], v[76:79]
    ds_read_b128 v[60:63], v19 offset:11264
    v_mfma_f32_16x16x32_bf16 v[80:83], v[44:47], v[108:111], v[80:83]
    v_mfma_f32_16x16x32_bf16 v[72:75], v[108:111], v[108:111], v[72:75]
    s_waitcnt lgkmcnt(3)
    v_mfma_f32_16x16x32_bf16 v[76:79], v[48:51], v[112:115], v[76:79]
    v_mfma_f32_16x16x32_bf16 v[80:83], v[52:55], v[112:115], v[80:83]
    v_mfma_f32_16x16x32_bf16 v[72:75], v[112:115], v[112:115], v[72:75]
    s_waitcnt lgkmcnt(1)
    s_waitcnt lgkmcnt(0)
    v_mfma_f32_16x16x32_bf16 v[80:83], v[60:63], v[116:119], v[80:83]
    v_mfma_f32_16x16x32_bf16 v[76:79], v[56:59], v[116:119], v[76:79]
    v_mfma_f32_16x16x32_bf16 v[72:75], v[116:119], v[116:119], v[72:75]
    s_nop 6
    v_mov_b32_dpp v76, v80 row_ror:8 row_mask:0xf bank_mask:0xc
    v_mov_b32_dpp v77, v81 row_ror:8 row_mask:0xf bank_mask:0xc
    v_mov_b32_dpp v78, v82 row_ror:8 row_mask:0xf bank_mask:0xc
    v_mov_b32_dpp v79, v83 row_ror:8 row_mask:0xf bank_mask:0xc
    v_max3_f32 v120, v76, v77, v78
    v_mov_b32_dpp v72, v74 row_ror:8 row_mask:0xf bank_mask:0xc
    v_mov_b32_dpp v73, v75 row_ror:8 row_mask:0xf bank_mask:0xc
    v_max_f32 v120, v120, v79
    v_max3_f32 v120, v120, v72, v73
    s_nop 1
    v_max_f32_dpp v120, v120, v120 row_ror:8 row_mask:0xf bank_mask:0xf
    v_mov_b32 v121, v120
    s_nop 1
    v_permlane32_swap_b32 v120, v121
    v_max_f32 v120, v120, v121
    v_mov_b32 v121, v120
    s_nop 1
    v_permlane16_swap_b32 v120, v121
    v_max_f32 v120, v120, v121
    v_mul_f32 v120, s58, v120
    v_pk_fma_f32 v[76:77], v[76:77], s[58:59], v[120:121] op_sel_hi:[1,1,0] neg_lo:[0,0,1] neg_hi:[0,0,1]
    v_pk_fma_f32 v[78:79], v[78:79], s[58:59], v[120:121] op_sel_hi:[1,1,0] neg_lo:[0,0,1] neg_hi:[0,0,1]
    v_pk_fma_f32 v[72:73], v[72:73], s[58:59], v[120:121] op_sel_hi:[1,1,0] neg_lo:[0,0,1] neg_hi:[0,0,1]
    v_exp_f32 v76, v76
    v_exp_f32 v77, v77
    v_exp_f32 v78, v78
    v_exp_f32 v79, v79
    v_exp_f32 v72, v72
    v_exp_f32 v73, v73
    v_pk_add_f32 v[120:121], v[76:77], v[78:79]
    v_pk_add_f32 v[120:121], v[120:121], v[72:73]
    v_add_f32 v120, v120, v121
    s_nop 1
    v_add_f32_dpp v120, v120, v120 row_ror:8 row_mask:0xf bank_mask:0xf
    v_mov_b32 v121, v120
    s_nop 1
    v_permlane32_swap_b32 v120, v121
    v_add_f32 v120, v120, v121
    v_mov_b32 v121, v120
    s_nop 1
    v_permlane16_swap_b32 v120, v121
    v_add_f32 v120, v120, v121
    v_rcp_f32 v120, v120
    s_nop 0
    v_pk_mul_f32 v[76:77], v[76:77], v[120:121] op_sel_hi:[1,0]
    v_pk_mul_f32 v[78:79], v[78:79], v[120:121] op_sel_hi:[1,0]
    v_pk_mul_f32 v[72:73], v[72:73], v[120:121] op_sel_hi:[1,0]
    v_cvt_pk_bf16_f32 v84, v76, v77
    v_cvt_pk_bf16_f32 v85, v78, v79
    v_cvt_pk_bf16_f32 v88, v72, v73
    v_mov_b32_dpp v86, v84 row_ror:8 row_mask:0xf bank_mask:0xf
    v_mov_b32_dpp v87, v85 row_ror:8 row_mask:0xf bank_mask:0xf
    v_mov_b32_dpp v89, v88 row_ror:8 row_mask:0xf bank_mask:0xf
    buffer_store_dwordx4 v[84:87], v17, s[8:11], s56 offen sc1
    v_permlane16_swap_b32 v88, v90
    v_permlane16_swap_b32 v89, v91
    buffer_store_dwordx4 v[88:91], v18, s[8:11], s56 offen sc1
    s_memrealtime s[44:45]
    s_lshl_b32 s32, s6, 7
    s_add_u32 s32, s32, 30720
    v_mov_b32 v3, s32
    s_waitcnt lgkmcnt(0)
    s_lshl_b32 s44, s44, 7
    s_sub_u32 s44, s44, s62
    s_add_u32 s44, s44, 127
    s_lshr_b32 s44, s44, 7
    s_cmp_eq_u32 s50, 0
    s_cselect_b32 s45, s99, 0x40000000
    s_cmp_eq_u32 s48, 0
    s_cmov_b32 s45, s99
    s_cmov_b32 s44, 0
    v_mov_b32 v2, s44
    buffer_store_dword v2, v3, s[8:11], s45 offen sc1
    s_add_u32 s34, s48, 1
    s_min_u32 s34, s34, 63
    v_cmp_gt_i32 vcc, s34, v14
    s_cbranch_vccz A_kq_109
    s_mul_i32 s33, s6, 6
    v_and_b32 v2, 1, v1
    v_mul_u32_u24 v2, 5, v2
    v_add_u32 v2, s33, v2
    v_lshrrev_b32 v2, 3, v2
    v_lshlrev_b32 v2, 4, v2
    v_and_b32 v5, 2, v1
    v_lshl_add_u32 v2, v5, 8, v2
    s_mul_i32 s32, s34, 2048
    s_add_u32 s32, s32, 0xa800000
kq_poll_110:
    buffer_load_dword v3, v2, s[8:11], s32 offen sc1
    s_waitcnt vmcnt(0)
    v_cmp_gt_i32 vcc, s34, v3
    s_cbranch_vccz kq_ok_111
    s_cmp_eq_u32 s52, 0
    s_cbranch_scc1 kq_ok_111
    s_sub_u32 s52, s52, 1
    s_sleep 1
    s_branch kq_poll_110
kq_ok_111:
A_kq_109:
    s_mul_i32 s32, s34, 393216
    s_mul_i32 s33, s6, 12288
    s_add_u32 s32, s32, s33
    s_add_u32 m0, s55, 12288
    s_add_u32 s33, s32, 0x400000
    buffer_load_dwordx4 v12, s[8:11], s33 offen offset:0 sc1 lds
    buffer_load_dwordx4 v12, s[8:11], s33 offen offset:1024 sc1 lds
    buffer_load_dwordx4 v12, s[8:11], s33 offen offset:2048 sc1 lds
    buffer_load_dwordx4 v12, s[8:11], s33 offen offset:3072 sc1 lds
    s_add_u32 m0, s55, 16384
    s_add_u32 s33, s32, 0x401000
    buffer_load_dwordx4 v12, s[8:11], s33 offen offset:0 sc1 lds
    buffer_load_dwordx4 v12, s[8:11], s33 offen offset:1024 sc1 lds
    buffer_load_dwordx4 v12, s[8:11], s33 offen offset:2048 sc1 lds
    buffer_load_dwordx4 v12, s[8:11], s33 offen offset:3072 sc1 lds
    s_add_u32 m0, s55, 20480
    s_add_u32 s33, s32, 0x402000
    buffer_load_dwordx4 v12, s[8:11], s33 offen offset:0 sc1 lds
    buffer_load_dwordx4 v12, s[8:11], s33 offen offset:1024 sc1 lds
    buffer_load_dwordx4 v12, s[8:11], s33 offen offset:2048 sc1 lds
    buffer_load_dwordx4 v12, s[8:11], s33 offen offset:3072 sc1 lds
    s_add_u32 s34, s48, 2
    s_min_u32 s34, s34, 63
    s_mul_i32 s33, s6, 6
    v_and_b32 v2, 1, v1
    v_mul_u32_u24 v2, 5, v2
    v_add_u32 v2, s33, v2
    v_lshrrev_b32 v2, 3, v2
    v_lshlrev_b32 v2, 4, v2
    v_and_b32 v5, 2, v1
    v_lshl_add_u32 v2, v5, 8, v2
    s_mul_i32 s32, s34, 2048
    s_add_u32 s32, s32, 0xa800000
    buffer_load_dword v14, v2, s[8:11], s32 offen sc1
    s_branch A_next
A_mrt_104:
    s_cmp_eq_u32 s52, 0
    s_cbranch_scc1 A_mok_103
    s_sub_u32 s52, s52, 1
    s_mov_b32 s50, 1
    s_memrealtime s[44:45]
    s_waitcnt lgkmcnt(0)
    s_add_u32 s38, s44, 300
    s_lshl_b32 s38, s38, 7
    s_or_b32 s38, s38, s48
    v_mov_b32 v4, s38
    v_mov_b32 v5, s38
    s_and_b32 s38, s48, 1
    s_lshl_b32 s38, s38, 9
    s_add_u32 s38, s38, s5
    buffer_store_dwordx2 v[4:5], v10, s[8:11], s38 offen sc1
    s_nop 7
    v_mov_b32 v72, 0
    v_mov_b32 v73, 0
    v_mov_b32 v74, 0
    v_mov_b32 v75, 0
    v_mov_b32 v76, 0
    v_mov_b32 v77, 0
    v_mov_b32 v78, 0
    v_mov_b32 v79, 0
    v_mov_b32 v80, 0
    v_mov_b32 v81, 0
    v_mov_b32 v82, 0
    v_mov_b32 v83, 0
    v_mov_b32 v84, 0
    v_mov_b32 v85, 0
    v_mov_b32 v86, 0
    v_mov_b32 v87, 0
    v_mov_b32 v88, 0
    v_mov_b32 v89, 0
    v_mov_b32 v90, 0
    v_mov_b32 v91, 0
    v_mov_b32 v92, 0
    v_mov_b32 v93, 0
    v_mov_b32 v94, 0
    v_mov_b32 v95, 0
    s_waitcnt vmcnt(0) lgkmcnt(0)
    buffer_load_dwordx4 v[24:27], v13, s[8:11], s32 offen sc1
    s_nop 13
    buffer_load_dwordx4 v[28:31], v13, s[8:11], s33 offen sc1
    s_nop 13
    buffer_load_dwordx4 v[32:35], v12, s[8:11], s34 offen sc1
    s_nop 13
    buffer_load_dwordx4 v[36:39], v12, s[8:11], s34 offen offset:1024 sc1
    s_branch A_ml_102
A_crt_107:
    s_nop 7
    v_mov_b32 v72, 0
    v_mov_b32 v73, 0
    v_mov_b32 v74, 0
    v_mov_b32 v75, 0
    v_mov_b32 v76, 0
    v_mov_b32 v77, 0
    v_mov_b32 v78, 0
    v_mov_b32 v79, 0
    v_mov_b32 v80, 0
    v_mov_b32 v81, 0
    v_mov_b32 v82, 0
    v_mov_b32 v83, 0
    v_mov_b32 v84, 0
    v_mov_b32 v85, 0
    v_mov_b32 v86, 0
    v_mov_b32 v87, 0
    v_mov_b32 v88, 0
    v_mov_b32 v89, 0
    v_mov_b32 v90, 0
    v_mov_b32 v91, 0
    v_mov_b32 v92, 0
    v_mov_b32 v93, 0
    v_mov_b32 v94, 0
    v_mov_b32 v95, 0
A_cl_105:
    s_mov_b32 s50, 1
    s_memrealtime s[44:45]
    s_waitcnt lgkmcnt(0)
    s_add_u32 s38, s44, 300
    s_lshl_b32 s38, s38, 7
    s_or_b32 s38, s38, s48
    v_mov_b32 v4, s38
    v_mov_b32 v5, s38
    s_and_b32 s38, s48, 1
    s_lshl_b32 s38, s38, 9
    buffer_store_dwordx2 v[4:5], v8, s[8:11], s38 offen sc1
    buffer_load_dwordx4 v[32:35], v12, s[8:11], s34 offen sc1
    buffer_load_dwordx4 v[36:39], v12, s[8:11], s34 offen offset:1024 sc1
    s_waitcnt vmcnt(0)
    v_max3_u32 v2, v32, v33, v34
    v_max3_u32 v2, v2, v35, v36
    v_max3_u32 v2, v2, v37, v38
    v_max_u32 v2, v2, v39
    v_cmp_eq_u32 vcc, -1, v2
    s_cbranch_vccz A_cre_108
    s_cmp_eq_u32 s52, 0
    s_cbranch_scc1 A_cre_108
    s_sub_u32 s52, s52, 1
    s_nop 0
    s_branch A_cl_105
A_cre_108:
    v_smfmac_f32_16x16x64_bf16 v[72:75], v[24:27], a[0:7], v11
    v_smfmac_f32_16x16x64_bf16 v[76:79], v[24:27], a[8:15], v11
    v_smfmac_f32_16x16x64_bf16 v[80:83], v[24:27], a[16:23], v11
    v_smfmac_f32_16x16x64_bf16 v[84:87], v[24:27], a[24:31], v11
    v_smfmac_f32_16x16x64_bf16 v[88:91], v[24:27], a[32:39], v11
    v_smfmac_f32_16x16x64_bf16 v[92:95], v[24:27], a[40:47], v11
    v_smfmac_f32_16x16x64_bf16 v[72:75], v[28:31], a[48:55], v11
    v_smfmac_f32_16x16x64_bf16 v[76:79], v[28:31], a[56:63], v11
    v_smfmac_f32_16x16x64_bf16 v[80:83], v[28:31], a[64:71], v11
    v_smfmac_f32_16x16x64_bf16 v[84:87], v[28:31], a[72:79], v11
    v_smfmac_f32_16x16x64_bf16 v[72:75], v[32:35], a[96:103], v11
    v_smfmac_f32_16x16x64_bf16 v[76:79], v[32:35], a[104:111], v11
    v_smfmac_f32_16x16x64_bf16 v[80:83], v[32:35], a[112:119], v11
    v_smfmac_f32_16x16x64_bf16 v[84:87], v[32:35], a[120:127], v11
    v_smfmac_f32_16x16x64_bf16 v[72:75], v[36:39], a[144:151], v11
    v_smfmac_f32_16x16x64_bf16 v[76:79], v[36:39], a[152:159], v11
    v_smfmac_f32_16x16x64_bf16 v[80:83], v[36:39], a[160:167], v11
    v_smfmac_f32_16x16x64_bf16 v[84:87], v[36:39], a[168:175], v11
    s_memrealtime s[44:45]
    s_nop 6
    s_branch A_cok_106
A_post:
    s_cmp_eq_u32 s6, 0
    s_cbranch_scc1 A_post2
    v_readfirstlane_b32 s36, v3
    s_nop 1
    s_lshr_b32 s101, s36, 16
    s_and_b32 s100, s36, 0xffff
    s_min_u32 s100, s100, 170
    s_min_u32 s101, s101, 100
A_post2:
    s_add_u32 s36, s44, s100
    s_add_u32 s36, s36, 0xffffffe1
    s_add_u32 s37, s36, s101
    s_add_u32 s37, s37, 0xe
    s_lshl_b32 s38, s36, 7
    s_lshl_b32 s39, s37, 7
    s_or_b32 s38, s38, s48
    s_or_b32 s39, s39, s48
    v_mov_b32 v4, s38
    v_mov_b32 v5, s39
    s_and_b32 s38, s48, 1
    s_lshl_b32 s38, s38, 9
    s_mov_b32 s49, s37
    buffer_store_dwordx2 v[4:5], v8, s[8:11], s38 offen sc1
    s_branch A_post_ret
A_re:
    s_memrealtime s[44:45]
    s_waitcnt lgkmcnt(0)
    s_cmp_eq_u32 s48, 1
    s_cselect_b32 s45, 20, 0
    s_add_u32 s44, s44, s45
    s_add_u32 s101, s101, s45
    s_add_u32 s36, s44, s100
    s_add_u32 s36, s36, 0x9
    s_add_u32 s37, s36, s101
    s_add_u32 s37, s37, 0x4
    s_lshl_b32 s38, s36, 7
    s_lshl_b32 s39, s37, 7
    s_or_b32 s38, s38, s48
    s_or_b32 s39, s39, s48
    v_mov_b32 v4, s38
    v_mov_b32 v5, s39
    s_and_b32 s38, s48, 1
    s_lshl_b32 s38, s38, 9
    s_mov_b32 s49, s37
    buffer_store_dwordx2 v[4:5], v8, s[8:11], s38 offen sc1
    s_sub_u32 s101, s101, s45
    s_branch A_re_ret
A_w3:
    s_waitcnt lgkmcnt(0)
    s_cmp_lg_u32 s6, 0
    s_cbranch_scc1 A_w3h
    s_add_u32 s63, s48, 1
    s_andn2_b32 s47, 1, s63
    s_lshl_b32 s47, s47, 9
    s_add_u32 s47, s47, s99
    buffer_load_dword v6, v9, s[8:11], s47 offen offset:4 sc1
    v_max_i32_dpp v20, v20, v20 row_ror:1 row_mask:0xf bank_mask:0xf
    s_nop 1
    v_max_i32_dpp v20, v20, v20 row_ror:2 row_mask:0xf bank_mask:0xf
    s_nop 1
    v_max_i32_dpp v20, v20, v20 row_ror:4 row_mask:0xf bank_mask:0xf
    s_nop 1
    v_max_i32_dpp v20, v20, v20 row_ror:8 row_mask:0xf bank_mask:0xf
    v_mov_b32 v2, v20
    s_nop 1
    v_permlane16_swap_b32 v20, v2
    v_max_i32 v3, v20, v2
    s_nop 0
    v_readlane_b32 s36, v3, 0
    v_readlane_b32 s37, v3, 32
    s_nop 1
    s_add_u32 s38, s100, 1
    s_min_i32 s36, s36, s38
    s_sub_u32 s38, s100, s36
    s_ashr_i32 s38, s38, 2
    s_max_i32 s38, s38, 1
    s_cmp_lt_i32 s36, 30
    s_cmov_b32 s38, 0
    s_sub_u32 s100, s100, s38
    s_max_i32 s100, s100, s36
    s_add_u32 s38, s101, 1
    s_min_i32 s37, s37, s38
    s_sub_u32 s38, s101, s37
    s_ashr_i32 s38, s38, 2
    s_max_i32 s38, s38, 1
    s_cmp_lt_i32 s37, 30
    s_cmov_b32 s38, 0
    s_sub_u32 s101, s101, s38
    s_max_i32 s101, s101, s37
    s_min_i32 s100, s100, 170
    s_min_i32 s101, s101, 100
    s_waitcnt vmcnt(0)
    v_readlane_b32 s36, v6, 0
    v_readlane_b32 s41, v6, 1
    v_readlane_b32 s42, v6, 2
    v_readlane_b32 s43, v6, 3
    s_sub_u32 s40, s41, s36
    s_and_b32 s40, s40, 0x8000007f
    s_cmp_eq_u32 s40, 0
    s_cmov_b32 s36, s41
    s_sub_u32 s40, s42, s36
    s_and_b32 s40, s40, 0x8000007f
    s_cmp_eq_u32 s40, 0
    s_cmov_b32 s36, s42
    s_sub_u32 s40, s43, s36
    s_and_b32 s40, s40, 0x8000007f
    s_cmp_eq_u32 s40, 0
    s_cmov_b32 s36, s43
    s_lshl_b32 s37, s49, 7
    s_sub_u32 s37, s36, s37
    s_ashr_i32 s37, s37, 7
    s_max_i32 s37, s37, 0
    s_cmp_gt_i32 s37, 20000
    s_cmov_b32 s37, 0
    s_cmp_eq_u32 s48, 0
    s_cmov_b32 s37, 5000
    s_add_u32 s49, s49, s37
    s_lshl_b32 s79, s49, 7
    s_add_u32 s36, s49, s100
    s_add_u32 s36, s36, 0x3
    s_add_u32 s37, s36, s101
    s_add_u32 s37, s37, 0x4
    s_lshl_b32 s38, s36, 7
    s_lshl_b32 s39, s37, 7
    s_or_b32 s38, s38, s63
    s_or_b32 s39, s39, s63
    v_mov_b32 v4, s38
    v_mov_b32 v5, s39
    s_and_b32 s38, s63, 1
    s_lshl_b32 s38, s38, 9
    s_mov_b32 s49, s37
    buffer_store_dwordx2 v[4:5], v8, s[8:11], s38 offen sc1
    s_lshl_b32 s36, s101, 16
    s_or_b32 s36, s36, s100
    v_mov_b32 v2, s36
    s_and_b32 s36, s48, 3
    s_cselect_b32 s36, 0x40000000, 0
    buffer_store_dword v2, v8, s[8:11], s36 offen offset:1024 sc1
    s_sleep 3
    s_branch A_w3k
A_w3h:
    s_sleep 7
A_w3k:
    s_add_u32 s34, s48, 1
    s_min_u32 s34, s34, 63
    v_cmp_gt_i32 vcc, s34, v14
    s_cbranch_vccz A_kq_112
    s_mul_i32 s33, s6, 6
    v_and_b32 v2, 1, v1
    v_mul_u32_u24 v2, 5, v2
    v_add_u32 v2, s33, v2
    v_lshrrev_b32 v2, 3, v2
    v_lshlrev_b32 v2, 4, v2
    v_and_b32 v5, 2, v1
    v_lshl_add_u32 v2, v5, 8, v2
    s_mul_i32 s32, s34, 2048
    s_add_u32 s32, s32, 0xa800000
kq_poll_113:
    buffer_load_dword v3, v2, s[8:11], s32 offen sc1
    s_waitcnt vmcnt(0)
    v_cmp_gt_i32 vcc, s34, v3
    s_cbranch_vccz kq_ok_114
    s_cmp_eq_u32 s52, 0
    s_cbranch_scc1 kq_ok_114
    s_sub_u32 s52, s52, 1
    s_sleep 1
    s_branch kq_poll_113
kq_ok_114:
A_kq_112:
    s_mul_i32 s32, s34, 393216
    s_mul_i32 s33, s6, 12288
    s_add_u32 s32, s32, s33
    s_add_u32 m0, s55, 0
    s_add_u32 s33, s32, 0x1c00000
    buffer_load_dwordx4 v12, s[8:11], s33 offen offset:0 sc1 lds
    buffer_load_dwordx4 v12, s[8:11], s33 offen offset:1024 sc1 lds
    buffer_load_dwordx4 v12, s[8:11], s33 offen offset:2048 sc1 lds
    buffer_load_dwordx4 v12, s[8:11], s33 offen offset:3072 sc1 lds
    s_add_u32 m0, s55, 4096
    s_add_u32 s33, s32, 0x1c01000
    buffer_load_dwordx4 v12, s[8:11], s33 offen offset:0 sc1 lds
    buffer_load_dwordx4 v12, s[8:11], s33 offen offset:1024 sc1 lds
    buffer_load_dwordx4 v12, s[8:11], s33 offen offset:2048 sc1 lds
    buffer_load_dwordx4 v12, s[8:11], s33 offen offset:3072 sc1 lds
    s_add_u32 m0, s55, 8192
    s_add_u32 s33, s32, 0x1c02000
    buffer_load_dwordx4 v12, s[8:11], s33 offen offset:0 sc1 lds
    buffer_load_dwordx4 v12, s[8:11], s33 offen offset:1024 sc1 lds
    buffer_load_dwordx4 v12, s[8:11], s33 offen offset:2048 sc1 lds
    buffer_load_dwordx4 v12, s[8:11], s33 offen offset:3072 sc1 lds
    s_add_u32 s34, s48, 2
    s_min_u32 s34, s34, 63
    s_mul_i32 s33, s6, 6
    v_and_b32 v2, 1, v1
    v_mul_u32_u24 v2, 5, v2
    v_add_u32 v2, s33, v2
    v_lshrrev_b32 v2, 3, v2
    v_lshlrev_b32 v2, 4, v2
    v_and_b32 v5, 2, v1
    v_lshl_add_u32 v2, v5, 8, v2
    s_mul_i32 s32, s34, 2048
    s_add_u32 s32, s32, 0xa800000
    buffer_load_dword v14, v2, s[8:11], s32 offen sc1
    buffer_load_dword v20, v21, s[8:11], s7 offen sc1
    s_branch A_next
A_w123:
    s_cmp_eq_u32 s4, 3
    s_cbranch_scc1 A_w3
    ds_read_b64_tr_b16 v[116:117], v16 offset:15360
    ds_read_b64_tr_b16 v[118:119], v16 offset:15872
    ds_read_b128 v[60:63], v19 offset:11264
    s_sub_u32 s34, s4, 1
    s_mul_i32 s35, s34, 6144
    v_add_u32 v4, s35, v19
    ds_read_b128 v[84:87], v4 offset:12288
    ds_read_b128 v[88:91], v4 offset:13312
    ds_read_b128 v[92:95], v4 offset:14336
    ds_read_b128 v[120:123], v4 offset:15360
    ds_read_b128 v[124:127], v4 offset:16384
    ds_read_b128 v[20:23], v4 offset:17408
    s_mul_i32 s32, s48, 81920
    s_mul_i32 s33, s6, 2560
    s_add_u32 s32, s32, s33
    s_add_u32 s56, s32, 0xa821000
    s_waitcnt lgkmcnt(5)
    v_mfma_f32_16x16x32_bf16 v[76:79], v[64:67], v[84:87], 0
    v_mfma_f32_16x16x32_bf16 v[80:83], v[68:71], v[84:87], 0
    v_mfma_f32_16x16x32_bf16 v[72:75], v[96:99], v[84:87], 0
    s_waitcnt lgkmcnt(4)
    v_mfma_f32_16x16x32_bf16 v[76:79], v[24:27], v[88:91], v[76:79]
    v_mfma_f32_16x16x32_bf16 v[80:83], v[28:31], v[88:91], v[80:83]
    v_mfma_f32_16x16x32_bf16 v[72:75], v[100:103], v[88:91], v[72:75]
    s_waitcnt lgkmcnt(3)
    v_mfma_f32_16x16x32_bf16 v[76:79], v[32:35], v[92:95], v[76:79]
    v_mfma_f32_16x16x32_bf16 v[80:83], v[36:39], v[92:95], v[80:83]
    v_mfma_f32_16x16x32_bf16 v[72:75], v[104:107], v[92:95], v[72:75]
    s_waitcnt lgkmcnt(2)
    v_mfma_f32_16x16x32_bf16 v[76:79], v[40:43], v[120:123], v[76:79]
    v_mfma_f32_16x16x32_bf16 v[80:83], v[44:47], v[120:123], v[80:83]
    v_mfma_f32_16x16x32_bf16 v[72:75], v[108:111], v[120:123], v[72:75]
    s_waitcnt lgkmcnt(1)
    v_mfma_f32_16x16x32_bf16 v[76:79], v[48:51], v[124:127], v[76:79]
    v_mfma_f32_16x16x32_bf16 v[80:83], v[52:55], v[124:127], v[80:83]
    v_mfma_f32_16x16x32_bf16 v[72:75], v[112:115], v[124:127], v[72:75]
    s_waitcnt lgkmcnt(0)
    v_mfma_f32_16x16x32_bf16 v[76:79], v[56:59], v[20:23], v[76:79]
    v_mfma_f32_16x16x32_bf16 v[80:83], v[60:63], v[20:23], v[80:83]
    v_mfma_f32_16x16x32_bf16 v[72:75], v[116:119], v[20:23], v[72:75]
    v_mov_b32 v120, 0xff61b1e6
    s_nop 6
    v_cndmask_b32 v72, v120, v72, s[60:61]
    v_cndmask_b32 v73, v120, v73, s[60:61]
    v_cndmask_b32 v74, v120, v74, s[60:61]
    v_cndmask_b32 v75, v120, v75, s[60:61]
    v_mov_b32 v120, 0xd04e79ff
    v_cndmask_b32 v76, v120, v76, s[64:65]
    v_cndmask_b32 v77, v120, v77, s[66:67]
    v_cndmask_b32 v78, v120, v78, s[68:69]
    v_cndmask_b32 v79, v120, v79, s[70:71]
    v_cndmask_b32 v80, v120, v80, s[72:73]
    v_cndmask_b32 v81, v120, v81, s[74:75]
    v_cndmask_b32 v82, v120, v82, s[76:77]
    v_cndmask_b32 v83, v120, v83, s[78:79]
    v_max3_f32 v120, v76, v77, v78
    v_max3_f32 v121, v79, v80, v81
    v_max3_f32 v120, v120, v82, v83
    v_max3_f32 v121, v121, v72, v73
    v_max3_f32 v120, v120, v74, v75
    v_max_f32 v120, v120, v121
    v_mov_b32 v121, v120
    s_nop 1
    v_permlane32_swap_b32 v120, v121
    v_max_f32 v120, v120, v121
    v_mov_b32 v121, v120
    s_nop 1
    v_permlane16_swap_b32 v120, v121
    v_max_f32 v120, v120, v121
    v_mul_f32 v120, s58, v120
    v_pk_fma_f32 v[72:73], v[72:73], s[58:59], v[120:121] op_sel_hi:[1,1,0] neg_lo:[0,0,1] neg_hi:[0,0,1]
    v_pk_fma_f32 v[74:75], v[74:75], s[58:59], v[120:121] op_sel_hi:[1,1,0] neg_lo:[0,0,1] neg_hi:[0,0,1]
    v_pk_fma_f32 v[76:77], v[76:77], s[58:59], v[120:121] op_sel_hi:[1,1,0] neg_lo:[0,0,1] neg_hi:[0,0,1]
    v_pk_fma_f32 v[78:79], v[78:79], s[58:59], v[120:121] op_sel_hi:[1,1,0] neg_lo:[0,0,1] neg_hi:[0,0,1]
    v_pk_fma_f32 v[80:81], v[80:81], s[58:59], v[120:121] op_sel_hi:[1,1,0] neg_lo:[0,0,1] neg_hi:[0,0,1]
    v_pk_fma_f32 v[82:83], v[82:83], s[58:59], v[120:121] op_sel_hi:[1,1,0] neg_lo:[0,0,1] neg_hi:[0,0,1]
    v_exp_f32 v72, v72
    v_exp_f32 v73, v73
    v_exp_f32 v74, v74
    v_exp_f32 v75, v75
    v_exp_f32 v76, v76
    v_exp_f32 v77, v77
    v_exp_f32 v78, v78
    v_exp_f32 v79, v79
    v_exp_f32 v80, v80
    v_exp_f32 v81, v81
    v_exp_f32 v82, v82
    v_exp_f32 v83, v83
    v_pk_add_f32 v[120:121], v[72:73], v[74:75]
    v_pk_add_f32 v[122:123], v[76:77], v[78:79]
    v_pk_add_f32 v[120:121], v[120:121], v[80:81]
    v_pk_add_f32 v[122:123], v[122:123], v[82:83]
    v_pk_add_f32 v[120:121], v[120:121], v[122:123]
    v_add_f32 v120, v120, v121
    v_mov_b32 v121, v120
    s_nop 1
    v_permlane32_swap_b32 v120, v121
    v_add_f32 v120, v120, v121
    v_mov_b32 v121, v120
    s_nop 1
    v_permlane16_swap_b32 v120, v121
    v_add_f32 v120, v120, v121
    v_rcp_f32 v120, v120
    s_nop 0
    v_pk_mul_f32 v[72:73], v[72:73], v[120:121] op_sel_hi:[1,0]
    v_pk_mul_f32 v[74:75], v[74:75], v[120:121] op_sel_hi:[1,0]
    v_pk_mul_f32 v[76:77], v[76:77], v[120:121] op_sel_hi:[1,0]
    v_pk_mul_f32 v[78:79], v[78:79], v[120:121] op_sel_hi:[1,0]
    v_pk_mul_f32 v[80:81], v[80:81], v[120:121] op_sel_hi:[1,0]
    v_pk_mul_f32 v[82:83], v[82:83], v[120:121] op_sel_hi:[1,0]
    v_cvt_pk_bf16_f32 v88, v72, v73
    v_cvt_pk_bf16_f32 v89, v74, v75
    v_cvt_pk_bf16_f32 v84, v76, v77
    v_cvt_pk_bf16_f32 v85, v78, v79
    v_cvt_pk_bf16_f32 v86, v80, v81
    v_cvt_pk_bf16_f32 v87, v82, v83
    buffer_store_dwordx4 v[84:87], v17, s[8:11], s56 offen sc1
    v_permlane16_swap_b32 v88, v90
    v_permlane16_swap_b32 v89, v91
    buffer_store_dwordx4 v[88:91], v18, s[8:11], s56 offen sc1
    s_nop 1
A_next:
    s_waitcnt lgkmcnt(0)
    s_cmp_ge_u32 s48, 63
    s_cbranch_scc1 A_end
    v_xor_b32 v19, 57344, v19
    s_add_u32 s48, s48, 1
    s_nop 0
    s_branch A_loop
A_end:
    s_endpgm
V_start:
    s_mov_b32 s12, s72
    s_and_b32 s13, s73, 0xffff
    s_mov_b32 s14, 0x780000
    s_mov_b32 s15, 0x20000
    s_mov_b32 s20, s74
    s_and_b32 s21, s75, 0xffff
    s_mov_b32 s22, 0x780000
    s_mov_b32 s23, 0x20000
    s_mul_i32 s50, s6, 384
    s_mul_i32 s51, s6, 245760
    s_lshl_b32 s54, s4, 10
    v_lshrrev_b32 v2, 5, v1
    v_lshlrev_b32 v2, 10, v2
    v_bfe_u32 v3, v1, 2, 3
    v_lshl_add_u32 v2, v3, 7, v2
    v_and_b32 v4, 3, v1
    v_lshl_add_u32 v2, v4, 3, v2
    v_lshrrev_b32 v3, 1, v3
    s_mul_i32 s32, s4, 1
    s_add_u32 s32, s32, 0
    s_lshr_b32 s33, s32, 2
    s_mul_i32 s33, s33, 8192
    v_add_u32 v4, s32, v3
    v_and_b32 v4, 3, v4
    v_lshl_add_u32 v4, v4, 5, v2
    v_add_u32 v6, s33, v4
    v_lshrrev_b32 v2, 4, v1
    v_and_b32 v3, 1, v2
    v_lshlrev_b32 v3, 11, v3
    v_lshrrev_b32 v2, 1, v2
    v_lshl_add_u32 v3, v2, 9, v3
    v_bfe_u32 v4, v1, 2, 1
    v_lshl_add_u32 v3, v4, 7, v3
    v_and_b32 v4, 3, v1
    v_lshl_add_u32 v3, v4, 3, v3
    v_bfe_u32 v4, v1, 3, 1
    v_lshl_add_u32 v2, v2, 1, v4
    s_mul_i32 s32, s4, 10
    s_add_u32 s32, s32, 0
    s_lshr_b32 s33, s32, 2
    s_lshl_b32 s33, s33, 12
    v_add_u32 v4, s32, v2
    v_and_b32 v4, 3, v4
    v_lshl_add_u32 v4, v4, 5, v3
    v_add_u32 v20, s33, v4
    v_add_u32 v4, s32, v2
    v_add_u32 v4, 1, v4
    v_and_b32 v4, 3, v4
    v_lshl_add_u32 v4, v4, 5, v3
    v_add_u32 v4, 256, v4
    v_add_u32 v21, s33, v4
    s_mul_i32 s32, s4, 10
    s_add_u32 s32, s32, 2
    s_lshr_b32 s33, s32, 2
    s_lshl_b32 s33, s33, 12
    v_add_u32 v4, s32, v2
    v_and_b32 v4, 3, v4
    v_lshl_add_u32 v4, v4, 5, v3
    v_add_u32 v22, s33, v4
    v_add_u32 v4, s32, v2
    v_add_u32 v4, 1, v4
    v_and_b32 v4, 3, v4
    v_lshl_add_u32 v4, v4, 5, v3
    v_add_u32 v4, 256, v4
    v_add_u32 v23, s33, v4
    v_lshrrev_b32 v2, 3, v1
    v_bfe_u32 v3, v1, 1, 2
    v_lshrrev_b32 v4, 1, v2
    v_sub_u32 v3, v3, v4
    v_and_b32 v3, 3, v3
    v_and_b32 v4, 1, v1
    v_lshl_add_u32 v3, v3, 1, v4
    v_lshrrev_b32 v4, 2, v2
    v_lshlrev_b32 v4, 2, v4
    v_bfe_u32 v5, v2, 1, 1
    v_lshl_add_u32 v4, v5, 3, v4
    v_and_b32 v5, 1, v2
    v_add_u32 v4, v4, v5
    s_and_b32 s32, s4, 1
    s_lshl_b32 s32, s32, 4
    s_lshr_b32 s33, s4, 1
    s_lshl_b32 s33, s33, 1
    s_add_u32 s32, s32, s33
    v_add_u32 v4, s32, v4
    v_mul_u32_u24 v4, 12288, v4
    v_lshl_add_u32 v24, v3, 4, v4
    v_lshrrev_b32 v2, 3, v1
    v_bfe_u32 v3, v1, 1, 2
    v_lshrrev_b32 v4, 1, v2
    v_sub_u32 v3, v3, v4
    v_and_b32 v3, 3, v3
    v_and_b32 v4, 1, v1
    v_lshl_add_u32 v3, v3, 1, v4
    v_lshrrev_b32 v4, 2, v2
    v_and_b32 v5, 3, v2
    v_lshl_add_u32 v4, v4, 3, v5
    s_and_b32 s32, s4, 1
    s_lshl_b32 s32, s32, 4
    s_lshr_b32 s33, s4, 1
    s_lshl_b32 s33, s33, 2
    s_add_u32 s32, s32, s33
    v_add_u32 v4, s32, v4
    v_mul_u32_u24 v4, 1280, v4
    v_lshl_add_u32 v25, v3, 4, v4
    s_mul_i32 s32, s4, 32768
    s_add_u32 s32, s32, 16384
    v_lshl_add_u32 v7, v1, 4, s32
    s_cmp_eq_u32 s4, 0
    s_cbranch_scc1 V_ld_w0
    s_cmp_eq_u32 s4, 1
    s_cbranch_scc1 V_ld_w1
    s_cmp_eq_u32 s4, 2
    s_cbranch_scc1 V_ld_w2
    s_add_u32 m0, s54, 0
    s_add_u32 s32, s50, 0
    buffer_load_dwordx4 v24, s[12:15], s32 offen nt lds
    s_add_u32 m0, s54, 4096
    s_add_u32 s32, s50, 393216
    buffer_load_dwordx4 v24, s[12:15], s32 offen nt lds
    s_add_u32 m0, s54, 8192
    s_add_u32 s32, s50, 128
    buffer_load_dwordx4 v24, s[12:15], s32 offen nt lds
    s_add_u32 m0, s54, 12288
    s_add_u32 s32, s50, 393344
    buffer_load_dwordx4 v24, s[12:15], s32 offen nt lds
    s_add_u32 m0, s54, 16384
    s_add_u32 s32, s50, 256
    buffer_load_dwordx4 v24, s[12:15], s32 offen nt lds
    s_add_u32 m0, s54, 20480
    s_add_u32 s32, s50, 393472
    buffer_load_dwordx4 v24, s[12:15], s32 offen nt lds
    s_add_u32 m0, s54, 24576
    s_add_u32 s32, s50, 786432
    buffer_load_dwordx4 v24, s[12:15], s32 offen nt lds
    s_add_u32 m0, s54, 28672
    s_add_u32 s32, s50, 1179648
    buffer_load_dwordx4 v24, s[12:15], s32 offen nt lds
    s_add_u32 m0, s54, 32768
    s_add_u32 s32, s50, 786560
    buffer_load_dwordx4 v24, s[12:15], s32 offen nt lds
    s_add_u32 m0, s54, 36864
    s_add_u32 s32, s50, 1179776
    buffer_load_dwordx4 v24, s[12:15], s32 offen nt lds
    s_add_u32 m0, s54, 40960
    s_add_u32 s32, s50, 786688
    buffer_load_dwordx4 v24, s[12:15], s32 offen nt lds
    s_add_u32 m0, s54, 45056
    s_add_u32 s32, s50, 1179904
    buffer_load_dwordx4 v24, s[12:15], s32 offen nt lds
    s_add_u32 m0, s54, 49152
    s_add_u32 s32, s50, 1572864
    buffer_load_dwordx4 v24, s[12:15], s32 offen nt lds
    s_add_u32 m0, s54, 53248
    s_add_u32 s32, s50, 1966080
    buffer_load_dwordx4 v24, s[12:15], s32 offen nt lds
    s_add_u32 m0, s54, 57344
    s_add_u32 s32, s50, 1572992
    buffer_load_dwordx4 v24, s[12:15], s32 offen nt lds
    s_add_u32 m0, s54, 61440
    s_add_u32 s32, s50, 1966208
    buffer_load_dwordx4 v24, s[12:15], s32 offen nt lds
    s_add_u32 m0, s54, 65536
    s_add_u32 s32, s50, 1573120
    buffer_load_dwordx4 v24, s[12:15], s32 offen nt lds
    s_add_u32 m0, s54, 69632
    s_add_u32 s32, s50, 1966336
    buffer_load_dwordx4 v24, s[12:15], s32 offen nt lds
    s_add_u32 m0, s54, 73728
    s_add_u32 s32, s50, 2359296
    buffer_load_dwordx4 v24, s[12:15], s32 offen nt lds
    s_add_u32 m0, s54, 77824
    s_add_u32 s32, s50, 2752512
    buffer_load_dwordx4 v24, s[12:15], s32 offen nt lds
    s_add_u32 m0, s54, 81920
    s_add_u32 s32, s50, 2359424
    buffer_load_dwordx4 v24, s[12:15], s32 offen nt lds
    s_add_u32 m0, s54, 86016
    s_add_u32 s32, s50, 2752640
    buffer_load_dwordx4 v24, s[12:15], s32 offen nt lds
    s_add_u32 m0, s54, 90112
    s_add_u32 s32, s50, 2359552
    buffer_load_dwordx4 v24, s[12:15], s32 offen nt lds
    s_add_u32 m0, s54, 94208
    s_add_u32 s32, s50, 2752768
    buffer_load_dwordx4 v24, s[12:15], s32 offen nt lds
    s_add_u32 m0, s54, 98304
    s_add_u32 s32, s50, 3145728
    buffer_load_dwordx4 v24, s[12:15], s32 offen nt lds
    s_add_u32 m0, s54, 102400
    s_add_u32 s32, s50, 3538944
    buffer_load_dwordx4 v24, s[12:15], s32 offen nt lds
    s_add_u32 m0, s54, 106496
    s_add_u32 s32, s50, 3145856
    buffer_load_dwordx4 v24, s[12:15], s32 offen nt lds
    s_add_u32 m0, s54, 110592
    s_add_u32 s32, s50, 3539072
    buffer_load_dwordx4 v24, s[12:15], s32 offen nt lds
    s_add_u32 m0, s54, 114688
    s_add_u32 s32, s50, 3145984
    buffer_load_dwordx4 v24, s[12:15], s32 offen nt lds
    s_add_u32 m0, s54, 118784
    s_add_u32 s32, s50, 3539200
    buffer_load_dwordx4 v24, s[12:15], s32 offen nt lds
    s_add_u32 m0, s54, 122880
    s_add_u32 s32, s50, 3932160
    buffer_load_dwordx4 v24, s[12:15], s32 offen nt lds
    s_add_u32 m0, s54, 126976
    s_add_u32 s32, s50, 4325376
    buffer_load_dwordx4 v24, s[12:15], s32 offen nt lds
    s_add_u32 m0, s54, 131072
    s_add_u32 s32, s50, 3932288
    buffer_load_dwordx4 v24, s[12:15], s32 offen nt lds
    s_add_u32 m0, s54, 135168
    s_add_u32 s32, s50, 4325504
    buffer_load_dwordx4 v24, s[12:15], s32 offen nt lds
    s_add_u32 m0, s54, 139264
    s_add_u32 s32, s50, 3932416
    buffer_load_dwordx4 v24, s[12:15], s32 offen nt lds
    s_add_u32 m0, s54, 143360
    s_add_u32 s32, s50, 4325632
    buffer_load_dwordx4 v24, s[12:15], s32 offen nt lds
    s_waitcnt vmcnt(30)
    s_barrier
    ds_read_b64_tr_b16 a[48:49], v6 offset:0
    ds_read_b64_tr_b16 a[50:51], v6 offset:2048
    ds_read_b64_tr_b16 a[52:53], v6 offset:4096
    ds_read_b64_tr_b16 a[54:55], v6 offset:6144
    ds_read_b64_tr_b16 a[56:57], v6 offset:8192
    ds_read_b64_tr_b16 a[58:59], v6 offset:10240
    ds_read_b64_tr_b16 a[60:61], v6 offset:12288
    ds_read_b64_tr_b16 a[62:63], v6 offset:14336
    ds_read_b64_tr_b16 a[64:65], v6 offset:16384
    ds_read_b64_tr_b16 a[66:67], v6 offset:18432
    ds_read_b64_tr_b16 a[68:69], v6 offset:20480
    ds_read_b64_tr_b16 a[70:71], v6 offset:22528
    s_waitcnt lgkmcnt(4)
    s_waitcnt lgkmcnt(0)
    s_waitcnt vmcnt(24)
    s_barrier
    s_add_u32 m0, s54, 0
    s_add_u32 s32, s50, 4718592
    buffer_load_dwordx4 v24, s[12:15], s32 offen nt lds
    s_add_u32 m0, s54, 4096
    s_add_u32 s32, s50, 5111808
    buffer_load_dwordx4 v24, s[12:15], s32 offen nt lds
    s_add_u32 m0, s54, 8192
    s_add_u32 s32, s50, 4718720
    buffer_load_dwordx4 v24, s[12:15], s32 offen nt lds
    s_add_u32 m0, s54, 12288
    s_add_u32 s32, s50, 5111936
    buffer_load_dwordx4 v24, s[12:15], s32 offen nt lds
    s_add_u32 m0, s54, 16384
    s_add_u32 s32, s50, 4718848
    buffer_load_dwordx4 v24, s[12:15], s32 offen nt lds
    s_add_u32 m0, s54, 20480
    s_add_u32 s32, s50, 5112064
    buffer_load_dwordx4 v24, s[12:15], s32 offen nt lds
    ds_read_b64_tr_b16 a[72:73], v6 offset:24576
    ds_read_b64_tr_b16 a[74:75], v6 offset:26624
    ds_read_b64_tr_b16 a[76:77], v6 offset:28672
    ds_read_b64_tr_b16 a[78:79], v6 offset:30720
    ds_read_b64_tr_b16 a[80:81], v6 offset:32768
    ds_read_b64_tr_b16 a[82:83], v6 offset:34816
    ds_read_b64_tr_b16 a[84:85], v6 offset:36864
    ds_read_b64_tr_b16 a[86:87], v6 offset:38912
    ds_read_b64_tr_b16 a[88:89], v6 offset:40960
    ds_read_b64_tr_b16 a[90:91], v6 offset:43008
    ds_read_b64_tr_b16 a[92:93], v6 offset:45056
    ds_read_b64_tr_b16 a[94:95], v6 offset:47104
    s_waitcnt lgkmcnt(4)
    s_waitcnt lgkmcnt(0)
    s_waitcnt vmcnt(24)
    s_barrier
    s_add_u32 m0, s54, 24576
    s_add_u32 s32, s50, 5505024
    buffer_load_dwordx4 v24, s[12:15], s32 offen nt lds
    s_add_u32 m0, s54, 28672
    s_add_u32 s32, s50, 5898240
    buffer_load_dwordx4 v24, s[12:15], s32 offen nt lds
    s_add_u32 m0, s54, 32768
    s_add_u32 s32, s50, 5505152
    buffer_load_dwordx4 v24, s[12:15], s32 offen nt lds
    s_add_u32 m0, s54, 36864
    s_add_u32 s32, s50, 5898368
    buffer_load_dwordx4 v24, s[12:15], s32 offen nt lds
    s_add_u32 m0, s54, 40960
    s_add_u32 s32, s50, 5505280
    buffer_load_dwordx4 v24, s[12:15], s32 offen nt lds
    s_add_u32 m0, s54, 45056
    s_add_u32 s32, s50, 5898496
    buffer_load_dwordx4 v24, s[12:15], s32 offen nt lds
    ds_read_b64_tr_b16 v[28:29], v6 offset:49152
    ds_read_b64_tr_b16 v[30:31], v6 offset:51200
    ds_read_b64_tr_b16 v[32:33], v6 offset:53248
    ds_read_b64_tr_b16 v[34:35], v6 offset:55296
    ds_read_b64_tr_b16 v[36:37], v6 offset:57344
    ds_read_b64_tr_b16 v[38:39], v6 offset:59392
    ds_read_b64_tr_b16 v[40:41], v6 offset:61440
    ds_read_b64_tr_b16 v[42:43], v6 offset:63488
    v_add_u32 v9, 0x10000, v6
    ds_read_b64_tr_b16 v[44:45], v9 offset:0
    ds_read_b64_tr_b16 v[46:47], v9 offset:2048
    ds_read_b64_tr_b16 v[48:49], v9 offset:4096
    ds_read_b64_tr_b16 v[50:51], v9 offset:6144
    s_waitcnt lgkmcnt(4)
    s_waitcnt lgkmcnt(0)
    s_waitcnt vmcnt(24)
    s_barrier
    s_add_u32 m0, s54, 49152
    s_add_u32 s32, s50, 6291456
    buffer_load_dwordx4 v24, s[12:15], s32 offen nt lds
    s_add_u32 m0, s54, 53248
    s_add_u32 s32, s50, 6684672
    buffer_load_dwordx4 v24, s[12:15], s32 offen nt lds
    s_add_u32 m0, s54, 57344
    s_add_u32 s32, s50, 6291584
    buffer_load_dwordx4 v24, s[12:15], s32 offen nt lds
    s_add_u32 m0, s54, 61440
    s_add_u32 s32, s50, 6684800
    buffer_load_dwordx4 v24, s[12:15], s32 offen nt lds
    s_add_u32 m0, s54, 65536
    s_add_u32 s32, s50, 6291712
    buffer_load_dwordx4 v24, s[12:15], s32 offen nt lds
    s_add_u32 m0, s54, 69632
    s_add_u32 s32, s50, 6684928
    buffer_load_dwordx4 v24, s[12:15], s32 offen nt lds
    v_add_u32 v10, 0x10000, v6
    ds_read_b64_tr_b16 a[120:121], v10 offset:8192
    ds_read_b64_tr_b16 a[122:123], v10 offset:10240
    ds_read_b64_tr_b16 a[124:125], v10 offset:12288
    ds_read_b64_tr_b16 a[126:127], v10 offset:14336
    ds_read_b64_tr_b16 a[128:129], v10 offset:16384
    ds_read_b64_tr_b16 a[130:131], v10 offset:18432
    ds_read_b64_tr_b16 a[132:133], v10 offset:20480
    ds_read_b64_tr_b16 a[134:135], v10 offset:22528
    ds_read_b64_tr_b16 a[136:137], v10 offset:24576
    ds_read_b64_tr_b16 a[138:139], v10 offset:26624
    ds_read_b64_tr_b16 a[140:141], v10 offset:28672
    ds_read_b64_tr_b16 a[142:143], v10 offset:30720
    s_waitcnt lgkmcnt(4)
    s_waitcnt lgkmcnt(0)
    s_waitcnt vmcnt(24)
    s_barrier
    s_add_u32 m0, s54, 73728
    s_add_u32 s32, s50, 7077888
    buffer_load_dwordx4 v24, s[12:15], s32 offen nt lds
    s_add_u32 m0, s54, 77824
    s_add_u32 s32, s50, 7471104
    buffer_load_dwordx4 v24, s[12:15], s32 offen nt lds
    s_add_u32 m0, s54, 81920
    s_add_u32 s32, s50, 7078016
    buffer_load_dwordx4 v24, s[12:15], s32 offen nt lds
    s_add_u32 m0, s54, 86016
    s_add_u32 s32, s50, 7471232
    buffer_load_dwordx4 v24, s[12:15], s32 offen nt lds
    s_add_u32 m0, s54, 90112
    s_add_u32 s32, s50, 7078144
    buffer_load_dwordx4 v24, s[12:15], s32 offen nt lds
    s_add_u32 m0, s54, 94208
    s_add_u32 s32, s50, 7471360
    buffer_load_dwordx4 v24, s[12:15], s32 offen nt lds
    v_add_u32 v9, 0x18000, v6
    ds_read_b64_tr_b16 a[96:97], v9 offset:0
    ds_read_b64_tr_b16 a[98:99], v9 offset:2048
    ds_read_b64_tr_b16 a[100:101], v9 offset:4096
    ds_read_b64_tr_b16 a[102:103], v9 offset:6144
    ds_read_b64_tr_b16 a[104:105], v9 offset:8192
    ds_read_b64_tr_b16 a[106:107], v9 offset:10240
    ds_read_b64_tr_b16 a[108:109], v9 offset:12288
    ds_read_b64_tr_b16 a[110:111], v9 offset:14336
    ds_read_b64_tr_b16 a[112:113], v9 offset:16384
    ds_read_b64_tr_b16 a[114:115], v9 offset:18432
    ds_read_b64_tr_b16 a[116:117], v9 offset:20480
    ds_read_b64_tr_b16 a[118:119], v9 offset:22528
    s_waitcnt lgkmcnt(4)
    s_waitcnt lgkmcnt(0)
    s_waitcnt vmcnt(24)
    s_barrier
    v_add_u32 v10, 0x18000, v6
    ds_read_b64_tr_b16 a[0:1], v10 offset:24576
    ds_read_b64_tr_b16 a[2:3], v10 offset:26624
    ds_read_b64_tr_b16 a[4:5], v10 offset:28672
    ds_read_b64_tr_b16 a[6:7], v10 offset:30720
    v_add_u32 v9, 0x20000, v6
    ds_read_b64_tr_b16 a[8:9], v9 offset:0
    ds_read_b64_tr_b16 a[10:11], v9 offset:2048
    ds_read_b64_tr_b16 a[12:13], v9 offset:4096
    ds_read_b64_tr_b16 a[14:15], v9 offset:6144
    ds_read_b64_tr_b16 a[16:17], v9 offset:8192
    ds_read_b64_tr_b16 a[18:19], v9 offset:10240
    ds_read_b64_tr_b16 a[20:21], v9 offset:12288
    ds_read_b64_tr_b16 a[22:23], v9 offset:14336
    s_waitcnt lgkmcnt(4)
    s_waitcnt lgkmcnt(0)
    s_waitcnt vmcnt(18)
    s_barrier
    s_add_u32 m0, s54, 98304
    s_add_u32 s32, s51, 0
    buffer_load_dwordx4 v25, s[20:23], s32 offen nt lds
    s_add_u32 m0, s54, 102400
    s_add_u32 s32, s51, 128
    buffer_load_dwordx4 v25, s[20:23], s32 offen nt lds
    s_add_u32 m0, s54, 106496
    s_add_u32 s32, s51, 256
    buffer_load_dwordx4 v25, s[20:23], s32 offen nt lds
    s_add_u32 m0, s54, 110592
    s_add_u32 s32, s51, 384
    buffer_load_dwordx4 v25, s[20:23], s32 offen nt lds
    s_add_u32 m0, s54, 114688
    s_add_u32 s32, s51, 512
    buffer_load_dwordx4 v25, s[20:23], s32 offen nt lds
    s_add_u32 m0, s54, 118784
    s_add_u32 s32, s51, 640
    buffer_load_dwordx4 v25, s[20:23], s32 offen nt lds
    s_add_u32 m0, s54, 122880
    s_add_u32 s32, s51, 768
    buffer_load_dwordx4 v25, s[20:23], s32 offen nt lds
    s_add_u32 m0, s54, 126976
    s_add_u32 s32, s51, 896
    buffer_load_dwordx4 v25, s[20:23], s32 offen nt lds
    s_add_u32 m0, s54, 131072
    s_add_u32 s32, s51, 1024
    buffer_load_dwordx4 v25, s[20:23], s32 offen nt lds
    s_add_u32 m0, s54, 135168
    s_add_u32 s32, s51, 1152
    buffer_load_dwordx4 v25, s[20:23], s32 offen nt lds
    ds_read_b64_tr_b16 v[52:53], v6 offset:0
    ds_read_b64_tr_b16 v[54:55], v6 offset:2048
    ds_read_b64_tr_b16 v[56:57], v6 offset:4096
    ds_read_b64_tr_b16 v[58:59], v6 offset:6144
    ds_read_b64_tr_b16 v[60:61], v6 offset:8192
    ds_read_b64_tr_b16 v[62:63], v6 offset:10240
    ds_read_b64_tr_b16 v[64:65], v6 offset:12288
    ds_read_b64_tr_b16 v[66:67], v6 offset:14336
    ds_read_b64_tr_b16 v[68:69], v6 offset:16384
    ds_read_b64_tr_b16 v[70:71], v6 offset:18432
    ds_read_b64_tr_b16 v[72:73], v6 offset:20480
    ds_read_b64_tr_b16 v[74:75], v6 offset:22528
    s_waitcnt lgkmcnt(4)
    s_waitcnt lgkmcnt(0)
    s_waitcnt vmcnt(22)
    s_barrier
    ds_read_b64_tr_b16 a[168:169], v6 offset:24576
    ds_read_b64_tr_b16 a[170:171], v6 offset:26624
    ds_read_b64_tr_b16 a[172:173], v6 offset:28672
    ds_read_b64_tr_b16 a[174:175], v6 offset:30720
    ds_read_b64_tr_b16 a[176:177], v6 offset:32768
    ds_read_b64_tr_b16 a[178:179], v6 offset:34816
    ds_read_b64_tr_b16 a[180:181], v6 offset:36864
    ds_read_b64_tr_b16 a[182:183], v6 offset:38912
    ds_read_b64_tr_b16 a[184:185], v6 offset:40960
    ds_read_b64_tr_b16 a[186:187], v6 offset:43008
    ds_read_b64_tr_b16 a[188:189], v6 offset:45056
    ds_read_b64_tr_b16 a[190:191], v6 offset:47104
    s_waitcnt lgkmcnt(4)
    s_waitcnt lgkmcnt(0)
    s_waitcnt vmcnt(16)
    s_barrier
    s_add_u32 m0, s54, 0
    s_add_u32 s32, s51, 40960
    buffer_load_dwordx4 v25, s[20:23], s32 offen nt lds
    s_add_u32 m0, s54, 4096
    s_add_u32 s32, s51, 41088
    buffer_load_dwordx4 v25, s[20:23], s32 offen nt lds
    s_add_u32 m0, s54, 8192
    s_add_u32 s32, s51, 41216
    buffer_load_dwordx4 v25, s[20:23], s32 offen nt lds
    s_add_u32 m0, s54, 12288
    s_add_u32 s32, s51, 41344
    buffer_load_dwordx4 v25, s[20:23], s32 offen nt lds
    s_add_u32 m0, s54, 16384
    s_add_u32 s32, s51, 41472
    buffer_load_dwordx4 v25, s[20:23], s32 offen nt lds
    s_add_u32 m0, s54, 20480
    s_add_u32 s32, s51, 41600
    buffer_load_dwordx4 v25, s[20:23], s32 offen nt lds
    s_add_u32 m0, s54, 24576
    s_add_u32 s32, s51, 41728
    buffer_load_dwordx4 v25, s[20:23], s32 offen nt lds
    s_add_u32 m0, s54, 28672
    s_add_u32 s32, s51, 41856
    buffer_load_dwordx4 v25, s[20:23], s32 offen nt lds
    s_add_u32 m0, s54, 32768
    s_add_u32 s32, s51, 41984
    buffer_load_dwordx4 v25, s[20:23], s32 offen nt lds
    s_add_u32 m0, s54, 36864
    s_add_u32 s32, s51, 42112
    buffer_load_dwordx4 v25, s[20:23], s32 offen nt lds
    ds_read_b64_tr_b16 a[144:145], v6 offset:49152
    ds_read_b64_tr_b16 a[146:147], v6 offset:51200
    ds_read_b64_tr_b16 a[148:149], v6 offset:53248
    ds_read_b64_tr_b16 a[150:151], v6 offset:55296
    ds_read_b64_tr_b16 a[152:153], v6 offset:57344
    ds_read_b64_tr_b16 a[154:155], v6 offset:59392
    ds_read_b64_tr_b16 a[156:157], v6 offset:61440
    ds_read_b64_tr_b16 a[158:159], v6 offset:63488
    v_add_u32 v10, 0x10000, v6
    ds_read_b64_tr_b16 a[160:161], v10 offset:0
    ds_read_b64_tr_b16 a[162:163], v10 offset:2048
    ds_read_b64_tr_b16 a[164:165], v10 offset:4096
    ds_read_b64_tr_b16 a[166:167], v10 offset:6144
    s_waitcnt lgkmcnt(4)
    s_waitcnt lgkmcnt(0)
    s_waitcnt vmcnt(20)
    s_barrier
    v_add_u32 v9, 0x10000, v6
    ds_read_b64_tr_b16 a[24:25], v9 offset:8192
    ds_read_b64_tr_b16 a[26:27], v9 offset:10240
    ds_read_b64_tr_b16 a[28:29], v9 offset:12288
    ds_read_b64_tr_b16 a[30:31], v9 offset:14336
    ds_read_b64_tr_b16 a[32:33], v9 offset:16384
    ds_read_b64_tr_b16 a[34:35], v9 offset:18432
    ds_read_b64_tr_b16 a[36:37], v9 offset:20480
    ds_read_b64_tr_b16 a[38:39], v9 offset:22528
    ds_read_b64_tr_b16 a[40:41], v9 offset:24576
    ds_read_b64_tr_b16 a[42:43], v9 offset:26624
    ds_read_b64_tr_b16 a[44:45], v9 offset:28672
    ds_read_b64_tr_b16 a[46:47], v9 offset:30720
    s_waitcnt lgkmcnt(4)
    s_waitcnt lgkmcnt(0)
    s_waitcnt vmcnt(10)
    s_barrier
    s_add_u32 m0, s54, 40960
    s_add_u32 s32, s51, 81920
    buffer_load_dwordx4 v25, s[20:23], s32 offen nt lds
    s_add_u32 m0, s54, 45056
    s_add_u32 s32, s51, 82048
    buffer_load_dwordx4 v25, s[20:23], s32 offen nt lds
    s_add_u32 m0, s54, 49152
    s_add_u32 s32, s51, 82176
    buffer_load_dwordx4 v25, s[20:23], s32 offen nt lds
    s_add_u32 m0, s54, 53248
    s_add_u32 s32, s51, 82304
    buffer_load_dwordx4 v25, s[20:23], s32 offen nt lds
    s_add_u32 m0, s54, 57344
    s_add_u32 s32, s51, 82432
    buffer_load_dwordx4 v25, s[20:23], s32 offen nt lds
    s_add_u32 m0, s54, 61440
    s_add_u32 s32, s51, 82560
    buffer_load_dwordx4 v25, s[20:23], s32 offen nt lds
    s_add_u32 m0, s54, 65536
    s_add_u32 s32, s51, 82688
    buffer_load_dwordx4 v25, s[20:23], s32 offen nt lds
    s_add_u32 m0, s54, 69632
    s_add_u32 s32, s51, 82816
    buffer_load_dwordx4 v25, s[20:23], s32 offen nt lds
    s_add_u32 m0, s54, 73728
    s_add_u32 s32, s51, 82944
    buffer_load_dwordx4 v25, s[20:23], s32 offen nt lds
    s_add_u32 m0, s54, 77824
    s_add_u32 s32, s51, 83072
    buffer_load_dwordx4 v25, s[20:23], s32 offen nt lds
    v_add_u32 v10, 0x18000, v20
    ds_read_b64_tr_b16 a[192:193], v10 offset:0
    v_add_u32 v9, 0x18000, v21
    ds_read_b64_tr_b16 a[194:195], v9 offset:0
    ds_read_b64_tr_b16 a[196:197], v10 offset:1024
    ds_read_b64_tr_b16 a[198:199], v9 offset:1024
    v_add_u32 v10, 0x18000, v22
    ds_read_b64_tr_b16 a[200:201], v10 offset:0
    v_add_u32 v9, 0x18000, v23
    ds_read_b64_tr_b16 a[202:203], v9 offset:0
    ds_read_b64_tr_b16 a[204:205], v10 offset:1024
    ds_read_b64_tr_b16 a[206:207], v9 offset:1024
    v_add_u32 v10, 0x18000, v20
    ds_read_b64_tr_b16 a[208:209], v10 offset:4096
    v_add_u32 v9, 0x18000, v21
    ds_read_b64_tr_b16 a[210:211], v9 offset:4096
    ds_read_b64_tr_b16 a[212:213], v10 offset:5120
    ds_read_b64_tr_b16 a[214:215], v9 offset:5120
    s_waitcnt lgkmcnt(4)
    v_add_u32 v10, 0x18000, v22
    ds_read_b64_tr_b16 a[216:217], v10 offset:4096
    v_add_u32 v9, 0x18000, v23
    ds_read_b64_tr_b16 a[218:219], v9 offset:4096
    ds_read_b64_tr_b16 a[220:221], v10 offset:5120
    ds_read_b64_tr_b16 a[222:223], v9 offset:5120
    v_add_u32 v10, 0x18000, v20
    ds_read_b64_tr_b16 a[224:225], v10 offset:8192
    v_add_u32 v9, 0x18000, v21
    ds_read_b64_tr_b16 a[226:227], v9 offset:8192
    ds_read_b64_tr_b16 a[228:229], v10 offset:9216
    ds_read_b64_tr_b16 a[230:231], v9 offset:9216
    s_waitcnt lgkmcnt(4)
    s_waitcnt lgkmcnt(0)
    s_waitcnt vmcnt(10)
    s_barrier
    s_add_u32 m0, s54, 81920
    s_add_u32 s32, s51, 122880
    buffer_load_dwordx4 v25, s[20:23], s32 offen nt lds
    s_add_u32 m0, s54, 86016
    s_add_u32 s32, s51, 123008
    buffer_load_dwordx4 v25, s[20:23], s32 offen nt lds
    s_add_u32 m0, s54, 90112
    s_add_u32 s32, s51, 123136
    buffer_load_dwordx4 v25, s[20:23], s32 offen nt lds
    s_add_u32 m0, s54, 94208
    s_add_u32 s32, s51, 123264
    buffer_load_dwordx4 v25, s[20:23], s32 offen nt lds
    s_add_u32 m0, s54, 98304
    s_add_u32 s32, s51, 123392
    buffer_load_dwordx4 v25, s[20:23], s32 offen nt lds
    s_add_u32 m0, s54, 102400
    s_add_u32 s32, s51, 123520
    buffer_load_dwordx4 v25, s[20:23], s32 offen nt lds
    s_add_u32 m0, s54, 106496
    s_add_u32 s32, s51, 123648
    buffer_load_dwordx4 v25, s[20:23], s32 offen nt lds
    s_add_u32 m0, s54, 110592
    s_add_u32 s32, s51, 123776
    buffer_load_dwordx4 v25, s[20:23], s32 offen nt lds
    s_add_u32 m0, s54, 114688
    s_add_u32 s32, s51, 123904
    buffer_load_dwordx4 v25, s[20:23], s32 offen nt lds
    s_add_u32 m0, s54, 118784
    s_add_u32 s32, s51, 124032
    buffer_load_dwordx4 v25, s[20:23], s32 offen nt lds
    s_add_u32 m0, s54, 122880
    s_add_u32 s32, s51, 163840
    buffer_load_dwordx4 v25, s[20:23], s32 offen nt lds
    s_add_u32 m0, s54, 126976
    s_add_u32 s32, s51, 163968
    buffer_load_dwordx4 v25, s[20:23], s32 offen nt lds
    s_add_u32 m0, s54, 131072
    s_add_u32 s32, s51, 164096
    buffer_load_dwordx4 v25, s[20:23], s32 offen nt lds
    s_add_u32 m0, s54, 135168
    s_add_u32 s32, s51, 164224
    buffer_load_dwordx4 v25, s[20:23], s32 offen nt lds
    s_add_u32 m0, s54, 139264
    s_add_u32 s32, s51, 164352
    buffer_load_dwordx4 v25, s[20:23], s32 offen nt lds
    s_add_u32 m0, s54, 143360
    s_add_u32 s32, s51, 164480
    buffer_load_dwordx4 v25, s[20:23], s32 offen nt lds
    s_add_u32 m0, s54, 147456
    s_add_u32 s32, s51, 164608
    buffer_load_dwordx4 v25, s[20:23], s32 offen nt lds
    s_add_u32 m0, s54, 151552
    s_add_u32 s32, s51, 164736
    buffer_load_dwordx4 v25, s[20:23], s32 offen nt lds
    s_add_u32 m0, s54, 155648
    s_add_u32 s32, s51, 164864
    buffer_load_dwordx4 v25, s[20:23], s32 offen nt lds
    s_add_u32 m0, s54, 159744
    s_add_u32 s32, s51, 164992
    buffer_load_dwordx4 v25, s[20:23], s32 offen nt lds
    ds_read_b64_tr_b16 a[232:233], v20 offset:0
    ds_read_b64_tr_b16 a[234:235], v21 offset:0
    ds_read_b64_tr_b16 a[236:237], v20 offset:1024
    ds_read_b64_tr_b16 a[238:239], v21 offset:1024
    ds_read_b64_tr_b16 a[240:241], v22 offset:0
    ds_read_b64_tr_b16 a[242:243], v23 offset:0
    ds_read_b64_tr_b16 a[244:245], v22 offset:1024
    ds_read_b64_tr_b16 a[246:247], v23 offset:1024
    ds_read_b64_tr_b16 a[248:249], v20 offset:4096
    ds_read_b64_tr_b16 a[250:251], v21 offset:4096
    ds_read_b64_tr_b16 a[252:253], v20 offset:5120
    ds_read_b64_tr_b16 a[254:255], v21 offset:5120
    s_waitcnt lgkmcnt(4)
    ds_read_b64_tr_b16 v[160:161], v22 offset:4096
    ds_read_b64_tr_b16 v[162:163], v23 offset:4096
    ds_read_b64_tr_b16 v[164:165], v22 offset:5120
    ds_read_b64_tr_b16 v[166:167], v23 offset:5120
    ds_read_b64_tr_b16 v[168:169], v20 offset:8192
    ds_read_b64_tr_b16 v[170:171], v21 offset:8192
    ds_read_b64_tr_b16 v[172:173], v20 offset:9216
    ds_read_b64_tr_b16 v[174:175], v21 offset:9216
    s_waitcnt lgkmcnt(4)
    s_waitcnt lgkmcnt(0)
    s_waitcnt vmcnt(20)
    s_barrier
    s_add_u32 m0, s54, 0
    s_add_u32 s32, s51, 204800
    buffer_load_dwordx4 v25, s[20:23], s32 offen nt lds
    s_add_u32 m0, s54, 4096
    s_add_u32 s32, s51, 204928
    buffer_load_dwordx4 v25, s[20:23], s32 offen nt lds
    s_add_u32 m0, s54, 8192
    s_add_u32 s32, s51, 205056
    buffer_load_dwordx4 v25, s[20:23], s32 offen nt lds
    s_add_u32 m0, s54, 12288
    s_add_u32 s32, s51, 205184
    buffer_load_dwordx4 v25, s[20:23], s32 offen nt lds
    s_add_u32 m0, s54, 16384
    s_add_u32 s32, s51, 205312
    buffer_load_dwordx4 v25, s[20:23], s32 offen nt lds
    s_add_u32 m0, s54, 20480
    s_add_u32 s32, s51, 205440
    buffer_load_dwordx4 v25, s[20:23], s32 offen nt lds
    s_add_u32 m0, s54, 24576
    s_add_u32 s32, s51, 205568
    buffer_load_dwordx4 v25, s[20:23], s32 offen nt lds
    s_add_u32 m0, s54, 28672
    s_add_u32 s32, s51, 205696
    buffer_load_dwordx4 v25, s[20:23], s32 offen nt lds
    s_add_u32 m0, s54, 32768
    s_add_u32 s32, s51, 205824
    buffer_load_dwordx4 v25, s[20:23], s32 offen nt lds
    s_add_u32 m0, s54, 36864
    s_add_u32 s32, s51, 205952
    buffer_load_dwordx4 v25, s[20:23], s32 offen nt lds
    s_mov_b32 s28, s88
    s_and_b32 s29, s89, 0xffff
    s_mov_b32 s30, 0x100
    s_mov_b32 s31, 0x20000
    v_mov_b32 v2, 0
    buffer_load_dword v3, v2, s[28:31], 0 offen offset:60 sc1
    ds_read_b64_tr_b16 v[176:177], v20 offset:40960
    ds_read_b64_tr_b16 v[178:179], v21 offset:40960
    ds_read_b64_tr_b16 v[180:181], v20 offset:41984
    ds_read_b64_tr_b16 v[182:183], v21 offset:41984
    ds_read_b64_tr_b16 v[184:185], v22 offset:40960
    ds_read_b64_tr_b16 v[186:187], v23 offset:40960
    ds_read_b64_tr_b16 v[188:189], v22 offset:41984
    ds_read_b64_tr_b16 v[190:191], v23 offset:41984
    ds_read_b64_tr_b16 v[192:193], v20 offset:45056
    ds_read_b64_tr_b16 v[194:195], v21 offset:45056
    ds_read_b64_tr_b16 v[196:197], v20 offset:46080
    ds_read_b64_tr_b16 v[198:199], v21 offset:46080
    s_waitcnt lgkmcnt(4)
    ds_read_b64_tr_b16 v[200:201], v22 offset:45056
    ds_read_b64_tr_b16 v[202:203], v23 offset:45056
    ds_read_b64_tr_b16 v[204:205], v22 offset:46080
    ds_read_b64_tr_b16 v[206:207], v23 offset:46080
    ds_read_b64_tr_b16 v[208:209], v20 offset:49152
    ds_read_b64_tr_b16 v[210:211], v21 offset:49152
    ds_read_b64_tr_b16 v[212:213], v20 offset:50176
    ds_read_b64_tr_b16 v[214:215], v21 offset:50176
    s_waitcnt lgkmcnt(4)
    s_waitcnt lgkmcnt(0)
    s_waitcnt vmcnt(21)
    s_barrier
    v_add_u32 v10, 0x10000, v20
    ds_read_b64_tr_b16 v[76:77], v10 offset:16384
    v_add_u32 v9, 0x10000, v21
    ds_read_b64_tr_b16 v[78:79], v9 offset:16384
    ds_read_b64_tr_b16 v[80:81], v10 offset:17408
    ds_read_b64_tr_b16 v[82:83], v9 offset:17408
    v_add_u32 v10, 0x10000, v22
    ds_read_b64_tr_b16 v[84:85], v10 offset:16384
    v_add_u32 v9, 0x10000, v23
    ds_read_b64_tr_b16 v[86:87], v9 offset:16384
    ds_read_b64_tr_b16 v[88:89], v10 offset:17408
    ds_read_b64_tr_b16 v[90:91], v9 offset:17408
    v_add_u32 v10, 0x10000, v20
    ds_read_b64_tr_b16 v[92:93], v10 offset:20480
    v_add_u32 v9, 0x10000, v21
    ds_read_b64_tr_b16 v[94:95], v9 offset:20480
    ds_read_b64_tr_b16 v[96:97], v10 offset:21504
    ds_read_b64_tr_b16 v[98:99], v9 offset:21504
    s_waitcnt lgkmcnt(4)
    v_add_u32 v10, 0x10000, v22
    ds_read_b64_tr_b16 v[100:101], v10 offset:20480
    v_add_u32 v9, 0x10000, v23
    ds_read_b64_tr_b16 v[102:103], v9 offset:20480
    ds_read_b64_tr_b16 v[104:105], v10 offset:21504
    ds_read_b64_tr_b16 v[106:107], v9 offset:21504
    v_add_u32 v10, 0x10000, v20
    ds_read_b64_tr_b16 v[108:109], v10 offset:24576
    v_add_u32 v9, 0x10000, v21
    ds_read_b64_tr_b16 v[110:111], v9 offset:24576
    ds_read_b64_tr_b16 v[112:113], v10 offset:25600
    ds_read_b64_tr_b16 v[114:115], v9 offset:25600
    s_waitcnt lgkmcnt(4)
    s_waitcnt lgkmcnt(0)
    s_waitcnt vmcnt(11)
    s_barrier
    v_add_u32 v10, 0x18000, v20
    ds_read_b64_tr_b16 v[216:217], v10 offset:24576
    v_add_u32 v9, 0x18000, v21
    ds_read_b64_tr_b16 v[218:219], v9 offset:24576
    ds_read_b64_tr_b16 v[220:221], v10 offset:25600
    ds_read_b64_tr_b16 v[222:223], v9 offset:25600
    v_add_u32 v10, 0x18000, v22
    ds_read_b64_tr_b16 v[224:225], v10 offset:24576
    v_add_u32 v9, 0x18000, v23
    ds_read_b64_tr_b16 v[226:227], v9 offset:24576
    ds_read_b64_tr_b16 v[228:229], v10 offset:25600
    ds_read_b64_tr_b16 v[230:231], v9 offset:25600
    v_add_u32 v10, 0x18000, v20
    ds_read_b64_tr_b16 v[232:233], v10 offset:28672
    v_add_u32 v9, 0x18000, v21
    ds_read_b64_tr_b16 v[234:235], v9 offset:28672
    ds_read_b64_tr_b16 v[236:237], v10 offset:29696
    ds_read_b64_tr_b16 v[238:239], v9 offset:29696
    s_waitcnt lgkmcnt(4)
    v_add_u32 v10, 0x18000, v22
    ds_read_b64_tr_b16 v[240:241], v10 offset:28672
    v_add_u32 v9, 0x18000, v23
    ds_read_b64_tr_b16 v[242:243], v9 offset:28672
    ds_read_b64_tr_b16 v[244:245], v10 offset:29696
    ds_read_b64_tr_b16 v[246:247], v9 offset:29696
    v_add_u32 v10, 0x20000, v20
    ds_read_b64_tr_b16 v[248:249], v10 offset:0
    v_add_u32 v9, 0x20000, v21
    ds_read_b64_tr_b16 v[250:251], v9 offset:0
    ds_read_b64_tr_b16 v[252:253], v10 offset:1024
    ds_read_b64_tr_b16 v[254:255], v9 offset:1024
    s_waitcnt lgkmcnt(4)
    s_waitcnt lgkmcnt(0)
    s_waitcnt vmcnt(1)
    s_barrier
    ds_read_b64_tr_b16 v[116:117], v20 offset:0
    ds_read_b64_tr_b16 v[118:119], v21 offset:0
    ds_read_b64_tr_b16 v[120:121], v20 offset:1024
    ds_read_b64_tr_b16 v[122:123], v21 offset:1024
    ds_read_b64_tr_b16 v[124:125], v22 offset:0
    ds_read_b64_tr_b16 v[126:127], v23 offset:0
    ds_read_b64_tr_b16 v[128:129], v22 offset:1024
    ds_read_b64_tr_b16 v[130:131], v23 offset:1024
    ds_read_b64_tr_b16 v[132:133], v20 offset:4096
    ds_read_b64_tr_b16 v[134:135], v21 offset:4096
    ds_read_b64_tr_b16 v[136:137], v20 offset:5120
    ds_read_b64_tr_b16 v[138:139], v21 offset:5120
    s_waitcnt lgkmcnt(4)
    ds_read_b64_tr_b16 v[140:141], v22 offset:4096
    ds_read_b64_tr_b16 v[142:143], v23 offset:4096
    ds_read_b64_tr_b16 v[144:145], v22 offset:5120
    ds_read_b64_tr_b16 v[146:147], v23 offset:5120
    ds_read_b64_tr_b16 v[148:149], v20 offset:8192
    ds_read_b64_tr_b16 v[150:151], v21 offset:8192
    ds_read_b64_tr_b16 v[152:153], v20 offset:9216
    ds_read_b64_tr_b16 v[154:155], v21 offset:9216
    s_waitcnt lgkmcnt(4)
    s_waitcnt lgkmcnt(0)
    s_barrier
    s_branch V_ld_wx
V_ld_w0:
    s_add_u32 m0, s54, 0
    s_add_u32 s32, s50, 0
    buffer_load_dwordx4 v24, s[12:15], s32 offen nt lds
    s_add_u32 m0, s54, 4096
    s_add_u32 s32, s50, 393216
    buffer_load_dwordx4 v24, s[12:15], s32 offen nt lds
    s_add_u32 m0, s54, 8192
    s_add_u32 s32, s50, 128
    buffer_load_dwordx4 v24, s[12:15], s32 offen nt lds
    s_add_u32 m0, s54, 12288
    s_add_u32 s32, s50, 393344
    buffer_load_dwordx4 v24, s[12:15], s32 offen nt lds
    s_add_u32 m0, s54, 16384
    s_add_u32 s32, s50, 256
    buffer_load_dwordx4 v24, s[12:15], s32 offen nt lds
    s_add_u32 m0, s54, 20480
    s_add_u32 s32, s50, 393472
    buffer_load_dwordx4 v24, s[12:15], s32 offen nt lds
    s_add_u32 m0, s54, 24576
    s_add_u32 s32, s50, 786432
    buffer_load_dwordx4 v24, s[12:15], s32 offen nt lds
    s_add_u32 m0, s54, 28672
    s_add_u32 s32, s50, 1179648
    buffer_load_dwordx4 v24, s[12:15], s32 offen nt lds
    s_add_u32 m0, s54, 32768
    s_add_u32 s32, s50, 786560
    buffer_load_dwordx4 v24, s[12:15], s32 offen nt lds
    s_add_u32 m0, s54, 36864
    s_add_u32 s32, s50, 1179776
    buffer_load_dwordx4 v24, s[12:15], s32 offen nt lds
    s_add_u32 m0, s54, 40960
    s_add_u32 s32, s50, 786688
    buffer_load_dwordx4 v24, s[12:15], s32 offen nt lds
    s_add_u32 m0, s54, 45056
    s_add_u32 s32, s50, 1179904
    buffer_load_dwordx4 v24, s[12:15], s32 offen nt lds
    s_add_u32 m0, s54, 49152
    s_add_u32 s32, s50, 1572864
    buffer_load_dwordx4 v24, s[12:15], s32 offen nt lds
    s_add_u32 m0, s54, 53248
    s_add_u32 s32, s50, 1966080
    buffer_load_dwordx4 v24, s[12:15], s32 offen nt lds
    s_add_u32 m0, s54, 57344
    s_add_u32 s32, s50, 1572992
    buffer_load_dwordx4 v24, s[12:15], s32 offen nt lds
    s_add_u32 m0, s54, 61440
    s_add_u32 s32, s50, 1966208
    buffer_load_dwordx4 v24, s[12:15], s32 offen nt lds
    s_add_u32 m0, s54, 65536
    s_add_u32 s32, s50, 1573120
    buffer_load_dwordx4 v24, s[12:15], s32 offen nt lds
    s_add_u32 m0, s54, 69632
    s_add_u32 s32, s50, 1966336
    buffer_load_dwordx4 v24, s[12:15], s32 offen nt lds
    s_add_u32 m0, s54, 73728
    s_add_u32 s32, s50, 2359296
    buffer_load_dwordx4 v24, s[12:15], s32 offen nt lds
    s_add_u32 m0, s54, 77824
    s_add_u32 s32, s50, 2752512
    buffer_load_dwordx4 v24, s[12:15], s32 offen nt lds
    s_add_u32 m0, s54, 81920
    s_add_u32 s32, s50, 2359424
    buffer_load_dwordx4 v24, s[12:15], s32 offen nt lds
    s_add_u32 m0, s54, 86016
    s_add_u32 s32, s50, 2752640
    buffer_load_dwordx4 v24, s[12:15], s32 offen nt lds
    s_add_u32 m0, s54, 90112
    s_add_u32 s32, s50, 2359552
    buffer_load_dwordx4 v24, s[12:15], s32 offen nt lds
    s_add_u32 m0, s54, 94208
    s_add_u32 s32, s50, 2752768
    buffer_load_dwordx4 v24, s[12:15], s32 offen nt lds
    s_add_u32 m0, s54, 98304
    s_add_u32 s32, s50, 3145728
    buffer_load_dwordx4 v24, s[12:15], s32 offen nt lds
    s_add_u32 m0, s54, 102400
    s_add_u32 s32, s50, 3538944
    buffer_load_dwordx4 v24, s[12:15], s32 offen nt lds
    s_add_u32 m0, s54, 106496
    s_add_u32 s32, s50, 3145856
    buffer_load_dwordx4 v24, s[12:15], s32 offen nt lds
    s_add_u32 m0, s54, 110592
    s_add_u32 s32, s50, 3539072
    buffer_load_dwordx4 v24, s[12:15], s32 offen nt lds
    s_add_u32 m0, s54, 114688
    s_add_u32 s32, s50, 3145984
    buffer_load_dwordx4 v24, s[12:15], s32 offen nt lds
    s_add_u32 m0, s54, 118784
    s_add_u32 s32, s50, 3539200
    buffer_load_dwordx4 v24, s[12:15], s32 offen nt lds
    s_add_u32 m0, s54, 122880
    s_add_u32 s32, s50, 3932160
    buffer_load_dwordx4 v24, s[12:15], s32 offen nt lds
    s_add_u32 m0, s54, 126976
    s_add_u32 s32, s50, 4325376
    buffer_load_dwordx4 v24, s[12:15], s32 offen nt lds
    s_add_u32 m0, s54, 131072
    s_add_u32 s32, s50, 3932288
    buffer_load_dwordx4 v24, s[12:15], s32 offen nt lds
    s_add_u32 m0, s54, 135168
    s_add_u32 s32, s50, 4325504
    buffer_load_dwordx4 v24, s[12:15], s32 offen nt lds
    s_add_u32 m0, s54, 139264
    s_add_u32 s32, s50, 3932416
    buffer_load_dwordx4 v24, s[12:15], s32 offen nt lds
    s_add_u32 m0, s54, 143360
    s_add_u32 s32, s50, 4325632
    buffer_load_dwordx4 v24, s[12:15], s32 offen nt lds
    s_waitcnt vmcnt(30)
    s_barrier
    ds_read_b64_tr_b16 a[48:49], v6 offset:0
    ds_read_b64_tr_b16 a[50:51], v6 offset:2048
    ds_read_b64_tr_b16 a[52:53], v6 offset:4096
    ds_read_b64_tr_b16 a[54:55], v6 offset:6144
    ds_read_b64_tr_b16 a[56:57], v6 offset:8192
    ds_read_b64_tr_b16 a[58:59], v6 offset:10240
    ds_read_b64_tr_b16 a[60:61], v6 offset:12288
    ds_read_b64_tr_b16 a[62:63], v6 offset:14336
    ds_read_b64_tr_b16 a[64:65], v6 offset:16384
    ds_read_b64_tr_b16 a[66:67], v6 offset:18432
    ds_read_b64_tr_b16 a[68:69], v6 offset:20480
    ds_read_b64_tr_b16 a[70:71], v6 offset:22528
    s_waitcnt lgkmcnt(4)
    s_waitcnt lgkmcnt(0)
    s_waitcnt vmcnt(24)
    s_barrier
    s_add_u32 m0, s54, 0
    s_add_u32 s32, s50, 4718592
    buffer_load_dwordx4 v24, s[12:15], s32 offen nt lds
    s_add_u32 m0, s54, 4096
    s_add_u32 s32, s50, 5111808
    buffer_load_dwordx4 v24, s[12:15], s32 offen nt lds
    s_add_u32 m0, s54, 8192
    s_add_u32 s32, s50, 4718720
    buffer_load_dwordx4 v24, s[12:15], s32 offen nt lds
    s_add_u32 m0, s54, 12288
    s_add_u32 s32, s50, 5111936
    buffer_load_dwordx4 v24, s[12:15], s32 offen nt lds
    s_add_u32 m0, s54, 16384
    s_add_u32 s32, s50, 4718848
    buffer_load_dwordx4 v24, s[12:15], s32 offen nt lds
    s_add_u32 m0, s54, 20480
    s_add_u32 s32, s50, 5112064
    buffer_load_dwordx4 v24, s[12:15], s32 offen nt lds
    ds_read_b64_tr_b16 a[72:73], v6 offset:24576
    ds_read_b64_tr_b16 a[74:75], v6 offset:26624
    ds_read_b64_tr_b16 a[76:77], v6 offset:28672
    ds_read_b64_tr_b16 a[78:79], v6 offset:30720
    ds_read_b64_tr_b16 a[80:81], v6 offset:32768
    ds_read_b64_tr_b16 a[82:83], v6 offset:34816
    ds_read_b64_tr_b16 a[84:85], v6 offset:36864
    ds_read_b64_tr_b16 a[86:87], v6 offset:38912
    ds_read_b64_tr_b16 a[88:89], v6 offset:40960
    ds_read_b64_tr_b16 a[90:91], v6 offset:43008
    ds_read_b64_tr_b16 a[92:93], v6 offset:45056
    ds_read_b64_tr_b16 a[94:95], v6 offset:47104
    s_waitcnt lgkmcnt(4)
    s_waitcnt lgkmcnt(0)
    s_waitcnt vmcnt(24)
    s_barrier
    s_add_u32 m0, s54, 24576
    s_add_u32 s32, s50, 5505024
    buffer_load_dwordx4 v24, s[12:15], s32 offen nt lds
    s_add_u32 m0, s54, 28672
    s_add_u32 s32, s50, 5898240
    buffer_load_dwordx4 v24, s[12:15], s32 offen nt lds
    s_add_u32 m0, s54, 32768
    s_add_u32 s32, s50, 5505152
    buffer_load_dwordx4 v24, s[12:15], s32 offen nt lds
    s_add_u32 m0, s54, 36864
    s_add_u32 s32, s50, 5898368
    buffer_load_dwordx4 v24, s[12:15], s32 offen nt lds
    s_add_u32 m0, s54, 40960
    s_add_u32 s32, s50, 5505280
    buffer_load_dwordx4 v24, s[12:15], s32 offen nt lds
    s_add_u32 m0, s54, 45056
    s_add_u32 s32, s50, 5898496
    buffer_load_dwordx4 v24, s[12:15], s32 offen nt lds
    ds_read_b64_tr_b16 a[0:1], v6 offset:49152
    ds_read_b64_tr_b16 a[2:3], v6 offset:51200
    ds_read_b64_tr_b16 a[4:5], v6 offset:53248
    ds_read_b64_tr_b16 a[6:7], v6 offset:55296
    ds_read_b64_tr_b16 a[8:9], v6 offset:57344
    ds_read_b64_tr_b16 a[10:11], v6 offset:59392
    ds_read_b64_tr_b16 a[12:13], v6 offset:61440
    ds_read_b64_tr_b16 a[14:15], v6 offset:63488
    v_add_u32 v10, 0x10000, v6
    ds_read_b64_tr_b16 a[16:17], v10 offset:0
    ds_read_b64_tr_b16 a[18:19], v10 offset:2048
    ds_read_b64_tr_b16 a[20:21], v10 offset:4096
    ds_read_b64_tr_b16 a[22:23], v10 offset:6144
    s_waitcnt lgkmcnt(4)
    s_waitcnt lgkmcnt(0)
    s_waitcnt vmcnt(24)
    s_barrier
    s_add_u32 m0, s54, 49152
    s_add_u32 s32, s50, 6291456
    buffer_load_dwordx4 v24, s[12:15], s32 offen nt lds
    s_add_u32 m0, s54, 53248
    s_add_u32 s32, s50, 6684672
    buffer_load_dwordx4 v24, s[12:15], s32 offen nt lds
    s_add_u32 m0, s54, 57344
    s_add_u32 s32, s50, 6291584
    buffer_load_dwordx4 v24, s[12:15], s32 offen nt lds
    s_add_u32 m0, s54, 61440
    s_add_u32 s32, s50, 6684800
    buffer_load_dwordx4 v24, s[12:15], s32 offen nt lds
    s_add_u32 m0, s54, 65536
    s_add_u32 s32, s50, 6291712
    buffer_load_dwordx4 v24, s[12:15], s32 offen nt lds
    s_add_u32 m0, s54, 69632
    s_add_u32 s32, s50, 6684928
    buffer_load_dwordx4 v24, s[12:15], s32 offen nt lds
    v_add_u32 v9, 0x10000, v6
    ds_read_b64_tr_b16 a[96:97], v9 offset:8192
    ds_read_b64_tr_b16 a[98:99], v9 offset:10240
    ds_read_b64_tr_b16 a[100:101], v9 offset:12288
    ds_read_b64_tr_b16 a[102:103], v9 offset:14336
    ds_read_b64_tr_b16 a[104:105], v9 offset:16384
    ds_read_b64_tr_b16 a[106:107], v9 offset:18432
    ds_read_b64_tr_b16 a[108:109], v9 offset:20480
    ds_read_b64_tr_b16 a[110:111], v9 offset:22528
    ds_read_b64_tr_b16 a[112:113], v9 offset:24576
    ds_read_b64_tr_b16 a[114:115], v9 offset:26624
    ds_read_b64_tr_b16 a[116:117], v9 offset:28672
    ds_read_b64_tr_b16 a[118:119], v9 offset:30720
    s_waitcnt lgkmcnt(4)
    s_waitcnt lgkmcnt(0)
    s_waitcnt vmcnt(24)
    s_barrier
    s_add_u32 m0, s54, 73728
    s_add_u32 s32, s50, 7077888
    buffer_load_dwordx4 v24, s[12:15], s32 offen nt lds
    s_add_u32 m0, s54, 77824
    s_add_u32 s32, s50, 7471104
    buffer_load_dwordx4 v24, s[12:15], s32 offen nt lds
    s_add_u32 m0, s54, 81920
    s_add_u32 s32, s50, 7078016
    buffer_load_dwordx4 v24, s[12:15], s32 offen nt lds
    s_add_u32 m0, s54, 86016
    s_add_u32 s32, s50, 7471232
    buffer_load_dwordx4 v24, s[12:15], s32 offen nt lds
    s_add_u32 m0, s54, 90112
    s_add_u32 s32, s50, 7078144
    buffer_load_dwordx4 v24, s[12:15], s32 offen nt lds
    s_add_u32 m0, s54, 94208
    s_add_u32 s32, s50, 7471360
    buffer_load_dwordx4 v24, s[12:15], s32 offen nt lds
    v_add_u32 v10, 0x18000, v6
    ds_read_b64_tr_b16 a[120:121], v10 offset:0
    ds_read_b64_tr_b16 a[122:123], v10 offset:2048
    ds_read_b64_tr_b16 a[124:125], v10 offset:4096
    ds_read_b64_tr_b16 a[126:127], v10 offset:6144
    ds_read_b64_tr_b16 a[128:129], v10 offset:8192
    ds_read_b64_tr_b16 a[130:131], v10 offset:10240
    ds_read_b64_tr_b16 a[132:133], v10 offset:12288
    ds_read_b64_tr_b16 a[134:135], v10 offset:14336
    ds_read_b64_tr_b16 a[136:137], v10 offset:16384
    ds_read_b64_tr_b16 a[138:139], v10 offset:18432
    ds_read_b64_tr_b16 a[140:141], v10 offset:20480
    ds_read_b64_tr_b16 a[142:143], v10 offset:22528
    s_waitcnt lgkmcnt(4)
    s_waitcnt lgkmcnt(0)
    s_waitcnt vmcnt(24)
    s_barrier
    v_add_u32 v9, 0x18000, v6
    ds_read_b64_tr_b16 v[28:29], v9 offset:24576
    ds_read_b64_tr_b16 v[30:31], v9 offset:26624
    ds_read_b64_tr_b16 v[32:33], v9 offset:28672
    ds_read_b64_tr_b16 v[34:35], v9 offset:30720
    v_add_u32 v10, 0x20000, v6
    ds_read_b64_tr_b16 v[36:37], v10 offset:0
    ds_read_b64_tr_b16 v[38:39], v10 offset:2048
    ds_read_b64_tr_b16 v[40:41], v10 offset:4096
    ds_read_b64_tr_b16 v[42:43], v10 offset:6144
    ds_read_b64_tr_b16 v[44:45], v10 offset:8192
    ds_read_b64_tr_b16 v[46:47], v10 offset:10240
    ds_read_b64_tr_b16 v[48:49], v10 offset:12288
    ds_read_b64_tr_b16 v[50:51], v10 offset:14336
    s_waitcnt lgkmcnt(4)
    s_waitcnt lgkmcnt(0)
    s_waitcnt vmcnt(18)
    s_barrier
    s_add_u32 m0, s54, 98304
    s_add_u32 s32, s51, 0
    buffer_load_dwordx4 v25, s[20:23], s32 offen nt lds
    s_add_u32 m0, s54, 102400
    s_add_u32 s32, s51, 128
    buffer_load_dwordx4 v25, s[20:23], s32 offen nt lds
    s_add_u32 m0, s54, 106496
    s_add_u32 s32, s51, 256
    buffer_load_dwordx4 v25, s[20:23], s32 offen nt lds
    s_add_u32 m0, s54, 110592
    s_add_u32 s32, s51, 384
    buffer_load_dwordx4 v25, s[20:23], s32 offen nt lds
    s_add_u32 m0, s54, 114688
    s_add_u32 s32, s51, 512
    buffer_load_dwordx4 v25, s[20:23], s32 offen nt lds
    s_add_u32 m0, s54, 118784
    s_add_u32 s32, s51, 640
    buffer_load_dwordx4 v25, s[20:23], s32 offen nt lds
    s_add_u32 m0, s54, 122880
    s_add_u32 s32, s51, 768
    buffer_load_dwordx4 v25, s[20:23], s32 offen nt lds
    s_add_u32 m0, s54, 126976
    s_add_u32 s32, s51, 896
    buffer_load_dwordx4 v25, s[20:23], s32 offen nt lds
    s_add_u32 m0, s54, 131072
    s_add_u32 s32, s51, 1024
    buffer_load_dwordx4 v25, s[20:23], s32 offen nt lds
    s_add_u32 m0, s54, 135168
    s_add_u32 s32, s51, 1152
    buffer_load_dwordx4 v25, s[20:23], s32 offen nt lds
    ds_read_b64_tr_b16 a[24:25], v6 offset:0
    ds_read_b64_tr_b16 a[26:27], v6 offset:2048
    ds_read_b64_tr_b16 a[28:29], v6 offset:4096
    ds_read_b64_tr_b16 a[30:31], v6 offset:6144
    ds_read_b64_tr_b16 a[32:33], v6 offset:8192
    ds_read_b64_tr_b16 a[34:35], v6 offset:10240
    ds_read_b64_tr_b16 a[36:37], v6 offset:12288
    ds_read_b64_tr_b16 a[38:39], v6 offset:14336
    ds_read_b64_tr_b16 a[40:41], v6 offset:16384
    ds_read_b64_tr_b16 a[42:43], v6 offset:18432
    ds_read_b64_tr_b16 a[44:45], v6 offset:20480
    ds_read_b64_tr_b16 a[46:47], v6 offset:22528
    s_waitcnt lgkmcnt(4)
    s_waitcnt lgkmcnt(0)
    s_waitcnt vmcnt(22)
    s_barrier
    ds_read_b64_tr_b16 a[144:145], v6 offset:24576
    ds_read_b64_tr_b16 a[146:147], v6 offset:26624
    ds_read_b64_tr_b16 a[148:149], v6 offset:28672
    ds_read_b64_tr_b16 a[150:151], v6 offset:30720
    ds_read_b64_tr_b16 a[152:153], v6 offset:32768
    ds_read_b64_tr_b16 a[154:155], v6 offset:34816
    ds_read_b64_tr_b16 a[156:157], v6 offset:36864
    ds_read_b64_tr_b16 a[158:159], v6 offset:38912
    ds_read_b64_tr_b16 a[160:161], v6 offset:40960
    ds_read_b64_tr_b16 a[162:163], v6 offset:43008
    ds_read_b64_tr_b16 a[164:165], v6 offset:45056
    ds_read_b64_tr_b16 a[166:167], v6 offset:47104
    s_waitcnt lgkmcnt(4)
    s_waitcnt lgkmcnt(0)
    s_waitcnt vmcnt(16)
    s_barrier
    s_add_u32 m0, s54, 0
    s_add_u32 s32, s51, 40960
    buffer_load_dwordx4 v25, s[20:23], s32 offen nt lds
    s_add_u32 m0, s54, 4096
    s_add_u32 s32, s51, 41088
    buffer_load_dwordx4 v25, s[20:23], s32 offen nt lds
    s_add_u32 m0, s54, 8192
    s_add_u32 s32, s51, 41216
    buffer_load_dwordx4 v25, s[20:23], s32 offen nt lds
    s_add_u32 m0, s54, 12288
    s_add_u32 s32, s51, 41344
    buffer_load_dwordx4 v25, s[20:23], s32 offen nt lds
    s_add_u32 m0, s54, 16384
    s_add_u32 s32, s51, 41472
    buffer_load_dwordx4 v25, s[20:23], s32 offen nt lds
    s_add_u32 m0, s54, 20480
    s_add_u32 s32, s51, 41600
    buffer_load_dwordx4 v25, s[20:23], s32 offen nt lds
    s_add_u32 m0, s54, 24576
    s_add_u32 s32, s51, 41728
    buffer_load_dwordx4 v25, s[20:23], s32 offen nt lds
    s_add_u32 m0, s54, 28672
    s_add_u32 s32, s51, 41856
    buffer_load_dwordx4 v25, s[20:23], s32 offen nt lds
    s_add_u32 m0, s54, 32768
    s_add_u32 s32, s51, 41984
    buffer_load_dwordx4 v25, s[20:23], s32 offen nt lds
    s_add_u32 m0, s54, 36864
    s_add_u32 s32, s51, 42112
    buffer_load_dwordx4 v25, s[20:23], s32 offen nt lds
    ds_read_b64_tr_b16 a[168:169], v6 offset:49152
    ds_read_b64_tr_b16 a[170:171], v6 offset:51200
    ds_read_b64_tr_b16 a[172:173], v6 offset:53248
    ds_read_b64_tr_b16 a[174:175], v6 offset:55296
    ds_read_b64_tr_b16 a[176:177], v6 offset:57344
    ds_read_b64_tr_b16 a[178:179], v6 offset:59392
    ds_read_b64_tr_b16 a[180:181], v6 offset:61440
    ds_read_b64_tr_b16 a[182:183], v6 offset:63488
    v_add_u32 v9, 0x10000, v6
    ds_read_b64_tr_b16 a[184:185], v9 offset:0
    ds_read_b64_tr_b16 a[186:187], v9 offset:2048
    ds_read_b64_tr_b16 a[188:189], v9 offset:4096
    ds_read_b64_tr_b16 a[190:191], v9 offset:6144
    s_waitcnt lgkmcnt(4)
    s_waitcnt lgkmcnt(0)
    s_waitcnt vmcnt(20)
    s_barrier
    v_add_u32 v10, 0x10000, v6
    ds_read_b64_tr_b16 v[52:53], v10 offset:8192
    ds_read_b64_tr_b16 v[54:55], v10 offset:10240
    ds_read_b64_tr_b16 v[56:57], v10 offset:12288
    ds_read_b64_tr_b16 v[58:59], v10 offset:14336
    ds_read_b64_tr_b16 v[60:61], v10 offset:16384
    ds_read_b64_tr_b16 v[62:63], v10 offset:18432
    ds_read_b64_tr_b16 v[64:65], v10 offset:20480
    ds_read_b64_tr_b16 v[66:67], v10 offset:22528
    ds_read_b64_tr_b16 v[68:69], v10 offset:24576
    ds_read_b64_tr_b16 v[70:71], v10 offset:26624
    ds_read_b64_tr_b16 v[72:73], v10 offset:28672
    ds_read_b64_tr_b16 v[74:75], v10 offset:30720
    s_waitcnt lgkmcnt(4)
    s_waitcnt lgkmcnt(0)
    s_waitcnt vmcnt(10)
    s_barrier
    s_add_u32 m0, s54, 40960
    s_add_u32 s32, s51, 81920
    buffer_load_dwordx4 v25, s[20:23], s32 offen nt lds
    s_add_u32 m0, s54, 45056
    s_add_u32 s32, s51, 82048
    buffer_load_dwordx4 v25, s[20:23], s32 offen nt lds
    s_add_u32 m0, s54, 49152
    s_add_u32 s32, s51, 82176
    buffer_load_dwordx4 v25, s[20:23], s32 offen nt lds
    s_add_u32 m0, s54, 53248
    s_add_u32 s32, s51, 82304
    buffer_load_dwordx4 v25, s[20:23], s32 offen nt lds
    s_add_u32 m0, s54, 57344
    s_add_u32 s32, s51, 82432
    buffer_load_dwordx4 v25, s[20:23], s32 offen nt lds
    s_add_u32 m0, s54, 61440
    s_add_u32 s32, s51, 82560
    buffer_load_dwordx4 v25, s[20:23], s32 offen nt lds
    s_add_u32 m0, s54, 65536
    s_add_u32 s32, s51, 82688
    buffer_load_dwordx4 v25, s[20:23], s32 offen nt lds
    s_add_u32 m0, s54, 69632
    s_add_u32 s32, s51, 82816
    buffer_load_dwordx4 v25, s[20:23], s32 offen nt lds
    s_add_u32 m0, s54, 73728
    s_add_u32 s32, s51, 82944
    buffer_load_dwordx4 v25, s[20:23], s32 offen nt lds
    s_add_u32 m0, s54, 77824
    s_add_u32 s32, s51, 83072
    buffer_load_dwordx4 v25, s[20:23], s32 offen nt lds
    v_add_u32 v9, 0x18000, v20
    ds_read_b64_tr_b16 a[192:193], v9 offset:0
    v_add_u32 v10, 0x18000, v21
    ds_read_b64_tr_b16 a[194:195], v10 offset:0
    ds_read_b64_tr_b16 a[196:197], v9 offset:1024
    ds_read_b64_tr_b16 a[198:199], v10 offset:1024
    v_add_u32 v9, 0x18000, v22
    ds_read_b64_tr_b16 a[200:201], v9 offset:0
    v_add_u32 v10, 0x18000, v23
    ds_read_b64_tr_b16 a[202:203], v10 offset:0
    ds_read_b64_tr_b16 a[204:205], v9 offset:1024
    ds_read_b64_tr_b16 a[206:207], v10 offset:1024
    v_add_u32 v9, 0x18000, v20
    ds_read_b64_tr_b16 a[208:209], v9 offset:4096
    v_add_u32 v10, 0x18000, v21
    ds_read_b64_tr_b16 a[210:211], v10 offset:4096
    ds_read_b64_tr_b16 a[212:213], v9 offset:5120
    ds_read_b64_tr_b16 a[214:215], v10 offset:5120
    s_waitcnt lgkmcnt(4)
    v_add_u32 v9, 0x18000, v22
    ds_read_b64_tr_b16 a[216:217], v9 offset:4096
    v_add_u32 v10, 0x18000, v23
    ds_read_b64_tr_b16 a[218:219], v10 offset:4096
    ds_read_b64_tr_b16 a[220:221], v9 offset:5120
    ds_read_b64_tr_b16 a[222:223], v10 offset:5120
    v_add_u32 v9, 0x18000, v20
    ds_read_b64_tr_b16 a[224:225], v9 offset:8192
    v_add_u32 v10, 0x18000, v21
    ds_read_b64_tr_b16 a[226:227], v10 offset:8192
    ds_read_b64_tr_b16 a[228:229], v9 offset:9216
    ds_read_b64_tr_b16 a[230:231], v10 offset:9216
    s_waitcnt lgkmcnt(4)
    s_waitcnt lgkmcnt(0)
    s_waitcnt vmcnt(10)
    s_barrier
    s_add_u32 m0, s54, 81920
    s_add_u32 s32, s51, 122880
    buffer_load_dwordx4 v25, s[20:23], s32 offen nt lds
    s_add_u32 m0, s54, 86016
    s_add_u32 s32, s51, 123008
    buffer_load_dwordx4 v25, s[20:23], s32 offen nt lds
    s_add_u32 m0, s54, 90112
    s_add_u32 s32, s51, 123136
    buffer_load_dwordx4 v25, s[20:23], s32 offen nt lds
    s_add_u32 m0, s54, 94208
    s_add_u32 s32, s51, 123264
    buffer_load_dwordx4 v25, s[20:23], s32 offen nt lds
    s_add_u32 m0, s54, 98304
    s_add_u32 s32, s51, 123392
    buffer_load_dwordx4 v25, s[20:23], s32 offen nt lds
    s_add_u32 m0, s54, 102400
    s_add_u32 s32, s51, 123520
    buffer_load_dwordx4 v25, s[20:23], s32 offen nt lds
    s_add_u32 m0, s54, 106496
    s_add_u32 s32, s51, 123648
    buffer_load_dwordx4 v25, s[20:23], s32 offen nt lds
    s_add_u32 m0, s54, 110592
    s_add_u32 s32, s51, 123776
    buffer_load_dwordx4 v25, s[20:23], s32 offen nt lds
    s_add_u32 m0, s54, 114688
    s_add_u32 s32, s51, 123904
    buffer_load_dwordx4 v25, s[20:23], s32 offen nt lds
    s_add_u32 m0, s54, 118784
    s_add_u32 s32, s51, 124032
    buffer_load_dwordx4 v25, s[20:23], s32 offen nt lds
    s_add_u32 m0, s54, 122880
    s_add_u32 s32, s51, 163840
    buffer_load_dwordx4 v25, s[20:23], s32 offen nt lds
    s_add_u32 m0, s54, 126976
    s_add_u32 s32, s51, 163968
    buffer_load_dwordx4 v25, s[20:23], s32 offen nt lds
    s_add_u32 m0, s54, 131072
    s_add_u32 s32, s51, 164096
    buffer_load_dwordx4 v25, s[20:23], s32 offen nt lds
    s_add_u32 m0, s54, 135168
    s_add_u32 s32, s51, 164224
    buffer_load_dwordx4 v25, s[20:23], s32 offen nt lds
    s_add_u32 m0, s54, 139264
    s_add_u32 s32, s51, 164352
    buffer_load_dwordx4 v25, s[20:23], s32 offen nt lds
    s_add_u32 m0, s54, 143360
    s_add_u32 s32, s51, 164480
    buffer_load_dwordx4 v25, s[20:23], s32 offen nt lds
    s_add_u32 m0, s54, 147456
    s_add_u32 s32, s51, 164608
    buffer_load_dwordx4 v25, s[20:23], s32 offen nt lds
    s_add_u32 m0, s54, 151552
    s_add_u32 s32, s51, 164736
    buffer_load_dwordx4 v25, s[20:23], s32 offen nt lds
    s_add_u32 m0, s54, 155648
    s_add_u32 s32, s51, 164864
    buffer_load_dwordx4 v25, s[20:23], s32 offen nt lds
    s_add_u32 m0, s54, 159744
    s_add_u32 s32, s51, 164992
    buffer_load_dwordx4 v25, s[20:23], s32 offen nt lds
    ds_read_b64_tr_b16 a[232:233], v20 offset:0
    ds_read_b64_tr_b16 a[234:235], v21 offset:0
    ds_read_b64_tr_b16 a[236:237], v20 offset:1024
    ds_read_b64_tr_b16 a[238:239], v21 offset:1024
    ds_read_b64_tr_b16 a[240:241], v22 offset:0
    ds_read_b64_tr_b16 a[242:243], v23 offset:0
    ds_read_b64_tr_b16 a[244:245], v22 offset:1024
    ds_read_b64_tr_b16 a[246:247], v23 offset:1024
    ds_read_b64_tr_b16 a[248:249], v20 offset:4096
    ds_read_b64_tr_b16 a[250:251], v21 offset:4096
    ds_read_b64_tr_b16 a[252:253], v20 offset:5120
    ds_read_b64_tr_b16 a[254:255], v21 offset:5120
    s_waitcnt lgkmcnt(4)
    ds_read_b64_tr_b16 v[160:161], v22 offset:4096
    ds_read_b64_tr_b16 v[162:163], v23 offset:4096
    ds_read_b64_tr_b16 v[164:165], v22 offset:5120
    ds_read_b64_tr_b16 v[166:167], v23 offset:5120
    ds_read_b64_tr_b16 v[168:169], v20 offset:8192
    ds_read_b64_tr_b16 v[170:171], v21 offset:8192
    ds_read_b64_tr_b16 v[172:173], v20 offset:9216
    ds_read_b64_tr_b16 v[174:175], v21 offset:9216
    s_waitcnt lgkmcnt(4)
    s_waitcnt lgkmcnt(0)
    s_waitcnt vmcnt(20)
    s_barrier
    s_add_u32 m0, s54, 0
    s_add_u32 s32, s51, 204800
    buffer_load_dwordx4 v25, s[20:23], s32 offen nt lds
    s_add_u32 m0, s54, 4096
    s_add_u32 s32, s51, 204928
    buffer_load_dwordx4 v25, s[20:23], s32 offen nt lds
    s_add_u32 m0, s54, 8192
    s_add_u32 s32, s51, 205056
    buffer_load_dwordx4 v25, s[20:23], s32 offen nt lds
    s_add_u32 m0, s54, 12288
    s_add_u32 s32, s51, 205184
    buffer_load_dwordx4 v25, s[20:23], s32 offen nt lds
    s_add_u32 m0, s54, 16384
    s_add_u32 s32, s51, 205312
    buffer_load_dwordx4 v25, s[20:23], s32 offen nt lds
    s_add_u32 m0, s54, 20480
    s_add_u32 s32, s51, 205440
    buffer_load_dwordx4 v25, s[20:23], s32 offen nt lds
    s_add_u32 m0, s54, 24576
    s_add_u32 s32, s51, 205568
    buffer_load_dwordx4 v25, s[20:23], s32 offen nt lds
    s_add_u32 m0, s54, 28672
    s_add_u32 s32, s51, 205696
    buffer_load_dwordx4 v25, s[20:23], s32 offen nt lds
    s_add_u32 m0, s54, 32768
    s_add_u32 s32, s51, 205824
    buffer_load_dwordx4 v25, s[20:23], s32 offen nt lds
    s_add_u32 m0, s54, 36864
    s_add_u32 s32, s51, 205952
    buffer_load_dwordx4 v25, s[20:23], s32 offen nt lds
    s_mov_b32 s28, s88
    s_and_b32 s29, s89, 0xffff
    s_mov_b32 s30, 0x100
    s_mov_b32 s31, 0x20000
    v_mov_b32 v2, 0
    buffer_load_dword v3, v2, s[28:31], 0 offen offset:60 sc1
    ds_read_b64_tr_b16 v[176:177], v20 offset:40960
    ds_read_b64_tr_b16 v[178:179], v21 offset:40960
    ds_read_b64_tr_b16 v[180:181], v20 offset:41984
    ds_read_b64_tr_b16 v[182:183], v21 offset:41984
    ds_read_b64_tr_b16 v[184:185], v22 offset:40960
    ds_read_b64_tr_b16 v[186:187], v23 offset:40960
    ds_read_b64_tr_b16 v[188:189], v22 offset:41984
    ds_read_b64_tr_b16 v[190:191], v23 offset:41984
    ds_read_b64_tr_b16 v[192:193], v20 offset:45056
    ds_read_b64_tr_b16 v[194:195], v21 offset:45056
    ds_read_b64_tr_b16 v[196:197], v20 offset:46080
    ds_read_b64_tr_b16 v[198:199], v21 offset:46080
    s_waitcnt lgkmcnt(4)
    ds_read_b64_tr_b16 v[200:201], v22 offset:45056
    ds_read_b64_tr_b16 v[202:203], v23 offset:45056
    ds_read_b64_tr_b16 v[204:205], v22 offset:46080
    ds_read_b64_tr_b16 v[206:207], v23 offset:46080
    ds_read_b64_tr_b16 v[208:209], v20 offset:49152
    ds_read_b64_tr_b16 v[210:211], v21 offset:49152
    ds_read_b64_tr_b16 v[212:213], v20 offset:50176
    ds_read_b64_tr_b16 v[214:215], v21 offset:50176
    s_waitcnt lgkmcnt(4)
    s_waitcnt lgkmcnt(0)
    s_waitcnt vmcnt(21)
    s_barrier
    v_add_u32 v9, 0x10000, v20
    ds_read_b64_tr_b16 v[76:77], v9 offset:16384
    v_add_u32 v10, 0x10000, v21
    ds_read_b64_tr_b16 v[78:79], v10 offset:16384
    ds_read_b64_tr_b16 v[80:81], v9 offset:17408
    ds_read_b64_tr_b16 v[82:83], v10 offset:17408
    v_add_u32 v9, 0x10000, v22
    ds_read_b64_tr_b16 v[84:85], v9 offset:16384
    v_add_u32 v10, 0x10000, v23
    ds_read_b64_tr_b16 v[86:87], v10 offset:16384
    ds_read_b64_tr_b16 v[88:89], v9 offset:17408
    ds_read_b64_tr_b16 v[90:91], v10 offset:17408
    v_add_u32 v9, 0x10000, v20
    ds_read_b64_tr_b16 v[92:93], v9 offset:20480
    v_add_u32 v10, 0x10000, v21
    ds_read_b64_tr_b16 v[94:95], v10 offset:20480
    ds_read_b64_tr_b16 v[96:97], v9 offset:21504
    ds_read_b64_tr_b16 v[98:99], v10 offset:21504
    s_waitcnt lgkmcnt(4)
    v_add_u32 v9, 0x10000, v22
    ds_read_b64_tr_b16 v[100:101], v9 offset:20480
    v_add_u32 v10, 0x10000, v23
    ds_read_b64_tr_b16 v[102:103], v10 offset:20480
    ds_read_b64_tr_b16 v[104:105], v9 offset:21504
    ds_read_b64_tr_b16 v[106:107], v10 offset:21504
    v_add_u32 v9, 0x10000, v20
    ds_read_b64_tr_b16 v[108:109], v9 offset:24576
    v_add_u32 v10, 0x10000, v21
    ds_read_b64_tr_b16 v[110:111], v10 offset:24576
    ds_read_b64_tr_b16 v[112:113], v9 offset:25600
    ds_read_b64_tr_b16 v[114:115], v10 offset:25600
    s_waitcnt lgkmcnt(4)
    s_waitcnt lgkmcnt(0)
    s_waitcnt vmcnt(11)
    s_barrier
    v_add_u32 v9, 0x18000, v20
    ds_read_b64_tr_b16 v[216:217], v9 offset:24576
    v_add_u32 v10, 0x18000, v21
    ds_read_b64_tr_b16 v[218:219], v10 offset:24576
    ds_read_b64_tr_b16 v[220:221], v9 offset:25600
    ds_read_b64_tr_b16 v[222:223], v10 offset:25600
    v_add_u32 v9, 0x18000, v22
    ds_read_b64_tr_b16 v[224:225], v9 offset:24576
    v_add_u32 v10, 0x18000, v23
    ds_read_b64_tr_b16 v[226:227], v10 offset:24576
    ds_read_b64_tr_b16 v[228:229], v9 offset:25600
    ds_read_b64_tr_b16 v[230:231], v10 offset:25600
    v_add_u32 v9, 0x18000, v20
    ds_read_b64_tr_b16 v[232:233], v9 offset:28672
    v_add_u32 v10, 0x18000, v21
    ds_read_b64_tr_b16 v[234:235], v10 offset:28672
    ds_read_b64_tr_b16 v[236:237], v9 offset:29696
    ds_read_b64_tr_b16 v[238:239], v10 offset:29696
    s_waitcnt lgkmcnt(4)
    v_add_u32 v9, 0x18000, v22
    ds_read_b64_tr_b16 v[240:241], v9 offset:28672
    v_add_u32 v10, 0x18000, v23
    ds_read_b64_tr_b16 v[242:243], v10 offset:28672
    ds_read_b64_tr_b16 v[244:245], v9 offset:29696
    ds_read_b64_tr_b16 v[246:247], v10 offset:29696
    v_add_u32 v9, 0x20000, v20
    ds_read_b64_tr_b16 v[248:249], v9 offset:0
    v_add_u32 v10, 0x20000, v21
    ds_read_b64_tr_b16 v[250:251], v10 offset:0
    ds_read_b64_tr_b16 v[252:253], v9 offset:1024
    ds_read_b64_tr_b16 v[254:255], v10 offset:1024
    s_waitcnt lgkmcnt(4)
    s_waitcnt lgkmcnt(0)
    s_waitcnt vmcnt(1)
    s_barrier
    ds_read_b64_tr_b16 v[116:117], v20 offset:0
    ds_read_b64_tr_b16 v[118:119], v21 offset:0
    ds_read_b64_tr_b16 v[120:121], v20 offset:1024
    ds_read_b64_tr_b16 v[122:123], v21 offset:1024
    ds_read_b64_tr_b16 v[124:125], v22 offset:0
    ds_read_b64_tr_b16 v[126:127], v23 offset:0
    ds_read_b64_tr_b16 v[128:129], v22 offset:1024
    ds_read_b64_tr_b16 v[130:131], v23 offset:1024
    ds_read_b64_tr_b16 v[132:133], v20 offset:4096
    ds_read_b64_tr_b16 v[134:135], v21 offset:4096
    ds_read_b64_tr_b16 v[136:137], v20 offset:5120
    ds_read_b64_tr_b16 v[138:139], v21 offset:5120
    s_waitcnt lgkmcnt(4)
    ds_read_b64_tr_b16 v[140:141], v22 offset:4096
    ds_read_b64_tr_b16 v[142:143], v23 offset:4096
    ds_read_b64_tr_b16 v[144:145], v22 offset:5120
    ds_read_b64_tr_b16 v[146:147], v23 offset:5120
    ds_read_b64_tr_b16 v[148:149], v20 offset:8192
    ds_read_b64_tr_b16 v[150:151], v21 offset:8192
    ds_read_b64_tr_b16 v[152:153], v20 offset:9216
    ds_read_b64_tr_b16 v[154:155], v21 offset:9216
    s_waitcnt lgkmcnt(4)
    s_waitcnt lgkmcnt(0)
    s_barrier
    s_branch V_ld_wx
V_ld_w1:
    s_add_u32 m0, s54, 0
    s_add_u32 s32, s50, 0
    buffer_load_dwordx4 v24, s[12:15], s32 offen nt lds
    s_add_u32 m0, s54, 4096
    s_add_u32 s32, s50, 393216
    buffer_load_dwordx4 v24, s[12:15], s32 offen nt lds
    s_add_u32 m0, s54, 8192
    s_add_u32 s32, s50, 128
    buffer_load_dwordx4 v24, s[12:15], s32 offen nt lds
    s_add_u32 m0, s54, 12288
    s_add_u32 s32, s50, 393344
    buffer_load_dwordx4 v24, s[12:15], s32 offen nt lds
    s_add_u32 m0, s54, 16384
    s_add_u32 s32, s50, 256
    buffer_load_dwordx4 v24, s[12:15], s32 offen nt lds
    s_add_u32 m0, s54, 20480
    s_add_u32 s32, s50, 393472
    buffer_load_dwordx4 v24, s[12:15], s32 offen nt lds
    s_add_u32 m0, s54, 24576
    s_add_u32 s32, s50, 786432
    buffer_load_dwordx4 v24, s[12:15], s32 offen nt lds
    s_add_u32 m0, s54, 28672
    s_add_u32 s32, s50, 1179648
    buffer_load_dwordx4 v24, s[12:15], s32 offen nt lds
    s_add_u32 m0, s54, 32768
    s_add_u32 s32, s50, 786560
    buffer_load_dwordx4 v24, s[12:15], s32 offen nt lds
    s_add_u32 m0, s54, 36864
    s_add_u32 s32, s50, 1179776
    buffer_load_dwordx4 v24, s[12:15], s32 offen nt lds
    s_add_u32 m0, s54, 40960
    s_add_u32 s32, s50, 786688
    buffer_load_dwordx4 v24, s[12:15], s32 offen nt lds
    s_add_u32 m0, s54, 45056
    s_add_u32 s32, s50, 1179904
    buffer_load_dwordx4 v24, s[12:15], s32 offen nt lds
    s_add_u32 m0, s54, 49152
    s_add_u32 s32, s50, 1572864
    buffer_load_dwordx4 v24, s[12:15], s32 offen nt lds
    s_add_u32 m0, s54, 53248
    s_add_u32 s32, s50, 1966080
    buffer_load_dwordx4 v24, s[12:15], s32 offen nt lds
    s_add_u32 m0, s54, 57344
    s_add_u32 s32, s50, 1572992
    buffer_load_dwordx4 v24, s[12:15], s32 offen nt lds
    s_add_u32 m0, s54, 61440
    s_add_u32 s32, s50, 1966208
    buffer_load_dwordx4 v24, s[12:15], s32 offen nt lds
    s_add_u32 m0, s54, 65536
    s_add_u32 s32, s50, 1573120
    buffer_load_dwordx4 v24, s[12:15], s32 offen nt lds
    s_add_u32 m0, s54, 69632
    s_add_u32 s32, s50, 1966336
    buffer_load_dwordx4 v24, s[12:15], s32 offen nt lds
    s_add_u32 m0, s54, 73728
    s_add_u32 s32, s50, 2359296
    buffer_load_dwordx4 v24, s[12:15], s32 offen nt lds
    s_add_u32 m0, s54, 77824
    s_add_u32 s32, s50, 2752512
    buffer_load_dwordx4 v24, s[12:15], s32 offen nt lds
    s_add_u32 m0, s54, 81920
    s_add_u32 s32, s50, 2359424
    buffer_load_dwordx4 v24, s[12:15], s32 offen nt lds
    s_add_u32 m0, s54, 86016
    s_add_u32 s32, s50, 2752640
    buffer_load_dwordx4 v24, s[12:15], s32 offen nt lds
    s_add_u32 m0, s54, 90112
    s_add_u32 s32, s50, 2359552
    buffer_load_dwordx4 v24, s[12:15], s32 offen nt lds
    s_add_u32 m0, s54, 94208
    s_add_u32 s32, s50, 2752768
    buffer_load_dwordx4 v24, s[12:15], s32 offen nt lds
    s_add_u32 m0, s54, 98304
    s_add_u32 s32, s50, 3145728
    buffer_load_dwordx4 v24, s[12:15], s32 offen nt lds
    s_add_u32 m0, s54, 102400
    s_add_u32 s32, s50, 3538944
    buffer_load_dwordx4 v24, s[12:15], s32 offen nt lds
    s_add_u32 m0, s54, 106496
    s_add_u32 s32, s50, 3145856
    buffer_load_dwordx4 v24, s[12:15], s32 offen nt lds
    s_add_u32 m0, s54, 110592
    s_add_u32 s32, s50, 3539072
    buffer_load_dwordx4 v24, s[12:15], s32 offen nt lds
    s_add_u32 m0, s54, 114688
    s_add_u32 s32, s50, 3145984
    buffer_load_dwordx4 v24, s[12:15], s32 offen nt lds
    s_add_u32 m0, s54, 118784
    s_add_u32 s32, s50, 3539200
    buffer_load_dwordx4 v24, s[12:15], s32 offen nt lds
    s_add_u32 m0, s54, 122880
    s_add_u32 s32, s50, 3932160
    buffer_load_dwordx4 v24, s[12:15], s32 offen nt lds
    s_add_u32 m0, s54, 126976
    s_add_u32 s32, s50, 4325376
    buffer_load_dwordx4 v24, s[12:15], s32 offen nt lds
    s_add_u32 m0, s54, 131072
    s_add_u32 s32, s50, 3932288
    buffer_load_dwordx4 v24, s[12:15], s32 offen nt lds
    s_add_u32 m0, s54, 135168
    s_add_u32 s32, s50, 4325504
    buffer_load_dwordx4 v24, s[12:15], s32 offen nt lds
    s_add_u32 m0, s54, 139264
    s_add_u32 s32, s50, 3932416
    buffer_load_dwordx4 v24, s[12:15], s32 offen nt lds
    s_add_u32 m0, s54, 143360
    s_add_u32 s32, s50, 4325632
    buffer_load_dwordx4 v24, s[12:15], s32 offen nt lds
    s_waitcnt vmcnt(30)
    s_barrier
    ds_read_b64_tr_b16 a[48:49], v6 offset:0
    ds_read_b64_tr_b16 a[50:51], v6 offset:2048
    ds_read_b64_tr_b16 a[52:53], v6 offset:4096
    ds_read_b64_tr_b16 a[54:55], v6 offset:6144
    ds_read_b64_tr_b16 a[56:57], v6 offset:8192
    ds_read_b64_tr_b16 a[58:59], v6 offset:10240
    ds_read_b64_tr_b16 a[60:61], v6 offset:12288
    ds_read_b64_tr_b16 a[62:63], v6 offset:14336
    ds_read_b64_tr_b16 a[64:65], v6 offset:16384
    ds_read_b64_tr_b16 a[66:67], v6 offset:18432
    ds_read_b64_tr_b16 a[68:69], v6 offset:20480
    ds_read_b64_tr_b16 a[70:71], v6 offset:22528
    s_waitcnt lgkmcnt(4)
    s_waitcnt lgkmcnt(0)
    s_waitcnt vmcnt(24)
    s_barrier
    s_add_u32 m0, s54, 0
    s_add_u32 s32, s50, 4718592
    buffer_load_dwordx4 v24, s[12:15], s32 offen nt lds
    s_add_u32 m0, s54, 4096
    s_add_u32 s32, s50, 5111808
    buffer_load_dwordx4 v24, s[12:15], s32 offen nt lds
    s_add_u32 m0, s54, 8192
    s_add_u32 s32, s50, 4718720
    buffer_load_dwordx4 v24, s[12:15], s32 offen nt lds
    s_add_u32 m0, s54, 12288
    s_add_u32 s32, s50, 5111936
    buffer_load_dwordx4 v24, s[12:15], s32 offen nt lds
    s_add_u32 m0, s54, 16384
    s_add_u32 s32, s50, 4718848
    buffer_load_dwordx4 v24, s[12:15], s32 offen nt lds
    s_add_u32 m0, s54, 20480
    s_add_u32 s32, s50, 5112064
    buffer_load_dwordx4 v24, s[12:15], s32 offen nt lds
    ds_read_b64_tr_b16 a[72:73], v6 offset:24576
    ds_read_b64_tr_b16 a[74:75], v6 offset:26624
    ds_read_b64_tr_b16 a[76:77], v6 offset:28672
    ds_read_b64_tr_b16 a[78:79], v6 offset:30720
    ds_read_b64_tr_b16 a[80:81], v6 offset:32768
    ds_read_b64_tr_b16 a[82:83], v6 offset:34816
    ds_read_b64_tr_b16 a[84:85], v6 offset:36864
    ds_read_b64_tr_b16 a[86:87], v6 offset:38912
    ds_read_b64_tr_b16 a[88:89], v6 offset:40960
    ds_read_b64_tr_b16 a[90:91], v6 offset:43008
    ds_read_b64_tr_b16 a[92:93], v6 offset:45056
    ds_read_b64_tr_b16 a[94:95], v6 offset:47104
    s_waitcnt lgkmcnt(4)
    s_waitcnt lgkmcnt(0)
    s_waitcnt vmcnt(24)
    s_barrier
    s_add_u32 m0, s54, 24576
    s_add_u32 s32, s50, 5505024
    buffer_load_dwordx4 v24, s[12:15], s32 offen nt lds
    s_add_u32 m0, s54, 28672
    s_add_u32 s32, s50, 5898240
    buffer_load_dwordx4 v24, s[12:15], s32 offen nt lds
    s_add_u32 m0, s54, 32768
    s_add_u32 s32, s50, 5505152
    buffer_load_dwordx4 v24, s[12:15], s32 offen nt lds
    s_add_u32 m0, s54, 36864
    s_add_u32 s32, s50, 5898368
    buffer_load_dwordx4 v24, s[12:15], s32 offen nt lds
    s_add_u32 m0, s54, 40960
    s_add_u32 s32, s50, 5505280
    buffer_load_dwordx4 v24, s[12:15], s32 offen nt lds
    s_add_u32 m0, s54, 45056
    s_add_u32 s32, s50, 5898496
    buffer_load_dwordx4 v24, s[12:15], s32 offen nt lds
    ds_read_b64_tr_b16 a[96:97], v6 offset:49152
    ds_read_b64_tr_b16 a[98:99], v6 offset:51200
    ds_read_b64_tr_b16 a[100:101], v6 offset:53248
    ds_read_b64_tr_b16 a[102:103], v6 offset:55296
    ds_read_b64_tr_b16 a[104:105], v6 offset:57344
    ds_read_b64_tr_b16 a[106:107], v6 offset:59392
    ds_read_b64_tr_b16 a[108:109], v6 offset:61440
    ds_read_b64_tr_b16 a[110:111], v6 offset:63488
    v_add_u32 v9, 0x10000, v6
    ds_read_b64_tr_b16 a[112:113], v9 offset:0
    ds_read_b64_tr_b16 a[114:115], v9 offset:2048
    ds_read_b64_tr_b16 a[116:117], v9 offset:4096
    ds_read_b64_tr_b16 a[118:119], v9 offset:6144
    s_waitcnt lgkmcnt(4)
    s_waitcnt lgkmcnt(0)
    s_waitcnt vmcnt(24)
    s_barrier
    s_add_u32 m0, s54, 49152
    s_add_u32 s32, s50, 6291456
    buffer_load_dwordx4 v24, s[12:15], s32 offen nt lds
    s_add_u32 m0, s54, 53248
    s_add_u32 s32, s50, 6684672
    buffer_load_dwordx4 v24, s[12:15], s32 offen nt lds
    s_add_u32 m0, s54, 57344
    s_add_u32 s32, s50, 6291584
    buffer_load_dwordx4 v24, s[12:15], s32 offen nt lds
    s_add_u32 m0, s54, 61440
    s_add_u32 s32, s50, 6684800
    buffer_load_dwordx4 v24, s[12:15], s32 offen nt lds
    s_add_u32 m0, s54, 65536
    s_add_u32 s32, s50, 6291712
    buffer_load_dwordx4 v24, s[12:15], s32 offen nt lds
    s_add_u32 m0, s54, 69632
    s_add_u32 s32, s50, 6684928
    buffer_load_dwordx4 v24, s[12:15], s32 offen nt lds
    v_add_u32 v10, 0x10000, v6
    ds_read_b64_tr_b16 a[0:1], v10 offset:8192
    ds_read_b64_tr_b16 a[2:3], v10 offset:10240
    ds_read_b64_tr_b16 a[4:5], v10 offset:12288
    ds_read_b64_tr_b16 a[6:7], v10 offset:14336
    ds_read_b64_tr_b16 a[8:9], v10 offset:16384
    ds_read_b64_tr_b16 a[10:11], v10 offset:18432
    ds_read_b64_tr_b16 a[12:13], v10 offset:20480
    ds_read_b64_tr_b16 a[14:15], v10 offset:22528
    ds_read_b64_tr_b16 a[16:17], v10 offset:24576
    ds_read_b64_tr_b16 a[18:19], v10 offset:26624
    ds_read_b64_tr_b16 a[20:21], v10 offset:28672
    ds_read_b64_tr_b16 a[22:23], v10 offset:30720
    s_waitcnt lgkmcnt(4)
    s_waitcnt lgkmcnt(0)
    s_waitcnt vmcnt(24)
    s_barrier
    s_add_u32 m0, s54, 73728
    s_add_u32 s32, s50, 7077888
    buffer_load_dwordx4 v24, s[12:15], s32 offen nt lds
    s_add_u32 m0, s54, 77824
    s_add_u32 s32, s50, 7471104
    buffer_load_dwordx4 v24, s[12:15], s32 offen nt lds
    s_add_u32 m0, s54, 81920
    s_add_u32 s32, s50, 7078016
    buffer_load_dwordx4 v24, s[12:15], s32 offen nt lds
    s_add_u32 m0, s54, 86016
    s_add_u32 s32, s50, 7471232
    buffer_load_dwordx4 v24, s[12:15], s32 offen nt lds
    s_add_u32 m0, s54, 90112
    s_add_u32 s32, s50, 7078144
    buffer_load_dwordx4 v24, s[12:15], s32 offen nt lds
    s_add_u32 m0, s54, 94208
    s_add_u32 s32, s50, 7471360
    buffer_load_dwordx4 v24, s[12:15], s32 offen nt lds
    v_add_u32 v9, 0x18000, v6
    ds_read_b64_tr_b16 v[28:29], v9 offset:0
    ds_read_b64_tr_b16 v[30:31], v9 offset:2048
    ds_read_b64_tr_b16 v[32:33], v9 offset:4096
    ds_read_b64_tr_b16 v[34:35], v9 offset:6144
    ds_read_b64_tr_b16 v[36:37], v9 offset:8192
    ds_read_b64_tr_b16 v[38:39], v9 offset:10240
    ds_read_b64_tr_b16 v[40:41], v9 offset:12288
    ds_read_b64_tr_b16 v[42:43], v9 offset:14336
    ds_read_b64_tr_b16 v[44:45], v9 offset:16384
    ds_read_b64_tr_b16 v[46:47], v9 offset:18432
    ds_read_b64_tr_b16 v[48:49], v9 offset:20480
    ds_read_b64_tr_b16 v[50:51], v9 offset:22528
    s_waitcnt lgkmcnt(4)
    s_waitcnt lgkmcnt(0)
    s_waitcnt vmcnt(24)
    s_barrier
    v_add_u32 v10, 0x18000, v6
    ds_read_b64_tr_b16 a[120:121], v10 offset:24576
    ds_read_b64_tr_b16 a[122:123], v10 offset:26624
    ds_read_b64_tr_b16 a[124:125], v10 offset:28672
    ds_read_b64_tr_b16 a[126:127], v10 offset:30720
    v_add_u32 v9, 0x20000, v6
    ds_read_b64_tr_b16 a[128:129], v9 offset:0
    ds_read_b64_tr_b16 a[130:131], v9 offset:2048
    ds_read_b64_tr_b16 a[132:133], v9 offset:4096
    ds_read_b64_tr_b16 a[134:135], v9 offset:6144
    ds_read_b64_tr_b16 a[136:137], v9 offset:8192
    ds_read_b64_tr_b16 a[138:139], v9 offset:10240
    ds_read_b64_tr_b16 a[140:141], v9 offset:12288
    ds_read_b64_tr_b16 a[142:143], v9 offset:14336
    s_waitcnt lgkmcnt(4)
    s_waitcnt lgkmcnt(0)
    s_waitcnt vmcnt(18)
    s_barrier
    s_add_u32 m0, s54, 98304
    s_add_u32 s32, s51, 0
    buffer_load_dwordx4 v25, s[20:23], s32 offen nt lds
    s_add_u32 m0, s54, 102400
    s_add_u32 s32, s51, 128
    buffer_load_dwordx4 v25, s[20:23], s32 offen nt lds
    s_add_u32 m0, s54, 106496
    s_add_u32 s32, s51, 256
    buffer_load_dwordx4 v25, s[20:23], s32 offen nt lds
    s_add_u32 m0, s54, 110592
    s_add_u32 s32, s51, 384
    buffer_load_dwordx4 v25, s[20:23], s32 offen nt lds
    s_add_u32 m0, s54, 114688
    s_add_u32 s32, s51, 512
    buffer_load_dwordx4 v25, s[20:23], s32 offen nt lds
    s_add_u32 m0, s54, 118784
    s_add_u32 s32, s51, 640
    buffer_load_dwordx4 v25, s[20:23], s32 offen nt lds
    s_add_u32 m0, s54, 122880
    s_add_u32 s32, s51, 768
    buffer_load_dwordx4 v25, s[20:23], s32 offen nt lds
    s_add_u32 m0, s54, 126976
    s_add_u32 s32, s51, 896
    buffer_load_dwordx4 v25, s[20:23], s32 offen nt lds
    s_add_u32 m0, s54, 131072
    s_add_u32 s32, s51, 1024
    buffer_load_dwordx4 v25, s[20:23], s32 offen nt lds
    s_add_u32 m0, s54, 135168
    s_add_u32 s32, s51, 1152
    buffer_load_dwordx4 v25, s[20:23], s32 offen nt lds
    ds_read_b64_tr_b16 a[144:145], v6 offset:0
    ds_read_b64_tr_b16 a[146:147], v6 offset:2048
    ds_read_b64_tr_b16 a[148:149], v6 offset:4096
    ds_read_b64_tr_b16 a[150:151], v6 offset:6144
    ds_read_b64_tr_b16 a[152:153], v6 offset:8192
    ds_read_b64_tr_b16 a[154:155], v6 offset:10240
    ds_read_b64_tr_b16 a[156:157], v6 offset:12288
    ds_read_b64_tr_b16 a[158:159], v6 offset:14336
    ds_read_b64_tr_b16 a[160:161], v6 offset:16384
    ds_read_b64_tr_b16 a[162:163], v6 offset:18432
    ds_read_b64_tr_b16 a[164:165], v6 offset:20480
    ds_read_b64_tr_b16 a[166:167], v6 offset:22528
    s_waitcnt lgkmcnt(4)
    s_waitcnt lgkmcnt(0)
    s_waitcnt vmcnt(22)
    s_barrier
    ds_read_b64_tr_b16 a[24:25], v6 offset:24576
    ds_read_b64_tr_b16 a[26:27], v6 offset:26624
    ds_read_b64_tr_b16 a[28:29], v6 offset:28672
    ds_read_b64_tr_b16 a[30:31], v6 offset:30720
    ds_read_b64_tr_b16 a[32:33], v6 offset:32768
    ds_read_b64_tr_b16 a[34:35], v6 offset:34816
    ds_read_b64_tr_b16 a[36:37], v6 offset:36864
    ds_read_b64_tr_b16 a[38:39], v6 offset:38912
    ds_read_b64_tr_b16 a[40:41], v6 offset:40960
    ds_read_b64_tr_b16 a[42:43], v6 offset:43008
    ds_read_b64_tr_b16 a[44:45], v6 offset:45056
    ds_read_b64_tr_b16 a[46:47], v6 offset:47104
    s_waitcnt lgkmcnt(4)
    s_waitcnt lgkmcnt(0)
    s_waitcnt vmcnt(16)
    s_barrier
    s_add_u32 m0, s54, 0
    s_add_u32 s32, s51, 40960
    buffer_load_dwordx4 v25, s[20:23], s32 offen nt lds
    s_add_u32 m0, s54, 4096
    s_add_u32 s32, s51, 41088
    buffer_load_dwordx4 v25, s[20:23], s32 offen nt lds
    s_add_u32 m0, s54, 8192
    s_add_u32 s32, s51, 41216
    buffer_load_dwordx4 v25, s[20:23], s32 offen nt lds
    s_add_u32 m0, s54, 12288
    s_add_u32 s32, s51, 41344
    buffer_load_dwordx4 v25, s[20:23], s32 offen nt lds
    s_add_u32 m0, s54, 16384
    s_add_u32 s32, s51, 41472
    buffer_load_dwordx4 v25, s[20:23], s32 offen nt lds
    s_add_u32 m0, s54, 20480
    s_add_u32 s32, s51, 41600
    buffer_load_dwordx4 v25, s[20:23], s32 offen nt lds
    s_add_u32 m0, s54, 24576
    s_add_u32 s32, s51, 41728
    buffer_load_dwordx4 v25, s[20:23], s32 offen nt lds
    s_add_u32 m0, s54, 28672
    s_add_u32 s32, s51, 41856
    buffer_load_dwordx4 v25, s[20:23], s32 offen nt lds
    s_add_u32 m0, s54, 32768
    s_add_u32 s32, s51, 41984
    buffer_load_dwordx4 v25, s[20:23], s32 offen nt lds
    s_add_u32 m0, s54, 36864
    s_add_u32 s32, s51, 42112
    buffer_load_dwordx4 v25, s[20:23], s32 offen nt lds
    ds_read_b64_tr_b16 v[52:53], v6 offset:49152
    ds_read_b64_tr_b16 v[54:55], v6 offset:51200
    ds_read_b64_tr_b16 v[56:57], v6 offset:53248
    ds_read_b64_tr_b16 v[58:59], v6 offset:55296
    ds_read_b64_tr_b16 v[60:61], v6 offset:57344
    ds_read_b64_tr_b16 v[62:63], v6 offset:59392
    ds_read_b64_tr_b16 v[64:65], v6 offset:61440
    ds_read_b64_tr_b16 v[66:67], v6 offset:63488
    v_add_u32 v10, 0x10000, v6
    ds_read_b64_tr_b16 v[68:69], v10 offset:0
    ds_read_b64_tr_b16 v[70:71], v10 offset:2048
    ds_read_b64_tr_b16 v[72:73], v10 offset:4096
    ds_read_b64_tr_b16 v[74:75], v10 offset:6144
    s_waitcnt lgkmcnt(4)
    s_waitcnt lgkmcnt(0)
    s_waitcnt vmcnt(20)
    s_barrier
    v_add_u32 v9, 0x10000, v6
    ds_read_b64_tr_b16 a[168:169], v9 offset:8192
    ds_read_b64_tr_b16 a[170:171], v9 offset:10240
    ds_read_b64_tr_b16 a[172:173], v9 offset:12288
    ds_read_b64_tr_b16 a[174:175], v9 offset:14336
    ds_read_b64_tr_b16 a[176:177], v9 offset:16384
    ds_read_b64_tr_b16 a[178:179], v9 offset:18432
    ds_read_b64_tr_b16 a[180:181], v9 offset:20480
    ds_read_b64_tr_b16 a[182:183], v9 offset:22528
    ds_read_b64_tr_b16 a[184:185], v9 offset:24576
    ds_read_b64_tr_b16 a[186:187], v9 offset:26624
    ds_read_b64_tr_b16 a[188:189], v9 offset:28672
    ds_read_b64_tr_b16 a[190:191], v9 offset:30720
    s_waitcnt lgkmcnt(4)
    s_waitcnt lgkmcnt(0)
    s_waitcnt vmcnt(10)
    s_barrier
    s_add_u32 m0, s54, 40960
    s_add_u32 s32, s51, 81920
    buffer_load_dwordx4 v25, s[20:23], s32 offen nt lds
    s_add_u32 m0, s54, 45056
    s_add_u32 s32, s51, 82048
    buffer_load_dwordx4 v25, s[20:23], s32 offen nt lds
    s_add_u32 m0, s54, 49152
    s_add_u32 s32, s51, 82176
    buffer_load_dwordx4 v25, s[20:23], s32 offen nt lds
    s_add_u32 m0, s54, 53248
    s_add_u32 s32, s51, 82304
    buffer_load_dwordx4 v25, s[20:23], s32 offen nt lds
    s_add_u32 m0, s54, 57344
    s_add_u32 s32, s51, 82432
    buffer_load_dwordx4 v25, s[20:23], s32 offen nt lds
    s_add_u32 m0, s54, 61440
    s_add_u32 s32, s51, 82560
    buffer_load_dwordx4 v25, s[20:23], s32 offen nt lds
    s_add_u32 m0, s54, 65536
    s_add_u32 s32, s51, 82688
    buffer_load_dwordx4 v25, s[20:23], s32 offen nt lds
    s_add_u32 m0, s54, 69632
    s_add_u32 s32, s51, 82816
    buffer_load_dwordx4 v25, s[20:23], s32 offen nt lds
    s_add_u32 m0, s54, 73728
    s_add_u32 s32, s51, 82944
    buffer_load_dwordx4 v25, s[20:23], s32 offen nt lds
    s_add_u32 m0, s54, 77824
    s_add_u32 s32, s51, 83072
    buffer_load_dwordx4 v25, s[20:23], s32 offen nt lds
    v_add_u32 v10, 0x18000, v20
    ds_read_b64_tr_b16 a[192:193], v10 offset:0
    v_add_u32 v9, 0x18000, v21
    ds_read_b64_tr_b16 a[194:195], v9 offset:0
    ds_read_b64_tr_b16 a[196:197], v10 offset:1024
    ds_read_b64_tr_b16 a[198:199], v9 offset:1024
    v_add_u32 v10, 0x18000, v22
    ds_read_b64_tr_b16 a[200:201], v10 offset:0
    v_add_u32 v9, 0x18000, v23
    ds_read_b64_tr_b16 a[202:203], v9 offset:0
    ds_read_b64_tr_b16 a[204:205], v10 offset:1024
    ds_read_b64_tr_b16 a[206:207], v9 offset:1024
    v_add_u32 v10, 0x18000, v20
    ds_read_b64_tr_b16 a[208:209], v10 offset:4096
    v_add_u32 v9, 0x18000, v21
    ds_read_b64_tr_b16 a[210:211], v9 offset:4096
    ds_read_b64_tr_b16 a[212:213], v10 offset:5120
    ds_read_b64_tr_b16 a[214:215], v9 offset:5120
    s_waitcnt lgkmcnt(4)
    v_add_u32 v10, 0x18000, v22
    ds_read_b64_tr_b16 a[216:217], v10 offset:4096
    v_add_u32 v9, 0x18000, v23
    ds_read_b64_tr_b16 a[218:219], v9 offset:4096
    ds_read_b64_tr_b16 a[220:221], v10 offset:5120
    ds_read_b64_tr_b16 a[222:223], v9 offset:5120
    v_add_u32 v10, 0x18000, v20
    ds_read_b64_tr_b16 a[224:225], v10 offset:8192
    v_add_u32 v9, 0x18000, v21
    ds_read_b64_tr_b16 a[226:227], v9 offset:8192
    ds_read_b64_tr_b16 a[228:229], v10 offset:9216
    ds_read_b64_tr_b16 a[230:231], v9 offset:9216
    s_waitcnt lgkmcnt(4)
    s_waitcnt lgkmcnt(0)
    s_waitcnt vmcnt(10)
    s_barrier
    s_add_u32 m0, s54, 81920
    s_add_u32 s32, s51, 122880
    buffer_load_dwordx4 v25, s[20:23], s32 offen nt lds
    s_add_u32 m0, s54, 86016
    s_add_u32 s32, s51, 123008
    buffer_load_dwordx4 v25, s[20:23], s32 offen nt lds
    s_add_u32 m0, s54, 90112
    s_add_u32 s32, s51, 123136
    buffer_load_dwordx4 v25, s[20:23], s32 offen nt lds
    s_add_u32 m0, s54, 94208
    s_add_u32 s32, s51, 123264
    buffer_load_dwordx4 v25, s[20:23], s32 offen nt lds
    s_add_u32 m0, s54, 98304
    s_add_u32 s32, s51, 123392
    buffer_load_dwordx4 v25, s[20:23], s32 offen nt lds
    s_add_u32 m0, s54, 102400
    s_add_u32 s32, s51, 123520
    buffer_load_dwordx4 v25, s[20:23], s32 offen nt lds
    s_add_u32 m0, s54, 106496
    s_add_u32 s32, s51, 123648
    buffer_load_dwordx4 v25, s[20:23], s32 offen nt lds
    s_add_u32 m0, s54, 110592
    s_add_u32 s32, s51, 123776
    buffer_load_dwordx4 v25, s[20:23], s32 offen nt lds
    s_add_u32 m0, s54, 114688
    s_add_u32 s32, s51, 123904
    buffer_load_dwordx4 v25, s[20:23], s32 offen nt lds
    s_add_u32 m0, s54, 118784
    s_add_u32 s32, s51, 124032
    buffer_load_dwordx4 v25, s[20:23], s32 offen nt lds
    s_add_u32 m0, s54, 122880
    s_add_u32 s32, s51, 163840
    buffer_load_dwordx4 v25, s[20:23], s32 offen nt lds
    s_add_u32 m0, s54, 126976
    s_add_u32 s32, s51, 163968
    buffer_load_dwordx4 v25, s[20:23], s32 offen nt lds
    s_add_u32 m0, s54, 131072
    s_add_u32 s32, s51, 164096
    buffer_load_dwordx4 v25, s[20:23], s32 offen nt lds
    s_add_u32 m0, s54, 135168
    s_add_u32 s32, s51, 164224
    buffer_load_dwordx4 v25, s[20:23], s32 offen nt lds
    s_add_u32 m0, s54, 139264
    s_add_u32 s32, s51, 164352
    buffer_load_dwordx4 v25, s[20:23], s32 offen nt lds
    s_add_u32 m0, s54, 143360
    s_add_u32 s32, s51, 164480
    buffer_load_dwordx4 v25, s[20:23], s32 offen nt lds
    s_add_u32 m0, s54, 147456
    s_add_u32 s32, s51, 164608
    buffer_load_dwordx4 v25, s[20:23], s32 offen nt lds
    s_add_u32 m0, s54, 151552
    s_add_u32 s32, s51, 164736
    buffer_load_dwordx4 v25, s[20:23], s32 offen nt lds
    s_add_u32 m0, s54, 155648
    s_add_u32 s32, s51, 164864
    buffer_load_dwordx4 v25, s[20:23], s32 offen nt lds
    s_add_u32 m0, s54, 159744
    s_add_u32 s32, s51, 164992
    buffer_load_dwordx4 v25, s[20:23], s32 offen nt lds
    ds_read_b64_tr_b16 a[232:233], v20 offset:0
    ds_read_b64_tr_b16 a[234:235], v21 offset:0
    ds_read_b64_tr_b16 a[236:237], v20 offset:1024
    ds_read_b64_tr_b16 a[238:239], v21 offset:1024
    ds_read_b64_tr_b16 a[240:241], v22 offset:0
    ds_read_b64_tr_b16 a[242:243], v23 offset:0
    ds_read_b64_tr_b16 a[244:245], v22 offset:1024
    ds_read_b64_tr_b16 a[246:247], v23 offset:1024
    ds_read_b64_tr_b16 a[248:249], v20 offset:4096
    ds_read_b64_tr_b16 a[250:251], v21 offset:4096
    ds_read_b64_tr_b16 a[252:253], v20 offset:5120
    ds_read_b64_tr_b16 a[254:255], v21 offset:5120
    s_waitcnt lgkmcnt(4)
    ds_read_b64_tr_b16 v[160:161], v22 offset:4096
    ds_read_b64_tr_b16 v[162:163], v23 offset:4096
    ds_read_b64_tr_b16 v[164:165], v22 offset:5120
    ds_read_b64_tr_b16 v[166:167], v23 offset:5120
    ds_read_b64_tr_b16 v[168:169], v20 offset:8192
    ds_read_b64_tr_b16 v[170:171], v21 offset:8192
    ds_read_b64_tr_b16 v[172:173], v20 offset:9216
    ds_read_b64_tr_b16 v[174:175], v21 offset:9216
    s_waitcnt lgkmcnt(4)
    s_waitcnt lgkmcnt(0)
    s_waitcnt vmcnt(20)
    s_barrier
    s_add_u32 m0, s54, 0
    s_add_u32 s32, s51, 204800
    buffer_load_dwordx4 v25, s[20:23], s32 offen nt lds
    s_add_u32 m0, s54, 4096
    s_add_u32 s32, s51, 204928
    buffer_load_dwordx4 v25, s[20:23], s32 offen nt lds
    s_add_u32 m0, s54, 8192
    s_add_u32 s32, s51, 205056
    buffer_load_dwordx4 v25, s[20:23], s32 offen nt lds
    s_add_u32 m0, s54, 12288
    s_add_u32 s32, s51, 205184
    buffer_load_dwordx4 v25, s[20:23], s32 offen nt lds
    s_add_u32 m0, s54, 16384
    s_add_u32 s32, s51, 205312
    buffer_load_dwordx4 v25, s[20:23], s32 offen nt lds
    s_add_u32 m0, s54, 20480
    s_add_u32 s32, s51, 205440
    buffer_load_dwordx4 v25, s[20:23], s32 offen nt lds
    s_add_u32 m0, s54, 24576
    s_add_u32 s32, s51, 205568
    buffer_load_dwordx4 v25, s[20:23], s32 offen nt lds
    s_add_u32 m0, s54, 28672
    s_add_u32 s32, s51, 205696
    buffer_load_dwordx4 v25, s[20:23], s32 offen nt lds
    s_add_u32 m0, s54, 32768
    s_add_u32 s32, s51, 205824
    buffer_load_dwordx4 v25, s[20:23], s32 offen nt lds
    s_add_u32 m0, s54, 36864
    s_add_u32 s32, s51, 205952
    buffer_load_dwordx4 v25, s[20:23], s32 offen nt lds
    s_mov_b32 s28, s88
    s_and_b32 s29, s89, 0xffff
    s_mov_b32 s30, 0x100
    s_mov_b32 s31, 0x20000
    v_mov_b32 v2, 0
    buffer_load_dword v3, v2, s[28:31], 0 offen offset:60 sc1
    ds_read_b64_tr_b16 v[176:177], v20 offset:40960
    ds_read_b64_tr_b16 v[178:179], v21 offset:40960
    ds_read_b64_tr_b16 v[180:181], v20 offset:41984
    ds_read_b64_tr_b16 v[182:183], v21 offset:41984
    ds_read_b64_tr_b16 v[184:185], v22 offset:40960
    ds_read_b64_tr_b16 v[186:187], v23 offset:40960
    ds_read_b64_tr_b16 v[188:189], v22 offset:41984
    ds_read_b64_tr_b16 v[190:191], v23 offset:41984
    ds_read_b64_tr_b16 v[192:193], v20 offset:45056
    ds_read_b64_tr_b16 v[194:195], v21 offset:45056
    ds_read_b64_tr_b16 v[196:197], v20 offset:46080
    ds_read_b64_tr_b16 v[198:199], v21 offset:46080
    s_waitcnt lgkmcnt(4)
    ds_read_b64_tr_b16 v[200:201], v22 offset:45056
    ds_read_b64_tr_b16 v[202:203], v23 offset:45056
    ds_read_b64_tr_b16 v[204:205], v22 offset:46080
    ds_read_b64_tr_b16 v[206:207], v23 offset:46080
    ds_read_b64_tr_b16 v[208:209], v20 offset:49152
    ds_read_b64_tr_b16 v[210:211], v21 offset:49152
    ds_read_b64_tr_b16 v[212:213], v20 offset:50176
    ds_read_b64_tr_b16 v[214:215], v21 offset:50176
    s_waitcnt lgkmcnt(4)
    s_waitcnt lgkmcnt(0)
    s_waitcnt vmcnt(21)
    s_barrier
    v_add_u32 v10, 0x10000, v20
    ds_read_b64_tr_b16 v[76:77], v10 offset:16384
    v_add_u32 v9, 0x10000, v21
    ds_read_b64_tr_b16 v[78:79], v9 offset:16384
    ds_read_b64_tr_b16 v[80:81], v10 offset:17408
    ds_read_b64_tr_b16 v[82:83], v9 offset:17408
    v_add_u32 v10, 0x10000, v22
    ds_read_b64_tr_b16 v[84:85], v10 offset:16384
    v_add_u32 v9, 0x10000, v23
    ds_read_b64_tr_b16 v[86:87], v9 offset:16384
    ds_read_b64_tr_b16 v[88:89], v10 offset:17408
    ds_read_b64_tr_b16 v[90:91], v9 offset:17408
    v_add_u32 v10, 0x10000, v20
    ds_read_b64_tr_b16 v[92:93], v10 offset:20480
    v_add_u32 v9, 0x10000, v21
    ds_read_b64_tr_b16 v[94:95], v9 offset:20480
    ds_read_b64_tr_b16 v[96:97], v10 offset:21504
    ds_read_b64_tr_b16 v[98:99], v9 offset:21504
    s_waitcnt lgkmcnt(4)
    v_add_u32 v10, 0x10000, v22
    ds_read_b64_tr_b16 v[100:101], v10 offset:20480
    v_add_u32 v9, 0x10000, v23
    ds_read_b64_tr_b16 v[102:103], v9 offset:20480
    ds_read_b64_tr_b16 v[104:105], v10 offset:21504
    ds_read_b64_tr_b16 v[106:107], v9 offset:21504
    v_add_u32 v10, 0x10000, v20
    ds_read_b64_tr_b16 v[108:109], v10 offset:24576
    v_add_u32 v9, 0x10000, v21
    ds_read_b64_tr_b16 v[110:111], v9 offset:24576
    ds_read_b64_tr_b16 v[112:113], v10 offset:25600
    ds_read_b64_tr_b16 v[114:115], v9 offset:25600
    s_waitcnt lgkmcnt(4)
    s_waitcnt lgkmcnt(0)
    s_waitcnt vmcnt(11)
    s_barrier
    v_add_u32 v10, 0x18000, v20
    ds_read_b64_tr_b16 v[216:217], v10 offset:24576
    v_add_u32 v9, 0x18000, v21
    ds_read_b64_tr_b16 v[218:219], v9 offset:24576
    ds_read_b64_tr_b16 v[220:221], v10 offset:25600
    ds_read_b64_tr_b16 v[222:223], v9 offset:25600
    v_add_u32 v10, 0x18000, v22
    ds_read_b64_tr_b16 v[224:225], v10 offset:24576
    v_add_u32 v9, 0x18000, v23
    ds_read_b64_tr_b16 v[226:227], v9 offset:24576
    ds_read_b64_tr_b16 v[228:229], v10 offset:25600
    ds_read_b64_tr_b16 v[230:231], v9 offset:25600
    v_add_u32 v10, 0x18000, v20
    ds_read_b64_tr_b16 v[232:233], v10 offset:28672
    v_add_u32 v9, 0x18000, v21
    ds_read_b64_tr_b16 v[234:235], v9 offset:28672
    ds_read_b64_tr_b16 v[236:237], v10 offset:29696
    ds_read_b64_tr_b16 v[238:239], v9 offset:29696
    s_waitcnt lgkmcnt(4)
    v_add_u32 v10, 0x18000, v22
    ds_read_b64_tr_b16 v[240:241], v10 offset:28672
    v_add_u32 v9, 0x18000, v23
    ds_read_b64_tr_b16 v[242:243], v9 offset:28672
    ds_read_b64_tr_b16 v[244:245], v10 offset:29696
    ds_read_b64_tr_b16 v[246:247], v9 offset:29696
    v_add_u32 v10, 0x20000, v20
    ds_read_b64_tr_b16 v[248:249], v10 offset:0
    v_add_u32 v9, 0x20000, v21
    ds_read_b64_tr_b16 v[250:251], v9 offset:0
    ds_read_b64_tr_b16 v[252:253], v10 offset:1024
    ds_read_b64_tr_b16 v[254:255], v9 offset:1024
    s_waitcnt lgkmcnt(4)
    s_waitcnt lgkmcnt(0)
    s_waitcnt vmcnt(1)
    s_barrier
    ds_read_b64_tr_b16 v[116:117], v20 offset:0
    ds_read_b64_tr_b16 v[118:119], v21 offset:0
    ds_read_b64_tr_b16 v[120:121], v20 offset:1024
    ds_read_b64_tr_b16 v[122:123], v21 offset:1024
    ds_read_b64_tr_b16 v[124:125], v22 offset:0
    ds_read_b64_tr_b16 v[126:127], v23 offset:0
    ds_read_b64_tr_b16 v[128:129], v22 offset:1024
    ds_read_b64_tr_b16 v[130:131], v23 offset:1024
    ds_read_b64_tr_b16 v[132:133], v20 offset:4096
    ds_read_b64_tr_b16 v[134:135], v21 offset:4096
    ds_read_b64_tr_b16 v[136:137], v20 offset:5120
    ds_read_b64_tr_b16 v[138:139], v21 offset:5120
    s_waitcnt lgkmcnt(4)
    ds_read_b64_tr_b16 v[140:141], v22 offset:4096
    ds_read_b64_tr_b16 v[142:143], v23 offset:4096
    ds_read_b64_tr_b16 v[144:145], v22 offset:5120
    ds_read_b64_tr_b16 v[146:147], v23 offset:5120
    ds_read_b64_tr_b16 v[148:149], v20 offset:8192
    ds_read_b64_tr_b16 v[150:151], v21 offset:8192
    ds_read_b64_tr_b16 v[152:153], v20 offset:9216
    ds_read_b64_tr_b16 v[154:155], v21 offset:9216
    s_waitcnt lgkmcnt(4)
    s_waitcnt lgkmcnt(0)
    s_barrier
    s_branch V_ld_wx
V_ld_w2:
    s_add_u32 m0, s54, 0
    s_add_u32 s32, s50, 0
    buffer_load_dwordx4 v24, s[12:15], s32 offen nt lds
    s_add_u32 m0, s54, 4096
    s_add_u32 s32, s50, 393216
    buffer_load_dwordx4 v24, s[12:15], s32 offen nt lds
    s_add_u32 m0, s54, 8192
    s_add_u32 s32, s50, 128
    buffer_load_dwordx4 v24, s[12:15], s32 offen nt lds
    s_add_u32 m0, s54, 12288
    s_add_u32 s32, s50, 393344
    buffer_load_dwordx4 v24, s[12:15], s32 offen nt lds
    s_add_u32 m0, s54, 16384
    s_add_u32 s32, s50, 256
    buffer_load_dwordx4 v24, s[12:15], s32 offen nt lds
    s_add_u32 m0, s54, 20480
    s_add_u32 s32, s50, 393472
    buffer_load_dwordx4 v24, s[12:15], s32 offen nt lds
    s_add_u32 m0, s54, 24576
    s_add_u32 s32, s50, 786432
    buffer_load_dwordx4 v24, s[12:15], s32 offen nt lds
    s_add_u32 m0, s54, 28672
    s_add_u32 s32, s50, 1179648
    buffer_load_dwordx4 v24, s[12:15], s32 offen nt lds
    s_add_u32 m0, s54, 32768
    s_add_u32 s32, s50, 786560
    buffer_load_dwordx4 v24, s[12:15], s32 offen nt lds
    s_add_u32 m0, s54, 36864
    s_add_u32 s32, s50, 1179776
    buffer_load_dwordx4 v24, s[12:15], s32 offen nt lds
    s_add_u32 m0, s54, 40960
    s_add_u32 s32, s50, 786688
    buffer_load_dwordx4 v24, s[12:15], s32 offen nt lds
    s_add_u32 m0, s54, 45056
    s_add_u32 s32, s50, 1179904
    buffer_load_dwordx4 v24, s[12:15], s32 offen nt lds
    s_add_u32 m0, s54, 49152
    s_add_u32 s32, s50, 1572864
    buffer_load_dwordx4 v24, s[12:15], s32 offen nt lds
    s_add_u32 m0, s54, 53248
    s_add_u32 s32, s50, 1966080
    buffer_load_dwordx4 v24, s[12:15], s32 offen nt lds
    s_add_u32 m0, s54, 57344
    s_add_u32 s32, s50, 1572992
    buffer_load_dwordx4 v24, s[12:15], s32 offen nt lds
    s_add_u32 m0, s54, 61440
    s_add_u32 s32, s50, 1966208
    buffer_load_dwordx4 v24, s[12:15], s32 offen nt lds
    s_add_u32 m0, s54, 65536
    s_add_u32 s32, s50, 1573120
    buffer_load_dwordx4 v24, s[12:15], s32 offen nt lds
    s_add_u32 m0, s54, 69632
    s_add_u32 s32, s50, 1966336
    buffer_load_dwordx4 v24, s[12:15], s32 offen nt lds
    s_add_u32 m0, s54, 73728
    s_add_u32 s32, s50, 2359296
    buffer_load_dwordx4 v24, s[12:15], s32 offen nt lds
    s_add_u32 m0, s54, 77824
    s_add_u32 s32, s50, 2752512
    buffer_load_dwordx4 v24, s[12:15], s32 offen nt lds
    s_add_u32 m0, s54, 81920
    s_add_u32 s32, s50, 2359424
    buffer_load_dwordx4 v24, s[12:15], s32 offen nt lds
    s_add_u32 m0, s54, 86016
    s_add_u32 s32, s50, 2752640
    buffer_load_dwordx4 v24, s[12:15], s32 offen nt lds
    s_add_u32 m0, s54, 90112
    s_add_u32 s32, s50, 2359552
    buffer_load_dwordx4 v24, s[12:15], s32 offen nt lds
    s_add_u32 m0, s54, 94208
    s_add_u32 s32, s50, 2752768
    buffer_load_dwordx4 v24, s[12:15], s32 offen nt lds
    s_add_u32 m0, s54, 98304
    s_add_u32 s32, s50, 3145728
    buffer_load_dwordx4 v24, s[12:15], s32 offen nt lds
    s_add_u32 m0, s54, 102400
    s_add_u32 s32, s50, 3538944
    buffer_load_dwordx4 v24, s[12:15], s32 offen nt lds
    s_add_u32 m0, s54, 106496
    s_add_u32 s32, s50, 3145856
    buffer_load_dwordx4 v24, s[12:15], s32 offen nt lds
    s_add_u32 m0, s54, 110592
    s_add_u32 s32, s50, 3539072
    buffer_load_dwordx4 v24, s[12:15], s32 offen nt lds
    s_add_u32 m0, s54, 114688
    s_add_u32 s32, s50, 3145984
    buffer_load_dwordx4 v24, s[12:15], s32 offen nt lds
    s_add_u32 m0, s54, 118784
    s_add_u32 s32, s50, 3539200
    buffer_load_dwordx4 v24, s[12:15], s32 offen nt lds
    s_add_u32 m0, s54, 122880
    s_add_u32 s32, s50, 3932160
    buffer_load_dwordx4 v24, s[12:15], s32 offen nt lds
    s_add_u32 m0, s54, 126976
    s_add_u32 s32, s50, 4325376
    buffer_load_dwordx4 v24, s[12:15], s32 offen nt lds
    s_add_u32 m0, s54, 131072
    s_add_u32 s32, s50, 3932288
    buffer_load_dwordx4 v24, s[12:15], s32 offen nt lds
    s_add_u32 m0, s54, 135168
    s_add_u32 s32, s50, 4325504
    buffer_load_dwordx4 v24, s[12:15], s32 offen nt lds
    s_add_u32 m0, s54, 139264
    s_add_u32 s32, s50, 3932416
    buffer_load_dwordx4 v24, s[12:15], s32 offen nt lds
    s_add_u32 m0, s54, 143360
    s_add_u32 s32, s50, 4325632
    buffer_load_dwordx4 v24, s[12:15], s32 offen nt lds
    s_waitcnt vmcnt(30)
    s_barrier
    ds_read_b64_tr_b16 a[48:49], v6 offset:0
    ds_read_b64_tr_b16 a[50:51], v6 offset:2048
    ds_read_b64_tr_b16 a[52:53], v6 offset:4096
    ds_read_b64_tr_b16 a[54:55], v6 offset:6144
    ds_read_b64_tr_b16 a[56:57], v6 offset:8192
    ds_read_b64_tr_b16 a[58:59], v6 offset:10240
    ds_read_b64_tr_b16 a[60:61], v6 offset:12288
    ds_read_b64_tr_b16 a[62:63], v6 offset:14336
    ds_read_b64_tr_b16 a[64:65], v6 offset:16384
    ds_read_b64_tr_b16 a[66:67], v6 offset:18432
    ds_read_b64_tr_b16 a[68:69], v6 offset:20480
    ds_read_b64_tr_b16 a[70:71], v6 offset:22528
    s_waitcnt lgkmcnt(4)
    s_waitcnt lgkmcnt(0)
    s_waitcnt vmcnt(24)
    s_barrier
    s_add_u32 m0, s54, 0
    s_add_u32 s32, s50, 4718592
    buffer_load_dwordx4 v24, s[12:15], s32 offen nt lds
    s_add_u32 m0, s54, 4096
    s_add_u32 s32, s50, 5111808
    buffer_load_dwordx4 v24, s[12:15], s32 offen nt lds
    s_add_u32 m0, s54, 8192
    s_add_u32 s32, s50, 4718720
    buffer_load_dwordx4 v24, s[12:15], s32 offen nt lds
    s_add_u32 m0, s54, 12288
    s_add_u32 s32, s50, 5111936
    buffer_load_dwordx4 v24, s[12:15], s32 offen nt lds
    s_add_u32 m0, s54, 16384
    s_add_u32 s32, s50, 4718848
    buffer_load_dwordx4 v24, s[12:15], s32 offen nt lds
    s_add_u32 m0, s54, 20480
    s_add_u32 s32, s50, 5112064
    buffer_load_dwordx4 v24, s[12:15], s32 offen nt lds
    ds_read_b64_tr_b16 a[72:73], v6 offset:24576
    ds_read_b64_tr_b16 a[74:75], v6 offset:26624
    ds_read_b64_tr_b16 a[76:77], v6 offset:28672
    ds_read_b64_tr_b16 a[78:79], v6 offset:30720
    ds_read_b64_tr_b16 a[80:81], v6 offset:32768
    ds_read_b64_tr_b16 a[82:83], v6 offset:34816
    ds_read_b64_tr_b16 a[84:85], v6 offset:36864
    ds_read_b64_tr_b16 a[86:87], v6 offset:38912
    ds_read_b64_tr_b16 a[88:89], v6 offset:40960
    ds_read_b64_tr_b16 a[90:91], v6 offset:43008
    ds_read_b64_tr_b16 a[92:93], v6 offset:45056
    ds_read_b64_tr_b16 a[94:95], v6 offset:47104
    s_waitcnt lgkmcnt(4)
    s_waitcnt lgkmcnt(0)
    s_waitcnt vmcnt(24)
    s_barrier
    s_add_u32 m0, s54, 24576
    s_add_u32 s32, s50, 5505024
    buffer_load_dwordx4 v24, s[12:15], s32 offen nt lds
    s_add_u32 m0, s54, 28672
    s_add_u32 s32, s50, 5898240
    buffer_load_dwordx4 v24, s[12:15], s32 offen nt lds
    s_add_u32 m0, s54, 32768
    s_add_u32 s32, s50, 5505152
    buffer_load_dwordx4 v24, s[12:15], s32 offen nt lds
    s_add_u32 m0, s54, 36864
    s_add_u32 s32, s50, 5898368
    buffer_load_dwordx4 v24, s[12:15], s32 offen nt lds
    s_add_u32 m0, s54, 40960
    s_add_u32 s32, s50, 5505280
    buffer_load_dwordx4 v24, s[12:15], s32 offen nt lds
    s_add_u32 m0, s54, 45056
    s_add_u32 s32, s50, 5898496
    buffer_load_dwordx4 v24, s[12:15], s32 offen nt lds
    ds_read_b64_tr_b16 a[120:121], v6 offset:49152
    ds_read_b64_tr_b16 a[122:123], v6 offset:51200
    ds_read_b64_tr_b16 a[124:125], v6 offset:53248
    ds_read_b64_tr_b16 a[126:127], v6 offset:55296
    ds_read_b64_tr_b16 a[128:129], v6 offset:57344
    ds_read_b64_tr_b16 a[130:131], v6 offset:59392
    ds_read_b64_tr_b16 a[132:133], v6 offset:61440
    ds_read_b64_tr_b16 a[134:135], v6 offset:63488
    v_add_u32 v10, 0x10000, v6
    ds_read_b64_tr_b16 a[136:137], v10 offset:0
    ds_read_b64_tr_b16 a[138:139], v10 offset:2048
    ds_read_b64_tr_b16 a[140:141], v10 offset:4096
    ds_read_b64_tr_b16 a[142:143], v10 offset:6144
    s_waitcnt lgkmcnt(4)
    s_waitcnt lgkmcnt(0)
    s_waitcnt vmcnt(24)
    s_barrier
    s_add_u32 m0, s54, 49152
    s_add_u32 s32, s50, 6291456
    buffer_load_dwordx4 v24, s[12:15], s32 offen nt lds
    s_add_u32 m0, s54, 53248
    s_add_u32 s32, s50, 6684672
    buffer_load_dwordx4 v24, s[12:15], s32 offen nt lds
    s_add_u32 m0, s54, 57344
    s_add_u32 s32, s50, 6291584
    buffer_load_dwordx4 v24, s[12:15], s32 offen nt lds
    s_add_u32 m0, s54, 61440
    s_add_u32 s32, s50, 6684800
    buffer_load_dwordx4 v24, s[12:15], s32 offen nt lds
    s_add_u32 m0, s54, 65536
    s_add_u32 s32, s50, 6291712
    buffer_load_dwordx4 v24, s[12:15], s32 offen nt lds
    s_add_u32 m0, s54, 69632
    s_add_u32 s32, s50, 6684928
    buffer_load_dwordx4 v24, s[12:15], s32 offen nt lds
    v_add_u32 v9, 0x10000, v6
    ds_read_b64_tr_b16 v[28:29], v9 offset:8192
    ds_read_b64_tr_b16 v[30:31], v9 offset:10240
    ds_read_b64_tr_b16 v[32:33], v9 offset:12288
    ds_read_b64_tr_b16 v[34:35], v9 offset:14336
    ds_read_b64_tr_b16 v[36:37], v9 offset:16384
    ds_read_b64_tr_b16 v[38:39], v9 offset:18432
    ds_read_b64_tr_b16 v[40:41], v9 offset:20480
    ds_read_b64_tr_b16 v[42:43], v9 offset:22528
    ds_read_b64_tr_b16 v[44:45], v9 offset:24576
    ds_read_b64_tr_b16 v[46:47], v9 offset:26624
    ds_read_b64_tr_b16 v[48:49], v9 offset:28672
    ds_read_b64_tr_b16 v[50:51], v9 offset:30720
    s_waitcnt lgkmcnt(4)
    s_waitcnt lgkmcnt(0)
    s_waitcnt vmcnt(24)
    s_barrier
    s_add_u32 m0, s54, 73728
    s_add_u32 s32, s50, 7077888
    buffer_load_dwordx4 v24, s[12:15], s32 offen nt lds
    s_add_u32 m0, s54, 77824
    s_add_u32 s32, s50, 7471104
    buffer_load_dwordx4 v24, s[12:15], s32 offen nt lds
    s_add_u32 m0, s54, 81920
    s_add_u32 s32, s50, 7078016
    buffer_load_dwordx4 v24, s[12:15], s32 offen nt lds
    s_add_u32 m0, s54, 86016
    s_add_u32 s32, s50, 7471232
    buffer_load_dwordx4 v24, s[12:15], s32 offen nt lds
    s_add_u32 m0, s54, 90112
    s_add_u32 s32, s50, 7078144
    buffer_load_dwordx4 v24, s[12:15], s32 offen nt lds
    s_add_u32 m0, s54, 94208
    s_add_u32 s32, s50, 7471360
    buffer_load_dwordx4 v24, s[12:15], s32 offen nt lds
    v_add_u32 v10, 0x18000, v6
    ds_read_b64_tr_b16 a[0:1], v10 offset:0
    ds_read_b64_tr_b16 a[2:3], v10 offset:2048
    ds_read_b64_tr_b16 a[4:5], v10 offset:4096
    ds_read_b64_tr_b16 a[6:7], v10 offset:6144
    ds_read_b64_tr_b16 a[8:9], v10 offset:8192
    ds_read_b64_tr_b16 a[10:11], v10 offset:10240
    ds_read_b64_tr_b16 a[12:13], v10 offset:12288
    ds_read_b64_tr_b16 a[14:15], v10 offset:14336
    ds_read_b64_tr_b16 a[16:17], v10 offset:16384
    ds_read_b64_tr_b16 a[18:19], v10 offset:18432
    ds_read_b64_tr_b16 a[20:21], v10 offset:20480
    ds_read_b64_tr_b16 a[22:23], v10 offset:22528
    s_waitcnt lgkmcnt(4)
    s_waitcnt lgkmcnt(0)
    s_waitcnt vmcnt(24)
    s_barrier
    v_add_u32 v9, 0x18000, v6
    ds_read_b64_tr_b16 a[96:97], v9 offset:24576
    ds_read_b64_tr_b16 a[98:99], v9 offset:26624
    ds_read_b64_tr_b16 a[100:101], v9 offset:28672
    ds_read_b64_tr_b16 a[102:103], v9 offset:30720
    v_add_u32 v10, 0x20000, v6
    ds_read_b64_tr_b16 a[104:105], v10 offset:0
    ds_read_b64_tr_b16 a[106:107], v10 offset:2048
    ds_read_b64_tr_b16 a[108:109], v10 offset:4096
    ds_read_b64_tr_b16 a[110:111], v10 offset:6144
    ds_read_b64_tr_b16 a[112:113], v10 offset:8192
    ds_read_b64_tr_b16 a[114:115], v10 offset:10240
    ds_read_b64_tr_b16 a[116:117], v10 offset:12288
    ds_read_b64_tr_b16 a[118:119], v10 offset:14336
    s_waitcnt lgkmcnt(4)
    s_waitcnt lgkmcnt(0)
    s_waitcnt vmcnt(18)
    s_barrier
    s_add_u32 m0, s54, 98304
    s_add_u32 s32, s51, 0
    buffer_load_dwordx4 v25, s[20:23], s32 offen nt lds
    s_add_u32 m0, s54, 102400
    s_add_u32 s32, s51, 128
    buffer_load_dwordx4 v25, s[20:23], s32 offen nt lds
    s_add_u32 m0, s54, 106496
    s_add_u32 s32, s51, 256
    buffer_load_dwordx4 v25, s[20:23], s32 offen nt lds
    s_add_u32 m0, s54, 110592
    s_add_u32 s32, s51, 384
    buffer_load_dwordx4 v25, s[20:23], s32 offen nt lds
    s_add_u32 m0, s54, 114688
    s_add_u32 s32, s51, 512
    buffer_load_dwordx4 v25, s[20:23], s32 offen nt lds
    s_add_u32 m0, s54, 118784
    s_add_u32 s32, s51, 640
    buffer_load_dwordx4 v25, s[20:23], s32 offen nt lds
    s_add_u32 m0, s54, 122880
    s_add_u32 s32, s51, 768
    buffer_load_dwordx4 v25, s[20:23], s32 offen nt lds
    s_add_u32 m0, s54, 126976
    s_add_u32 s32, s51, 896
    buffer_load_dwordx4 v25, s[20:23], s32 offen nt lds
    s_add_u32 m0, s54, 131072
    s_add_u32 s32, s51, 1024
    buffer_load_dwordx4 v25, s[20:23], s32 offen nt lds
    s_add_u32 m0, s54, 135168
    s_add_u32 s32, s51, 1152
    buffer_load_dwordx4 v25, s[20:23], s32 offen nt lds
    ds_read_b64_tr_b16 a[168:169], v6 offset:0
    ds_read_b64_tr_b16 a[170:171], v6 offset:2048
    ds_read_b64_tr_b16 a[172:173], v6 offset:4096
    ds_read_b64_tr_b16 a[174:175], v6 offset:6144
    ds_read_b64_tr_b16 a[176:177], v6 offset:8192
    ds_read_b64_tr_b16 a[178:179], v6 offset:10240
    ds_read_b64_tr_b16 a[180:181], v6 offset:12288
    ds_read_b64_tr_b16 a[182:183], v6 offset:14336
    ds_read_b64_tr_b16 a[184:185], v6 offset:16384
    ds_read_b64_tr_b16 a[186:187], v6 offset:18432
    ds_read_b64_tr_b16 a[188:189], v6 offset:20480
    ds_read_b64_tr_b16 a[190:191], v6 offset:22528
    s_waitcnt lgkmcnt(4)
    s_waitcnt lgkmcnt(0)
    s_waitcnt vmcnt(22)
    s_barrier
    ds_read_b64_tr_b16 v[52:53], v6 offset:24576
    ds_read_b64_tr_b16 v[54:55], v6 offset:26624
    ds_read_b64_tr_b16 v[56:57], v6 offset:28672
    ds_read_b64_tr_b16 v[58:59], v6 offset:30720
    ds_read_b64_tr_b16 v[60:61], v6 offset:32768
    ds_read_b64_tr_b16 v[62:63], v6 offset:34816
    ds_read_b64_tr_b16 v[64:65], v6 offset:36864
    ds_read_b64_tr_b16 v[66:67], v6 offset:38912
    ds_read_b64_tr_b16 v[68:69], v6 offset:40960
    ds_read_b64_tr_b16 v[70:71], v6 offset:43008
    ds_read_b64_tr_b16 v[72:73], v6 offset:45056
    ds_read_b64_tr_b16 v[74:75], v6 offset:47104
    s_waitcnt lgkmcnt(4)
    s_waitcnt lgkmcnt(0)
    s_waitcnt vmcnt(16)
    s_barrier
    s_add_u32 m0, s54, 0
    s_add_u32 s32, s51, 40960
    buffer_load_dwordx4 v25, s[20:23], s32 offen nt lds
    s_add_u32 m0, s54, 4096
    s_add_u32 s32, s51, 41088
    buffer_load_dwordx4 v25, s[20:23], s32 offen nt lds
    s_add_u32 m0, s54, 8192
    s_add_u32 s32, s51, 41216
    buffer_load_dwordx4 v25, s[20:23], s32 offen nt lds
    s_add_u32 m0, s54, 12288
    s_add_u32 s32, s51, 41344
    buffer_load_dwordx4 v25, s[20:23], s32 offen nt lds
    s_add_u32 m0, s54, 16384
    s_add_u32 s32, s51, 41472
    buffer_load_dwordx4 v25, s[20:23], s32 offen nt lds
    s_add_u32 m0, s54, 20480
    s_add_u32 s32, s51, 41600
    buffer_load_dwordx4 v25, s[20:23], s32 offen nt lds
    s_add_u32 m0, s54, 24576
    s_add_u32 s32, s51, 41728
    buffer_load_dwordx4 v25, s[20:23], s32 offen nt lds
    s_add_u32 m0, s54, 28672
    s_add_u32 s32, s51, 41856
    buffer_load_dwordx4 v25, s[20:23], s32 offen nt lds
    s_add_u32 m0, s54, 32768
    s_add_u32 s32, s51, 41984
    buffer_load_dwordx4 v25, s[20:23], s32 offen nt lds
    s_add_u32 m0, s54, 36864
    s_add_u32 s32, s51, 42112
    buffer_load_dwordx4 v25, s[20:23], s32 offen nt lds
    ds_read_b64_tr_b16 a[24:25], v6 offset:49152
    ds_read_b64_tr_b16 a[26:27], v6 offset:51200
    ds_read_b64_tr_b16 a[28:29], v6 offset:53248
    ds_read_b64_tr_b16 a[30:31], v6 offset:55296
    ds_read_b64_tr_b16 a[32:33], v6 offset:57344
    ds_read_b64_tr_b16 a[34:35], v6 offset:59392
    ds_read_b64_tr_b16 a[36:37], v6 offset:61440
    ds_read_b64_tr_b16 a[38:39], v6 offset:63488
    v_add_u32 v9, 0x10000, v6
    ds_read_b64_tr_b16 a[40:41], v9 offset:0
    ds_read_b64_tr_b16 a[42:43], v9 offset:2048
    ds_read_b64_tr_b16 a[44:45], v9 offset:4096
    ds_read_b64_tr_b16 a[46:47], v9 offset:6144
    s_waitcnt lgkmcnt(4)
    s_waitcnt lgkmcnt(0)
    s_waitcnt vmcnt(20)
    s_barrier
    v_add_u32 v10, 0x10000, v6
    ds_read_b64_tr_b16 a[144:145], v10 offset:8192
    ds_read_b64_tr_b16 a[146:147], v10 offset:10240
    ds_read_b64_tr_b16 a[148:149], v10 offset:12288
    ds_read_b64_tr_b16 a[150:151], v10 offset:14336
    ds_read_b64_tr_b16 a[152:153], v10 offset:16384
    ds_read_b64_tr_b16 a[154:155], v10 offset:18432
    ds_read_b64_tr_b16 a[156:157], v10 offset:20480
    ds_read_b64_tr_b16 a[158:159], v10 offset:22528
    ds_read_b64_tr_b16 a[160:161], v10 offset:24576
    ds_read_b64_tr_b16 a[162:163], v10 offset:26624
    ds_read_b64_tr_b16 a[164:165], v10 offset:28672
    ds_read_b64_tr_b16 a[166:167], v10 offset:30720
    s_waitcnt lgkmcnt(4)
    s_waitcnt lgkmcnt(0)
    s_waitcnt vmcnt(10)
    s_barrier
    s_add_u32 m0, s54, 40960
    s_add_u32 s32, s51, 81920
    buffer_load_dwordx4 v25, s[20:23], s32 offen nt lds
    s_add_u32 m0, s54, 45056
    s_add_u32 s32, s51, 82048
    buffer_load_dwordx4 v25, s[20:23], s32 offen nt lds
    s_add_u32 m0, s54, 49152
    s_add_u32 s32, s51, 82176
    buffer_load_dwordx4 v25, s[20:23], s32 offen nt lds
    s_add_u32 m0, s54, 53248
    s_add_u32 s32, s51, 82304
    buffer_load_dwordx4 v25, s[20:23], s32 offen nt lds
    s_add_u32 m0, s54, 57344
    s_add_u32 s32, s51, 82432
    buffer_load_dwordx4 v25, s[20:23], s32 offen nt lds
    s_add_u32 m0, s54, 61440
    s_add_u32 s32, s51, 82560
    buffer_load_dwordx4 v25, s[20:23], s32 offen nt lds
    s_add_u32 m0, s54, 65536
    s_add_u32 s32, s51, 82688
    buffer_load_dwordx4 v25, s[20:23], s32 offen nt lds
    s_add_u32 m0, s54, 69632
    s_add_u32 s32, s51, 82816
    buffer_load_dwordx4 v25, s[20:23], s32 offen nt lds
    s_add_u32 m0, s54, 73728
    s_add_u32 s32, s51, 82944
    buffer_load_dwordx4 v25, s[20:23], s32 offen nt lds
    s_add_u32 m0, s54, 77824
    s_add_u32 s32, s51, 83072
    buffer_load_dwordx4 v25, s[20:23], s32 offen nt lds
    v_add_u32 v9, 0x18000, v20
    ds_read_b64_tr_b16 a[192:193], v9 offset:0
    v_add_u32 v10, 0x18000, v21
    ds_read_b64_tr_b16 a[194:195], v10 offset:0
    ds_read_b64_tr_b16 a[196:197], v9 offset:1024
    ds_read_b64_tr_b16 a[198:199], v10 offset:1024
    v_add_u32 v9, 0x18000, v22
    ds_read_b64_tr_b16 a[200:201], v9 offset:0
    v_add_u32 v10, 0x18000, v23
    ds_read_b64_tr_b16 a[202:203], v10 offset:0
    ds_read_b64_tr_b16 a[204:205], v9 offset:1024
    ds_read_b64_tr_b16 a[206:207], v10 offset:1024
    v_add_u32 v9, 0x18000, v20
    ds_read_b64_tr_b16 a[208:209], v9 offset:4096
    v_add_u32 v10, 0x18000, v21
    ds_read_b64_tr_b16 a[210:211], v10 offset:4096
    ds_read_b64_tr_b16 a[212:213], v9 offset:5120
    ds_read_b64_tr_b16 a[214:215], v10 offset:5120
    s_waitcnt lgkmcnt(4)
    v_add_u32 v9, 0x18000, v22
    ds_read_b64_tr_b16 a[216:217], v9 offset:4096
    v_add_u32 v10, 0x18000, v23
    ds_read_b64_tr_b16 a[218:219], v10 offset:4096
    ds_read_b64_tr_b16 a[220:221], v9 offset:5120
    ds_read_b64_tr_b16 a[222:223], v10 offset:5120
    v_add_u32 v9, 0x18000, v20
    ds_read_b64_tr_b16 a[224:225], v9 offset:8192
    v_add_u32 v10, 0x18000, v21
    ds_read_b64_tr_b16 a[226:227], v10 offset:8192
    ds_read_b64_tr_b16 a[228:229], v9 offset:9216
    ds_read_b64_tr_b16 a[230:231], v10 offset:9216
    s_waitcnt lgkmcnt(4)
    s_waitcnt lgkmcnt(0)
    s_waitcnt vmcnt(10)
    s_barrier
    s_add_u32 m0, s54, 81920
    s_add_u32 s32, s51, 122880
    buffer_load_dwordx4 v25, s[20:23], s32 offen nt lds
    s_add_u32 m0, s54, 86016
    s_add_u32 s32, s51, 123008
    buffer_load_dwordx4 v25, s[20:23], s32 offen nt lds
    s_add_u32 m0, s54, 90112
    s_add_u32 s32, s51, 123136
    buffer_load_dwordx4 v25, s[20:23], s32 offen nt lds
    s_add_u32 m0, s54, 94208
    s_add_u32 s32, s51, 123264
    buffer_load_dwordx4 v25, s[20:23], s32 offen nt lds
    s_add_u32 m0, s54, 98304
    s_add_u32 s32, s51, 123392
    buffer_load_dwordx4 v25, s[20:23], s32 offen nt lds
    s_add_u32 m0, s54, 102400
    s_add_u32 s32, s51, 123520
    buffer_load_dwordx4 v25, s[20:23], s32 offen nt lds
    s_add_u32 m0, s54, 106496
    s_add_u32 s32, s51, 123648
    buffer_load_dwordx4 v25, s[20:23], s32 offen nt lds
    s_add_u32 m0, s54, 110592
    s_add_u32 s32, s51, 123776
    buffer_load_dwordx4 v25, s[20:23], s32 offen nt lds
    s_add_u32 m0, s54, 114688
    s_add_u32 s32, s51, 123904
    buffer_load_dwordx4 v25, s[20:23], s32 offen nt lds
    s_add_u32 m0, s54, 118784
    s_add_u32 s32, s51, 124032
    buffer_load_dwordx4 v25, s[20:23], s32 offen nt lds
    s_add_u32 m0, s54, 122880
    s_add_u32 s32, s51, 163840
    buffer_load_dwordx4 v25, s[20:23], s32 offen nt lds
    s_add_u32 m0, s54, 126976
    s_add_u32 s32, s51, 163968
    buffer_load_dwordx4 v25, s[20:23], s32 offen nt lds
    s_add_u32 m0, s54, 131072
    s_add_u32 s32, s51, 164096
    buffer_load_dwordx4 v25, s[20:23], s32 offen nt lds
    s_add_u32 m0, s54, 135168
    s_add_u32 s32, s51, 164224
    buffer_load_dwordx4 v25, s[20:23], s32 offen nt lds
    s_add_u32 m0, s54, 139264
    s_add_u32 s32, s51, 164352
    buffer_load_dwordx4 v25, s[20:23], s32 offen nt lds
    s_add_u32 m0, s54, 143360
    s_add_u32 s32, s51, 164480
    buffer_load_dwordx4 v25, s[20:23], s32 offen nt lds
    s_add_u32 m0, s54, 147456
    s_add_u32 s32, s51, 164608
    buffer_load_dwordx4 v25, s[20:23], s32 offen nt lds
    s_add_u32 m0, s54, 151552
    s_add_u32 s32, s51, 164736
    buffer_load_dwordx4 v25, s[20:23], s32 offen nt lds
    s_add_u32 m0, s54, 155648
    s_add_u32 s32, s51, 164864
    buffer_load_dwordx4 v25, s[20:23], s32 offen nt lds
    s_add_u32 m0, s54, 159744
    s_add_u32 s32, s51, 164992
    buffer_load_dwordx4 v25, s[20:23], s32 offen nt lds
    ds_read_b64_tr_b16 a[232:233], v20 offset:0
    ds_read_b64_tr_b16 a[234:235], v21 offset:0
    ds_read_b64_tr_b16 a[236:237], v20 offset:1024
    ds_read_b64_tr_b16 a[238:239], v21 offset:1024
    ds_read_b64_tr_b16 a[240:241], v22 offset:0
    ds_read_b64_tr_b16 a[242:243], v23 offset:0
    ds_read_b64_tr_b16 a[244:245], v22 offset:1024
    ds_read_b64_tr_b16 a[246:247], v23 offset:1024
    ds_read_b64_tr_b16 a[248:249], v20 offset:4096
    ds_read_b64_tr_b16 a[250:251], v21 offset:4096
    ds_read_b64_tr_b16 a[252:253], v20 offset:5120
    ds_read_b64_tr_b16 a[254:255], v21 offset:5120
    s_waitcnt lgkmcnt(4)
    ds_read_b64_tr_b16 v[160:161], v22 offset:4096
    ds_read_b64_tr_b16 v[162:163], v23 offset:4096
    ds_read_b64_tr_b16 v[164:165], v22 offset:5120
    ds_read_b64_tr_b16 v[166:167], v23 offset:5120
    ds_read_b64_tr_b16 v[168:169], v20 offset:8192
    ds_read_b64_tr_b16 v[170:171], v21 offset:8192
    ds_read_b64_tr_b16 v[172:173], v20 offset:9216
    ds_read_b64_tr_b16 v[174:175], v21 offset:9216
    s_waitcnt lgkmcnt(4)
    s_waitcnt lgkmcnt(0)
    s_waitcnt vmcnt(20)
    s_barrier
    s_add_u32 m0, s54, 0
    s_add_u32 s32, s51, 204800
    buffer_load_dwordx4 v25, s[20:23], s32 offen nt lds
    s_add_u32 m0, s54, 4096
    s_add_u32 s32, s51, 204928
    buffer_load_dwordx4 v25, s[20:23], s32 offen nt lds
    s_add_u32 m0, s54, 8192
    s_add_u32 s32, s51, 205056
    buffer_load_dwordx4 v25, s[20:23], s32 offen nt lds
    s_add_u32 m0, s54, 12288
    s_add_u32 s32, s51, 205184
    buffer_load_dwordx4 v25, s[20:23], s32 offen nt lds
    s_add_u32 m0, s54, 16384
    s_add_u32 s32, s51, 205312
    buffer_load_dwordx4 v25, s[20:23], s32 offen nt lds
    s_add_u32 m0, s54, 20480
    s_add_u32 s32, s51, 205440
    buffer_load_dwordx4 v25, s[20:23], s32 offen nt lds
    s_add_u32 m0, s54, 24576
    s_add_u32 s32, s51, 205568
    buffer_load_dwordx4 v25, s[20:23], s32 offen nt lds
    s_add_u32 m0, s54, 28672
    s_add_u32 s32, s51, 205696
    buffer_load_dwordx4 v25, s[20:23], s32 offen nt lds
    s_add_u32 m0, s54, 32768
    s_add_u32 s32, s51, 205824
    buffer_load_dwordx4 v25, s[20:23], s32 offen nt lds
    s_add_u32 m0, s54, 36864
    s_add_u32 s32, s51, 205952
    buffer_load_dwordx4 v25, s[20:23], s32 offen nt lds
    s_mov_b32 s28, s88
    s_and_b32 s29, s89, 0xffff
    s_mov_b32 s30, 0x100
    s_mov_b32 s31, 0x20000
    v_mov_b32 v2, 0
    buffer_load_dword v3, v2, s[28:31], 0 offen offset:60 sc1
    ds_read_b64_tr_b16 v[176:177], v20 offset:40960
    ds_read_b64_tr_b16 v[178:179], v21 offset:40960
    ds_read_b64_tr_b16 v[180:181], v20 offset:41984
    ds_read_b64_tr_b16 v[182:183], v21 offset:41984
    ds_read_b64_tr_b16 v[184:185], v22 offset:40960
    ds_read_b64_tr_b16 v[186:187], v23 offset:40960
    ds_read_b64_tr_b16 v[188:189], v22 offset:41984
    ds_read_b64_tr_b16 v[190:191], v23 offset:41984
    ds_read_b64_tr_b16 v[192:193], v20 offset:45056
    ds_read_b64_tr_b16 v[194:195], v21 offset:45056
    ds_read_b64_tr_b16 v[196:197], v20 offset:46080
    ds_read_b64_tr_b16 v[198:199], v21 offset:46080
    s_waitcnt lgkmcnt(4)
    ds_read_b64_tr_b16 v[200:201], v22 offset:45056
    ds_read_b64_tr_b16 v[202:203], v23 offset:45056
    ds_read_b64_tr_b16 v[204:205], v22 offset:46080
    ds_read_b64_tr_b16 v[206:207], v23 offset:46080
    ds_read_b64_tr_b16 v[208:209], v20 offset:49152
    ds_read_b64_tr_b16 v[210:211], v21 offset:49152
    ds_read_b64_tr_b16 v[212:213], v20 offset:50176
    ds_read_b64_tr_b16 v[214:215], v21 offset:50176
    s_waitcnt lgkmcnt(4)
    s_waitcnt lgkmcnt(0)
    s_waitcnt vmcnt(21)
    s_barrier
    v_add_u32 v9, 0x10000, v20
    ds_read_b64_tr_b16 v[76:77], v9 offset:16384
    v_add_u32 v10, 0x10000, v21
    ds_read_b64_tr_b16 v[78:79], v10 offset:16384
    ds_read_b64_tr_b16 v[80:81], v9 offset:17408
    ds_read_b64_tr_b16 v[82:83], v10 offset:17408
    v_add_u32 v9, 0x10000, v22
    ds_read_b64_tr_b16 v[84:85], v9 offset:16384
    v_add_u32 v10, 0x10000, v23
    ds_read_b64_tr_b16 v[86:87], v10 offset:16384
    ds_read_b64_tr_b16 v[88:89], v9 offset:17408
    ds_read_b64_tr_b16 v[90:91], v10 offset:17408
    v_add_u32 v9, 0x10000, v20
    ds_read_b64_tr_b16 v[92:93], v9 offset:20480
    v_add_u32 v10, 0x10000, v21
    ds_read_b64_tr_b16 v[94:95], v10 offset:20480
    ds_read_b64_tr_b16 v[96:97], v9 offset:21504
    ds_read_b64_tr_b16 v[98:99], v10 offset:21504
    s_waitcnt lgkmcnt(4)
    v_add_u32 v9, 0x10000, v22
    ds_read_b64_tr_b16 v[100:101], v9 offset:20480
    v_add_u32 v10, 0x10000, v23
    ds_read_b64_tr_b16 v[102:103], v10 offset:20480
    ds_read_b64_tr_b16 v[104:105], v9 offset:21504
    ds_read_b64_tr_b16 v[106:107], v10 offset:21504
    v_add_u32 v9, 0x10000, v20
    ds_read_b64_tr_b16 v[108:109], v9 offset:24576
    v_add_u32 v10, 0x10000, v21
    ds_read_b64_tr_b16 v[110:111], v10 offset:24576
    ds_read_b64_tr_b16 v[112:113], v9 offset:25600
    ds_read_b64_tr_b16 v[114:115], v10 offset:25600
    s_waitcnt lgkmcnt(4)
    s_waitcnt lgkmcnt(0)
    s_waitcnt vmcnt(11)
    s_barrier
    v_add_u32 v9, 0x18000, v20
    ds_read_b64_tr_b16 v[216:217], v9 offset:24576
    v_add_u32 v10, 0x18000, v21
    ds_read_b64_tr_b16 v[218:219], v10 offset:24576
    ds_read_b64_tr_b16 v[220:221], v9 offset:25600
    ds_read_b64_tr_b16 v[222:223], v10 offset:25600
    v_add_u32 v9, 0x18000, v22
    ds_read_b64_tr_b16 v[224:225], v9 offset:24576
    v_add_u32 v10, 0x18000, v23
    ds_read_b64_tr_b16 v[226:227], v10 offset:24576
    ds_read_b64_tr_b16 v[228:229], v9 offset:25600
    ds_read_b64_tr_b16 v[230:231], v10 offset:25600
    v_add_u32 v9, 0x18000, v20
    ds_read_b64_tr_b16 v[232:233], v9 offset:28672
    v_add_u32 v10, 0x18000, v21
    ds_read_b64_tr_b16 v[234:235], v10 offset:28672
    ds_read_b64_tr_b16 v[236:237], v9 offset:29696
    ds_read_b64_tr_b16 v[238:239], v10 offset:29696
    s_waitcnt lgkmcnt(4)
    v_add_u32 v9, 0x18000, v22
    ds_read_b64_tr_b16 v[240:241], v9 offset:28672
    v_add_u32 v10, 0x18000, v23
    ds_read_b64_tr_b16 v[242:243], v10 offset:28672
    ds_read_b64_tr_b16 v[244:245], v9 offset:29696
    ds_read_b64_tr_b16 v[246:247], v10 offset:29696
    v_add_u32 v9, 0x20000, v20
    ds_read_b64_tr_b16 v[248:249], v9 offset:0
    v_add_u32 v10, 0x20000, v21
    ds_read_b64_tr_b16 v[250:251], v10 offset:0
    ds_read_b64_tr_b16 v[252:253], v9 offset:1024
    ds_read_b64_tr_b16 v[254:255], v10 offset:1024
    s_waitcnt lgkmcnt(4)
    s_waitcnt lgkmcnt(0)
    s_waitcnt vmcnt(1)
    s_barrier
    ds_read_b64_tr_b16 v[116:117], v20 offset:0
    ds_read_b64_tr_b16 v[118:119], v21 offset:0
    ds_read_b64_tr_b16 v[120:121], v20 offset:1024
    ds_read_b64_tr_b16 v[122:123], v21 offset:1024
    ds_read_b64_tr_b16 v[124:125], v22 offset:0
    ds_read_b64_tr_b16 v[126:127], v23 offset:0
    ds_read_b64_tr_b16 v[128:129], v22 offset:1024
    ds_read_b64_tr_b16 v[130:131], v23 offset:1024
    ds_read_b64_tr_b16 v[132:133], v20 offset:4096
    ds_read_b64_tr_b16 v[134:135], v21 offset:4096
    ds_read_b64_tr_b16 v[136:137], v20 offset:5120
    ds_read_b64_tr_b16 v[138:139], v21 offset:5120
    s_waitcnt lgkmcnt(4)
    ds_read_b64_tr_b16 v[140:141], v22 offset:4096
    ds_read_b64_tr_b16 v[142:143], v23 offset:4096
    ds_read_b64_tr_b16 v[144:145], v22 offset:5120
    ds_read_b64_tr_b16 v[146:147], v23 offset:5120
    ds_read_b64_tr_b16 v[148:149], v20 offset:8192
    ds_read_b64_tr_b16 v[150:151], v21 offset:8192
    ds_read_b64_tr_b16 v[152:153], v20 offset:9216
    ds_read_b64_tr_b16 v[154:155], v21 offset:9216
    s_waitcnt lgkmcnt(4)
    s_waitcnt lgkmcnt(0)
    s_barrier
V_ld_wx:
    ds_write_b128 v7, v[28:31] offset:0
    ds_write_b128 v7, v[32:35] offset:1024
    ds_write_b128 v7, v[36:39] offset:2048
    ds_write_b128 v7, v[40:43] offset:3072
    ds_write_b128 v7, v[44:47] offset:4096
    ds_write_b128 v7, v[48:51] offset:5120
    ds_write_b128 v7, v[52:55] offset:6144
    ds_write_b128 v7, v[56:59] offset:7168
    ds_write_b128 v7, v[60:63] offset:8192
    ds_write_b128 v7, v[64:67] offset:9216
    ds_write_b128 v7, v[68:71] offset:10240
    ds_write_b128 v7, v[72:75] offset:11264
    s_waitcnt lgkmcnt(4)
    ds_write_b128 v7, v[76:79] offset:12288
    ds_write_b128 v7, v[80:83] offset:13312
    ds_write_b128 v7, v[84:87] offset:14336
    ds_write_b128 v7, v[88:91] offset:15360
    ds_write_b128 v7, v[92:95] offset:16384
    ds_write_b128 v7, v[96:99] offset:17408
    ds_write_b128 v7, v[100:103] offset:18432
    ds_write_b128 v7, v[104:107] offset:19456
    s_waitcnt lgkmcnt(4)
    ds_write_b128 v7, v[108:111] offset:20480
    ds_write_b128 v7, v[112:115] offset:21504
    ds_write_b128 v7, v[116:119] offset:22528
    ds_write_b128 v7, v[120:123] offset:23552
    ds_write_b128 v7, v[124:127] offset:24576
    ds_write_b128 v7, v[128:131] offset:25600
    ds_write_b128 v7, v[132:135] offset:26624
    ds_write_b128 v7, v[136:139] offset:27648
    s_waitcnt lgkmcnt(4)
    ds_write_b128 v7, v[140:143] offset:28672
    ds_write_b128 v7, v[144:147] offset:29696
    ds_write_b128 v7, v[148:151] offset:30720
    ds_write_b128 v7, v[152:155] offset:31744
    s_waitcnt lgkmcnt(0)
    s_mov_b32 s52, 1048576
    s_branch prepw_ck_117
prepw_115:
    buffer_load_dword v3, v2, s[28:31], 0 offen offset:60 sc1
prepw_ck_117:
    s_waitcnt vmcnt(0)
    v_readfirstlane_b32 s32, v3
    s_nop 1
    s_and_b32 s33, s32, 255
    s_cmp_ge_u32 s33, 56
    s_cbranch_scc1 prepw_ok_116
    s_cmp_eq_u32 s52, 0
    s_cbranch_scc1 prepw_ok_116
    s_sub_u32 s52, s52, 1
    s_sleep 4
    s_branch prepw_115
prepw_ok_116:
    s_bfe_u32 s33, s32, 0x80008
    s_bfe_u32 s34, s32, 0x80018
    s_add_u32 s33, s33, s34
    s_bfe_u32 s34, s32, 0x80010
    s_sub_u32 s33, s33, s34
    s_cmp_ge_i32 s33, 28
    s_cselect_b32 s96, 0, 8192
    s_mov_b32 s98, s96
    s_xor_b32 s97, s96, 8192
    s_add_u32 s99, s96, 0xa20d000
    v_lshlrev_b32 v13, 4, v0
    v_lshlrev_b32 v12, 4, v1
    v_and_b32 v2, 8, v1
    v_mov_b32 v3, 0x4444
    v_mov_b32 v4, 0xeeee
    v_cmp_eq_u32 vcc, 0, v2
    s_nop 1
    v_cndmask_b32 v11, v4, v3, vcc
    v_lshrrev_b32 v2, 4, v1
    v_and_b32 v3, 15, v1
    v_lshrrev_b32 v4, 1, v2
    v_lshlrev_b32 v4, 10, v4
    v_lshl_add_u32 v4, v3, 4, v4
    v_and_b32 v5, 1, v2
    v_lshl_add_u32 v4, v5, 3, v4
    s_lshl_b32 s32, s4, 8
    v_add_u32 v15, s32, v4
    v_bfe_u32 v5, v1, 2, 2
    v_lshlrev_b32 v4, 4, v5
    v_and_b32 v5, 1, v1
    v_lshl_add_u32 v4, v5, 3, v4
    v_lshl_add_u32 v16, v2, 7, v4
    s_mul_i32 s32, s4, 163840
    v_and_b32 v4, 1, v2
    v_lshlrev_b32 v4, 15, v4
    v_lshrrev_b32 v5, 1, v2
    v_lshl_add_u32 v4, v5, 14, v4
    v_lshl_add_u32 v4, v3, 4, v4
    v_add_u32 v17, s32, v4
    v_mov_b32 v5, 0x40000000
    v_and_b32 v4, 1, v2
    v_cmp_eq_u32 vcc, 0, v4
    s_nop 1
    v_cndmask_b32 v18, v5, v17, vcc
    v_mov_b32 v6, -1
    v_min_u32 v8, 3, v1
    v_lshlrev_b32 v8, 7, v8
    s_mul_i32 s32, s4, 3072
    v_lshl_add_u32 v4, v1, 6, s32
    v_cmp_gt_u32 vcc, 48, v1
    s_nop 1
    v_cndmask_b32 v9, v5, v4, vcc
    s_mov_b32 s48, 0
    s_mov_b32 s52, 4194304
    s_mov_b32 s28, 1
    s_mov_b32 s29, 1
V_loop:
    ds_read_b128 v[120:123], v7 offset:0
    ds_read_b128 v[124:127], v7 offset:1024
    ds_read_b128 v[128:131], v7 offset:6144
    ds_read_b128 v[132:135], v7 offset:7168
    ds_read_b128 v[136:139], v7 offset:2048
    ds_read_b128 v[140:143], v7 offset:3072
    ds_read_b128 v[144:147], v7 offset:12288
    ds_read_b128 v[148:151], v7 offset:13312
    ds_read_b128 v[152:155], v7 offset:22528
    ds_read_b128 v[156:159], v7 offset:23552
    v_mov_b32 v104, 0
    v_mov_b32 v105, 0
    v_mov_b32 v106, 0
    v_mov_b32 v107, 0
    v_mov_b32 v108, 0
    v_mov_b32 v109, 0
    v_mov_b32 v110, 0
    v_mov_b32 v111, 0
    v_mov_b32 v112, 0
    v_mov_b32 v113, 0
    v_mov_b32 v114, 0
    v_mov_b32 v115, 0
    v_mov_b32 v116, 0
    v_mov_b32 v117, 0
    v_mov_b32 v118, 0
    v_mov_b32 v119, 0
    v_mov_b32 v20, 0
    v_mov_b32 v21, 0
    v_mov_b32 v22, 0
    v_mov_b32 v23, 0
    v_mov_b32 v24, 0
    v_mov_b32 v25, 0
    v_mov_b32 v26, 0
    v_mov_b32 v27, 0
    v_mov_b32 v28, 0
    v_mov_b32 v29, 0
    v_mov_b32 v30, 0
    v_mov_b32 v31, 0
    v_mov_b32 v32, 0
    v_mov_b32 v33, 0
    v_mov_b32 v34, 0
    v_mov_b32 v35, 0
    v_mov_b32 v36, 0
    v_mov_b32 v37, 0
    v_mov_b32 v38, 0
    v_mov_b32 v39, 0
    v_xor_b32 v60, 1024, v13
    v_xor_b32 v61, 2048, v13
    v_xor_b32 v62, 3072, v13
    s_mul_hi_u32 s47, s48, 0x55555556
    s_mul_i32 s55, s48, 655360
    s_mul_i32 s46, s47, 131072
    s_add_u32 s55, s55, s46
    s_andn2_b32 s47, 1, s47
    s_lshl_b32 s47, s47, 13
    s_xor_b32 s47, s47, s96
    s_add_u32 s55, s55, s47
    s_add_u32 s55, s55, 0xb000000
    s_lshl_b32 s32, s6, 8
    s_add_u32 s55, s55, s32
    s_add_u32 s56, s55, 65536
    s_add_u32 s57, s55, 131072
    s_add_u32 s32, s48, 2
    s_min_u32 s32, s32, 63
    s_mul_i32 s50, s32, 393216
    s_mul_i32 s32, s6, 12288
    s_add_u32 s50, s50, s32
    s_add_u32 s51, s50, 0x400000
    s_add_u32 s50, s50, 0x1c00000
    s_lshl_b32 s32, s48, 15
    s_add_u32 s32, s32, s96
    s_add_u32 s32, s32, 0xa200000
    s_add_u32 s33, s32, 4096
    s_add_u32 s34, s32, 16384
    s_mov_b32 s63, s48
    s_andn2_b32 s47, 1, s63
    s_lshl_b32 s47, s47, 9
    s_add_u32 s47, s47, s99
    buffer_load_dword v6, v8, s[8:11], s47 offen offset:4 sc1
    s_waitcnt vmcnt(0) lgkmcnt(0)
    s_cmp_lg_u32 s48, 1
    s_cbranch_scc1 V1_nr
    v_min_u32 v4, 19, v1
    v_lshlrev_b32 v4, 7, v4
    s_add_u32 s40, s99, 63488
    s_mov_b32 s41, 0
V1_poll_118:
    buffer_load_dword v2, v4, s[8:11], s40 offen sc1
    s_waitcnt vmcnt(0)
    v_cmp_gt_i32 vcc, s41, v2
    s_cbranch_vccz V1_ok_119
    s_cmp_eq_u32 s52, 0
    s_cbranch_scc1 V1_ok_119
    s_sub_u32 s52, s52, 1
    s_sleep 1
    s_branch V1_poll_118
V1_ok_119:
    s_memrealtime s[44:45]
    s_waitcnt lgkmcnt(0)
    s_lshl_b32 s44, s44, 7
    s_mov_b32 s62, s44
    s_branch V_go
V1_nr:
    s_andn2_b32 s47, 1, s63
    s_lshl_b32 s47, s47, 9
    s_add_u32 s47, s47, s99
    s_memrealtime s[44:45]
    s_waitcnt lgkmcnt(0)
    s_lshl_b32 s44, s44, 7
    s_cmp_eq_u32 s63, 0
    s_cbranch_scc1 door_lt_124
    s_branch door_ck_122
door_ag_123:
    s_cmp_eq_u32 s52, 0
    s_cbranch_scc1 door_lt_124
    s_sub_u32 s52, s52, 1
    buffer_load_dword v6, v8, s[8:11], s47 offen offset:4 sc1
    s_sleep 4
door_ck_122:
    s_memrealtime s[44:45]
    v_readlane_b32 s62, v6, 0
    v_readlane_b32 s41, v6, 1
    v_readlane_b32 s42, v6, 2
    v_readlane_b32 s43, v6, 3
    s_sub_u32 s40, s41, s62
    s_and_b32 s40, s40, 0x8000007f
    s_cmp_eq_u32 s40, 0
    s_cmov_b32 s62, s41
    s_sub_u32 s40, s42, s62
    s_and_b32 s40, s40, 0x8000007f
    s_cmp_eq_u32 s40, 0
    s_cmov_b32 s62, s42
    s_sub_u32 s40, s43, s62
    s_and_b32 s40, s40, 0x8000007f
    s_cmp_eq_u32 s40, 0
    s_cmov_b32 s62, s43
    s_add_u32 s46, s62, 1
    s_and_b32 s46, s46, 127
    s_add_u32 s62, s62, 0x0
    s_waitcnt lgkmcnt(0)
    s_lshl_b32 s44, s44, 7
    s_cmp_lt_u32 s46, s63
    s_cbranch_scc1 door_ag_123
    s_cmp_gt_u32 s46, s63
    s_cbranch_scc1 door_lt_124
    s_sub_u32 s45, s44, s62
    s_cmp_lt_i32 s45, 0xfffff200
    s_cbranch_scc1 door_ag_123
    s_cmp_ge_i32 s45, 0
    s_cbranch_scc1 door_ok_121
door_md_125:
    s_cmp_ge_i32 s45, 0xfffffb00
    s_cbranch_scc1 door_120
    s_sleep 1
    s_memrealtime s[44:45]
    s_waitcnt lgkmcnt(0)
    s_lshl_b32 s44, s44, 7
    s_sub_u32 s45, s44, s62
    s_branch door_md_125
door_120:
    s_memrealtime s[44:45]
    s_waitcnt lgkmcnt(0)
    s_lshl_b32 s44, s44, 7
    s_sub_u32 s45, s44, s62
    s_cmp_lt_i32 s45, 0
    s_cbranch_scc1 door_120
    s_branch door_ok_121
door_lt_124:
    s_mov_b32 s62, s44
door_ok_121:
V_go:
    buffer_load_dwordx4 v[64:67], v13, s[8:11], s32 offen sc1
    s_nop 13
    buffer_load_dwordx4 v[68:71], v13, s[8:11], s33 offen sc1
    s_nop 13
    buffer_load_dwordx4 v[72:75], v12, s[8:11], s34 offen
    s_nop 13
    buffer_load_dwordx4 v[76:79], v12, s[8:11], s34 offen offset:1024
V_ml_126:
    s_waitcnt vmcnt(3)
    ds_write_b128 v13, v[64:67]
    v_smfmac_f32_16x16x64_bf16 v[104:107], v[64:67], a[0:7], v11
    v_max3_u32 v2, v64, v65, v66
    v_smfmac_f32_16x16x64_bf16 v[112:115], v[64:67], a[8:15], v11
    v_max_u32 v2, v2, v67
    v_smfmac_f32_16x16x64_bf16 v[116:119], v[64:67], a[16:23], v11
    s_waitcnt vmcnt(2)
    ds_write_b128 v13, v[68:71] offset:4096
    v_smfmac_f32_16x16x64_bf16 v[104:107], v[68:71], a[24:31], v11
    v_max3_u32 v2, v2, v68, v69
    v_smfmac_f32_16x16x64_bf16 v[112:115], v[68:71], a[32:39], v11
    v_max3_u32 v2, v2, v70, v71
    v_smfmac_f32_16x16x64_bf16 v[116:119], v[68:71], a[40:47], v11
    v_cmp_eq_u32 vcc, -1, v2
    s_cbranch_vccnz V_mrt_128
V_mok_127:
    s_waitcnt vmcnt(1)
    v_smfmac_f32_16x16x64_bf16 v[104:107], v[72:75], a[48:55], v11
    v_max3_u32 v2, v72, v73, v74
    v_smfmac_f32_16x16x64_bf16 v[112:115], v[72:75], a[56:63], v11
    v_max_u32 v2, v2, v75
    s_waitcnt lgkmcnt(0)
    s_barrier
    ds_read_b128 v[80:83], v60 offset:0
    v_smfmac_f32_16x16x64_bf16 v[116:119], v[72:75], a[64:71], v11
    ds_read_b128 v[84:87], v61 offset:0
    s_waitcnt vmcnt(0)
    v_smfmac_f32_16x16x64_bf16 v[104:107], v[76:79], a[72:79], v11
    ds_read_b128 v[88:91], v62 offset:0
    v_max3_u32 v2, v2, v76, v77
    v_smfmac_f32_16x16x64_bf16 v[112:115], v[76:79], a[80:87], v11
    ds_read_b128 v[92:95], v60 offset:4096
    v_max3_u32 v2, v2, v78, v79
    v_smfmac_f32_16x16x64_bf16 v[116:119], v[76:79], a[88:95], v11
    ds_read_b128 v[96:99], v61 offset:4096
    v_cmp_eq_u32 vcc, -1, v2
    s_cbranch_vccnz V_crt_131
V_cok_130:
    s_waitcnt lgkmcnt(4)
    v_smfmac_f32_16x16x64_bf16 v[104:107], v[80:83], a[96:103], v11
    ds_read_b128 v[100:103], v62 offset:4096
    s_waitcnt lgkmcnt(4)
    v_smfmac_f32_16x16x64_bf16 v[104:107], v[84:87], a[120:127], v11
    buffer_load_dword v10, v9, s[8:11], s50 offen sc1
    s_waitcnt lgkmcnt(3)
    v_smfmac_f32_16x16x64_bf16 v[104:107], v[88:91], v[120:127], v11
    s_waitcnt lgkmcnt(2)
    v_smfmac_f32_16x16x64_bf16 v[104:107], v[92:95], a[144:151], v11
    ds_read_b128 v[120:123], v7 offset:4096
    s_waitcnt lgkmcnt(2)
    v_smfmac_f32_16x16x64_bf16 v[104:107], v[96:99], a[168:175], v11
    buffer_load_dword v10, v9, s[8:11], s51 offen sc1
    ds_read_b128 v[124:127], v7 offset:5120
    s_waitcnt lgkmcnt(2)
    v_smfmac_f32_16x16x64_bf16 v[104:107], v[100:103], v[128:135], v11
    v_smfmac_f32_16x16x64_bf16 v[112:115], v[80:83], a[104:111], v11
    ds_read_b128 v[128:131], v7 offset:8192
    v_smfmac_f32_16x16x64_bf16 v[116:119], v[80:83], a[112:119], v11
    ds_read_b128 v[132:135], v7 offset:9216
    v_smfmac_f32_16x16x64_bf16 v[112:115], v[84:87], a[128:135], v11
    s_nop 2
    v_permlane32_swap_b32 v104, v108
    v_permlane32_swap_b32 v105, v109
    v_smfmac_f32_16x16x64_bf16 v[116:119], v[84:87], a[136:143], v11
    v_permlane32_swap_b32 v106, v110
    v_permlane32_swap_b32 v107, v111
    v_smfmac_f32_16x16x64_bf16 v[112:115], v[88:91], v[136:143], v11
    v_add_f32 v104, v104, v108
    v_add_f32 v105, v105, v109
    s_waitcnt lgkmcnt(2)
    v_smfmac_f32_16x16x64_bf16 v[116:119], v[88:91], v[120:127], v11
    ds_read_b128 v[136:139], v7 offset:10240
    v_add_f32 v106, v106, v110
    v_add_f32 v107, v107, v111
    v_smfmac_f32_16x16x64_bf16 v[112:115], v[92:95], a[152:159], v11
    ds_read_b128 v[140:143], v7 offset:11264
    v_cvt_pk_bf16_f32 v108, v104, v105
    v_cvt_pk_bf16_f32 v109, v106, v107
    v_smfmac_f32_16x16x64_bf16 v[116:119], v[92:95], a[160:167], v11
    ds_write_b64 v15, v[108:109] offset:10240
    v_smfmac_f32_16x16x64_bf16 v[112:115], v[96:99], a[176:183], v11
    v_smfmac_f32_16x16x64_bf16 v[116:119], v[96:99], a[184:191], v11
    s_waitcnt lgkmcnt(3)
    v_smfmac_f32_16x16x64_bf16 v[112:115], v[100:103], v[128:135], v11
    s_waitcnt lgkmcnt(0)
    s_barrier
    ds_read_b64_tr_b16 v[40:41], v16 offset:10240
    ds_read_b64_tr_b16 v[42:43], v16 offset:10304
    v_smfmac_f32_16x16x64_bf16 v[116:119], v[100:103], v[136:143], v11
    ds_read_b64_tr_b16 v[44:45], v16 offset:10752
    ds_read_b64_tr_b16 v[46:47], v16 offset:10816
    s_nop 5
    v_permlane32_swap_b32 v112, v116
    v_permlane32_swap_b32 v113, v117
    v_permlane32_swap_b32 v114, v118
    v_permlane32_swap_b32 v115, v119
    v_add_f32 v112, v112, v116
    v_add_f32 v113, v113, v117
    v_add_f32 v114, v114, v118
    v_add_f32 v115, v115, v119
    v_cvt_pk_bf16_f32 v116, v112, v113
    v_cvt_pk_bf16_f32 v117, v114, v115
    ds_write_b64 v15, v[116:117] offset:12288
    s_waitcnt lgkmcnt(3)
    v_smfmac_f32_16x16x64_bf16 v[20:23], v[40:43], a[192:199], v11
    ds_read_b128 v[120:123], v7 offset:14336
    v_smfmac_f32_16x16x64_bf16 v[24:27], v[40:43], a[200:207], v11
    ds_read_b128 v[124:127], v7 offset:15360
    v_smfmac_f32_16x16x64_bf16 v[28:31], v[40:43], a[208:215], v11
    ds_read_b128 v[128:131], v7 offset:24576
    v_smfmac_f32_16x16x64_bf16 v[32:35], v[40:43], a[216:223], v11
    s_waitcnt lgkmcnt(3)
    s_barrier
    ds_read_b64_tr_b16 v[48:49], v16 offset:12288
    ds_read_b64_tr_b16 v[50:51], v16 offset:12352
    ds_read_b64_tr_b16 v[52:53], v16 offset:12800
    v_smfmac_f32_16x16x64_bf16 v[36:39], v[40:43], a[224:231], v11
    ds_read_b64_tr_b16 v[54:55], v16 offset:12864
    ds_read_b64_tr_b16 v[56:57], v16 offset:13312
    v_smfmac_f32_16x16x64_bf16 v[20:23], v[44:47], a[232:239], v11
    ds_read_b64_tr_b16 v[58:59], v16 offset:13376
    v_smfmac_f32_16x16x64_bf16 v[24:27], v[44:47], a[240:247], v11
    ds_read_b64_tr_b16 v[60:61], v16 offset:13824
    v_smfmac_f32_16x16x64_bf16 v[28:31], v[44:47], a[248:255], v11
    ds_read_b64_tr_b16 v[62:63], v16 offset:13888
    v_smfmac_f32_16x16x64_bf16 v[32:35], v[44:47], v[160:167], v11
    ds_read_b128 v[132:135], v7 offset:25600
    v_smfmac_f32_16x16x64_bf16 v[36:39], v[44:47], v[168:175], v11
    ds_read_b128 v[136:139], v7 offset:16384
    s_waitcnt lgkmcnt(8)
    v_smfmac_f32_16x16x64_bf16 v[20:23], v[48:51], v[176:183], v11
    ds_read_b128 v[140:143], v7 offset:17408
    s_waitcnt lgkmcnt(7)
    v_smfmac_f32_16x16x64_bf16 v[20:23], v[52:55], v[144:151], v11
    s_waitcnt lgkmcnt(5)
    v_smfmac_f32_16x16x64_bf16 v[20:23], v[56:59], v[216:223], v11
    ds_read_b128 v[144:147], v7 offset:26624
    s_waitcnt lgkmcnt(4)
    v_smfmac_f32_16x16x64_bf16 v[20:23], v[60:63], v[152:159], v11
    ds_read_b128 v[148:151], v7 offset:27648
    v_smfmac_f32_16x16x64_bf16 v[24:27], v[48:51], v[184:191], v11
    ds_read_b128 v[152:155], v7 offset:18432
    v_smfmac_f32_16x16x64_bf16 v[24:27], v[52:55], v[120:127], v11
    ds_read_b128 v[156:159], v7 offset:19456
    v_smfmac_f32_16x16x64_bf16 v[24:27], v[56:59], v[224:231], v11
    ds_read_b128 v[120:123], v7 offset:28672
    s_waitcnt lgkmcnt(7)
    v_smfmac_f32_16x16x64_bf16 v[24:27], v[60:63], v[128:135], v11
    ds_read_b128 v[124:127], v7 offset:29696
    v_smfmac_f32_16x16x64_bf16 v[28:31], v[48:51], v[192:199], v11
    ds_read_b128 v[128:131], v7 offset:20480
    s_waitcnt lgkmcnt(7)
    v_smfmac_f32_16x16x64_bf16 v[28:31], v[52:55], v[136:143], v11
    ds_read_b128 v[132:135], v7 offset:21504
    v_smfmac_f32_16x16x64_bf16 v[28:31], v[56:59], v[232:239], v11
    ds_read_b128 v[136:139], v7 offset:30720
    v_cvt_pk_bf16_f32 v104, v20, v21
    s_waitcnt lgkmcnt(7)
    v_smfmac_f32_16x16x64_bf16 v[28:31], v[60:63], v[144:151], v11
    ds_read_b128 v[140:143], v7 offset:31744
    v_cvt_pk_bf16_f32 v105, v22, v23
    v_smfmac_f32_16x16x64_bf16 v[32:35], v[48:51], v[200:207], v11
    v_cvt_pk_bf16_f32 v106, v24, v25
    s_waitcnt lgkmcnt(6)
    v_smfmac_f32_16x16x64_bf16 v[32:35], v[52:55], v[152:159], v11
    v_cvt_pk_bf16_f32 v107, v26, v27
    v_smfmac_f32_16x16x64_bf16 v[32:35], v[56:59], v[240:247], v11
    v_permlane16_swap_b32 v104, v106
    s_waitcnt lgkmcnt(4)
    v_smfmac_f32_16x16x64_bf16 v[32:35], v[60:63], v[120:127], v11
    v_permlane16_swap_b32 v105, v107
    v_smfmac_f32_16x16x64_bf16 v[36:39], v[48:51], v[208:215], v11
    buffer_store_dwordx4 v[104:107], v17, s[8:11], s55 offen sc1
    s_waitcnt lgkmcnt(2)
    v_smfmac_f32_16x16x64_bf16 v[36:39], v[52:55], v[128:135], v11
    v_cvt_pk_bf16_f32 v108, v28, v29
    v_smfmac_f32_16x16x64_bf16 v[36:39], v[56:59], v[248:255], v11
    v_cvt_pk_bf16_f32 v109, v30, v31
    s_waitcnt lgkmcnt(0)
    v_smfmac_f32_16x16x64_bf16 v[36:39], v[60:63], v[136:143], v11
    v_cvt_pk_bf16_f32 v110, v32, v33
    v_cvt_pk_bf16_f32 v111, v34, v35
    s_nop 0
    v_permlane16_swap_b32 v108, v110
    v_permlane16_swap_b32 v109, v111
    buffer_store_dwordx4 v[108:111], v17, s[8:11], s56 offen sc1
    s_nop 1
    v_cvt_pk_bf16_f32 v112, v36, v37
    v_cvt_pk_bf16_f32 v113, v38, v39
    s_nop 0
    v_permlane16_swap_b32 v112, v114
    v_permlane16_swap_b32 v113, v115
    buffer_store_dwordx4 v[112:115], v18, s[8:11], s57 offen sc1
    s_cmp_ge_u32 s48, 63
    s_cbranch_scc1 V_end
    s_add_u32 s48, s48, 1
    s_branch V_loop
V_mrt_128:
    s_cmp_eq_u32 s52, 0
    s_cbranch_scc1 V_mok_127
    s_sub_u32 s52, s52, 1
    s_nop 7
    v_mov_b32 v104, 0
    v_mov_b32 v105, 0
    v_mov_b32 v106, 0
    v_mov_b32 v107, 0
    v_mov_b32 v108, 0
    v_mov_b32 v109, 0
    v_mov_b32 v110, 0
    v_mov_b32 v111, 0
    v_mov_b32 v112, 0
    v_mov_b32 v113, 0
    v_mov_b32 v114, 0
    v_mov_b32 v115, 0
    v_mov_b32 v116, 0
    v_mov_b32 v117, 0
    v_mov_b32 v118, 0
    v_mov_b32 v119, 0
    s_waitcnt vmcnt(0) lgkmcnt(0)
    buffer_load_dwordx4 v[64:67], v13, s[8:11], s32 offen sc1
    s_nop 13
    buffer_load_dwordx4 v[68:71], v13, s[8:11], s33 offen sc1
    s_nop 13
    buffer_load_dwordx4 v[72:75], v12, s[8:11], s34 offen sc1
    s_nop 13
    buffer_load_dwordx4 v[76:79], v12, s[8:11], s34 offen offset:1024 sc1
    s_branch V_ml_126
V_crt_131:
    s_nop 7
    v_mov_b32 v104, 0
    v_mov_b32 v105, 0
    v_mov_b32 v106, 0
    v_mov_b32 v107, 0
    v_mov_b32 v108, 0
    v_mov_b32 v109, 0
    v_mov_b32 v110, 0
    v_mov_b32 v111, 0
    v_mov_b32 v112, 0
    v_mov_b32 v113, 0
    v_mov_b32 v114, 0
    v_mov_b32 v115, 0
    v_mov_b32 v116, 0
    v_mov_b32 v117, 0
    v_mov_b32 v118, 0
    v_mov_b32 v119, 0
V_cl_129:
    buffer_load_dwordx4 v[72:75], v12, s[8:11], s34 offen sc1
    buffer_load_dwordx4 v[76:79], v12, s[8:11], s34 offen offset:1024 sc1
    s_waitcnt vmcnt(0)
    v_max3_u32 v2, v72, v73, v74
    v_max3_u32 v2, v2, v75, v76
    v_max3_u32 v2, v2, v77, v78
    v_max_u32 v2, v2, v79
    v_cmp_eq_u32 vcc, -1, v2
    s_cbranch_vccz V_cre_132
    s_cmp_eq_u32 s52, 0
    s_cbranch_scc1 V_cre_132
    s_sub_u32 s52, s52, 1
    s_nop 0
    s_branch V_cl_129
V_cre_132:
    v_smfmac_f32_16x16x64_bf16 v[104:107], v[64:67], a[0:7], v11
    v_smfmac_f32_16x16x64_bf16 v[112:115], v[64:67], a[8:15], v11
    v_smfmac_f32_16x16x64_bf16 v[116:119], v[64:67], a[16:23], v11
    v_smfmac_f32_16x16x64_bf16 v[104:107], v[68:71], a[24:31], v11
    v_smfmac_f32_16x16x64_bf16 v[112:115], v[68:71], a[32:39], v11
    v_smfmac_f32_16x16x64_bf16 v[116:119], v[68:71], a[40:47], v11
    v_smfmac_f32_16x16x64_bf16 v[104:107], v[72:75], a[48:55], v11
    v_smfmac_f32_16x16x64_bf16 v[112:115], v[72:75], a[56:63], v11
    v_smfmac_f32_16x16x64_bf16 v[116:119], v[72:75], a[64:71], v11
    v_smfmac_f32_16x16x64_bf16 v[104:107], v[76:79], a[72:79], v11
    v_smfmac_f32_16x16x64_bf16 v[112:115], v[76:79], a[80:87], v11
    v_smfmac_f32_16x16x64_bf16 v[116:119], v[76:79], a[88:95], v11
    s_nop 7
    s_branch V_cok_130
V_end:
    s_endpgm
QK_start:
    s_cmp_eq_u32 s7, 0
    s_cselect_b32 s32, s68, s70
    s_cselect_b32 s33, s69, s71
    s_mov_b32 s12, s32
    s_and_b32 s13, s33, 0xffff
    s_mov_b32 s14, 0x780000
    s_mov_b32 s15, 0x20000
    s_lshl_b32 s50, s6, 9
    s_lshl_b32 s54, s4, 10
    v_lshrrev_b32 v2, 5, v1
    v_lshlrev_b32 v2, 10, v2
    v_bfe_u32 v3, v1, 2, 3
    v_lshl_add_u32 v2, v3, 7, v2
    v_and_b32 v4, 3, v1
    v_lshl_add_u32 v2, v4, 3, v2
    v_lshrrev_b32 v3, 1, v3
    s_mul_i32 s32, s4, 4
    s_add_u32 s32, s32, 0
    s_lshr_b32 s33, s32, 2
    s_mul_i32 s33, s33, 4096
    v_add_u32 v4, s32, v3
    v_and_b32 v4, 3, v4
    v_lshl_add_u32 v4, v4, 5, v2
    v_add_u32 v16, s33, v4
    s_mul_i32 s32, s4, 4
    s_add_u32 s32, s32, 1
    s_lshr_b32 s33, s32, 2
    s_mul_i32 s33, s33, 4096
    v_add_u32 v4, s32, v3
    v_and_b32 v4, 3, v4
    v_lshl_add_u32 v4, v4, 5, v2
    v_add_u32 v17, s33, v4
    s_mul_i32 s32, s4, 4
    s_add_u32 s32, s32, 2
    s_lshr_b32 s33, s32, 2
    s_mul_i32 s33, s33, 4096
    v_add_u32 v4, s32, v3
    v_and_b32 v4, 3, v4
    v_lshl_add_u32 v4, v4, 5, v2
    v_add_u32 v18, s33, v4
    s_mul_i32 s32, s4, 4
    s_add_u32 s32, s32, 3
    s_lshr_b32 s33, s32, 2
    s_mul_i32 s33, s33, 4096
    v_add_u32 v4, s32, v3
    v_and_b32 v4, 3, v4
    v_lshl_add_u32 v4, v4, 5, v2
    v_add_u32 v19, s33, v4
    v_lshrrev_b32 v2, 3, v1
    v_bfe_u32 v3, v1, 1, 2
    v_lshrrev_b32 v4, 1, v2
    v_sub_u32 v3, v3, v4
    v_and_b32 v3, 3, v3
    v_and_b32 v4, 1, v1
    v_lshl_add_u32 v3, v3, 1, v4
    v_lshrrev_b32 v4, 2, v2
    v_and_b32 v5, 3, v2
    v_lshl_add_u32 v4, v4, 3, v5
    s_and_b32 s32, s4, 1
    s_lshl_b32 s32, s32, 4
    s_lshr_b32 s33, s4, 1
    s_lshl_b32 s33, s33, 2
    s_add_u32 s32, s32, s33
    v_add_u32 v4, s32, v4
    v_mul_u32_u24 v4, 12288, v4
    v_lshl_add_u32 v24, v3, 4, v4
    s_mul_i32 s32, s4, 0
    s_add_u32 s32, s32, 40960
    v_lshl_add_u32 v14, v1, 4, s32
    s_add_u32 m0, s54, 0
    s_add_u32 s32, s50, 0
    buffer_load_dwordx4 v24, s[12:15], s32 offen lds
    s_add_u32 m0, s54, 4096
    s_add_u32 s32, s50, 128
    buffer_load_dwordx4 v24, s[12:15], s32 offen lds
    s_add_u32 m0, s54, 8192
    s_add_u32 s32, s50, 256
    buffer_load_dwordx4 v24, s[12:15], s32 offen lds
    s_add_u32 m0, s54, 12288
    s_add_u32 s32, s50, 384
    buffer_load_dwordx4 v24, s[12:15], s32 offen lds
    s_add_u32 m0, s54, 16384
    s_add_u32 s32, s50, 393216
    buffer_load_dwordx4 v24, s[12:15], s32 offen lds
    s_add_u32 m0, s54, 20480
    s_add_u32 s32, s50, 393344
    buffer_load_dwordx4 v24, s[12:15], s32 offen lds
    s_add_u32 m0, s54, 24576
    s_add_u32 s32, s50, 393472
    buffer_load_dwordx4 v24, s[12:15], s32 offen lds
    s_add_u32 m0, s54, 28672
    s_add_u32 s32, s50, 393600
    buffer_load_dwordx4 v24, s[12:15], s32 offen lds
    s_add_u32 m0, s54, 32768
    s_add_u32 s32, s50, 786432
    buffer_load_dwordx4 v24, s[12:15], s32 offen lds
    s_add_u32 m0, s54, 36864
    s_add_u32 s32, s50, 786560
    buffer_load_dwordx4 v24, s[12:15], s32 offen lds
    s_add_u32 m0, s54, 40960
    s_add_u32 s32, s50, 786688
    buffer_load_dwordx4 v24, s[12:15], s32 offen lds
    s_add_u32 m0, s54, 45056
    s_add_u32 s32, s50, 786816
    buffer_load_dwordx4 v24, s[12:15], s32 offen lds
    s_add_u32 m0, s54, 49152
    s_add_u32 s32, s50, 1179648
    buffer_load_dwordx4 v24, s[12:15], s32 offen lds
    s_add_u32 m0, s54, 53248
    s_add_u32 s32, s50, 1179776
    buffer_load_dwordx4 v24, s[12:15], s32 offen lds
    s_add_u32 m0, s54, 57344
    s_add_u32 s32, s50, 1179904
    buffer_load_dwordx4 v24, s[12:15], s32 offen lds
    s_add_u32 m0, s54, 61440
    s_add_u32 s32, s50, 1180032
    buffer_load_dwordx4 v24, s[12:15], s32 offen lds
    s_add_u32 m0, s54, 65536
    s_add_u32 s32, s50, 1572864
    buffer_load_dwordx4 v24, s[12:15], s32 offen lds
    s_add_u32 m0, s54, 69632
    s_add_u32 s32, s50, 1572992
    buffer_load_dwordx4 v24, s[12:15], s32 offen lds
    s_add_u32 m0, s54, 73728
    s_add_u32 s32, s50, 1573120
    buffer_load_dwordx4 v24, s[12:15], s32 offen lds
    s_add_u32 m0, s54, 77824
    s_add_u32 s32, s50, 1573248
    buffer_load_dwordx4 v24, s[12:15], s32 offen lds
    s_add_u32 m0, s54, 81920
    s_add_u32 s32, s50, 1966080
    buffer_load_dwordx4 v24, s[12:15], s32 offen lds
    s_add_u32 m0, s54, 86016
    s_add_u32 s32, s50, 1966208
    buffer_load_dwordx4 v24, s[12:15], s32 offen lds
    s_add_u32 m0, s54, 90112
    s_add_u32 s32, s50, 1966336
    buffer_load_dwordx4 v24, s[12:15], s32 offen lds
    s_add_u32 m0, s54, 94208
    s_add_u32 s32, s50, 1966464
    buffer_load_dwordx4 v24, s[12:15], s32 offen lds
    s_add_u32 m0, s54, 98304
    s_add_u32 s32, s50, 2359296
    buffer_load_dwordx4 v24, s[12:15], s32 offen lds
    s_add_u32 m0, s54, 102400
    s_add_u32 s32, s50, 2359424
    buffer_load_dwordx4 v24, s[12:15], s32 offen lds
    s_add_u32 m0, s54, 106496
    s_add_u32 s32, s50, 2359552
    buffer_load_dwordx4 v24, s[12:15], s32 offen lds
    s_add_u32 m0, s54, 110592
    s_add_u32 s32, s50, 2359680
    buffer_load_dwordx4 v24, s[12:15], s32 offen lds
    s_add_u32 m0, s54, 114688
    s_add_u32 s32, s50, 2752512
    buffer_load_dwordx4 v24, s[12:15], s32 offen lds
    s_add_u32 m0, s54, 118784
    s_add_u32 s32, s50, 2752640
    buffer_load_dwordx4 v24, s[12:15], s32 offen lds
    s_add_u32 m0, s54, 122880
    s_add_u32 s32, s50, 2752768
    buffer_load_dwordx4 v24, s[12:15], s32 offen lds
    s_add_u32 m0, s54, 126976
    s_add_u32 s32, s50, 2752896
    buffer_load_dwordx4 v24, s[12:15], s32 offen lds
    s_add_u32 m0, s54, 131072
    s_add_u32 s32, s50, 3145728
    buffer_load_dwordx4 v24, s[12:15], s32 offen lds
    s_add_u32 m0, s54, 135168
    s_add_u32 s32, s50, 3145856
    buffer_load_dwordx4 v24, s[12:15], s32 offen lds
    s_add_u32 m0, s54, 139264
    s_add_u32 s32, s50, 3145984
    buffer_load_dwordx4 v24, s[12:15], s32 offen lds
    s_add_u32 m0, s54, 143360
    s_add_u32 s32, s50, 3146112
    buffer_load_dwordx4 v24, s[12:15], s32 offen lds
    s_add_u32 m0, s54, 147456
    s_add_u32 s32, s50, 3538944
    buffer_load_dwordx4 v24, s[12:15], s32 offen lds
    s_add_u32 m0, s54, 151552
    s_add_u32 s32, s50, 3539072
    buffer_load_dwordx4 v24, s[12:15], s32 offen lds
    s_add_u32 m0, s54, 155648
    s_add_u32 s32, s50, 3539200
    buffer_load_dwordx4 v24, s[12:15], s32 offen lds
    s_add_u32 m0, s54, 159744
    s_add_u32 s32, s50, 3539328
    buffer_load_dwordx4 v24, s[12:15], s32 offen lds
    s_waitcnt vmcnt(36)
    s_barrier
    ds_read_b64_tr_b16 a[0:1], v16 offset:0
    ds_read_b64_tr_b16 a[2:3], v16 offset:2048
    ds_read_b64_tr_b16 a[4:5], v17 offset:0
    ds_read_b64_tr_b16 a[6:7], v17 offset:2048
    ds_read_b64_tr_b16 a[8:9], v18 offset:0
    ds_read_b64_tr_b16 a[10:11], v18 offset:2048
    ds_read_b64_tr_b16 a[12:13], v19 offset:0
    ds_read_b64_tr_b16 a[14:15], v19 offset:2048
    s_waitcnt lgkmcnt(0)
    s_waitcnt vmcnt(32)
    s_barrier
    s_add_u32 m0, s54, 0
    s_add_u32 s32, s50, 3932160
    buffer_load_dwordx4 v24, s[12:15], s32 offen lds
    s_add_u32 m0, s54, 4096
    s_add_u32 s32, s50, 3932288
    buffer_load_dwordx4 v24, s[12:15], s32 offen lds
    s_add_u32 m0, s54, 8192
    s_add_u32 s32, s50, 3932416
    buffer_load_dwordx4 v24, s[12:15], s32 offen lds
    s_add_u32 m0, s54, 12288
    s_add_u32 s32, s50, 3932544
    buffer_load_dwordx4 v24, s[12:15], s32 offen lds
    ds_read_b64_tr_b16 a[16:17], v16 offset:16384
    ds_read_b64_tr_b16 a[18:19], v16 offset:18432
    ds_read_b64_tr_b16 a[20:21], v17 offset:16384
    ds_read_b64_tr_b16 a[22:23], v17 offset:18432
    ds_read_b64_tr_b16 a[24:25], v18 offset:16384
    ds_read_b64_tr_b16 a[26:27], v18 offset:18432
    ds_read_b64_tr_b16 a[28:29], v19 offset:16384
    ds_read_b64_tr_b16 a[30:31], v19 offset:18432
    s_waitcnt lgkmcnt(0)
    s_waitcnt vmcnt(32)
    s_barrier
    s_add_u32 m0, s54, 16384
    s_add_u32 s32, s50, 4325376
    buffer_load_dwordx4 v24, s[12:15], s32 offen lds
    s_add_u32 m0, s54, 20480
    s_add_u32 s32, s50, 4325504
    buffer_load_dwordx4 v24, s[12:15], s32 offen lds
    s_add_u32 m0, s54, 24576
    s_add_u32 s32, s50, 4325632
    buffer_load_dwordx4 v24, s[12:15], s32 offen lds
    s_add_u32 m0, s54, 28672
    s_add_u32 s32, s50, 4325760
    buffer_load_dwordx4 v24, s[12:15], s32 offen lds
    ds_read_b64_tr_b16 a[32:33], v16 offset:32768
    ds_read_b64_tr_b16 a[34:35], v16 offset:34816
    ds_read_b64_tr_b16 a[36:37], v17 offset:32768
    ds_read_b64_tr_b16 a[38:39], v17 offset:34816
    ds_read_b64_tr_b16 a[40:41], v18 offset:32768
    ds_read_b64_tr_b16 a[42:43], v18 offset:34816
    ds_read_b64_tr_b16 a[44:45], v19 offset:32768
    ds_read_b64_tr_b16 a[46:47], v19 offset:34816
    s_waitcnt lgkmcnt(0)
    s_waitcnt vmcnt(32)
    s_barrier
    s_add_u32 m0, s54, 32768
    s_add_u32 s32, s50, 4718592
    buffer_load_dwordx4 v24, s[12:15], s32 offen lds
    s_add_u32 m0, s54, 36864
    s_add_u32 s32, s50, 4718720
    buffer_load_dwordx4 v24, s[12:15], s32 offen lds
    s_add_u32 m0, s54, 40960
    s_add_u32 s32, s50, 4718848
    buffer_load_dwordx4 v24, s[12:15], s32 offen lds
    s_add_u32 m0, s54, 45056
    s_add_u32 s32, s50, 4718976
    buffer_load_dwordx4 v24, s[12:15], s32 offen lds
    ds_read_b64_tr_b16 a[48:49], v16 offset:49152
    ds_read_b64_tr_b16 a[50:51], v16 offset:51200
    ds_read_b64_tr_b16 a[52:53], v17 offset:49152
    ds_read_b64_tr_b16 a[54:55], v17 offset:51200
    ds_read_b64_tr_b16 a[56:57], v18 offset:49152
    ds_read_b64_tr_b16 a[58:59], v18 offset:51200
    ds_read_b64_tr_b16 a[60:61], v19 offset:49152
    ds_read_b64_tr_b16 a[62:63], v19 offset:51200
    s_waitcnt lgkmcnt(0)
    s_waitcnt vmcnt(32)
    s_barrier
    s_add_u32 m0, s54, 49152
    s_add_u32 s32, s50, 5111808
    buffer_load_dwordx4 v24, s[12:15], s32 offen lds
    s_add_u32 m0, s54, 53248
    s_add_u32 s32, s50, 5111936
    buffer_load_dwordx4 v24, s[12:15], s32 offen lds
    s_add_u32 m0, s54, 57344
    s_add_u32 s32, s50, 5112064
    buffer_load_dwordx4 v24, s[12:15], s32 offen lds
    s_add_u32 m0, s54, 61440
    s_add_u32 s32, s50, 5112192
    buffer_load_dwordx4 v24, s[12:15], s32 offen lds
    v_add_u32 v10, 0x10000, v16
    ds_read_b64_tr_b16 a[64:65], v10 offset:0
    ds_read_b64_tr_b16 a[66:67], v10 offset:2048
    v_add_u32 v11, 0x10000, v17
    ds_read_b64_tr_b16 a[68:69], v11 offset:0
    ds_read_b64_tr_b16 a[70:71], v11 offset:2048
    v_add_u32 v10, 0x10000, v18
    ds_read_b64_tr_b16 a[72:73], v10 offset:0
    ds_read_b64_tr_b16 a[74:75], v10 offset:2048
    v_add_u32 v11, 0x10000, v19
    ds_read_b64_tr_b16 a[76:77], v11 offset:0
    ds_read_b64_tr_b16 a[78:79], v11 offset:2048
    s_waitcnt lgkmcnt(0)
    s_waitcnt vmcnt(32)
    s_barrier
    s_add_u32 m0, s54, 65536
    s_add_u32 s32, s50, 5505024
    buffer_load_dwordx4 v24, s[12:15], s32 offen lds
    s_add_u32 m0, s54, 69632
    s_add_u32 s32, s50, 5505152
    buffer_load_dwordx4 v24, s[12:15], s32 offen lds
    s_add_u32 m0, s54, 73728
    s_add_u32 s32, s50, 5505280
    buffer_load_dwordx4 v24, s[12:15], s32 offen lds
    s_add_u32 m0, s54, 77824
    s_add_u32 s32, s50, 5505408
    buffer_load_dwordx4 v24, s[12:15], s32 offen lds
    v_add_u32 v10, 0x10000, v16
    ds_read_b64_tr_b16 a[80:81], v10 offset:16384
    ds_read_b64_tr_b16 a[82:83], v10 offset:18432
    v_add_u32 v11, 0x10000, v17
    ds_read_b64_tr_b16 a[84:85], v11 offset:16384
    ds_read_b64_tr_b16 a[86:87], v11 offset:18432
    v_add_u32 v10, 0x10000, v18
    ds_read_b64_tr_b16 a[88:89], v10 offset:16384
    ds_read_b64_tr_b16 a[90:91], v10 offset:18432
    v_add_u32 v11, 0x10000, v19
    ds_read_b64_tr_b16 a[92:93], v11 offset:16384
    ds_read_b64_tr_b16 a[94:95], v11 offset:18432
    s_waitcnt lgkmcnt(0)
    s_waitcnt vmcnt(32)
    s_barrier
    s_add_u32 m0, s54, 81920
    s_add_u32 s32, s50, 5898240
    buffer_load_dwordx4 v24, s[12:15], s32 offen lds
    s_add_u32 m0, s54, 86016
    s_add_u32 s32, s50, 5898368
    buffer_load_dwordx4 v24, s[12:15], s32 offen lds
    s_add_u32 m0, s54, 90112
    s_add_u32 s32, s50, 5898496
    buffer_load_dwordx4 v24, s[12:15], s32 offen lds
    s_add_u32 m0, s54, 94208
    s_add_u32 s32, s50, 5898624
    buffer_load_dwordx4 v24, s[12:15], s32 offen lds
    v_add_u32 v10, 0x18000, v16
    ds_read_b64_tr_b16 a[96:97], v10 offset:0
    ds_read_b64_tr_b16 a[98:99], v10 offset:2048
    v_add_u32 v11, 0x18000, v17
    ds_read_b64_tr_b16 a[100:101], v11 offset:0
    ds_read_b64_tr_b16 a[102:103], v11 offset:2048
    v_add_u32 v10, 0x18000, v18
    ds_read_b64_tr_b16 a[104:105], v10 offset:0
    ds_read_b64_tr_b16 a[106:107], v10 offset:2048
    v_add_u32 v11, 0x18000, v19
    ds_read_b64_tr_b16 a[108:109], v11 offset:0
    ds_read_b64_tr_b16 a[110:111], v11 offset:2048
    s_waitcnt lgkmcnt(0)
    s_waitcnt vmcnt(32)
    s_barrier
    s_add_u32 m0, s54, 98304
    s_add_u32 s32, s50, 6291456
    buffer_load_dwordx4 v24, s[12:15], s32 offen lds
    s_add_u32 m0, s54, 102400
    s_add_u32 s32, s50, 6291584
    buffer_load_dwordx4 v24, s[12:15], s32 offen lds
    s_add_u32 m0, s54, 106496
    s_add_u32 s32, s50, 6291712
    buffer_load_dwordx4 v24, s[12:15], s32 offen lds
    s_add_u32 m0, s54, 110592
    s_add_u32 s32, s50, 6291840
    buffer_load_dwordx4 v24, s[12:15], s32 offen lds
    v_add_u32 v10, 0x18000, v16
    ds_read_b64_tr_b16 a[112:113], v10 offset:16384
    ds_read_b64_tr_b16 a[114:115], v10 offset:18432
    v_add_u32 v11, 0x18000, v17
    ds_read_b64_tr_b16 a[116:117], v11 offset:16384
    ds_read_b64_tr_b16 a[118:119], v11 offset:18432
    v_add_u32 v10, 0x18000, v18
    ds_read_b64_tr_b16 a[120:121], v10 offset:16384
    ds_read_b64_tr_b16 a[122:123], v10 offset:18432
    v_add_u32 v11, 0x18000, v19
    ds_read_b64_tr_b16 a[124:125], v11 offset:16384
    ds_read_b64_tr_b16 a[126:127], v11 offset:18432
    s_waitcnt lgkmcnt(0)
    s_waitcnt vmcnt(32)
    s_barrier
    s_add_u32 m0, s54, 114688
    s_add_u32 s32, s50, 6684672
    buffer_load_dwordx4 v24, s[12:15], s32 offen lds
    s_add_u32 m0, s54, 118784
    s_add_u32 s32, s50, 6684800
    buffer_load_dwordx4 v24, s[12:15], s32 offen lds
    s_add_u32 m0, s54, 122880
    s_add_u32 s32, s50, 6684928
    buffer_load_dwordx4 v24, s[12:15], s32 offen lds
    s_add_u32 m0, s54, 126976
    s_add_u32 s32, s50, 6685056
    buffer_load_dwordx4 v24, s[12:15], s32 offen lds
    v_add_u32 v10, 0x20000, v16
    ds_read_b64_tr_b16 a[128:129], v10 offset:0
    ds_read_b64_tr_b16 a[130:131], v10 offset:2048
    v_add_u32 v11, 0x20000, v17
    ds_read_b64_tr_b16 a[132:133], v11 offset:0
    ds_read_b64_tr_b16 a[134:135], v11 offset:2048
    v_add_u32 v10, 0x20000, v18
    ds_read_b64_tr_b16 a[136:137], v10 offset:0
    ds_read_b64_tr_b16 a[138:139], v10 offset:2048
    v_add_u32 v11, 0x20000, v19
    ds_read_b64_tr_b16 a[140:141], v11 offset:0
    ds_read_b64_tr_b16 a[142:143], v11 offset:2048
    s_waitcnt lgkmcnt(0)
    s_waitcnt vmcnt(32)
    s_barrier
    s_add_u32 m0, s54, 131072
    s_add_u32 s32, s50, 7077888
    buffer_load_dwordx4 v24, s[12:15], s32 offen lds
    s_add_u32 m0, s54, 135168
    s_add_u32 s32, s50, 7078016
    buffer_load_dwordx4 v24, s[12:15], s32 offen lds
    s_add_u32 m0, s54, 139264
    s_add_u32 s32, s50, 7078144
    buffer_load_dwordx4 v24, s[12:15], s32 offen lds
    s_add_u32 m0, s54, 143360
    s_add_u32 s32, s50, 7078272
    buffer_load_dwordx4 v24, s[12:15], s32 offen lds
    v_add_u32 v10, 0x20000, v16
    ds_read_b64_tr_b16 a[144:145], v10 offset:16384
    ds_read_b64_tr_b16 a[146:147], v10 offset:18432
    v_add_u32 v11, 0x20000, v17
    ds_read_b64_tr_b16 a[148:149], v11 offset:16384
    ds_read_b64_tr_b16 a[150:151], v11 offset:18432
    v_add_u32 v10, 0x20000, v18
    ds_read_b64_tr_b16 a[152:153], v10 offset:16384
    ds_read_b64_tr_b16 a[154:155], v10 offset:18432
    v_add_u32 v11, 0x20000, v19
    ds_read_b64_tr_b16 a[156:157], v11 offset:16384
    ds_read_b64_tr_b16 a[158:159], v11 offset:18432
    s_waitcnt lgkmcnt(0)
    s_waitcnt vmcnt(32)
    s_barrier
    s_add_u32 m0, s54, 147456
    s_add_u32 s32, s50, 7471104
    buffer_load_dwordx4 v24, s[12:15], s32 offen lds
    s_add_u32 m0, s54, 151552
    s_add_u32 s32, s50, 7471232
    buffer_load_dwordx4 v24, s[12:15], s32 offen lds
    s_add_u32 m0, s54, 155648
    s_add_u32 s32, s50, 7471360
    buffer_load_dwordx4 v24, s[12:15], s32 offen lds
    s_add_u32 m0, s54, 159744
    s_add_u32 s32, s50, 7471488
    buffer_load_dwordx4 v24, s[12:15], s32 offen lds
    s_mov_b32 s28, s88
    s_and_b32 s29, s89, 0xffff
    s_mov_b32 s30, 0x100
    s_mov_b32 s31, 0x20000
    v_mov_b32 v2, 0
    buffer_load_dword v3, v2, s[28:31], 0 offen offset:60 sc1
    ds_read_b64_tr_b16 a[160:161], v16 offset:0
    ds_read_b64_tr_b16 a[162:163], v16 offset:2048
    ds_read_b64_tr_b16 a[164:165], v17 offset:0
    ds_read_b64_tr_b16 a[166:167], v17 offset:2048
    ds_read_b64_tr_b16 a[168:169], v18 offset:0
    ds_read_b64_tr_b16 a[170:171], v18 offset:2048
    ds_read_b64_tr_b16 a[172:173], v19 offset:0
    ds_read_b64_tr_b16 a[174:175], v19 offset:2048
    s_waitcnt lgkmcnt(0)
    s_waitcnt vmcnt(33)
    s_barrier
    ds_read_b64_tr_b16 a[176:177], v16 offset:16384
    ds_read_b64_tr_b16 a[178:179], v16 offset:18432
    ds_read_b64_tr_b16 a[180:181], v17 offset:16384
    ds_read_b64_tr_b16 a[182:183], v17 offset:18432
    ds_read_b64_tr_b16 a[184:185], v18 offset:16384
    ds_read_b64_tr_b16 a[186:187], v18 offset:18432
    ds_read_b64_tr_b16 a[188:189], v19 offset:16384
    ds_read_b64_tr_b16 a[190:191], v19 offset:18432
    s_waitcnt lgkmcnt(0)
    s_waitcnt vmcnt(29)
    s_barrier
    ds_read_b64_tr_b16 a[192:193], v16 offset:32768
    ds_read_b64_tr_b16 a[194:195], v16 offset:34816
    ds_read_b64_tr_b16 a[196:197], v17 offset:32768
    ds_read_b64_tr_b16 a[198:199], v17 offset:34816
    ds_read_b64_tr_b16 a[200:201], v18 offset:32768
    ds_read_b64_tr_b16 a[202:203], v18 offset:34816
    ds_read_b64_tr_b16 a[204:205], v19 offset:32768
    ds_read_b64_tr_b16 a[206:207], v19 offset:34816
    s_waitcnt lgkmcnt(0)
    s_waitcnt vmcnt(25)
    s_barrier
    ds_read_b64_tr_b16 a[208:209], v16 offset:49152
    ds_read_b64_tr_b16 a[210:211], v16 offset:51200
    ds_read_b64_tr_b16 a[212:213], v17 offset:49152
    ds_read_b64_tr_b16 a[214:215], v17 offset:51200
    ds_read_b64_tr_b16 a[216:217], v18 offset:49152
    ds_read_b64_tr_b16 a[218:219], v18 offset:51200
    ds_read_b64_tr_b16 a[220:221], v19 offset:49152
    ds_read_b64_tr_b16 a[222:223], v19 offset:51200
    s_waitcnt lgkmcnt(0)
    s_waitcnt vmcnt(21)
    s_barrier
    v_add_u32 v10, 0x10000, v16
    ds_read_b64_tr_b16 a[224:225], v10 offset:0
    ds_read_b64_tr_b16 a[226:227], v10 offset:2048
    v_add_u32 v11, 0x10000, v17
    ds_read_b64_tr_b16 a[228:229], v11 offset:0
    ds_read_b64_tr_b16 a[230:231], v11 offset:2048
    v_add_u32 v10, 0x10000, v18
    ds_read_b64_tr_b16 a[232:233], v10 offset:0
    ds_read_b64_tr_b16 a[234:235], v10 offset:2048
    v_add_u32 v11, 0x10000, v19
    ds_read_b64_tr_b16 a[236:237], v11 offset:0
    ds_read_b64_tr_b16 a[238:239], v11 offset:2048
    s_waitcnt lgkmcnt(0)
    s_waitcnt vmcnt(17)
    s_barrier
    v_add_u32 v10, 0x10000, v16
    ds_read_b64_tr_b16 a[240:241], v10 offset:16384
    ds_read_b64_tr_b16 a[242:243], v10 offset:18432
    v_add_u32 v11, 0x10000, v17
    ds_read_b64_tr_b16 a[244:245], v11 offset:16384
    ds_read_b64_tr_b16 a[246:247], v11 offset:18432
    v_add_u32 v10, 0x10000, v18
    ds_read_b64_tr_b16 a[248:249], v10 offset:16384
    ds_read_b64_tr_b16 a[250:251], v10 offset:18432
    v_add_u32 v11, 0x10000, v19
    ds_read_b64_tr_b16 a[252:253], v11 offset:16384
    ds_read_b64_tr_b16 a[254:255], v11 offset:18432
    s_waitcnt lgkmcnt(0)
    s_waitcnt vmcnt(13)
    s_barrier
    v_add_u32 v10, 0x18000, v16
    ds_read_b64_tr_b16 v[192:193], v10 offset:0
    ds_read_b64_tr_b16 v[194:195], v10 offset:2048
    v_add_u32 v11, 0x18000, v17
    ds_read_b64_tr_b16 v[196:197], v11 offset:0
    ds_read_b64_tr_b16 v[198:199], v11 offset:2048
    v_add_u32 v10, 0x18000, v18
    ds_read_b64_tr_b16 v[200:201], v10 offset:0
    ds_read_b64_tr_b16 v[202:203], v10 offset:2048
    v_add_u32 v11, 0x18000, v19
    ds_read_b64_tr_b16 v[204:205], v11 offset:0
    ds_read_b64_tr_b16 v[206:207], v11 offset:2048
    s_waitcnt lgkmcnt(0)
    s_waitcnt vmcnt(9)
    s_barrier
    v_add_u32 v10, 0x18000, v16
    ds_read_b64_tr_b16 v[208:209], v10 offset:16384
    ds_read_b64_tr_b16 v[210:211], v10 offset:18432
    v_add_u32 v11, 0x18000, v17
    ds_read_b64_tr_b16 v[212:213], v11 offset:16384
    ds_read_b64_tr_b16 v[214:215], v11 offset:18432
    v_add_u32 v10, 0x18000, v18
    ds_read_b64_tr_b16 v[216:217], v10 offset:16384
    ds_read_b64_tr_b16 v[218:219], v10 offset:18432
    v_add_u32 v11, 0x18000, v19
    ds_read_b64_tr_b16 v[220:221], v11 offset:16384
    ds_read_b64_tr_b16 v[222:223], v11 offset:18432
    s_waitcnt lgkmcnt(0)
    s_waitcnt vmcnt(5)
    s_barrier
    v_add_u32 v10, 0x20000, v16
    ds_read_b64_tr_b16 v[224:225], v10 offset:0
    ds_read_b64_tr_b16 v[226:227], v10 offset:2048
    v_add_u32 v11, 0x20000, v17
    ds_read_b64_tr_b16 v[228:229], v11 offset:0
    ds_read_b64_tr_b16 v[230:231], v11 offset:2048
    v_add_u32 v10, 0x20000, v18
    ds_read_b64_tr_b16 v[232:233], v10 offset:0
    ds_read_b64_tr_b16 v[234:235], v10 offset:2048
    v_add_u32 v11, 0x20000, v19
    ds_read_b64_tr_b16 v[236:237], v11 offset:0
    ds_read_b64_tr_b16 v[238:239], v11 offset:2048
    s_waitcnt lgkmcnt(0)
    s_waitcnt vmcnt(1)
    s_barrier
    v_add_u32 v10, 0x20000, v16
    ds_read_b64_tr_b16 v[240:241], v10 offset:16384
    ds_read_b64_tr_b16 v[242:243], v10 offset:18432
    v_add_u32 v11, 0x20000, v17
    ds_read_b64_tr_b16 v[244:245], v11 offset:16384
    ds_read_b64_tr_b16 v[246:247], v11 offset:18432
    v_add_u32 v10, 0x20000, v18
    ds_read_b64_tr_b16 v[248:249], v10 offset:16384
    ds_read_b64_tr_b16 v[250:251], v10 offset:18432
    v_add_u32 v11, 0x20000, v19
    ds_read_b64_tr_b16 v[252:253], v11 offset:16384
    ds_read_b64_tr_b16 v[254:255], v11 offset:18432
    s_waitcnt lgkmcnt(0)
    s_barrier
    s_mov_b32 s52, 1048576
    s_branch prepw_ck_135
prepw_133:
    buffer_load_dword v3, v2, s[28:31], 0 offen offset:60 sc1
prepw_ck_135:
    s_waitcnt vmcnt(0)
    v_readfirstlane_b32 s32, v3
    s_nop 1
    s_and_b32 s33, s32, 255
    s_cmp_ge_u32 s33, 56
    s_cbranch_scc1 prepw_ok_134
    s_cmp_eq_u32 s52, 0
    s_cbranch_scc1 prepw_ok_134
    s_sub_u32 s52, s52, 1
    s_sleep 4
    s_branch prepw_133
prepw_ok_134:
    s_bfe_u32 s33, s32, 0x80008
    s_bfe_u32 s34, s32, 0x80018
    s_add_u32 s33, s33, s34
    s_bfe_u32 s34, s32, 0x80010
    s_sub_u32 s33, s33, s34
    s_cmp_ge_i32 s33, 28
    s_cselect_b32 s96, 0, 8192
    s_mov_b32 s98, s96
    s_xor_b32 s97, s96, 8192
    s_add_u32 s99, s96, 0xa20d000
    v_lshlrev_b32 v7, 4, v0
    s_mov_b32 s48, 0
    s_mul_i32 s55, s48, 40960
    s_add_u32 s55, s55, 0
    s_add_u32 m0, s54, 0
    s_nop 0
    buffer_load_dwordx4 v7, s[8:11], s55 offen sc1 lds
    s_add_u32 s55, s55, 4096
    s_add_u32 m0, s54, 4096
    s_nop 0
    buffer_load_dwordx4 v7, s[8:11], s55 offen sc1 lds
    s_add_u32 s55, s55, 4096
    s_add_u32 m0, s54, 8192
    s_nop 0
    buffer_load_dwordx4 v7, s[8:11], s55 offen sc1 lds
    s_add_u32 s55, s55, 4096
    s_add_u32 m0, s54, 12288
    s_nop 0
    buffer_load_dwordx4 v7, s[8:11], s55 offen sc1 lds
    s_add_u32 s55, s55, 4096
    s_add_u32 m0, s54, 16384
    s_nop 0
    buffer_load_dwordx4 v7, s[8:11], s55 offen sc1 lds
    v_lshrrev_b32 v2, 4, v1
    v_and_b32 v3, 15, v1
    v_lshlrev_b32 v6, 9, v2
    v_lshl_add_u32 v6, v3, 4, v6
    v_mov_b32 v4, 0x40000000
    v_cmp_eq_u32 vcc, 0, v0
    s_nop 1
    v_cndmask_b32 v8, v4, v0, vcc
    v_mov_b32 v13, 64
    v_lshlrev_b32 v9, 4, v1
    s_lshl_b32 s32, s6, 3
    s_lshl_b32 s33, s4, 1
    s_add_u32 s32, s32, s33
    s_add_u32 s32, s32, 0
    s_mul_hi_u32 s33, s32, 0x2aaaaaab
    s_mul_i32 s33, s33, 6
    s_add_u32 s32, s32, s33
    s_lshl_b32 s32, s32, 10
    s_mul_i32 s33, s7, 0x1800000
    s_add_u32 s32, s32, s33
    v_add_u32 v24, s32, v9
    s_lshl_b32 s32, s6, 3
    s_lshl_b32 s33, s4, 1
    s_add_u32 s32, s32, s33
    s_add_u32 s32, s32, 1
    s_mul_hi_u32 s33, s32, 0x2aaaaaab
    s_mul_i32 s33, s33, 6
    s_add_u32 s32, s32, s33
    s_lshl_b32 s32, s32, 10
    s_mul_i32 s33, s7, 0x1800000
    s_add_u32 s32, s32, s33
    v_add_u32 v25, s32, v9
    s_mov_b32 s49, 0x40000000
    v_mov_b32 v20, -1
    v_mov_b32 v21, -1
    v_mov_b32 v22, -1
    v_mov_b32 v23, -1
    v_mov_b32 v4, 0x40000000
    s_cmp_lg_u32 s4, 0
    s_mov_b32 s32, 640
    s_cmov_b32 s32, 3584
    v_cmp_gt_u32 vcc, s32, v7
    s_nop 1
    v_cndmask_b32 v16, v4, v7, vcc
    s_lshl_b32 s32, s6, 2
    s_add_u32 s32, s32, 2
    s_mul_hi_u32 s57, s32, 0x55555556
    s_xor_b32 s32, s57, s7
    s_and_b32 s32, s32, 1
    s_add_u32 s57, s57, s32
    s_mul_i32 s32, s57, 3
    s_lshr_b32 s32, s32, 2
    s_cmp_lg_u32 s32, s6
    s_cmov_b32 s57, 99
    s_lshr_b32 s56, s57, 3
    s_lshl_b32 s56, s56, 14
    s_and_b32 s32, s57, 7
    s_mul_i32 s32, s32, 640
    s_add_u32 s56, s56, s32
    v_mov_b32 v15, -1
    v_mov_b32 v26, 0
    s_mov_b32 s52, 1048576
    s_waitcnt vmcnt(0)
QK_loop:
    s_waitcnt vmcnt(5) lgkmcnt(0)
    s_barrier
    ds_read_b128 v[60:63], v6 offset:0
    ds_read_b128 v[64:67], v6 offset:256
    s_waitcnt lgkmcnt(1)
    v_mfma_f32_16x16x32_bf16 v[28:31], a[0:3], v[60:63], 0
    ds_read_b128 v[68:71], v6 offset:2048
    s_waitcnt lgkmcnt(1)
    v_mfma_f32_16x16x32_bf16 v[32:35], a[0:3], v[64:67], 0
    ds_read_b128 v[72:75], v6 offset:2304
    v_mfma_f32_16x16x32_bf16 v[36:39], a[4:7], v[60:63], 0
    s_mul_i32 s55, s48, 40960
    s_add_u32 s55, s55, 20480
    s_add_u32 m0, s54, 20480
    s_nop 0
    buffer_load_dwordx4 v7, s[8:11], s55 offen sc1 lds
    v_mfma_f32_16x16x32_bf16 v[40:43], a[4:7], v[64:67], 0
    v_mfma_f32_16x16x32_bf16 v[44:47], a[8:11], v[60:63], 0
    v_mfma_f32_16x16x32_bf16 v[48:51], a[8:11], v[64:67], 0
    s_add_u32 s55, s55, 4096
    s_add_u32 m0, s54, 24576
    s_nop 0
    buffer_load_dwordx4 v7, s[8:11], s55 offen sc1 lds
    v_mfma_f32_16x16x32_bf16 v[52:55], a[12:15], v[60:63], 0
    v_mfma_f32_16x16x32_bf16 v[56:59], a[12:15], v[64:67], 0
    s_waitcnt lgkmcnt(1)
    v_mfma_f32_16x16x32_bf16 v[28:31], a[16:19], v[68:71], v[28:31]
    ds_read_b128 v[60:63], v6 offset:4096
    s_waitcnt lgkmcnt(1)
    v_mfma_f32_16x16x32_bf16 v[32:35], a[16:19], v[72:75], v[32:35]
    ds_read_b128 v[64:67], v6 offset:4352
    v_mfma_f32_16x16x32_bf16 v[36:39], a[20:23], v[68:71], v[36:39]
    s_add_u32 s55, s55, 4096
    s_add_u32 m0, s54, 28672
    s_nop 0
    buffer_load_dwordx4 v7, s[8:11], s55 offen sc1 lds
    v_mfma_f32_16x16x32_bf16 v[40:43], a[20:23], v[72:75], v[40:43]
    v_mfma_f32_16x16x32_bf16 v[44:47], a[24:27], v[68:71], v[44:47]
    v_mfma_f32_16x16x32_bf16 v[48:51], a[24:27], v[72:75], v[48:51]
    s_add_u32 s55, s55, 4096
    s_add_u32 m0, s54, 32768
    s_nop 0
    buffer_load_dwordx4 v7, s[8:11], s55 offen sc1 lds
    v_mfma_f32_16x16x32_bf16 v[52:55], a[28:31], v[68:71], v[52:55]
    v_mfma_f32_16x16x32_bf16 v[56:59], a[28:31], v[72:75], v[56:59]
    s_waitcnt lgkmcnt(1)
    v_mfma_f32_16x16x32_bf16 v[28:31], a[32:35], v[60:63], v[28:31]
    ds_read_b128 v[68:71], v6 offset:6144
    s_waitcnt lgkmcnt(1)
    v_mfma_f32_16x16x32_bf16 v[32:35], a[32:35], v[64:67], v[32:35]
    ds_read_b128 v[72:75], v6 offset:6400
    v_mfma_f32_16x16x32_bf16 v[36:39], a[36:39], v[60:63], v[36:39]
    s_add_u32 s55, s55, 4096
    s_add_u32 m0, s54, 36864
    s_nop 0
    buffer_load_dwordx4 v7, s[8:11], s55 offen sc1 lds
    v_mfma_f32_16x16x32_bf16 v[40:43], a[36:39], v[64:67], v[40:43]
    v_mfma_f32_16x16x32_bf16 v[44:47], a[40:43], v[60:63], v[44:47]
    v_mfma_f32_16x16x32_bf16 v[48:51], a[40:43], v[64:67], v[48:51]
    v_mfma_f32_16x16x32_bf16 v[52:55], a[44:47], v[60:63], v[52:55]
    v_mfma_f32_16x16x32_bf16 v[56:59], a[44:47], v[64:67], v[56:59]
    s_waitcnt lgkmcnt(1)
    v_mfma_f32_16x16x32_bf16 v[28:31], a[48:51], v[68:71], v[28:31]
    ds_read_b128 v[60:63], v6 offset:8192
    s_waitcnt lgkmcnt(1)
    v_mfma_f32_16x16x32_bf16 v[32:35], a[48:51], v[72:75], v[32:35]
    ds_read_b128 v[64:67], v6 offset:8448
    v_mfma_f32_16x16x32_bf16 v[36:39], a[52:55], v[68:71], v[36:39]
    v_mfma_f32_16x16x32_bf16 v[40:43], a[52:55], v[72:75], v[40:43]
    v_mfma_f32_16x16x32_bf16 v[44:47], a[56:59], v[68:71], v[44:47]
    v_mfma_f32_16x16x32_bf16 v[48:51], a[56:59], v[72:75], v[48:51]
    v_mfma_f32_16x16x32_bf16 v[52:55], a[60:63], v[68:71], v[52:55]
    v_mfma_f32_16x16x32_bf16 v[56:59], a[60:63], v[72:75], v[56:59]
    s_waitcnt lgkmcnt(1)
    v_mfma_f32_16x16x32_bf16 v[28:31], a[64:67], v[60:63], v[28:31]
    ds_read_b128 v[68:71], v6 offset:10240
    s_waitcnt lgkmcnt(1)
    v_mfma_f32_16x16x32_bf16 v[32:35], a[64:67], v[64:67], v[32:35]
    ds_read_b128 v[72:75], v6 offset:10496
    v_mfma_f32_16x16x32_bf16 v[36:39], a[68:71], v[60:63], v[36:39]
    v_mfma_f32_16x16x32_bf16 v[40:43], a[68:71], v[64:67], v[40:43]
    v_mfma_f32_16x16x32_bf16 v[44:47], a[72:75], v[60:63], v[44:47]
    v_mfma_f32_16x16x32_bf16 v[48:51], a[72:75], v[64:67], v[48:51]
    v_mfma_f32_16x16x32_bf16 v[52:55], a[76:79], v[60:63], v[52:55]
    v_mfma_f32_16x16x32_bf16 v[56:59], a[76:79], v[64:67], v[56:59]
    s_waitcnt lgkmcnt(1)
    v_mfma_f32_16x16x32_bf16 v[28:31], a[80:83], v[68:71], v[28:31]
    ds_read_b128 v[60:63], v6 offset:12288
    s_waitcnt lgkmcnt(1)
    v_mfma_f32_16x16x32_bf16 v[32:35], a[80:83], v[72:75], v[32:35]
    ds_read_b128 v[64:67], v6 offset:12544
    v_mfma_f32_16x16x32_bf16 v[36:39], a[84:87], v[68:71], v[36:39]
    v_mfma_f32_16x16x32_bf16 v[40:43], a[84:87], v[72:75], v[40:43]
    v_mfma_f32_16x16x32_bf16 v[44:47], a[88:91], v[68:71], v[44:47]
    v_mfma_f32_16x16x32_bf16 v[48:51], a[88:91], v[72:75], v[48:51]
    v_mfma_f32_16x16x32_bf16 v[52:55], a[92:95], v[68:71], v[52:55]
    v_mfma_f32_16x16x32_bf16 v[56:59], a[92:95], v[72:75], v[56:59]
    s_waitcnt lgkmcnt(1)
    v_mfma_f32_16x16x32_bf16 v[28:31], a[96:99], v[60:63], v[28:31]
    ds_read_b128 v[68:71], v6 offset:14336
    s_waitcnt lgkmcnt(1)
    v_mfma_f32_16x16x32_bf16 v[32:35], a[96:99], v[64:67], v[32:35]
    ds_read_b128 v[72:75], v6 offset:14592
    v_mfma_f32_16x16x32_bf16 v[36:39], a[100:103], v[60:63], v[36:39]
    v_mfma_f32_16x16x32_bf16 v[40:43], a[100:103], v[64:67], v[40:43]
    v_mfma_f32_16x16x32_bf16 v[44:47], a[104:107], v[60:63], v[44:47]
    v_mfma_f32_16x16x32_bf16 v[48:51], a[104:107], v[64:67], v[48:51]
    v_mfma_f32_16x16x32_bf16 v[52:55], a[108:111], v[60:63], v[52:55]
    v_mfma_f32_16x16x32_bf16 v[56:59], a[108:111], v[64:67], v[56:59]
    s_waitcnt lgkmcnt(1)
    v_mfma_f32_16x16x32_bf16 v[28:31], a[112:115], v[68:71], v[28:31]
    ds_read_b128 v[60:63], v6 offset:16384
    s_waitcnt lgkmcnt(1)
    v_mfma_f32_16x16x32_bf16 v[32:35], a[112:115], v[72:75], v[32:35]
    ds_read_b128 v[64:67], v6 offset:16640
    v_mfma_f32_16x16x32_bf16 v[36:39], a[116:119], v[68:71], v[36:39]
    v_mfma_f32_16x16x32_bf16 v[40:43], a[116:119], v[72:75], v[40:43]
    v_mfma_f32_16x16x32_bf16 v[44:47], a[120:123], v[68:71], v[44:47]
    v_mfma_f32_16x16x32_bf16 v[48:51], a[120:123], v[72:75], v[48:51]
    v_mfma_f32_16x16x32_bf16 v[52:55], a[124:127], v[68:71], v[52:55]
    v_mfma_f32_16x16x32_bf16 v[56:59], a[124:127], v[72:75], v[56:59]
    s_waitcnt lgkmcnt(1)
    v_mfma_f32_16x16x32_bf16 v[28:31], a[128:131], v[60:63], v[28:31]
    ds_read_b128 v[68:71], v6 offset:18432
    s_waitcnt lgkmcnt(1)
    v_mfma_f32_16x16x32_bf16 v[32:35], a[128:131], v[64:67], v[32:35]
    ds_read_b128 v[72:75], v6 offset:18688
    v_mfma_f32_16x16x32_bf16 v[36:39], a[132:135], v[60:63], v[36:39]
    v_mfma_f32_16x16x32_bf16 v[40:43], a[132:135], v[64:67], v[40:43]
    v_mfma_f32_16x16x32_bf16 v[44:47], a[136:139], v[60:63], v[44:47]
    v_mfma_f32_16x16x32_bf16 v[48:51], a[136:139], v[64:67], v[48:51]
    v_mfma_f32_16x16x32_bf16 v[52:55], a[140:143], v[60:63], v[52:55]
    v_mfma_f32_16x16x32_bf16 v[56:59], a[140:143], v[64:67], v[56:59]
    s_waitcnt lgkmcnt(1)
    v_mfma_f32_16x16x32_bf16 v[28:31], a[144:147], v[68:71], v[28:31]
    s_waitcnt lgkmcnt(0)
    v_mfma_f32_16x16x32_bf16 v[32:35], a[144:147], v[72:75], v[32:35]
    v_mfma_f32_16x16x32_bf16 v[36:39], a[148:151], v[68:71], v[36:39]
    v_mfma_f32_16x16x32_bf16 v[40:43], a[148:151], v[72:75], v[40:43]
    v_mfma_f32_16x16x32_bf16 v[44:47], a[152:155], v[68:71], v[44:47]
    v_mfma_f32_16x16x32_bf16 v[48:51], a[152:155], v[72:75], v[48:51]
    v_mfma_f32_16x16x32_bf16 v[52:55], a[156:159], v[68:71], v[52:55]
    v_mfma_f32_16x16x32_bf16 v[56:59], a[156:159], v[72:75], v[56:59]
    s_waitcnt vmcnt(0) lgkmcnt(0)
    s_barrier
    ds_read_b128 v[60:63], v6 offset:20480
    ds_read_b128 v[64:67], v6 offset:20736
    buffer_store_dword v13, v8, s[8:11], s49 offen sc1
    s_add_u32 s34, s48, 1
    s_min_u32 s34, s34, 63
    s_waitcnt lgkmcnt(1)
    v_mfma_f32_16x16x32_bf16 v[28:31], a[160:163], v[60:63], v[28:31]
    ds_read_b128 v[68:71], v6 offset:22528
    s_waitcnt lgkmcnt(1)
    v_mfma_f32_16x16x32_bf16 v[32:35], a[160:163], v[64:67], v[32:35]
    ds_read_b128 v[72:75], v6 offset:22784
    v_mfma_f32_16x16x32_bf16 v[36:39], a[164:167], v[60:63], v[36:39]
    s_mul_i32 s55, s34, 40960
    s_add_u32 s55, s55, 0
    s_add_u32 m0, s54, 0
    s_nop 0
    buffer_load_dwordx4 v7, s[8:11], s55 offen sc1 lds
    v_mfma_f32_16x16x32_bf16 v[40:43], a[164:167], v[64:67], v[40:43]
    v_mfma_f32_16x16x32_bf16 v[44:47], a[168:171], v[60:63], v[44:47]
    v_mfma_f32_16x16x32_bf16 v[48:51], a[168:171], v[64:67], v[48:51]
    s_add_u32 s55, s55, 4096
    s_add_u32 m0, s54, 4096
    s_nop 0
    buffer_load_dwordx4 v7, s[8:11], s55 offen sc1 lds
    v_mfma_f32_16x16x32_bf16 v[52:55], a[172:175], v[60:63], v[52:55]
    v_mfma_f32_16x16x32_bf16 v[56:59], a[172:175], v[64:67], v[56:59]
    s_waitcnt lgkmcnt(1)
    v_mfma_f32_16x16x32_bf16 v[28:31], a[176:179], v[68:71], v[28:31]
    ds_read_b128 v[60:63], v6 offset:24576
    s_waitcnt lgkmcnt(1)
    v_mfma_f32_16x16x32_bf16 v[32:35], a[176:179], v[72:75], v[32:35]
    ds_read_b128 v[64:67], v6 offset:24832
    v_mfma_f32_16x16x32_bf16 v[36:39], a[180:183], v[68:71], v[36:39]
    s_add_u32 s55, s55, 4096
    s_add_u32 m0, s54, 8192
    s_nop 0
    buffer_load_dwordx4 v7, s[8:11], s55 offen sc1 lds
    v_mfma_f32_16x16x32_bf16 v[40:43], a[180:183], v[72:75], v[40:43]
    v_mfma_f32_16x16x32_bf16 v[44:47], a[184:187], v[68:71], v[44:47]
    v_mfma_f32_16x16x32_bf16 v[48:51], a[184:187], v[72:75], v[48:51]
    s_add_u32 s55, s55, 4096
    s_add_u32 m0, s54, 12288
    s_nop 0
    buffer_load_dwordx4 v7, s[8:11], s55 offen sc1 lds
    v_mfma_f32_16x16x32_bf16 v[52:55], a[188:191], v[68:71], v[52:55]
    v_mfma_f32_16x16x32_bf16 v[56:59], a[188:191], v[72:75], v[56:59]
    s_waitcnt lgkmcnt(1)
    v_mfma_f32_16x16x32_bf16 v[28:31], a[192:195], v[60:63], v[28:31]
    ds_read_b128 v[68:71], v6 offset:26624
    s_waitcnt lgkmcnt(1)
    v_mfma_f32_16x16x32_bf16 v[32:35], a[192:195], v[64:67], v[32:35]
    ds_read_b128 v[72:75], v6 offset:26880
    v_mfma_f32_16x16x32_bf16 v[36:39], a[196:199], v[60:63], v[36:39]
    s_add_u32 s55, s55, 4096
    s_add_u32 m0, s54, 16384
    s_nop 0
    buffer_load_dwordx4 v7, s[8:11], s55 offen sc1 lds
    v_mfma_f32_16x16x32_bf16 v[40:43], a[196:199], v[64:67], v[40:43]
    v_mfma_f32_16x16x32_bf16 v[44:47], a[200:203], v[60:63], v[44:47]
    v_mfma_f32_16x16x32_bf16 v[48:51], a[200:203], v[64:67], v[48:51]
    v_mfma_f32_16x16x32_bf16 v[52:55], a[204:207], v[60:63], v[52:55]
    v_mfma_f32_16x16x32_bf16 v[56:59], a[204:207], v[64:67], v[56:59]
    s_waitcnt lgkmcnt(1)
    v_mfma_f32_16x16x32_bf16 v[28:31], a[208:211], v[68:71], v[28:31]
    ds_read_b128 v[60:63], v6 offset:28672
    s_waitcnt lgkmcnt(1)
    v_mfma_f32_16x16x32_bf16 v[32:35], a[208:211], v[72:75], v[32:35]
    ds_read_b128 v[64:67], v6 offset:28928
    v_mfma_f32_16x16x32_bf16 v[36:39], a[212:215], v[68:71], v[36:39]
    v_mfma_f32_16x16x32_bf16 v[40:43], a[212:215], v[72:75], v[40:43]
    v_mfma_f32_16x16x32_bf16 v[44:47], a[216:219], v[68:71], v[44:47]
    v_mfma_f32_16x16x32_bf16 v[48:51], a[216:219], v[72:75], v[48:51]
    v_mfma_f32_16x16x32_bf16 v[52:55], a[220:223], v[68:71], v[52:55]
    v_mfma_f32_16x16x32_bf16 v[56:59], a[220:223], v[72:75], v[56:59]
    s_waitcnt lgkmcnt(1)
    v_mfma_f32_16x16x32_bf16 v[28:31], a[224:227], v[60:63], v[28:31]
    ds_read_b128 v[68:71], v6 offset:30720
    s_waitcnt lgkmcnt(1)
    v_mfma_f32_16x16x32_bf16 v[32:35], a[224:227], v[64:67], v[32:35]
    ds_read_b128 v[72:75], v6 offset:30976
    v_mfma_f32_16x16x32_bf16 v[36:39], a[228:231], v[60:63], v[36:39]
    v_mfma_f32_16x16x32_bf16 v[40:43], a[228:231], v[64:67], v[40:43]
    v_mfma_f32_16x16x32_bf16 v[44:47], a[232:235], v[60:63], v[44:47]
    v_mfma_f32_16x16x32_bf16 v[48:51], a[232:235], v[64:67], v[48:51]
    v_mfma_f32_16x16x32_bf16 v[52:55], a[236:239], v[60:63], v[52:55]
    v_mfma_f32_16x16x32_bf16 v[56:59], a[236:239], v[64:67], v[56:59]
    s_waitcnt lgkmcnt(1)
    v_mfma_f32_16x16x32_bf16 v[28:31], a[240:243], v[68:71], v[28:31]
    ds_read_b128 v[60:63], v6 offset:32768
    s_waitcnt lgkmcnt(1)
    v_mfma_f32_16x16x32_bf16 v[32:35], a[240:243], v[72:75], v[32:35]
    ds_read_b128 v[64:67], v6 offset:33024
    v_mfma_f32_16x16x32_bf16 v[36:39], a[244:247], v[68:71], v[36:39]
    v_mfma_f32_16x16x32_bf16 v[40:43], a[244:247], v[72:75], v[40:43]
    v_mfma_f32_16x16x32_bf16 v[44:47], a[248:251], v[68:71], v[44:47]
    v_mfma_f32_16x16x32_bf16 v[48:51], a[248:251], v[72:75], v[48:51]
    v_mfma_f32_16x16x32_bf16 v[52:55], a[252:255], v[68:71], v[52:55]
    v_mfma_f32_16x16x32_bf16 v[56:59], a[252:255], v[72:75], v[56:59]
    s_waitcnt lgkmcnt(1)
    v_mfma_f32_16x16x32_bf16 v[28:31], v[192:195], v[60:63], v[28:31]
    ds_read_b128 v[68:71], v6 offset:34816
    s_waitcnt lgkmcnt(1)
    v_mfma_f32_16x16x32_bf16 v[32:35], v[192:195], v[64:67], v[32:35]
    ds_read_b128 v[72:75], v6 offset:35072
    v_mfma_f32_16x16x32_bf16 v[36:39], v[196:199], v[60:63], v[36:39]
    v_mfma_f32_16x16x32_bf16 v[40:43], v[196:199], v[64:67], v[40:43]
    v_mfma_f32_16x16x32_bf16 v[44:47], v[200:203], v[60:63], v[44:47]
    v_mfma_f32_16x16x32_bf16 v[48:51], v[200:203], v[64:67], v[48:51]
    v_mfma_f32_16x16x32_bf16 v[52:55], v[204:207], v[60:63], v[52:55]
    v_mfma_f32_16x16x32_bf16 v[56:59], v[204:207], v[64:67], v[56:59]
    s_waitcnt lgkmcnt(1)
    v_mfma_f32_16x16x32_bf16 v[28:31], v[208:211], v[68:71], v[28:31]
    ds_read_b128 v[60:63], v6 offset:36864
    s_waitcnt lgkmcnt(1)
    v_mfma_f32_16x16x32_bf16 v[32:35], v[208:211], v[72:75], v[32:35]
    ds_read_b128 v[64:67], v6 offset:37120
    v_mfma_f32_16x16x32_bf16 v[36:39], v[212:215], v[68:71], v[36:39]
    v_mfma_f32_16x16x32_bf16 v[40:43], v[212:215], v[72:75], v[40:43]
    v_mfma_f32_16x16x32_bf16 v[44:47], v[216:219], v[68:71], v[44:47]
    v_mfma_f32_16x16x32_bf16 v[48:51], v[216:219], v[72:75], v[48:51]
    v_mfma_f32_16x16x32_bf16 v[52:55], v[220:223], v[68:71], v[52:55]
    v_mfma_f32_16x16x32_bf16 v[56:59], v[220:223], v[72:75], v[56:59]
    s_waitcnt lgkmcnt(1)
    v_mfma_f32_16x16x32_bf16 v[28:31], v[224:227], v[60:63], v[28:31]
    ds_read_b128 v[68:71], v6 offset:38912
    s_waitcnt lgkmcnt(1)
    v_mfma_f32_16x16x32_bf16 v[32:35], v[224:227], v[64:67], v[32:35]
    ds_read_b128 v[72:75], v6 offset:39168
    v_mfma_f32_16x16x32_bf16 v[36:39], v[228:231], v[60:63], v[36:39]
    v_mfma_f32_16x16x32_bf16 v[40:43], v[228:231], v[64:67], v[40:43]
    v_mfma_f32_16x16x32_bf16 v[44:47], v[232:235], v[60:63], v[44:47]
    v_mfma_f32_16x16x32_bf16 v[48:51], v[232:235], v[64:67], v[48:51]
    v_mfma_f32_16x16x32_bf16 v[52:55], v[236:239], v[60:63], v[52:55]
    v_mfma_f32_16x16x32_bf16 v[56:59], v[236:239], v[64:67], v[56:59]
    s_waitcnt lgkmcnt(1)
    v_mfma_f32_16x16x32_bf16 v[28:31], v[240:243], v[68:71], v[28:31]
    s_waitcnt lgkmcnt(0)
    v_mfma_f32_16x16x32_bf16 v[32:35], v[240:243], v[72:75], v[32:35]
    v_mfma_f32_16x16x32_bf16 v[36:39], v[244:247], v[68:71], v[36:39]
    v_mfma_f32_16x16x32_bf16 v[40:43], v[244:247], v[72:75], v[40:43]
    v_mfma_f32_16x16x32_bf16 v[44:47], v[248:251], v[68:71], v[44:47]
    v_mfma_f32_16x16x32_bf16 v[48:51], v[248:251], v[72:75], v[48:51]
    v_mfma_f32_16x16x32_bf16 v[52:55], v[252:255], v[68:71], v[52:55]
    v_mfma_f32_16x16x32_bf16 v[56:59], v[252:255], v[72:75], v[56:59]
    s_mul_i32 s32, s48, 393216
    s_add_u32 s32, s32, 0x400000
    s_add_u32 s33, s32, 6144
    v_cvt_pk_bf16_f32 v92, v28, v29
    v_cvt_pk_bf16_f32 v93, v30, v31
    v_cvt_pk_bf16_f32 v94, v36, v37
    v_cvt_pk_bf16_f32 v95, v38, v39
    buffer_store_dwordx4 v[92:95], v24, s[8:11], s32 offen sc1
    v_cvt_pk_bf16_f32 v96, v32, v33
    v_cvt_pk_bf16_f32 v97, v34, v35
    v_cvt_pk_bf16_f32 v98, v40, v41
    v_cvt_pk_bf16_f32 v99, v42, v43
    buffer_store_dwordx4 v[96:99], v24, s[8:11], s33 offen sc1
    v_cvt_pk_bf16_f32 v92, v44, v45
    v_cvt_pk_bf16_f32 v93, v46, v47
    v_cvt_pk_bf16_f32 v94, v52, v53
    v_cvt_pk_bf16_f32 v95, v54, v55
    buffer_store_dwordx4 v[92:95], v25, s[8:11], s32 offen sc1
    v_cvt_pk_bf16_f32 v96, v48, v49
    v_cvt_pk_bf16_f32 v97, v50, v51
    v_cvt_pk_bf16_f32 v98, v56, v57
    v_cvt_pk_bf16_f32 v99, v58, v59
    buffer_store_dwordx4 v[96:99], v25, s[8:11], s33 offen sc1
    s_mul_i32 s49, s48, 2048
    s_lshl_b32 s32, s6, 4
    s_add_u32 s49, s49, s32
    s_lshl_b32 s32, s7, 9
    s_add_u32 s49, s49, s32
    s_add_u32 s49, s49, 0xa800000
    s_add_u32 s34, s48, 2
    s_cmp_lt_u32 s34, 32
    s_cselect_b32 s32, s97, s98
    s_lshl_b32 s47, s34, 16
    s_add_u32 s32, s32, s47
    s_add_u32 s32, s32, 0xa400000
    s_add_u32 s32, s32, s56
    s_mul_i32 s33, s34, 81920
    s_mul_i32 s35, s57, 2560
    s_add_u32 s33, s33, s35
    s_add_u32 s33, s33, 0xa820c00
    s_cmp_lg_u32 s4, 0
    s_cmov_b32 s32, s33
    s_cmp_ge_u32 s34, 64
    s_cmov_b32 s32, 0x40000000
    s_cmp_ge_u32 s57, 32
    s_cmov_b32 s32, 0x40000000
    buffer_store_dwordx4 v[20:23], v16, s[8:11], s32 offen sc1
    s_cmp_ge_u32 s48, 1
    s_cbranch_scc1 nf_136
    s_waitcnt vmcnt(0)
    s_barrier
    buffer_store_dword v13, v8, s[8:11], s49 offen sc1
nf_136:
    s_add_u32 s48, s48, 1
    s_cmp_lt_u32 s48, 64
    s_cbranch_scc1 QK_loop
    s_waitcnt vmcnt(0) lgkmcnt(0)
    s_barrier
    buffer_store_dword v13, v8, s[8:11], s49 offen sc1
    s_endpgm
VO_start:
    s_mov_b32 s12, s72
    s_and_b32 s13, s73, 0xffff
    s_mov_b32 s14, 0x780000
    s_mov_b32 s15, 0x20000
    s_mov_b32 s20, s74
    s_and_b32 s21, s75, 0xffff
    s_mov_b32 s22, 0x780000
    s_mov_b32 s23, 0x20000
    s_mul_i32 s50, s6, 384
    s_mul_i32 s51, s6, 245760
    s_lshl_b32 s54, s4, 10
    v_lshrrev_b32 v2, 5, v1
    v_lshlrev_b32 v2, 10, v2
    v_bfe_u32 v3, v1, 2, 3
    v_lshl_add_u32 v2, v3, 7, v2
    v_and_b32 v4, 3, v1
    v_lshl_add_u32 v2, v4, 3, v2
    v_lshrrev_b32 v3, 1, v3
    s_mul_i32 s32, s4, 3
    s_add_u32 s32, s32, 0
    s_lshr_b32 s33, s32, 2
    s_mul_i32 s33, s33, 4096
    v_add_u32 v4, s32, v3
    v_and_b32 v4, 3, v4
    v_lshl_add_u32 v4, v4, 5, v2
    v_add_u32 v16, s33, v4
    s_mul_i32 s32, s4, 3
    s_add_u32 s32, s32, 1
    s_lshr_b32 s33, s32, 2
    s_mul_i32 s33, s33, 4096
    v_add_u32 v4, s32, v3
    v_and_b32 v4, 3, v4
    v_lshl_add_u32 v4, v4, 5, v2
    v_add_u32 v17, s33, v4
    s_mul_i32 s32, s4, 3
    s_add_u32 s32, s32, 2
    s_lshr_b32 s33, s32, 2
    s_mul_i32 s33, s33, 4096
    v_add_u32 v4, s32, v3
    v_and_b32 v4, 3, v4
    v_lshl_add_u32 v4, v4, 5, v2
    v_add_u32 v18, s33, v4
    v_lshrrev_b32 v2, 3, v1
    v_bfe_u32 v3, v1, 1, 2
    v_lshrrev_b32 v4, 1, v2
    v_sub_u32 v3, v3, v4
    v_and_b32 v3, 3, v3
    v_and_b32 v4, 1, v1
    v_lshl_add_u32 v3, v3, 1, v4
    v_lshrrev_b32 v4, 2, v2
    v_and_b32 v5, 3, v2
    v_lshl_add_u32 v4, v4, 3, v5
    s_and_b32 s32, s4, 1
    s_lshl_b32 s32, s32, 4
    s_lshr_b32 s33, s4, 1
    s_lshl_b32 s33, s33, 2
    s_add_u32 s32, s32, s33
    v_add_u32 v4, s32, v4
    v_mul_u32_u24 v4, 12288, v4
    v_lshl_add_u32 v24, v3, 4, v4
    v_lshrrev_b32 v2, 5, v1
    v_lshlrev_b32 v2, 10, v2
    v_bfe_u32 v3, v1, 2, 3
    v_lshl_add_u32 v2, v3, 7, v2
    v_and_b32 v4, 3, v1
    v_lshl_add_u32 v2, v4, 3, v2
    v_lshrrev_b32 v3, 1, v3
    s_mul_i32 s32, s4, 10
    s_add_u32 s32, s32, 0
    s_lshr_b32 s33, s32, 2
    s_mul_i32 s33, s33, 4096
    v_add_u32 v4, s32, v3
    v_and_b32 v4, 3, v4
    v_lshl_add_u32 v4, v4, 5, v2
    v_add_u32 v20, s33, v4
    s_mul_i32 s32, s4, 10
    s_add_u32 s32, s32, 1
    s_lshr_b32 s33, s32, 2
    s_mul_i32 s33, s33, 4096
    v_add_u32 v4, s32, v3
    v_and_b32 v4, 3, v4
    v_lshl_add_u32 v4, v4, 5, v2
    v_add_u32 v21, s33, v4
    s_mul_i32 s32, s4, 10
    s_add_u32 s32, s32, 2
    s_lshr_b32 s33, s32, 2
    s_mul_i32 s33, s33, 4096
    v_add_u32 v4, s32, v3
    v_and_b32 v4, 3, v4
    v_lshl_add_u32 v4, v4, 5, v2
    v_add_u32 v22, s33, v4
    s_mul_i32 s32, s4, 10
    s_add_u32 s32, s32, 3
    s_lshr_b32 s33, s32, 2
    s_mul_i32 s33, s33, 4096
    v_add_u32 v4, s32, v3
    v_and_b32 v4, 3, v4
    v_lshl_add_u32 v4, v4, 5, v2
    v_add_u32 v23, s33, v4
    v_lshrrev_b32 v2, 3, v1
    v_bfe_u32 v3, v1, 1, 2
    v_lshrrev_b32 v4, 1, v2
    v_sub_u32 v3, v3, v4
    v_and_b32 v3, 3, v3
    v_and_b32 v4, 1, v1
    v_lshl_add_u32 v3, v3, 1, v4
    v_lshrrev_b32 v4, 2, v2
    v_and_b32 v5, 3, v2
    v_lshl_add_u32 v4, v4, 3, v5
    s_and_b32 s32, s4, 1
    s_lshl_b32 s32, s32, 4
    s_lshr_b32 s33, s4, 1
    s_lshl_b32 s33, s33, 2
    s_add_u32 s32, s32, s33
    v_add_u32 v4, s32, v4
    v_mul_u32_u24 v4, 1280, v4
    v_lshl_add_u32 v25, v3, 4, v4
    s_mul_i32 s32, s4, 26624
    s_add_u32 s32, s32, 53248
    v_lshl_add_u32 v14, v1, 4, s32
    s_add_u32 m0, s54, 0
    s_add_u32 s32, s50, 0
    buffer_load_dwordx4 v24, s[12:15], s32 offen nt lds
    s_add_u32 m0, s54, 4096
    s_add_u32 s32, s50, 128
    buffer_load_dwordx4 v24, s[12:15], s32 offen nt lds
    s_add_u32 m0, s54, 8192
    s_add_u32 s32, s50, 256
    buffer_load_dwordx4 v24, s[12:15], s32 offen nt lds
    s_add_u32 m0, s54, 12288
    s_add_u32 s32, s50, 393216
    buffer_load_dwordx4 v24, s[12:15], s32 offen nt lds
    s_add_u32 m0, s54, 16384
    s_add_u32 s32, s50, 393344
    buffer_load_dwordx4 v24, s[12:15], s32 offen nt lds
    s_add_u32 m0, s54, 20480
    s_add_u32 s32, s50, 393472
    buffer_load_dwordx4 v24, s[12:15], s32 offen nt lds
    s_add_u32 m0, s54, 24576
    s_add_u32 s32, s50, 786432
    buffer_load_dwordx4 v24, s[12:15], s32 offen nt lds
    s_add_u32 m0, s54, 28672
    s_add_u32 s32, s50, 786560
    buffer_load_dwordx4 v24, s[12:15], s32 offen nt lds
    s_add_u32 m0, s54, 32768
    s_add_u32 s32, s50, 786688
    buffer_load_dwordx4 v24, s[12:15], s32 offen nt lds
    s_add_u32 m0, s54, 36864
    s_add_u32 s32, s50, 1179648
    buffer_load_dwordx4 v24, s[12:15], s32 offen nt lds
    s_add_u32 m0, s54, 40960
    s_add_u32 s32, s50, 1179776
    buffer_load_dwordx4 v24, s[12:15], s32 offen nt lds
    s_add_u32 m0, s54, 45056
    s_add_u32 s32, s50, 1179904
    buffer_load_dwordx4 v24, s[12:15], s32 offen nt lds
    s_add_u32 m0, s54, 49152
    s_add_u32 s32, s50, 1572864
    buffer_load_dwordx4 v24, s[12:15], s32 offen nt lds
    s_add_u32 m0, s54, 53248
    s_add_u32 s32, s50, 1572992
    buffer_load_dwordx4 v24, s[12:15], s32 offen nt lds
    s_add_u32 m0, s54, 57344
    s_add_u32 s32, s50, 1573120
    buffer_load_dwordx4 v24, s[12:15], s32 offen nt lds
    s_add_u32 m0, s54, 61440
    s_add_u32 s32, s50, 1966080
    buffer_load_dwordx4 v24, s[12:15], s32 offen nt lds
    s_add_u32 m0, s54, 65536
    s_add_u32 s32, s50, 1966208
    buffer_load_dwordx4 v24, s[12:15], s32 offen nt lds
    s_add_u32 m0, s54, 69632
    s_add_u32 s32, s50, 1966336
    buffer_load_dwordx4 v24, s[12:15], s32 offen nt lds
    s_add_u32 m0, s54, 73728
    s_add_u32 s32, s50, 2359296
    buffer_load_dwordx4 v24, s[12:15], s32 offen nt lds
    s_add_u32 m0, s54, 77824
    s_add_u32 s32, s50, 2359424
    buffer_load_dwordx4 v24, s[12:15], s32 offen nt lds
    s_add_u32 m0, s54, 81920
    s_add_u32 s32, s50, 2359552
    buffer_load_dwordx4 v24, s[12:15], s32 offen nt lds
    s_add_u32 m0, s54, 86016
    s_add_u32 s32, s50, 2752512
    buffer_load_dwordx4 v24, s[12:15], s32 offen nt lds
    s_add_u32 m0, s54, 90112
    s_add_u32 s32, s50, 2752640
    buffer_load_dwordx4 v24, s[12:15], s32 offen nt lds
    s_add_u32 m0, s54, 94208
    s_add_u32 s32, s50, 2752768
    buffer_load_dwordx4 v24, s[12:15], s32 offen nt lds
    s_add_u32 m0, s54, 98304
    s_add_u32 s32, s50, 3145728
    buffer_load_dwordx4 v24, s[12:15], s32 offen nt lds
    s_add_u32 m0, s54, 102400
    s_add_u32 s32, s50, 3145856
    buffer_load_dwordx4 v24, s[12:15], s32 offen nt lds
    s_add_u32 m0, s54, 106496
    s_add_u32 s32, s50, 3145984
    buffer_load_dwordx4 v24, s[12:15], s32 offen nt lds
    s_add_u32 m0, s54, 110592
    s_add_u32 s32, s50, 3538944
    buffer_load_dwordx4 v24, s[12:15], s32 offen nt lds
    s_add_u32 m0, s54, 114688
    s_add_u32 s32, s50, 3539072
    buffer_load_dwordx4 v24, s[12:15], s32 offen nt lds
    s_add_u32 m0, s54, 118784
    s_add_u32 s32, s50, 3539200
    buffer_load_dwordx4 v24, s[12:15], s32 offen nt lds
    s_add_u32 m0, s54, 122880
    s_add_u32 s32, s50, 3932160
    buffer_load_dwordx4 v24, s[12:15], s32 offen nt lds
    s_add_u32 m0, s54, 126976
    s_add_u32 s32, s50, 3932288
    buffer_load_dwordx4 v24, s[12:15], s32 offen nt lds
    s_add_u32 m0, s54, 131072
    s_add_u32 s32, s50, 3932416
    buffer_load_dwordx4 v24, s[12:15], s32 offen nt lds
    s_add_u32 m0, s54, 135168
    s_add_u32 s32, s50, 4325376
    buffer_load_dwordx4 v24, s[12:15], s32 offen nt lds
    s_add_u32 m0, s54, 139264
    s_add_u32 s32, s50, 4325504
    buffer_load_dwordx4 v24, s[12:15], s32 offen nt lds
    s_add_u32 m0, s54, 143360
    s_add_u32 s32, s50, 4325632
    buffer_load_dwordx4 v24, s[12:15], s32 offen nt lds
    s_add_u32 m0, s54, 147456
    s_add_u32 s32, s50, 4718592
    buffer_load_dwordx4 v24, s[12:15], s32 offen nt lds
    s_add_u32 m0, s54, 151552
    s_add_u32 s32, s50, 4718720
    buffer_load_dwordx4 v24, s[12:15], s32 offen nt lds
    s_add_u32 m0, s54, 155648
    s_add_u32 s32, s50, 4718848
    buffer_load_dwordx4 v24, s[12:15], s32 offen nt lds
    s_waitcnt vmcnt(36)
    s_barrier
    ds_read_b64_tr_b16 a[0:1], v16 offset:0
    ds_read_b64_tr_b16 a[2:3], v16 offset:2048
    ds_read_b64_tr_b16 a[4:5], v17 offset:0
    ds_read_b64_tr_b16 a[6:7], v17 offset:2048
    ds_read_b64_tr_b16 a[8:9], v18 offset:0
    ds_read_b64_tr_b16 a[10:11], v18 offset:2048
    s_waitcnt lgkmcnt(0)
    s_waitcnt vmcnt(33)
    s_barrier
    s_add_u32 m0, s54, 0
    s_add_u32 s32, s50, 5111808
    buffer_load_dwordx4 v24, s[12:15], s32 offen nt lds
    s_add_u32 m0, s54, 4096
    s_add_u32 s32, s50, 5111936
    buffer_load_dwordx4 v24, s[12:15], s32 offen nt lds
    s_add_u32 m0, s54, 8192
    s_add_u32 s32, s50, 5112064
    buffer_load_dwordx4 v24, s[12:15], s32 offen nt lds
    ds_read_b64_tr_b16 a[12:13], v16 offset:12288
    ds_read_b64_tr_b16 a[14:15], v16 offset:14336
    ds_read_b64_tr_b16 a[16:17], v17 offset:12288
    ds_read_b64_tr_b16 a[18:19], v17 offset:14336
    ds_read_b64_tr_b16 a[20:21], v18 offset:12288
    ds_read_b64_tr_b16 a[22:23], v18 offset:14336
    s_waitcnt lgkmcnt(0)
    s_waitcnt vmcnt(33)
    s_barrier
    s_add_u32 m0, s54, 12288
    s_add_u32 s32, s50, 5505024
    buffer_load_dwordx4 v24, s[12:15], s32 offen nt lds
    s_add_u32 m0, s54, 16384
    s_add_u32 s32, s50, 5505152
    buffer_load_dwordx4 v24, s[12:15], s32 offen nt lds
    s_add_u32 m0, s54, 20480
    s_add_u32 s32, s50, 5505280
    buffer_load_dwordx4 v24, s[12:15], s32 offen nt lds
    ds_read_b64_tr_b16 a[24:25], v16 offset:24576
    ds_read_b64_tr_b16 a[26:27], v16 offset:26624
    ds_read_b64_tr_b16 a[28:29], v17 offset:24576
    ds_read_b64_tr_b16 a[30:31], v17 offset:26624
    ds_read_b64_tr_b16 a[32:33], v18 offset:24576
    ds_read_b64_tr_b16 a[34:35], v18 offset:26624
    s_waitcnt lgkmcnt(0)
    s_waitcnt vmcnt(33)
    s_barrier
    s_add_u32 m0, s54, 24576
    s_add_u32 s32, s50, 5898240
    buffer_load_dwordx4 v24, s[12:15], s32 offen nt lds
    s_add_u32 m0, s54, 28672
    s_add_u32 s32, s50, 5898368
    buffer_load_dwordx4 v24, s[12:15], s32 offen nt lds
    s_add_u32 m0, s54, 32768
    s_add_u32 s32, s50, 5898496
    buffer_load_dwordx4 v24, s[12:15], s32 offen nt lds
    ds_read_b64_tr_b16 a[36:37], v16 offset:36864
    ds_read_b64_tr_b16 a[38:39], v16 offset:38912
    ds_read_b64_tr_b16 a[40:41], v17 offset:36864
    ds_read_b64_tr_b16 a[42:43], v17 offset:38912
    ds_read_b64_tr_b16 a[44:45], v18 offset:36864
    ds_read_b64_tr_b16 a[46:47], v18 offset:38912
    s_waitcnt lgkmcnt(0)
    s_waitcnt vmcnt(33)
    s_barrier
    s_add_u32 m0, s54, 36864
    s_add_u32 s32, s50, 6291456
    buffer_load_dwordx4 v24, s[12:15], s32 offen nt lds
    s_add_u32 m0, s54, 40960
    s_add_u32 s32, s50, 6291584
    buffer_load_dwordx4 v24, s[12:15], s32 offen nt lds
    s_add_u32 m0, s54, 45056
    s_add_u32 s32, s50, 6291712
    buffer_load_dwordx4 v24, s[12:15], s32 offen nt lds
    ds_read_b64_tr_b16 a[48:49], v16 offset:49152
    ds_read_b64_tr_b16 a[50:51], v16 offset:51200
    ds_read_b64_tr_b16 a[52:53], v17 offset:49152
    ds_read_b64_tr_b16 a[54:55], v17 offset:51200
    ds_read_b64_tr_b16 a[56:57], v18 offset:49152
    ds_read_b64_tr_b16 a[58:59], v18 offset:51200
    s_waitcnt lgkmcnt(0)
    s_waitcnt vmcnt(33)
    s_barrier
    s_add_u32 m0, s54, 49152
    s_add_u32 s32, s50, 6684672
    buffer_load_dwordx4 v24, s[12:15], s32 offen nt lds
    s_add_u32 m0, s54, 53248
    s_add_u32 s32, s50, 6684800
    buffer_load_dwordx4 v24, s[12:15], s32 offen nt lds
    s_add_u32 m0, s54, 57344
    s_add_u32 s32, s50, 6684928
    buffer_load_dwordx4 v24, s[12:15], s32 offen nt lds
    ds_read_b64_tr_b16 a[60:61], v16 offset:61440
    ds_read_b64_tr_b16 a[62:63], v16 offset:63488
    ds_read_b64_tr_b16 a[64:65], v17 offset:61440
    ds_read_b64_tr_b16 a[66:67], v17 offset:63488
    ds_read_b64_tr_b16 a[68:69], v18 offset:61440
    ds_read_b64_tr_b16 a[70:71], v18 offset:63488
    s_waitcnt lgkmcnt(0)
    s_waitcnt vmcnt(33)
    s_barrier
    s_add_u32 m0, s54, 61440
    s_add_u32 s32, s50, 7077888
    buffer_load_dwordx4 v24, s[12:15], s32 offen nt lds
    s_add_u32 m0, s54, 65536
    s_add_u32 s32, s50, 7078016
    buffer_load_dwordx4 v24, s[12:15], s32 offen nt lds
    s_add_u32 m0, s54, 69632
    s_add_u32 s32, s50, 7078144
    buffer_load_dwordx4 v24, s[12:15], s32 offen nt lds
    v_add_u32 v10, 0x10000, v16
    ds_read_b64_tr_b16 a[72:73], v10 offset:8192
    ds_read_b64_tr_b16 a[74:75], v10 offset:10240
    v_add_u32 v11, 0x10000, v17
    ds_read_b64_tr_b16 a[76:77], v11 offset:8192
    ds_read_b64_tr_b16 a[78:79], v11 offset:10240
    v_add_u32 v10, 0x10000, v18
    ds_read_b64_tr_b16 a[80:81], v10 offset:8192
    ds_read_b64_tr_b16 a[82:83], v10 offset:10240
    s_waitcnt lgkmcnt(0)
    s_waitcnt vmcnt(33)
    s_barrier
    s_add_u32 m0, s54, 73728
    s_add_u32 s32, s50, 7471104
    buffer_load_dwordx4 v24, s[12:15], s32 offen nt lds
    s_add_u32 m0, s54, 77824
    s_add_u32 s32, s50, 7471232
    buffer_load_dwordx4 v24, s[12:15], s32 offen nt lds
    s_add_u32 m0, s54, 81920
    s_add_u32 s32, s50, 7471360
    buffer_load_dwordx4 v24, s[12:15], s32 offen nt lds
    v_add_u32 v11, 0x10000, v16
    ds_read_b64_tr_b16 a[84:85], v11 offset:20480
    ds_read_b64_tr_b16 a[86:87], v11 offset:22528
    v_add_u32 v10, 0x10000, v17
    ds_read_b64_tr_b16 a[88:89], v10 offset:20480
    ds_read_b64_tr_b16 a[90:91], v10 offset:22528
    v_add_u32 v11, 0x10000, v18
    ds_read_b64_tr_b16 a[92:93], v11 offset:20480
    ds_read_b64_tr_b16 a[94:95], v11 offset:22528
    s_waitcnt lgkmcnt(0)
    s_waitcnt vmcnt(33)
    s_barrier
    v_add_u32 v10, 0x18000, v16
    ds_read_b64_tr_b16 a[96:97], v10 offset:0
    ds_read_b64_tr_b16 a[98:99], v10 offset:2048
    v_add_u32 v11, 0x18000, v17
    ds_read_b64_tr_b16 a[100:101], v11 offset:0
    ds_read_b64_tr_b16 a[102:103], v11 offset:2048
    v_add_u32 v10, 0x18000, v18
    ds_read_b64_tr_b16 a[104:105], v10 offset:0
    ds_read_b64_tr_b16 a[106:107], v10 offset:2048
    s_waitcnt lgkmcnt(0)
    s_waitcnt vmcnt(30)
    s_barrier
    v_add_u32 v11, 0x18000, v16
    ds_read_b64_tr_b16 v[28:29], v11 offset:12288
    ds_read_b64_tr_b16 v[30:31], v11 offset:14336
    v_add_u32 v10, 0x18000, v17
    ds_read_b64_tr_b16 v[32:33], v10 offset:12288
    ds_read_b64_tr_b16 v[34:35], v10 offset:14336
    v_add_u32 v11, 0x18000, v18
    ds_read_b64_tr_b16 v[36:37], v11 offset:12288
    ds_read_b64_tr_b16 v[38:39], v11 offset:14336
    s_waitcnt lgkmcnt(0)
    s_waitcnt vmcnt(27)
    s_barrier
    v_add_u32 v10, 0x18000, v16
    ds_read_b64_tr_b16 a[108:109], v10 offset:24576
    ds_read_b64_tr_b16 a[110:111], v10 offset:26624
    v_add_u32 v11, 0x18000, v17
    ds_read_b64_tr_b16 a[112:113], v11 offset:24576
    ds_read_b64_tr_b16 a[114:115], v11 offset:26624
    v_add_u32 v10, 0x18000, v18
    ds_read_b64_tr_b16 a[116:117], v10 offset:24576
    ds_read_b64_tr_b16 a[118:119], v10 offset:26624
    s_waitcnt lgkmcnt(0)
    s_waitcnt vmcnt(24)
    s_barrier
    s_add_u32 m0, s54, 86016
    s_add_u32 s32, s51, 0
    buffer_load_dwordx4 v25, s[20:23], s32 offen nt lds
    s_add_u32 m0, s54, 90112
    s_add_u32 s32, s51, 128
    buffer_load_dwordx4 v25, s[20:23], s32 offen nt lds
    s_add_u32 m0, s54, 94208
    s_add_u32 s32, s51, 256
    buffer_load_dwordx4 v25, s[20:23], s32 offen nt lds
    s_add_u32 m0, s54, 98304
    s_add_u32 s32, s51, 384
    buffer_load_dwordx4 v25, s[20:23], s32 offen nt lds
    s_add_u32 m0, s54, 102400
    s_add_u32 s32, s51, 512
    buffer_load_dwordx4 v25, s[20:23], s32 offen nt lds
    s_add_u32 m0, s54, 106496
    s_add_u32 s32, s51, 640
    buffer_load_dwordx4 v25, s[20:23], s32 offen nt lds
    s_add_u32 m0, s54, 110592
    s_add_u32 s32, s51, 768
    buffer_load_dwordx4 v25, s[20:23], s32 offen nt lds
    s_add_u32 m0, s54, 114688
    s_add_u32 s32, s51, 896
    buffer_load_dwordx4 v25, s[20:23], s32 offen nt lds
    s_add_u32 m0, s54, 118784
    s_add_u32 s32, s51, 1024
    buffer_load_dwordx4 v25, s[20:23], s32 offen nt lds
    s_add_u32 m0, s54, 122880
    s_add_u32 s32, s51, 1152
    buffer_load_dwordx4 v25, s[20:23], s32 offen nt lds
    v_add_u32 v11, 0x20000, v16
    ds_read_b64_tr_b16 a[120:121], v11 offset:4096
    ds_read_b64_tr_b16 a[122:123], v11 offset:6144
    v_add_u32 v10, 0x20000, v17
    ds_read_b64_tr_b16 a[124:125], v10 offset:4096
    ds_read_b64_tr_b16 a[126:127], v10 offset:6144
    v_add_u32 v11, 0x20000, v18
    ds_read_b64_tr_b16 a[128:129], v11 offset:4096
    ds_read_b64_tr_b16 a[130:131], v11 offset:6144
    s_waitcnt lgkmcnt(0)
    s_waitcnt vmcnt(31)
    s_barrier
    v_add_u32 v10, 0x20000, v16
    ds_read_b64_tr_b16 a[132:133], v10 offset:16384
    ds_read_b64_tr_b16 a[134:135], v10 offset:18432
    v_add_u32 v11, 0x20000, v17
    ds_read_b64_tr_b16 a[136:137], v11 offset:16384
    ds_read_b64_tr_b16 a[138:139], v11 offset:18432
    v_add_u32 v10, 0x20000, v18
    ds_read_b64_tr_b16 a[140:141], v10 offset:16384
    ds_read_b64_tr_b16 a[142:143], v10 offset:18432
    s_waitcnt lgkmcnt(0)
    s_waitcnt vmcnt(28)
    s_barrier
    ds_read_b64_tr_b16 a[144:145], v16 offset:0
    ds_read_b64_tr_b16 a[146:147], v16 offset:2048
    ds_read_b64_tr_b16 a[148:149], v17 offset:0
    ds_read_b64_tr_b16 a[150:151], v17 offset:2048
    ds_read_b64_tr_b16 a[152:153], v18 offset:0
    ds_read_b64_tr_b16 a[154:155], v18 offset:2048
    s_waitcnt lgkmcnt(0)
    s_waitcnt vmcnt(25)
    s_barrier
    ds_read_b64_tr_b16 a[156:157], v16 offset:12288
    ds_read_b64_tr_b16 a[158:159], v16 offset:14336
    ds_read_b64_tr_b16 a[160:161], v17 offset:12288
    ds_read_b64_tr_b16 a[162:163], v17 offset:14336
    ds_read_b64_tr_b16 a[164:165], v18 offset:12288
    ds_read_b64_tr_b16 a[166:167], v18 offset:14336
    s_waitcnt lgkmcnt(0)
    s_waitcnt vmcnt(22)
    s_barrier
    ds_read_b64_tr_b16 a[168:169], v16 offset:24576
    ds_read_b64_tr_b16 a[170:171], v16 offset:26624
    ds_read_b64_tr_b16 a[172:173], v17 offset:24576
    ds_read_b64_tr_b16 a[174:175], v17 offset:26624
    ds_read_b64_tr_b16 a[176:177], v18 offset:24576
    ds_read_b64_tr_b16 a[178:179], v18 offset:26624
    s_waitcnt lgkmcnt(0)
    s_waitcnt vmcnt(19)
    s_barrier
    ds_read_b64_tr_b16 a[180:181], v16 offset:36864
    ds_read_b64_tr_b16 a[182:183], v16 offset:38912
    ds_read_b64_tr_b16 a[184:185], v17 offset:36864
    ds_read_b64_tr_b16 a[186:187], v17 offset:38912
    ds_read_b64_tr_b16 a[188:189], v18 offset:36864
    ds_read_b64_tr_b16 a[190:191], v18 offset:38912
    s_waitcnt lgkmcnt(0)
    s_waitcnt vmcnt(16)
    s_barrier
    s_add_u32 m0, s54, 0
    s_add_u32 s32, s51, 40960
    buffer_load_dwordx4 v25, s[20:23], s32 offen nt lds
    s_add_u32 m0, s54, 4096
    s_add_u32 s32, s51, 41088
    buffer_load_dwordx4 v25, s[20:23], s32 offen nt lds
    s_add_u32 m0, s54, 8192
    s_add_u32 s32, s51, 41216
    buffer_load_dwordx4 v25, s[20:23], s32 offen nt lds
    s_add_u32 m0, s54, 12288
    s_add_u32 s32, s51, 41344
    buffer_load_dwordx4 v25, s[20:23], s32 offen nt lds
    s_add_u32 m0, s54, 16384
    s_add_u32 s32, s51, 41472
    buffer_load_dwordx4 v25, s[20:23], s32 offen nt lds
    s_add_u32 m0, s54, 20480
    s_add_u32 s32, s51, 41600
    buffer_load_dwordx4 v25, s[20:23], s32 offen nt lds
    s_add_u32 m0, s54, 24576
    s_add_u32 s32, s51, 41728
    buffer_load_dwordx4 v25, s[20:23], s32 offen nt lds
    s_add_u32 m0, s54, 28672
    s_add_u32 s32, s51, 41856
    buffer_load_dwordx4 v25, s[20:23], s32 offen nt lds
    s_add_u32 m0, s54, 32768
    s_add_u32 s32, s51, 41984
    buffer_load_dwordx4 v25, s[20:23], s32 offen nt lds
    s_add_u32 m0, s54, 36864
    s_add_u32 s32, s51, 42112
    buffer_load_dwordx4 v25, s[20:23], s32 offen nt lds
    ds_read_b64_tr_b16 a[192:193], v16 offset:49152
    ds_read_b64_tr_b16 a[194:195], v16 offset:51200
    ds_read_b64_tr_b16 a[196:197], v17 offset:49152
    ds_read_b64_tr_b16 a[198:199], v17 offset:51200
    ds_read_b64_tr_b16 a[200:201], v18 offset:49152
    ds_read_b64_tr_b16 a[202:203], v18 offset:51200
    s_waitcnt lgkmcnt(0)
    s_waitcnt vmcnt(23)
    s_barrier
    ds_read_b64_tr_b16 a[204:205], v16 offset:61440
    ds_read_b64_tr_b16 a[206:207], v16 offset:63488
    ds_read_b64_tr_b16 a[208:209], v17 offset:61440
    ds_read_b64_tr_b16 a[210:211], v17 offset:63488
    ds_read_b64_tr_b16 a[212:213], v18 offset:61440
    ds_read_b64_tr_b16 a[214:215], v18 offset:63488
    s_waitcnt lgkmcnt(0)
    s_waitcnt vmcnt(20)
    s_barrier
    v_add_u32 v11, 0x10000, v16
    ds_read_b64_tr_b16 v[40:41], v11 offset:8192
    ds_read_b64_tr_b16 v[42:43], v11 offset:10240
    v_add_u32 v10, 0x10000, v17
    ds_read_b64_tr_b16 v[44:45], v10 offset:8192
    ds_read_b64_tr_b16 v[46:47], v10 offset:10240
    v_add_u32 v11, 0x10000, v18
    ds_read_b64_tr_b16 v[48:49], v11 offset:8192
    ds_read_b64_tr_b16 v[50:51], v11 offset:10240
    s_waitcnt lgkmcnt(0)
    s_waitcnt vmcnt(10)
    s_barrier
    s_add_u32 m0, s54, 40960
    s_add_u32 s32, s51, 81920
    buffer_load_dwordx4 v25, s[20:23], s32 offen nt lds
    s_add_u32 m0, s54, 45056
    s_add_u32 s32, s51, 82048
    buffer_load_dwordx4 v25, s[20:23], s32 offen nt lds
    s_add_u32 m0, s54, 49152
    s_add_u32 s32, s51, 82176
    buffer_load_dwordx4 v25, s[20:23], s32 offen nt lds
    s_add_u32 m0, s54, 53248
    s_add_u32 s32, s51, 82304
    buffer_load_dwordx4 v25, s[20:23], s32 offen nt lds
    s_add_u32 m0, s54, 57344
    s_add_u32 s32, s51, 82432
    buffer_load_dwordx4 v25, s[20:23], s32 offen nt lds
    s_add_u32 m0, s54, 61440
    s_add_u32 s32, s51, 82560
    buffer_load_dwordx4 v25, s[20:23], s32 offen nt lds
    s_add_u32 m0, s54, 65536
    s_add_u32 s32, s51, 82688
    buffer_load_dwordx4 v25, s[20:23], s32 offen nt lds
    s_add_u32 m0, s54, 69632
    s_add_u32 s32, s51, 82816
    buffer_load_dwordx4 v25, s[20:23], s32 offen nt lds
    s_add_u32 m0, s54, 73728
    s_add_u32 s32, s51, 82944
    buffer_load_dwordx4 v25, s[20:23], s32 offen nt lds
    s_add_u32 m0, s54, 77824
    s_add_u32 s32, s51, 83072
    buffer_load_dwordx4 v25, s[20:23], s32 offen nt lds
    v_add_u32 v10, 0x10000, v20
    ds_read_b64_tr_b16 a[216:217], v10 offset:20480
    ds_read_b64_tr_b16 a[218:219], v10 offset:22528
    v_add_u32 v11, 0x10000, v21
    ds_read_b64_tr_b16 a[220:221], v11 offset:20480
    ds_read_b64_tr_b16 a[222:223], v11 offset:22528
    v_add_u32 v10, 0x10000, v22
    ds_read_b64_tr_b16 a[224:225], v10 offset:20480
    ds_read_b64_tr_b16 a[226:227], v10 offset:22528
    v_add_u32 v11, 0x10000, v23
    ds_read_b64_tr_b16 a[228:229], v11 offset:20480
    ds_read_b64_tr_b16 a[230:231], v11 offset:22528
    v_add_u32 v10, 0x10000, v20
    ds_read_b64_tr_b16 a[232:233], v10 offset:24576
    ds_read_b64_tr_b16 a[234:235], v10 offset:26624
    v_add_u32 v11, 0x10000, v21
    ds_read_b64_tr_b16 a[236:237], v11 offset:24576
    ds_read_b64_tr_b16 a[238:239], v11 offset:26624
    s_waitcnt lgkmcnt(4)
    v_add_u32 v10, 0x10000, v22
    ds_read_b64_tr_b16 a[240:241], v10 offset:24576
    ds_read_b64_tr_b16 a[242:243], v10 offset:26624
    v_add_u32 v11, 0x10000, v23
    ds_read_b64_tr_b16 a[244:245], v11 offset:24576
    ds_read_b64_tr_b16 a[246:247], v11 offset:26624
    v_add_u32 v10, 0x10000, v20
    ds_read_b64_tr_b16 a[248:249], v10 offset:28672
    ds_read_b64_tr_b16 a[250:251], v10 offset:30720
    v_add_u32 v11, 0x10000, v21
    ds_read_b64_tr_b16 a[252:253], v11 offset:28672
    ds_read_b64_tr_b16 a[254:255], v11 offset:30720
    s_waitcnt lgkmcnt(4)
    s_waitcnt lgkmcnt(0)
    s_waitcnt vmcnt(10)
    s_barrier
    s_add_u32 m0, s54, 81920
    s_add_u32 s32, s51, 122880
    buffer_load_dwordx4 v25, s[20:23], s32 offen nt lds
    s_add_u32 m0, s54, 86016
    s_add_u32 s32, s51, 123008
    buffer_load_dwordx4 v25, s[20:23], s32 offen nt lds
    s_add_u32 m0, s54, 90112
    s_add_u32 s32, s51, 123136
    buffer_load_dwordx4 v25, s[20:23], s32 offen nt lds
    s_add_u32 m0, s54, 94208
    s_add_u32 s32, s51, 123264
    buffer_load_dwordx4 v25, s[20:23], s32 offen nt lds
    s_add_u32 m0, s54, 98304
    s_add_u32 s32, s51, 123392
    buffer_load_dwordx4 v25, s[20:23], s32 offen nt lds
    s_add_u32 m0, s54, 102400
    s_add_u32 s32, s51, 123520
    buffer_load_dwordx4 v25, s[20:23], s32 offen nt lds
    s_add_u32 m0, s54, 106496
    s_add_u32 s32, s51, 123648
    buffer_load_dwordx4 v25, s[20:23], s32 offen nt lds
    s_add_u32 m0, s54, 110592
    s_add_u32 s32, s51, 123776
    buffer_load_dwordx4 v25, s[20:23], s32 offen nt lds
    s_add_u32 m0, s54, 114688
    s_add_u32 s32, s51, 123904
    buffer_load_dwordx4 v25, s[20:23], s32 offen nt lds
    s_add_u32 m0, s54, 118784
    s_add_u32 s32, s51, 124032
    buffer_load_dwordx4 v25, s[20:23], s32 offen nt lds
    s_add_u32 m0, s54, 122880
    s_add_u32 s32, s51, 163840
    buffer_load_dwordx4 v25, s[20:23], s32 offen nt lds
    s_add_u32 m0, s54, 126976
    s_add_u32 s32, s51, 163968
    buffer_load_dwordx4 v25, s[20:23], s32 offen nt lds
    s_add_u32 m0, s54, 131072
    s_add_u32 s32, s51, 164096
    buffer_load_dwordx4 v25, s[20:23], s32 offen nt lds
    s_add_u32 m0, s54, 135168
    s_add_u32 s32, s51, 164224
    buffer_load_dwordx4 v25, s[20:23], s32 offen nt lds
    s_add_u32 m0, s54, 139264
    s_add_u32 s32, s51, 164352
    buffer_load_dwordx4 v25, s[20:23], s32 offen nt lds
    s_add_u32 m0, s54, 143360
    s_add_u32 s32, s51, 164480
    buffer_load_dwordx4 v25, s[20:23], s32 offen nt lds
    s_add_u32 m0, s54, 147456
    s_add_u32 s32, s51, 164608
    buffer_load_dwordx4 v25, s[20:23], s32 offen nt lds
    s_add_u32 m0, s54, 151552
    s_add_u32 s32, s51, 164736
    buffer_load_dwordx4 v25, s[20:23], s32 offen nt lds
    s_add_u32 m0, s54, 155648
    s_add_u32 s32, s51, 164864
    buffer_load_dwordx4 v25, s[20:23], s32 offen nt lds
    s_add_u32 m0, s54, 159744
    s_add_u32 s32, s51, 164992
    buffer_load_dwordx4 v25, s[20:23], s32 offen nt lds
    ds_read_b64_tr_b16 v[136:137], v20 offset:0
    ds_read_b64_tr_b16 v[138:139], v20 offset:2048
    ds_read_b64_tr_b16 v[140:141], v21 offset:0
    ds_read_b64_tr_b16 v[142:143], v21 offset:2048
    ds_read_b64_tr_b16 v[144:145], v22 offset:0
    ds_read_b64_tr_b16 v[146:147], v22 offset:2048
    ds_read_b64_tr_b16 v[148:149], v23 offset:0
    ds_read_b64_tr_b16 v[150:151], v23 offset:2048
    ds_read_b64_tr_b16 v[152:153], v20 offset:4096
    ds_read_b64_tr_b16 v[154:155], v20 offset:6144
    ds_read_b64_tr_b16 v[156:157], v21 offset:4096
    ds_read_b64_tr_b16 v[158:159], v21 offset:6144
    s_waitcnt lgkmcnt(4)
    ds_read_b64_tr_b16 v[160:161], v22 offset:4096
    ds_read_b64_tr_b16 v[162:163], v22 offset:6144
    ds_read_b64_tr_b16 v[164:165], v23 offset:4096
    ds_read_b64_tr_b16 v[166:167], v23 offset:6144
    ds_read_b64_tr_b16 v[168:169], v20 offset:8192
    ds_read_b64_tr_b16 v[170:171], v20 offset:10240
    ds_read_b64_tr_b16 v[172:173], v21 offset:8192
    ds_read_b64_tr_b16 v[174:175], v21 offset:10240
    s_waitcnt lgkmcnt(4)
    s_waitcnt lgkmcnt(0)
    s_waitcnt vmcnt(20)
    s_barrier
    s_add_u32 m0, s54, 0
    s_add_u32 s32, s51, 204800
    buffer_load_dwordx4 v25, s[20:23], s32 offen nt lds
    s_add_u32 m0, s54, 4096
    s_add_u32 s32, s51, 204928
    buffer_load_dwordx4 v25, s[20:23], s32 offen nt lds
    s_add_u32 m0, s54, 8192
    s_add_u32 s32, s51, 205056
    buffer_load_dwordx4 v25, s[20:23], s32 offen nt lds
    s_add_u32 m0, s54, 12288
    s_add_u32 s32, s51, 205184
    buffer_load_dwordx4 v25, s[20:23], s32 offen nt lds
    s_add_u32 m0, s54, 16384
    s_add_u32 s32, s51, 205312
    buffer_load_dwordx4 v25, s[20:23], s32 offen nt lds
    s_add_u32 m0, s54, 20480
    s_add_u32 s32, s51, 205440
    buffer_load_dwordx4 v25, s[20:23], s32 offen nt lds
    s_add_u32 m0, s54, 24576
    s_add_u32 s32, s51, 205568
    buffer_load_dwordx4 v25, s[20:23], s32 offen nt lds
    s_add_u32 m0, s54, 28672
    s_add_u32 s32, s51, 205696
    buffer_load_dwordx4 v25, s[20:23], s32 offen nt lds
    s_add_u32 m0, s54, 32768
    s_add_u32 s32, s51, 205824
    buffer_load_dwordx4 v25, s[20:23], s32 offen nt lds
    s_add_u32 m0, s54, 36864
    s_add_u32 s32, s51, 205952
    buffer_load_dwordx4 v25, s[20:23], s32 offen nt lds
    s_mov_b32 s28, s88
    s_and_b32 s29, s89, 0xffff
    s_mov_b32 s30, 0x100
    s_mov_b32 s31, 0x20000
    v_mov_b32 v2, 0
    buffer_load_dword v3, v2, s[28:31], 0 offen offset:60 sc1
    ds_read_b64_tr_b16 v[176:177], v20 offset:40960
    ds_read_b64_tr_b16 v[178:179], v20 offset:43008
    ds_read_b64_tr_b16 v[180:181], v21 offset:40960
    ds_read_b64_tr_b16 v[182:183], v21 offset:43008
    ds_read_b64_tr_b16 v[184:185], v22 offset:40960
    ds_read_b64_tr_b16 v[186:187], v22 offset:43008
    ds_read_b64_tr_b16 v[188:189], v23 offset:40960
    ds_read_b64_tr_b16 v[190:191], v23 offset:43008
    ds_read_b64_tr_b16 v[192:193], v20 offset:45056
    ds_read_b64_tr_b16 v[194:195], v20 offset:47104
    ds_read_b64_tr_b16 v[196:197], v21 offset:45056
    ds_read_b64_tr_b16 v[198:199], v21 offset:47104
    s_waitcnt lgkmcnt(4)
    ds_read_b64_tr_b16 v[200:201], v22 offset:45056
    ds_read_b64_tr_b16 v[202:203], v22 offset:47104
    ds_read_b64_tr_b16 v[204:205], v23 offset:45056
    ds_read_b64_tr_b16 v[206:207], v23 offset:47104
    ds_read_b64_tr_b16 v[208:209], v20 offset:49152
    ds_read_b64_tr_b16 v[210:211], v20 offset:51200
    ds_read_b64_tr_b16 v[212:213], v21 offset:49152
    ds_read_b64_tr_b16 v[214:215], v21 offset:51200
    s_waitcnt lgkmcnt(4)
    s_waitcnt lgkmcnt(0)
    s_waitcnt vmcnt(21)
    s_barrier
    v_add_u32 v10, 0x10000, v20
    ds_read_b64_tr_b16 v[216:217], v10 offset:16384
    ds_read_b64_tr_b16 v[218:219], v10 offset:18432
    v_add_u32 v11, 0x10000, v21
    ds_read_b64_tr_b16 v[220:221], v11 offset:16384
    ds_read_b64_tr_b16 v[222:223], v11 offset:18432
    v_add_u32 v10, 0x10000, v22
    ds_read_b64_tr_b16 v[224:225], v10 offset:16384
    ds_read_b64_tr_b16 v[226:227], v10 offset:18432
    v_add_u32 v11, 0x10000, v23
    ds_read_b64_tr_b16 v[228:229], v11 offset:16384
    ds_read_b64_tr_b16 v[230:231], v11 offset:18432
    v_add_u32 v10, 0x10000, v20
    ds_read_b64_tr_b16 v[232:233], v10 offset:20480
    ds_read_b64_tr_b16 v[234:235], v10 offset:22528
    v_add_u32 v11, 0x10000, v21
    ds_read_b64_tr_b16 v[236:237], v11 offset:20480
    ds_read_b64_tr_b16 v[238:239], v11 offset:22528
    s_waitcnt lgkmcnt(4)
    v_add_u32 v10, 0x10000, v22
    ds_read_b64_tr_b16 v[240:241], v10 offset:20480
    ds_read_b64_tr_b16 v[242:243], v10 offset:22528
    v_add_u32 v11, 0x10000, v23
    ds_read_b64_tr_b16 v[244:245], v11 offset:20480
    ds_read_b64_tr_b16 v[246:247], v11 offset:22528
    v_add_u32 v10, 0x10000, v20
    ds_read_b64_tr_b16 v[248:249], v10 offset:24576
    ds_read_b64_tr_b16 v[250:251], v10 offset:26624
    v_add_u32 v11, 0x10000, v21
    ds_read_b64_tr_b16 v[252:253], v11 offset:24576
    ds_read_b64_tr_b16 v[254:255], v11 offset:26624
    s_waitcnt lgkmcnt(4)
    s_waitcnt lgkmcnt(0)
    s_waitcnt vmcnt(11)
    s_barrier
    v_add_u32 v10, 0x18000, v20
    ds_read_b64_tr_b16 v[52:53], v10 offset:24576
    ds_read_b64_tr_b16 v[54:55], v10 offset:26624
    v_add_u32 v11, 0x18000, v21
    ds_read_b64_tr_b16 v[56:57], v11 offset:24576
    ds_read_b64_tr_b16 v[58:59], v11 offset:26624
    v_add_u32 v10, 0x18000, v22
    ds_read_b64_tr_b16 v[60:61], v10 offset:24576
    ds_read_b64_tr_b16 v[62:63], v10 offset:26624
    v_add_u32 v11, 0x18000, v23
    ds_read_b64_tr_b16 v[64:65], v11 offset:24576
    ds_read_b64_tr_b16 v[66:67], v11 offset:26624
    v_add_u32 v10, 0x18000, v20
    ds_read_b64_tr_b16 v[68:69], v10 offset:28672
    ds_read_b64_tr_b16 v[70:71], v10 offset:30720
    v_add_u32 v11, 0x18000, v21
    ds_read_b64_tr_b16 v[72:73], v11 offset:28672
    ds_read_b64_tr_b16 v[74:75], v11 offset:30720
    s_waitcnt lgkmcnt(4)
    v_add_u32 v10, 0x18000, v22
    ds_read_b64_tr_b16 v[76:77], v10 offset:28672
    ds_read_b64_tr_b16 v[78:79], v10 offset:30720
    v_add_u32 v11, 0x18000, v23
    ds_read_b64_tr_b16 v[80:81], v11 offset:28672
    ds_read_b64_tr_b16 v[82:83], v11 offset:30720
    v_add_u32 v10, 0x20000, v20
    ds_read_b64_tr_b16 v[84:85], v10 offset:0
    ds_read_b64_tr_b16 v[86:87], v10 offset:2048
    v_add_u32 v11, 0x20000, v21
    ds_read_b64_tr_b16 v[88:89], v11 offset:0
    ds_read_b64_tr_b16 v[90:91], v11 offset:2048
    s_waitcnt lgkmcnt(4)
    s_waitcnt lgkmcnt(0)
    s_waitcnt vmcnt(1)
    s_barrier
    ds_read_b64_tr_b16 v[92:93], v20 offset:0
    ds_read_b64_tr_b16 v[94:95], v20 offset:2048
    ds_read_b64_tr_b16 v[96:97], v21 offset:0
    ds_read_b64_tr_b16 v[98:99], v21 offset:2048
    ds_read_b64_tr_b16 v[100:101], v22 offset:0
    ds_read_b64_tr_b16 v[102:103], v22 offset:2048
    ds_read_b64_tr_b16 v[104:105], v23 offset:0
    ds_read_b64_tr_b16 v[106:107], v23 offset:2048
    ds_read_b64_tr_b16 v[108:109], v20 offset:4096
    ds_read_b64_tr_b16 v[110:111], v20 offset:6144
    ds_read_b64_tr_b16 v[112:113], v21 offset:4096
    ds_read_b64_tr_b16 v[114:115], v21 offset:6144
    s_waitcnt lgkmcnt(4)
    ds_read_b64_tr_b16 v[116:117], v22 offset:4096
    ds_read_b64_tr_b16 v[118:119], v22 offset:6144
    ds_read_b64_tr_b16 v[120:121], v23 offset:4096
    ds_read_b64_tr_b16 v[122:123], v23 offset:6144
    ds_read_b64_tr_b16 v[124:125], v20 offset:8192
    ds_read_b64_tr_b16 v[126:127], v20 offset:10240
    ds_read_b64_tr_b16 v[128:129], v21 offset:8192
    ds_read_b64_tr_b16 v[130:131], v21 offset:10240
    s_waitcnt lgkmcnt(4)
    s_waitcnt lgkmcnt(0)
    s_barrier
    s_mov_b32 s52, 1048576
    s_branch prepw_ck_139
prepw_137:
    buffer_load_dword v3, v2, s[28:31], 0 offen offset:60 sc1
prepw_ck_139:
    s_waitcnt vmcnt(0)
    v_readfirstlane_b32 s32, v3
    s_nop 1
    s_and_b32 s33, s32, 255
    s_cmp_ge_u32 s33, 56
    s_cbranch_scc1 prepw_ok_138
    s_cmp_eq_u32 s52, 0
    s_cbranch_scc1 prepw_ok_138
    s_sub_u32 s52, s52, 1
    s_sleep 4
    s_branch prepw_137
prepw_ok_138:
    s_bfe_u32 s33, s32, 0x80008
    s_bfe_u32 s34, s32, 0x80018
    s_add_u32 s33, s33, s34
    s_bfe_u32 s34, s32, 0x80010
    s_sub_u32 s33, s33, s34
    s_cmp_ge_i32 s33, 28
    s_cselect_b32 s96, 0, 8192
    s_mov_b32 s98, s96
    s_xor_b32 s97, s96, 8192
    s_add_u32 s99, s96, 0xa20d000
    v_lshlrev_b32 v7, 4, v0
    s_mov_b32 s48, s7
    s_mul_i32 s55, s48, 40960
    s_add_u32 s55, s55, 0
    s_add_u32 m0, s54, 0
    s_nop 0
    buffer_load_dwordx4 v7, s[8:11], s55 offen sc1 lds
    s_add_u32 s55, s55, 4096
    s_add_u32 m0, s54, 4096
    s_nop 0
    buffer_load_dwordx4 v7, s[8:11], s55 offen sc1 lds
    s_add_u32 s55, s55, 4096
    s_add_u32 m0, s54, 8192
    s_nop 0
    buffer_load_dwordx4 v7, s[8:11], s55 offen sc1 lds
    s_add_u32 s55, s55, 4096
    s_add_u32 m0, s54, 12288
    s_nop 0
    buffer_load_dwordx4 v7, s[8:11], s55 offen sc1 lds
    s_add_u32 s55, s55, 4096
    s_add_u32 m0, s54, 16384
    s_nop 0
    buffer_load_dwordx4 v7, s[8:11], s55 offen sc1 lds
    ds_write_b128 v14, v[28:31] offset:0
    ds_write_b128 v14, v[32:35] offset:1024
    ds_write_b128 v14, v[36:39] offset:2048
    ds_write_b128 v14, v[40:43] offset:3072
    ds_write_b128 v14, v[44:47] offset:4096
    ds_write_b128 v14, v[48:51] offset:5120
    ds_write_b128 v14, v[52:55] offset:6144
    ds_write_b128 v14, v[56:59] offset:7168
    ds_write_b128 v14, v[60:63] offset:8192
    ds_write_b128 v14, v[64:67] offset:9216
    ds_write_b128 v14, v[68:71] offset:10240
    ds_write_b128 v14, v[72:75] offset:11264
    s_waitcnt lgkmcnt(4)
    ds_write_b128 v14, v[76:79] offset:12288
    ds_write_b128 v14, v[80:83] offset:13312
    ds_write_b128 v14, v[84:87] offset:14336
    ds_write_b128 v14, v[88:91] offset:15360
    ds_write_b128 v14, v[92:95] offset:16384
    ds_write_b128 v14, v[96:99] offset:17408
    ds_write_b128 v14, v[100:103] offset:18432
    ds_write_b128 v14, v[104:107] offset:19456
    s_waitcnt lgkmcnt(4)
    ds_write_b128 v14, v[108:111] offset:20480
    ds_write_b128 v14, v[112:115] offset:21504
    ds_write_b128 v14, v[116:119] offset:22528
    ds_write_b128 v14, v[120:123] offset:23552
    ds_write_b128 v14, v[124:127] offset:24576
    ds_write_b128 v14, v[128:131] offset:25600
    s_waitcnt lgkmcnt(0)
    v_lshrrev_b32 v2, 4, v1
    v_and_b32 v3, 15, v1
    v_lshlrev_b32 v6, 9, v2
    v_lshl_add_u32 v6, v3, 4, v6
    v_mov_b32 v4, 0x40000000
    v_cmp_eq_u32 vcc, 0, v0
    s_nop 1
    v_cndmask_b32 v8, v4, v0, vcc
    v_mov_b32 v13, 64
    v_lshlrev_b32 v9, 4, v1
    s_mul_i32 s32, s4, 450560
    v_add_u32 v24, s32, v9
    v_lshrrev_b32 v4, 1, v2
    v_lshlrev_b32 v4, 8, v4
    v_lshl_add_u32 v4, v3, 4, v4
    v_and_b32 v5, 1, v2
    v_lshl_add_u32 v4, v5, 3, v4
    s_mul_i32 s32, s4, 1536
    v_add_u32 v12, s32, v4
    s_mov_b32 s49, 0x40000000
    v_mov_b32 v20, -1
    v_mov_b32 v21, -1
    v_mov_b32 v22, -1
    v_mov_b32 v23, -1
    v_mov_b32 v4, 0x40000000
    s_mul_i32 s32, s4, 163840
    v_lshlrev_b32 v5, 14, v2
    v_lshl_add_u32 v5, v3, 4, v5
    v_add_u32 v16, s32, v5
    v_cmp_gt_u32 vcc, 2, v2
    s_nop 1
    v_cndmask_b32 v17, v4, v16, vcc
    v_cmp_gt_u32 vcc, 32, v0
    s_nop 1
    v_cndmask_b32 v18, v4, v7, vcc
    s_lshl_b32 s56, s6, 9
    s_sub_u32 s32, s56, 2048
    s_add_u32 s56, s56, 16384
    s_cmp_ge_u32 s6, 4
    s_cmov_b32 s56, s32
    s_add_u32 s56, s56, s96
    s_add_u32 s56, s56, 0xa200000
    s_cmp_ge_u32 s6, 20
    s_cmov_b32 s56, 0x40000000
    v_mov_b32 v15, -1
    v_mov_b32 v26, 0
    s_mov_b32 s52, 1048576
    s_waitcnt vmcnt(0)
VO_loop:
    s_waitcnt vmcnt(14) lgkmcnt(0)
    s_barrier
    ds_read_b128 v[52:55], v6 offset:0
    ds_read_b128 v[56:59], v6 offset:256
    s_waitcnt lgkmcnt(1)
    v_mfma_f32_16x16x32_bf16 v[28:31], a[0:3], v[52:55], 0
    ds_read_b128 v[60:63], v6 offset:2048
    s_waitcnt lgkmcnt(1)
    v_mfma_f32_16x16x32_bf16 v[32:35], a[0:3], v[56:59], 0
    ds_read_b128 v[64:67], v6 offset:2304
    v_mfma_f32_16x16x32_bf16 v[36:39], a[4:7], v[52:55], 0
    s_mul_i32 s55, s48, 40960
    s_add_u32 s55, s55, 20480
    s_add_u32 m0, s54, 20480
    s_nop 0
    buffer_load_dwordx4 v7, s[8:11], s55 offen sc1 lds
    v_mfma_f32_16x16x32_bf16 v[40:43], a[4:7], v[56:59], 0
    v_mfma_f32_16x16x32_bf16 v[44:47], a[8:11], v[52:55], 0
    v_mfma_f32_16x16x32_bf16 v[48:51], a[8:11], v[56:59], 0
    s_add_u32 s55, s55, 4096
    s_add_u32 m0, s54, 24576
    s_nop 0
    buffer_load_dwordx4 v7, s[8:11], s55 offen sc1 lds
    s_waitcnt lgkmcnt(1)
    v_mfma_f32_16x16x32_bf16 v[28:31], a[12:15], v[60:63], v[28:31]
    ds_read_b128 v[52:55], v6 offset:4096
    s_waitcnt lgkmcnt(1)
    v_mfma_f32_16x16x32_bf16 v[32:35], a[12:15], v[64:67], v[32:35]
    ds_read_b128 v[56:59], v6 offset:4352
    v_mfma_f32_16x16x32_bf16 v[36:39], a[16:19], v[60:63], v[36:39]
    s_add_u32 s55, s55, 4096
    s_add_u32 m0, s54, 28672
    s_nop 0
    buffer_load_dwordx4 v7, s[8:11], s55 offen sc1 lds
    v_mfma_f32_16x16x32_bf16 v[40:43], a[16:19], v[64:67], v[40:43]
    v_mfma_f32_16x16x32_bf16 v[44:47], a[20:23], v[60:63], v[44:47]
    v_mfma_f32_16x16x32_bf16 v[48:51], a[20:23], v[64:67], v[48:51]
    s_add_u32 s55, s55, 4096
    s_add_u32 m0, s54, 32768
    s_nop 0
    buffer_load_dwordx4 v7, s[8:11], s55 offen sc1 lds
    s_waitcnt lgkmcnt(1)
    v_mfma_f32_16x16x32_bf16 v[28:31], a[24:27], v[52:55], v[28:31]
    ds_read_b128 v[60:63], v6 offset:6144
    s_waitcnt lgkmcnt(1)
    v_mfma_f32_16x16x32_bf16 v[32:35], a[24:27], v[56:59], v[32:35]
    ds_read_b128 v[64:67], v6 offset:6400
    v_mfma_f32_16x16x32_bf16 v[36:39], a[28:31], v[52:55], v[36:39]
    s_add_u32 s55, s55, 4096
    s_add_u32 m0, s54, 36864
    s_nop 0
    buffer_load_dwordx4 v7, s[8:11], s55 offen sc1 lds
    v_mfma_f32_16x16x32_bf16 v[40:43], a[28:31], v[56:59], v[40:43]
    v_mfma_f32_16x16x32_bf16 v[44:47], a[32:35], v[52:55], v[44:47]
    v_mfma_f32_16x16x32_bf16 v[48:51], a[32:35], v[56:59], v[48:51]
    s_waitcnt lgkmcnt(1)
    v_mfma_f32_16x16x32_bf16 v[28:31], a[36:39], v[60:63], v[28:31]
    ds_read_b128 v[52:55], v6 offset:8192
    s_waitcnt lgkmcnt(1)
    v_mfma_f32_16x16x32_bf16 v[32:35], a[36:39], v[64:67], v[32:35]
    ds_read_b128 v[56:59], v6 offset:8448
    v_mfma_f32_16x16x32_bf16 v[36:39], a[40:43], v[60:63], v[36:39]
    v_mfma_f32_16x16x32_bf16 v[40:43], a[40:43], v[64:67], v[40:43]
    v_mfma_f32_16x16x32_bf16 v[44:47], a[44:47], v[60:63], v[44:47]
    v_mfma_f32_16x16x32_bf16 v[48:51], a[44:47], v[64:67], v[48:51]
    s_waitcnt lgkmcnt(1)
    v_mfma_f32_16x16x32_bf16 v[28:31], a[48:51], v[52:55], v[28:31]
    ds_read_b128 v[60:63], v6 offset:10240
    s_waitcnt lgkmcnt(1)
    v_mfma_f32_16x16x32_bf16 v[32:35], a[48:51], v[56:59], v[32:35]
    ds_read_b128 v[64:67], v6 offset:10496
    v_mfma_f32_16x16x32_bf16 v[36:39], a[52:55], v[52:55], v[36:39]
    v_mfma_f32_16x16x32_bf16 v[40:43], a[52:55], v[56:59], v[40:43]
    v_mfma_f32_16x16x32_bf16 v[44:47], a[56:59], v[52:55], v[44:47]
    v_mfma_f32_16x16x32_bf16 v[48:51], a[56:59], v[56:59], v[48:51]
    s_waitcnt lgkmcnt(1)
    v_mfma_f32_16x16x32_bf16 v[28:31], a[60:63], v[60:63], v[28:31]
    ds_read_b128 v[52:55], v6 offset:12288
    s_waitcnt lgkmcnt(1)
    v_mfma_f32_16x16x32_bf16 v[32:35], a[60:63], v[64:67], v[32:35]
    ds_read_b128 v[56:59], v6 offset:12544
    v_mfma_f32_16x16x32_bf16 v[36:39], a[64:67], v[60:63], v[36:39]
    v_mfma_f32_16x16x32_bf16 v[40:43], a[64:67], v[64:67], v[40:43]
    v_mfma_f32_16x16x32_bf16 v[44:47], a[68:71], v[60:63], v[44:47]
    v_mfma_f32_16x16x32_bf16 v[48:51], a[68:71], v[64:67], v[48:51]
    s_waitcnt lgkmcnt(1)
    v_mfma_f32_16x16x32_bf16 v[28:31], a[72:75], v[52:55], v[28:31]
    ds_read_b128 v[60:63], v6 offset:14336
    s_waitcnt lgkmcnt(1)
    v_mfma_f32_16x16x32_bf16 v[32:35], a[72:75], v[56:59], v[32:35]
    ds_read_b128 v[64:67], v6 offset:14592
    v_mfma_f32_16x16x32_bf16 v[36:39], a[76:79], v[52:55], v[36:39]
    v_mfma_f32_16x16x32_bf16 v[40:43], a[76:79], v[56:59], v[40:43]
    v_mfma_f32_16x16x32_bf16 v[44:47], a[80:83], v[52:55], v[44:47]
    v_mfma_f32_16x16x32_bf16 v[48:51], a[80:83], v[56:59], v[48:51]
    s_waitcnt lgkmcnt(1)
    v_mfma_f32_16x16x32_bf16 v[28:31], a[84:87], v[60:63], v[28:31]
    ds_read_b128 v[52:55], v6 offset:16384
    s_waitcnt lgkmcnt(1)
    v_mfma_f32_16x16x32_bf16 v[32:35], a[84:87], v[64:67], v[32:35]
    ds_read_b128 v[56:59], v6 offset:16640
    v_mfma_f32_16x16x32_bf16 v[36:39], a[88:91], v[60:63], v[36:39]
    ds_read_b128 v[68:71], v14 offset:0
    v_mfma_f32_16x16x32_bf16 v[40:43], a[88:91], v[64:67], v[40:43]
    ds_read_b128 v[72:75], v14 offset:1024
    v_mfma_f32_16x16x32_bf16 v[44:47], a[92:95], v[60:63], v[44:47]
    ds_read_b128 v[76:79], v14 offset:2048
    v_mfma_f32_16x16x32_bf16 v[48:51], a[92:95], v[64:67], v[48:51]
    s_waitcnt lgkmcnt(4)
    v_mfma_f32_16x16x32_bf16 v[28:31], a[96:99], v[52:55], v[28:31]
    ds_read_b128 v[60:63], v6 offset:18432
    s_waitcnt lgkmcnt(4)
    v_mfma_f32_16x16x32_bf16 v[32:35], a[96:99], v[56:59], v[32:35]
    ds_read_b128 v[64:67], v6 offset:18688
    v_mfma_f32_16x16x32_bf16 v[36:39], a[100:103], v[52:55], v[36:39]
    v_mfma_f32_16x16x32_bf16 v[40:43], a[100:103], v[56:59], v[40:43]
    v_mfma_f32_16x16x32_bf16 v[44:47], a[104:107], v[52:55], v[44:47]
    v_mfma_f32_16x16x32_bf16 v[48:51], a[104:107], v[56:59], v[48:51]
    s_waitcnt lgkmcnt(4)
    s_waitcnt lgkmcnt(1)
    v_mfma_f32_16x16x32_bf16 v[28:31], v[68:71], v[60:63], v[28:31]
    s_waitcnt lgkmcnt(0)
    v_mfma_f32_16x16x32_bf16 v[32:35], v[68:71], v[64:67], v[32:35]
    v_mfma_f32_16x16x32_bf16 v[36:39], v[72:75], v[60:63], v[36:39]
    v_mfma_f32_16x16x32_bf16 v[40:43], v[72:75], v[64:67], v[40:43]
    v_mfma_f32_16x16x32_bf16 v[44:47], v[76:79], v[60:63], v[44:47]
    v_mfma_f32_16x16x32_bf16 v[48:51], v[76:79], v[64:67], v[48:51]
    s_waitcnt vmcnt(0) lgkmcnt(0)
    s_barrier
    ds_read_b128 v[52:55], v6 offset:20480
    ds_read_b128 v[56:59], v6 offset:20736
    buffer_store_dword v13, v8, s[8:11], s49 offen sc1
    s_add_u32 s34, s48, 2
    s_min_u32 s34, s34, 63
    s_waitcnt lgkmcnt(1)
    v_mfma_f32_16x16x32_bf16 v[28:31], a[108:111], v[52:55], v[28:31]
    ds_read_b128 v[60:63], v6 offset:22528
    s_waitcnt lgkmcnt(1)
    v_mfma_f32_16x16x32_bf16 v[32:35], a[108:111], v[56:59], v[32:35]
    ds_read_b128 v[64:67], v6 offset:22784
    v_mfma_f32_16x16x32_bf16 v[36:39], a[112:115], v[52:55], v[36:39]
    s_mul_i32 s55, s34, 40960
    s_add_u32 s55, s55, 0
    s_add_u32 m0, s54, 0
    s_nop 0
    buffer_load_dwordx4 v7, s[8:11], s55 offen sc1 lds
    v_mfma_f32_16x16x32_bf16 v[40:43], a[112:115], v[56:59], v[40:43]
    v_mfma_f32_16x16x32_bf16 v[44:47], a[116:119], v[52:55], v[44:47]
    v_mfma_f32_16x16x32_bf16 v[48:51], a[116:119], v[56:59], v[48:51]
    s_add_u32 s55, s55, 4096
    s_add_u32 m0, s54, 4096
    s_nop 0
    buffer_load_dwordx4 v7, s[8:11], s55 offen sc1 lds
    s_waitcnt lgkmcnt(1)
    v_mfma_f32_16x16x32_bf16 v[28:31], a[120:123], v[60:63], v[28:31]
    ds_read_b128 v[52:55], v6 offset:24576
    s_waitcnt lgkmcnt(1)
    v_mfma_f32_16x16x32_bf16 v[32:35], a[120:123], v[64:67], v[32:35]
    ds_read_b128 v[56:59], v6 offset:24832
    v_mfma_f32_16x16x32_bf16 v[36:39], a[124:127], v[60:63], v[36:39]
    s_add_u32 s55, s55, 4096
    s_add_u32 m0, s54, 8192
    s_nop 0
    buffer_load_dwordx4 v7, s[8:11], s55 offen sc1 lds
    v_mfma_f32_16x16x32_bf16 v[40:43], a[124:127], v[64:67], v[40:43]
    v_mfma_f32_16x16x32_bf16 v[44:47], a[128:131], v[60:63], v[44:47]
    v_mfma_f32_16x16x32_bf16 v[48:51], a[128:131], v[64:67], v[48:51]
    s_add_u32 s55, s55, 4096
    s_add_u32 m0, s54, 12288
    s_nop 0
    buffer_load_dwordx4 v7, s[8:11], s55 offen sc1 lds
    s_waitcnt lgkmcnt(1)
    v_mfma_f32_16x16x32_bf16 v[28:31], a[132:135], v[52:55], v[28:31]
    ds_read_b128 v[60:63], v6 offset:26624
    s_waitcnt lgkmcnt(1)
    v_mfma_f32_16x16x32_bf16 v[32:35], a[132:135], v[56:59], v[32:35]
    ds_read_b128 v[64:67], v6 offset:26880
    v_mfma_f32_16x16x32_bf16 v[36:39], a[136:139], v[52:55], v[36:39]
    s_add_u32 s55, s55, 4096
    s_add_u32 m0, s54, 16384
    s_nop 0
    buffer_load_dwordx4 v7, s[8:11], s55 offen sc1 lds
    v_mfma_f32_16x16x32_bf16 v[40:43], a[136:139], v[56:59], v[40:43]
    v_mfma_f32_16x16x32_bf16 v[44:47], a[140:143], v[52:55], v[44:47]
    v_mfma_f32_16x16x32_bf16 v[48:51], a[140:143], v[56:59], v[48:51]
    s_waitcnt lgkmcnt(1)
    v_mfma_f32_16x16x32_bf16 v[28:31], a[144:147], v[60:63], v[28:31]
    ds_read_b128 v[52:55], v6 offset:28672
    s_waitcnt lgkmcnt(1)
    v_mfma_f32_16x16x32_bf16 v[32:35], a[144:147], v[64:67], v[32:35]
    ds_read_b128 v[56:59], v6 offset:28928
    v_mfma_f32_16x16x32_bf16 v[36:39], a[148:151], v[60:63], v[36:39]
    v_mfma_f32_16x16x32_bf16 v[40:43], a[148:151], v[64:67], v[40:43]
    v_mfma_f32_16x16x32_bf16 v[44:47], a[152:155], v[60:63], v[44:47]
    v_mfma_f32_16x16x32_bf16 v[48:51], a[152:155], v[64:67], v[48:51]
    s_waitcnt lgkmcnt(1)
    v_mfma_f32_16x16x32_bf16 v[28:31], a[156:159], v[52:55], v[28:31]
    ds_read_b128 v[60:63], v6 offset:30720
    s_waitcnt lgkmcnt(1)
    v_mfma_f32_16x16x32_bf16 v[32:35], a[156:159], v[56:59], v[32:35]
    ds_read_b128 v[64:67], v6 offset:30976
    v_mfma_f32_16x16x32_bf16 v[36:39], a[160:163], v[52:55], v[36:39]
    v_mfma_f32_16x16x32_bf16 v[40:43], a[160:163], v[56:59], v[40:43]
    v_mfma_f32_16x16x32_bf16 v[44:47], a[164:167], v[52:55], v[44:47]
    v_mfma_f32_16x16x32_bf16 v[48:51], a[164:167], v[56:59], v[48:51]
    s_waitcnt lgkmcnt(1)
    v_mfma_f32_16x16x32_bf16 v[28:31], a[168:171], v[60:63], v[28:31]
    ds_read_b128 v[52:55], v6 offset:32768
    s_waitcnt lgkmcnt(1)
    v_mfma_f32_16x16x32_bf16 v[32:35], a[168:171], v[64:67], v[32:35]
    ds_read_b128 v[56:59], v6 offset:33024
    v_mfma_f32_16x16x32_bf16 v[36:39], a[172:175], v[60:63], v[36:39]
    v_mfma_f32_16x16x32_bf16 v[40:43], a[172:175], v[64:67], v[40:43]
    v_mfma_f32_16x16x32_bf16 v[44:47], a[176:179], v[60:63], v[44:47]
    v_mfma_f32_16x16x32_bf16 v[48:51], a[176:179], v[64:67], v[48:51]
    s_waitcnt lgkmcnt(1)
    v_mfma_f32_16x16x32_bf16 v[28:31], a[180:183], v[52:55], v[28:31]
    ds_read_b128 v[60:63], v6 offset:34816
    s_waitcnt lgkmcnt(1)
    v_mfma_f32_16x16x32_bf16 v[32:35], a[180:183], v[56:59], v[32:35]
    ds_read_b128 v[64:67], v6 offset:35072
    v_mfma_f32_16x16x32_bf16 v[36:39], a[184:187], v[52:55], v[36:39]
    v_mfma_f32_16x16x32_bf16 v[40:43], a[184:187], v[56:59], v[40:43]
    v_mfma_f32_16x16x32_bf16 v[44:47], a[188:191], v[52:55], v[44:47]
    v_mfma_f32_16x16x32_bf16 v[48:51], a[188:191], v[56:59], v[48:51]
    s_waitcnt lgkmcnt(1)
    v_mfma_f32_16x16x32_bf16 v[28:31], a[192:195], v[60:63], v[28:31]
    ds_read_b128 v[52:55], v6 offset:36864
    s_waitcnt lgkmcnt(1)
    v_mfma_f32_16x16x32_bf16 v[32:35], a[192:195], v[64:67], v[32:35]
    ds_read_b128 v[56:59], v6 offset:37120
    v_mfma_f32_16x16x32_bf16 v[36:39], a[196:199], v[60:63], v[36:39]
    ds_read_b128 v[68:71], v14 offset:3072
    v_mfma_f32_16x16x32_bf16 v[40:43], a[196:199], v[64:67], v[40:43]
    ds_read_b128 v[72:75], v14 offset:4096
    v_mfma_f32_16x16x32_bf16 v[44:47], a[200:203], v[60:63], v[44:47]
    ds_read_b128 v[76:79], v14 offset:5120
    v_mfma_f32_16x16x32_bf16 v[48:51], a[200:203], v[64:67], v[48:51]
    s_waitcnt lgkmcnt(4)
    v_mfma_f32_16x16x32_bf16 v[28:31], a[204:207], v[52:55], v[28:31]
    ds_read_b128 v[60:63], v6 offset:38912
    s_waitcnt lgkmcnt(4)
    v_mfma_f32_16x16x32_bf16 v[32:35], a[204:207], v[56:59], v[32:35]
    ds_read_b128 v[64:67], v6 offset:39168
    v_mfma_f32_16x16x32_bf16 v[36:39], a[208:211], v[52:55], v[36:39]
    v_mfma_f32_16x16x32_bf16 v[40:43], a[208:211], v[56:59], v[40:43]
    v_mfma_f32_16x16x32_bf16 v[44:47], a[212:215], v[52:55], v[44:47]
    v_mfma_f32_16x16x32_bf16 v[48:51], a[212:215], v[56:59], v[48:51]
    s_waitcnt lgkmcnt(4)
    s_waitcnt lgkmcnt(1)
    v_mfma_f32_16x16x32_bf16 v[28:31], v[68:71], v[60:63], v[28:31]
    s_waitcnt lgkmcnt(0)
    v_mfma_f32_16x16x32_bf16 v[32:35], v[68:71], v[64:67], v[32:35]
    v_mfma_f32_16x16x32_bf16 v[36:39], v[72:75], v[60:63], v[36:39]
    v_mfma_f32_16x16x32_bf16 v[40:43], v[72:75], v[64:67], v[40:43]
    v_mfma_f32_16x16x32_bf16 v[44:47], v[76:79], v[60:63], v[44:47]
    v_mfma_f32_16x16x32_bf16 v[48:51], v[76:79], v[64:67], v[48:51]
    ds_read_b128 v[52:55], v14 offset:6144
    ds_read_b128 v[56:59], v14 offset:16384
    v_cvt_pk_bf16_f32 v80, v28, v29
    v_cvt_pk_bf16_f32 v81, v30, v31
    ds_write_b64 v12, v[80:81] offset:40960
    v_cvt_pk_bf16_f32 v82, v32, v33
    v_cvt_pk_bf16_f32 v83, v34, v35
    ds_write_b64 v12, v[82:83] offset:47104
    v_cvt_pk_bf16_f32 v84, v36, v37
    v_cvt_pk_bf16_f32 v85, v38, v39
    ds_write_b64 v12, v[84:85] offset:41472
    v_cvt_pk_bf16_f32 v86, v40, v41
    v_cvt_pk_bf16_f32 v87, v42, v43
    ds_write_b64 v12, v[86:87] offset:47616
    v_cvt_pk_bf16_f32 v80, v44, v45
    v_cvt_pk_bf16_f32 v81, v46, v47
    ds_write_b64 v12, v[80:81] offset:41984
    v_cvt_pk_bf16_f32 v82, v48, v49
    v_cvt_pk_bf16_f32 v83, v50, v51
    ds_write_b64 v12, v[82:83] offset:48128
    s_mul_i32 s32, s48, 1802240
    s_lshl_b32 s33, s6, 10
    s_add_u32 s32, s32, s33
    s_add_u32 s32, s32, 0x3400000
    s_waitcnt lgkmcnt(0)
    s_barrier
    ds_read_b128 v[88:91], v9 offset:40960
    ds_read_b128 v[92:95], v9 offset:47104
    ds_read_b128 v[96:99], v9 offset:41984
    ds_read_b128 v[100:103], v9 offset:48128
    ds_read_b128 v[104:107], v9 offset:43008
    ds_read_b128 v[108:111], v9 offset:49152
    s_waitcnt lgkmcnt(5)
    v_mfma_f32_16x16x32_bf16 v[28:31], v[88:91], a[216:219], 0
    ds_read_b128 v[112:115], v9 offset:44032
    s_waitcnt lgkmcnt(5)
    v_mfma_f32_16x16x32_bf16 v[32:35], v[92:95], a[216:219], 0
    ds_read_b128 v[116:119], v9 offset:50176
    s_waitcnt lgkmcnt(5)
    v_mfma_f32_16x16x32_bf16 v[28:31], v[96:99], v[136:139], v[28:31]
    ds_read_b128 v[120:123], v9 offset:45056
    s_waitcnt lgkmcnt(5)
    v_mfma_f32_16x16x32_bf16 v[32:35], v[100:103], v[136:139], v[32:35]
    ds_read_b128 v[124:127], v9 offset:51200
    s_waitcnt lgkmcnt(5)
    v_mfma_f32_16x16x32_bf16 v[28:31], v[104:107], v[176:179], v[28:31]
    ds_read_b128 v[128:131], v9 offset:46080
    s_waitcnt lgkmcnt(5)
    v_mfma_f32_16x16x32_bf16 v[32:35], v[108:111], v[176:179], v[32:35]
    ds_read_b128 v[132:135], v9 offset:52224
    s_waitcnt lgkmcnt(5)
    v_mfma_f32_16x16x32_bf16 v[28:31], v[112:115], v[216:219], v[28:31]
    ds_read_b128 v[60:63], v14 offset:7168
    s_waitcnt lgkmcnt(5)
    v_mfma_f32_16x16x32_bf16 v[32:35], v[116:119], v[216:219], v[32:35]
    ds_read_b128 v[64:67], v14 offset:17408
    s_waitcnt lgkmcnt(5)
    v_mfma_f32_16x16x32_bf16 v[28:31], v[120:123], v[52:55], v[28:31]
    s_waitcnt lgkmcnt(4)
    v_mfma_f32_16x16x32_bf16 v[32:35], v[124:127], v[52:55], v[32:35]
    s_waitcnt lgkmcnt(3)
    v_mfma_f32_16x16x32_bf16 v[28:31], v[128:131], v[56:59], v[28:31]
    s_waitcnt lgkmcnt(2)
    v_mfma_f32_16x16x32_bf16 v[32:35], v[132:135], v[56:59], v[32:35]
    v_mfma_f32_16x16x32_bf16 v[36:39], v[88:91], a[220:223], 0
    v_mfma_f32_16x16x32_bf16 v[40:43], v[92:95], a[220:223], 0
    v_mfma_f32_16x16x32_bf16 v[36:39], v[96:99], v[140:143], v[36:39]
    ds_read_b128 v[52:55], v14 offset:8192
    v_mfma_f32_16x16x32_bf16 v[40:43], v[100:103], v[140:143], v[40:43]
    ds_read_b128 v[56:59], v14 offset:18432
    v_mfma_f32_16x16x32_bf16 v[36:39], v[104:107], v[180:183], v[36:39]
    v_mfma_f32_16x16x32_bf16 v[40:43], v[108:111], v[180:183], v[40:43]
    v_cvt_pk_bf16_f32 v80, v28, v29
    v_mfma_f32_16x16x32_bf16 v[36:39], v[112:115], v[220:223], v[36:39]
    v_cvt_pk_bf16_f32 v81, v30, v31
    v_mfma_f32_16x16x32_bf16 v[40:43], v[116:119], v[220:223], v[40:43]
    v_cvt_pk_bf16_f32 v82, v32, v33
    s_waitcnt lgkmcnt(3)
    v_mfma_f32_16x16x32_bf16 v[36:39], v[120:123], v[60:63], v[36:39]
    v_cvt_pk_bf16_f32 v83, v34, v35
    v_mfma_f32_16x16x32_bf16 v[40:43], v[124:127], v[60:63], v[40:43]
    buffer_store_dwordx4 v[80:83], v24, s[8:11], s32 offen sc1
    s_add_u32 s32, s32, 45056
    s_waitcnt lgkmcnt(2)
    v_mfma_f32_16x16x32_bf16 v[36:39], v[128:131], v[64:67], v[36:39]
    v_mfma_f32_16x16x32_bf16 v[40:43], v[132:135], v[64:67], v[40:43]
    v_mfma_f32_16x16x32_bf16 v[28:31], v[88:91], a[224:227], 0
    v_mfma_f32_16x16x32_bf16 v[32:35], v[92:95], a[224:227], 0
    v_mfma_f32_16x16x32_bf16 v[28:31], v[96:99], v[144:147], v[28:31]
    ds_read_b128 v[60:63], v14 offset:9216
    v_mfma_f32_16x16x32_bf16 v[32:35], v[100:103], v[144:147], v[32:35]
    ds_read_b128 v[64:67], v14 offset:19456
    v_mfma_f32_16x16x32_bf16 v[28:31], v[104:107], v[184:187], v[28:31]
    v_mfma_f32_16x16x32_bf16 v[32:35], v[108:111], v[184:187], v[32:35]
    v_cvt_pk_bf16_f32 v84, v36, v37
    v_mfma_f32_16x16x32_bf16 v[28:31], v[112:115], v[224:227], v[28:31]
    v_cvt_pk_bf16_f32 v85, v38, v39
    v_mfma_f32_16x16x32_bf16 v[32:35], v[116:119], v[224:227], v[32:35]
    v_cvt_pk_bf16_f32 v86, v40, v41
    s_waitcnt lgkmcnt(3)
    v_mfma_f32_16x16x32_bf16 v[28:31], v[120:123], v[52:55], v[28:31]
    v_cvt_pk_bf16_f32 v87, v42, v43
    v_mfma_f32_16x16x32_bf16 v[32:35], v[124:127], v[52:55], v[32:35]
    buffer_store_dwordx4 v[84:87], v24, s[8:11], s32 offen sc1
    s_add_u32 s32, s32, 45056
    s_waitcnt lgkmcnt(2)
    v_mfma_f32_16x16x32_bf16 v[28:31], v[128:131], v[56:59], v[28:31]
    v_mfma_f32_16x16x32_bf16 v[32:35], v[132:135], v[56:59], v[32:35]
    v_mfma_f32_16x16x32_bf16 v[36:39], v[88:91], a[228:231], 0
    v_mfma_f32_16x16x32_bf16 v[40:43], v[92:95], a[228:231], 0
    v_mfma_f32_16x16x32_bf16 v[36:39], v[96:99], v[148:151], v[36:39]
    ds_read_b128 v[52:55], v14 offset:10240
    v_mfma_f32_16x16x32_bf16 v[40:43], v[100:103], v[148:151], v[40:43]
    ds_read_b128 v[56:59], v14 offset:20480
    v_mfma_f32_16x16x32_bf16 v[36:39], v[104:107], v[188:191], v[36:39]
    v_mfma_f32_16x16x32_bf16 v[40:43], v[108:111], v[188:191], v[40:43]
    v_cvt_pk_bf16_f32 v80, v28, v29
    v_mfma_f32_16x16x32_bf16 v[36:39], v[112:115], v[228:231], v[36:39]
    v_cvt_pk_bf16_f32 v81, v30, v31
    v_mfma_f32_16x16x32_bf16 v[40:43], v[116:119], v[228:231], v[40:43]
    v_cvt_pk_bf16_f32 v82, v32, v33
    s_waitcnt lgkmcnt(3)
    v_mfma_f32_16x16x32_bf16 v[36:39], v[120:123], v[60:63], v[36:39]
    v_cvt_pk_bf16_f32 v83, v34, v35
    v_mfma_f32_16x16x32_bf16 v[40:43], v[124:127], v[60:63], v[40:43]
    buffer_store_dwordx4 v[80:83], v24, s[8:11], s32 offen sc1
    s_add_u32 s32, s32, 45056
    s_waitcnt lgkmcnt(2)
    v_mfma_f32_16x16x32_bf16 v[36:39], v[128:131], v[64:67], v[36:39]
    v_mfma_f32_16x16x32_bf16 v[40:43], v[132:135], v[64:67], v[40:43]
    v_mfma_f32_16x16x32_bf16 v[28:31], v[88:91], a[232:235], 0
    v_mfma_f32_16x16x32_bf16 v[32:35], v[92:95], a[232:235], 0
    v_mfma_f32_16x16x32_bf16 v[28:31], v[96:99], v[152:155], v[28:31]
    ds_read_b128 v[60:63], v14 offset:11264
    v_mfma_f32_16x16x32_bf16 v[32:35], v[100:103], v[152:155], v[32:35]
    ds_read_b128 v[64:67], v14 offset:21504
    v_mfma_f32_16x16x32_bf16 v[28:31], v[104:107], v[192:195], v[28:31]
    v_mfma_f32_16x16x32_bf16 v[32:35], v[108:111], v[192:195], v[32:35]
    v_cvt_pk_bf16_f32 v84, v36, v37
    v_mfma_f32_16x16x32_bf16 v[28:31], v[112:115], v[232:235], v[28:31]
    v_cvt_pk_bf16_f32 v85, v38, v39
    v_mfma_f32_16x16x32_bf16 v[32:35], v[116:119], v[232:235], v[32:35]
    v_cvt_pk_bf16_f32 v86, v40, v41
    s_waitcnt lgkmcnt(3)
    v_mfma_f32_16x16x32_bf16 v[28:31], v[120:123], v[52:55], v[28:31]
    v_cvt_pk_bf16_f32 v87, v42, v43
    v_mfma_f32_16x16x32_bf16 v[32:35], v[124:127], v[52:55], v[32:35]
    buffer_store_dwordx4 v[84:87], v24, s[8:11], s32 offen sc1
    s_add_u32 s32, s32, 45056
    s_waitcnt lgkmcnt(2)
    v_mfma_f32_16x16x32_bf16 v[28:31], v[128:131], v[56:59], v[28:31]
    v_mfma_f32_16x16x32_bf16 v[32:35], v[132:135], v[56:59], v[32:35]
    v_mfma_f32_16x16x32_bf16 v[36:39], v[88:91], a[236:239], 0
    v_mfma_f32_16x16x32_bf16 v[40:43], v[92:95], a[236:239], 0
    v_mfma_f32_16x16x32_bf16 v[36:39], v[96:99], v[156:159], v[36:39]
    ds_read_b128 v[52:55], v14 offset:12288
    v_mfma_f32_16x16x32_bf16 v[40:43], v[100:103], v[156:159], v[40:43]
    ds_read_b128 v[56:59], v14 offset:22528
    v_mfma_f32_16x16x32_bf16 v[36:39], v[104:107], v[196:199], v[36:39]
    v_mfma_f32_16x16x32_bf16 v[40:43], v[108:111], v[196:199], v[40:43]
    v_cvt_pk_bf16_f32 v80, v28, v29
    v_mfma_f32_16x16x32_bf16 v[36:39], v[112:115], v[236:239], v[36:39]
    v_cvt_pk_bf16_f32 v81, v30, v31
    v_mfma_f32_16x16x32_bf16 v[40:43], v[116:119], v[236:239], v[40:43]
    v_cvt_pk_bf16_f32 v82, v32, v33
    s_waitcnt lgkmcnt(3)
    v_mfma_f32_16x16x32_bf16 v[36:39], v[120:123], v[60:63], v[36:39]
    v_cvt_pk_bf16_f32 v83, v34, v35
    v_mfma_f32_16x16x32_bf16 v[40:43], v[124:127], v[60:63], v[40:43]
    buffer_store_dwordx4 v[80:83], v24, s[8:11], s32 offen sc1
    s_add_u32 s32, s32, 45056
    s_waitcnt lgkmcnt(2)
    v_mfma_f32_16x16x32_bf16 v[36:39], v[128:131], v[64:67], v[36:39]
    v_mfma_f32_16x16x32_bf16 v[40:43], v[132:135], v[64:67], v[40:43]
    v_mfma_f32_16x16x32_bf16 v[28:31], v[88:91], a[240:243], 0
    v_mfma_f32_16x16x32_bf16 v[32:35], v[92:95], a[240:243], 0
    v_mfma_f32_16x16x32_bf16 v[28:31], v[96:99], v[160:163], v[28:31]
    ds_read_b128 v[60:63], v14 offset:13312
    v_mfma_f32_16x16x32_bf16 v[32:35], v[100:103], v[160:163], v[32:35]
    ds_read_b128 v[64:67], v14 offset:23552
    v_mfma_f32_16x16x32_bf16 v[28:31], v[104:107], v[200:203], v[28:31]
    v_mfma_f32_16x16x32_bf16 v[32:35], v[108:111], v[200:203], v[32:35]
    v_cvt_pk_bf16_f32 v84, v36, v37
    v_mfma_f32_16x16x32_bf16 v[28:31], v[112:115], v[240:243], v[28:31]
    v_cvt_pk_bf16_f32 v85, v38, v39
    v_mfma_f32_16x16x32_bf16 v[32:35], v[116:119], v[240:243], v[32:35]
    v_cvt_pk_bf16_f32 v86, v40, v41
    s_waitcnt lgkmcnt(3)
    v_mfma_f32_16x16x32_bf16 v[28:31], v[120:123], v[52:55], v[28:31]
    v_cvt_pk_bf16_f32 v87, v42, v43
    v_mfma_f32_16x16x32_bf16 v[32:35], v[124:127], v[52:55], v[32:35]
    buffer_store_dwordx4 v[84:87], v24, s[8:11], s32 offen sc1
    s_add_u32 s32, s32, 45056
    s_waitcnt lgkmcnt(2)
    v_mfma_f32_16x16x32_bf16 v[28:31], v[128:131], v[56:59], v[28:31]
    v_mfma_f32_16x16x32_bf16 v[32:35], v[132:135], v[56:59], v[32:35]
    v_mfma_f32_16x16x32_bf16 v[36:39], v[88:91], a[244:247], 0
    v_mfma_f32_16x16x32_bf16 v[40:43], v[92:95], a[244:247], 0
    v_mfma_f32_16x16x32_bf16 v[36:39], v[96:99], v[164:167], v[36:39]
    ds_read_b128 v[52:55], v14 offset:14336
    v_mfma_f32_16x16x32_bf16 v[40:43], v[100:103], v[164:167], v[40:43]
    ds_read_b128 v[56:59], v14 offset:24576
    v_mfma_f32_16x16x32_bf16 v[36:39], v[104:107], v[204:207], v[36:39]
    v_mfma_f32_16x16x32_bf16 v[40:43], v[108:111], v[204:207], v[40:43]
    v_cvt_pk_bf16_f32 v80, v28, v29
    v_mfma_f32_16x16x32_bf16 v[36:39], v[112:115], v[244:247], v[36:39]
    v_cvt_pk_bf16_f32 v81, v30, v31
    v_mfma_f32_16x16x32_bf16 v[40:43], v[116:119], v[244:247], v[40:43]
    v_cvt_pk_bf16_f32 v82, v32, v33
    s_waitcnt lgkmcnt(3)
    v_mfma_f32_16x16x32_bf16 v[36:39], v[120:123], v[60:63], v[36:39]
    v_cvt_pk_bf16_f32 v83, v34, v35
    v_mfma_f32_16x16x32_bf16 v[40:43], v[124:127], v[60:63], v[40:43]
    buffer_store_dwordx4 v[80:83], v24, s[8:11], s32 offen sc1
    s_add_u32 s32, s32, 45056
    s_waitcnt lgkmcnt(2)
    v_mfma_f32_16x16x32_bf16 v[36:39], v[128:131], v[64:67], v[36:39]
    v_mfma_f32_16x16x32_bf16 v[40:43], v[132:135], v[64:67], v[40:43]
    v_mfma_f32_16x16x32_bf16 v[28:31], v[88:91], a[248:251], 0
    v_mfma_f32_16x16x32_bf16 v[32:35], v[92:95], a[248:251], 0
    v_mfma_f32_16x16x32_bf16 v[28:31], v[96:99], v[168:171], v[28:31]
    ds_read_b128 v[60:63], v14 offset:15360
    v_mfma_f32_16x16x32_bf16 v[32:35], v[100:103], v[168:171], v[32:35]
    ds_read_b128 v[64:67], v14 offset:25600
    v_mfma_f32_16x16x32_bf16 v[28:31], v[104:107], v[208:211], v[28:31]
    v_mfma_f32_16x16x32_bf16 v[32:35], v[108:111], v[208:211], v[32:35]
    v_cvt_pk_bf16_f32 v84, v36, v37
    v_mfma_f32_16x16x32_bf16 v[28:31], v[112:115], v[248:251], v[28:31]
    v_cvt_pk_bf16_f32 v85, v38, v39
    v_mfma_f32_16x16x32_bf16 v[32:35], v[116:119], v[248:251], v[32:35]
    v_cvt_pk_bf16_f32 v86, v40, v41
    s_waitcnt lgkmcnt(3)
    v_mfma_f32_16x16x32_bf16 v[28:31], v[120:123], v[52:55], v[28:31]
    v_cvt_pk_bf16_f32 v87, v42, v43
    v_mfma_f32_16x16x32_bf16 v[32:35], v[124:127], v[52:55], v[32:35]
    buffer_store_dwordx4 v[84:87], v24, s[8:11], s32 offen sc1
    s_add_u32 s32, s32, 45056
    s_waitcnt lgkmcnt(2)
    v_mfma_f32_16x16x32_bf16 v[28:31], v[128:131], v[56:59], v[28:31]
    v_mfma_f32_16x16x32_bf16 v[32:35], v[132:135], v[56:59], v[32:35]
    v_mfma_f32_16x16x32_bf16 v[36:39], v[88:91], a[252:255], 0
    v_mfma_f32_16x16x32_bf16 v[40:43], v[92:95], a[252:255], 0
    v_mfma_f32_16x16x32_bf16 v[36:39], v[96:99], v[172:175], v[36:39]
    v_mfma_f32_16x16x32_bf16 v[40:43], v[100:103], v[172:175], v[40:43]
    v_mfma_f32_16x16x32_bf16 v[36:39], v[104:107], v[212:215], v[36:39]
    v_mfma_f32_16x16x32_bf16 v[40:43], v[108:111], v[212:215], v[40:43]
    s_nop 0
    v_cvt_pk_bf16_f32 v80, v28, v29
    v_mfma_f32_16x16x32_bf16 v[36:39], v[112:115], v[252:255], v[36:39]
    v_cvt_pk_bf16_f32 v81, v30, v31
    v_mfma_f32_16x16x32_bf16 v[40:43], v[116:119], v[252:255], v[40:43]
    v_cvt_pk_bf16_f32 v82, v32, v33
    s_waitcnt lgkmcnt(1)
    v_mfma_f32_16x16x32_bf16 v[36:39], v[120:123], v[60:63], v[36:39]
    v_cvt_pk_bf16_f32 v83, v34, v35
    v_mfma_f32_16x16x32_bf16 v[40:43], v[124:127], v[60:63], v[40:43]
    buffer_store_dwordx4 v[80:83], v24, s[8:11], s32 offen sc1
    s_add_u32 s32, s32, 45056
    s_waitcnt lgkmcnt(0)
    v_mfma_f32_16x16x32_bf16 v[36:39], v[128:131], v[64:67], v[36:39]
    v_mfma_f32_16x16x32_bf16 v[40:43], v[132:135], v[64:67], v[40:43]
    s_nop 6
    v_cvt_pk_bf16_f32 v84, v36, v37
    v_cvt_pk_bf16_f32 v85, v38, v39
    v_cvt_pk_bf16_f32 v86, v40, v41
    v_cvt_pk_bf16_f32 v87, v42, v43
    buffer_store_dwordx4 v[84:87], v24, s[8:11], s32 offen sc1
    s_mul_i32 s49, s48, 2048
    s_lshl_b32 s32, s6, 4
    s_add_u32 s49, s49, s32
    s_add_u32 s49, s49, 0xa800400
    s_add_u32 s34, s48, 2
    s_mul_hi_u32 s47, s34, 0x55555556
    s_mul_i32 s32, s34, 655360
    s_mul_i32 s46, s47, 131072
    s_add_u32 s32, s32, s46
    s_andn2_b32 s47, 1, s47
    s_lshl_b32 s47, s47, 13
    s_xor_b32 s47, s47, s96
    s_add_u32 s32, s32, s47
    s_add_u32 s32, s32, 0xb000000
    s_lshl_b32 s33, s6, 8
    s_add_u32 s32, s32, s33
    s_cmp_ge_u32 s34, 64
    s_cmov_b32 s32, 0x40000000
    buffer_store_dwordx4 v[20:23], v16, s[8:11], s32 offen sc1
    s_add_u32 s32, s32, 65536
    buffer_store_dwordx4 v[20:23], v16, s[8:11], s32 offen sc1
    s_add_u32 s32, s32, 65536
    buffer_store_dwordx4 v[20:23], v17, s[8:11], s32 offen sc1
    s_add_u32 s34, s48, 3
    s_lshl_b32 s32, s34, 15
    s_add_u32 s32, s32, s56
    s_cmp_ge_u32 s34, 64
    s_cmov_b32 s32, 0x40000000
    buffer_store_dwordx4 v[20:23], v18, s[8:11], s32 offen sc1
    s_cmp_ge_u32 s48, 2
    s_cbranch_scc1 nf_140
    s_waitcnt vmcnt(0)
    s_barrier
    buffer_store_dword v13, v8, s[8:11], s49 offen sc1
nf_140:
    s_add_u32 s48, s48, 2
    s_cmp_lt_u32 s48, 64
    s_cbranch_scc1 VO_loop
    s_waitcnt vmcnt(0) lgkmcnt(0)
    s_barrier
    buffer_store_dword v13, v8, s[8:11], s49 offen sc1
    s_endpgm
FFN_start:
    s_mov_b32 s12, s80
    s_and_b32 s13, s81, 0xffff
    s_mov_b32 s14, 0x1e0000
    s_mov_b32 s15, 0x20000
    s_mov_b32 s16, s82
    s_and_b32 s17, s83, 0xffff
    s_mov_b32 s18, 0x1e0000
    s_mov_b32 s19, 0x20000
    s_mov_b32 s20, s84
    s_and_b32 s21, s85, 0xffff
    s_mov_b32 s22, 0x1e0000
    s_mov_b32 s23, 0x20000
    s_mul_i32 s50, s6, 256
    s_mul_i32 s51, s6, 163840
    s_lshl_b32 s54, s4, 10
    v_lshrrev_b32 v2, 5, v1
    v_lshlrev_b32 v2, 10, v2
    v_bfe_u32 v3, v1, 2, 3
    v_lshl_add_u32 v2, v3, 7, v2
    v_and_b32 v4, 3, v1
    v_lshl_add_u32 v2, v4, 3, v2
    v_lshrrev_b32 v3, 1, v3
    s_mul_i32 s32, s4, 2
    s_add_u32 s32, s32, 0
    s_lshr_b32 s33, s32, 2
    s_mul_i32 s33, s33, 4096
    v_add_u32 v4, s32, v3
    v_and_b32 v4, 3, v4
    v_lshl_add_u32 v4, v4, 5, v2
    v_add_u32 v16, s33, v4
    s_mul_i32 s32, s4, 2
    s_add_u32 s32, s32, 1
    s_lshr_b32 s33, s32, 2
    s_mul_i32 s33, s33, 4096
    v_add_u32 v4, s32, v3
    v_and_b32 v4, 3, v4
    v_lshl_add_u32 v4, v4, 5, v2
    v_add_u32 v17, s33, v4
    v_lshrrev_b32 v2, 3, v1
    v_bfe_u32 v3, v1, 1, 2
    v_lshrrev_b32 v4, 1, v2
    v_sub_u32 v3, v3, v4
    v_and_b32 v3, 3, v3
    v_and_b32 v4, 1, v1
    v_lshl_add_u32 v3, v3, 1, v4
    v_lshrrev_b32 v4, 2, v2
    v_and_b32 v5, 3, v2
    v_lshl_add_u32 v4, v4, 3, v5
    s_and_b32 s32, s4, 1
    s_lshl_b32 s32, s32, 4
    s_lshr_b32 s33, s4, 1
    s_lshl_b32 s33, s33, 2
    s_add_u32 s32, s32, s33
    v_add_u32 v4, s32, v4
    v_mul_u32_u24 v4, 3072, v4
    v_lshl_add_u32 v24, v3, 4, v4
    v_lshrrev_b32 v2, 5, v1
    v_lshlrev_b32 v2, 10, v2
    v_bfe_u32 v3, v1, 2, 3
    v_lshl_add_u32 v2, v3, 7, v2
    v_and_b32 v4, 3, v1
    v_lshl_add_u32 v2, v4, 3, v2
    v_lshrrev_b32 v3, 1, v3
    s_mul_i32 s32, s4, 10
    s_add_u32 s32, s32, 0
    s_lshr_b32 s33, s32, 2
    s_mul_i32 s33, s33, 4096
    v_add_u32 v4, s32, v3
    v_and_b32 v4, 3, v4
    v_lshl_add_u32 v4, v4, 5, v2
    v_add_u32 v20, s33, v4
    s_mul_i32 s32, s4, 10
    s_add_u32 s32, s32, 1
    s_lshr_b32 s33, s32, 2
    s_mul_i32 s33, s33, 4096
    v_add_u32 v4, s32, v3
    v_and_b32 v4, 3, v4
    v_lshl_add_u32 v4, v4, 5, v2
    v_add_u32 v21, s33, v4
    s_mul_i32 s32, s4, 10
    s_add_u32 s32, s32, 2
    s_lshr_b32 s33, s32, 2
    s_mul_i32 s33, s33, 4096
    v_add_u32 v4, s32, v3
    v_and_b32 v4, 3, v4
    v_lshl_add_u32 v4, v4, 5, v2
    v_add_u32 v22, s33, v4
    s_mul_i32 s32, s4, 10
    s_add_u32 s32, s32, 3
    s_lshr_b32 s33, s32, 2
    s_mul_i32 s33, s33, 4096
    v_add_u32 v4, s32, v3
    v_and_b32 v4, 3, v4
    v_lshl_add_u32 v4, v4, 5, v2
    v_add_u32 v23, s33, v4
    v_lshrrev_b32 v2, 3, v1
    v_bfe_u32 v3, v1, 1, 2
    v_lshrrev_b32 v4, 1, v2
    v_sub_u32 v3, v3, v4
    v_and_b32 v3, 3, v3
    v_and_b32 v4, 1, v1
    v_lshl_add_u32 v3, v3, 1, v4
    v_lshrrev_b32 v4, 2, v2
    v_and_b32 v5, 3, v2
    v_lshl_add_u32 v4, v4, 3, v5
    s_and_b32 s32, s4, 1
    s_lshl_b32 s32, s32, 4
    s_lshr_b32 s33, s4, 1
    s_lshl_b32 s33, s33, 2
    s_add_u32 s32, s32, s33
    v_add_u32 v4, s32, v4
    v_mul_u32_u24 v4, 1280, v4
    v_lshl_add_u32 v25, v3, 4, v4
    s_mul_i32 s32, s4, 28672
    s_add_u32 s32, s32, 49152
    v_lshl_add_u32 v14, v1, 4, s32
    s_add_u32 m0, s54, 0
    s_add_u32 s32, s50, 0
    buffer_load_dwordx4 v24, s[12:15], s32 offen nt lds
    s_add_u32 m0, s54, 4096
    s_add_u32 s32, s50, 128
    buffer_load_dwordx4 v24, s[12:15], s32 offen nt lds
    s_add_u32 m0, s54, 8192
    s_add_u32 s32, s50, 0
    buffer_load_dwordx4 v24, s[16:19], s32 offen nt lds
    s_add_u32 m0, s54, 12288
    s_add_u32 s32, s50, 128
    buffer_load_dwordx4 v24, s[16:19], s32 offen nt lds
    s_add_u32 m0, s54, 16384
    s_add_u32 s32, s50, 98304
    buffer_load_dwordx4 v24, s[12:15], s32 offen nt lds
    s_add_u32 m0, s54, 20480
    s_add_u32 s32, s50, 98432
    buffer_load_dwordx4 v24, s[12:15], s32 offen nt lds
    s_add_u32 m0, s54, 24576
    s_add_u32 s32, s50, 98304
    buffer_load_dwordx4 v24, s[16:19], s32 offen nt lds
    s_add_u32 m0, s54, 28672
    s_add_u32 s32, s50, 98432
    buffer_load_dwordx4 v24, s[16:19], s32 offen nt lds
    s_add_u32 m0, s54, 32768
    s_add_u32 s32, s50, 196608
    buffer_load_dwordx4 v24, s[12:15], s32 offen nt lds
    s_add_u32 m0, s54, 36864
    s_add_u32 s32, s50, 196736
    buffer_load_dwordx4 v24, s[12:15], s32 offen nt lds
    s_add_u32 m0, s54, 40960
    s_add_u32 s32, s50, 196608
    buffer_load_dwordx4 v24, s[16:19], s32 offen nt lds
    s_add_u32 m0, s54, 45056
    s_add_u32 s32, s50, 196736
    buffer_load_dwordx4 v24, s[16:19], s32 offen nt lds
    s_add_u32 m0, s54, 49152
    s_add_u32 s32, s50, 294912
    buffer_load_dwordx4 v24, s[12:15], s32 offen nt lds
    s_add_u32 m0, s54, 53248
    s_add_u32 s32, s50, 295040
    buffer_load_dwordx4 v24, s[12:15], s32 offen nt lds
    s_add_u32 m0, s54, 57344
    s_add_u32 s32, s50, 294912
    buffer_load_dwordx4 v24, s[16:19], s32 offen nt lds
    s_add_u32 m0, s54, 61440
    s_add_u32 s32, s50, 295040
    buffer_load_dwordx4 v24, s[16:19], s32 offen nt lds
    s_add_u32 m0, s54, 65536
    s_add_u32 s32, s50, 393216
    buffer_load_dwordx4 v24, s[12:15], s32 offen nt lds
    s_add_u32 m0, s54, 69632
    s_add_u32 s32, s50, 393344
    buffer_load_dwordx4 v24, s[12:15], s32 offen nt lds
    s_add_u32 m0, s54, 73728
    s_add_u32 s32, s50, 393216
    buffer_load_dwordx4 v24, s[16:19], s32 offen nt lds
    s_add_u32 m0, s54, 77824
    s_add_u32 s32, s50, 393344
    buffer_load_dwordx4 v24, s[16:19], s32 offen nt lds
    s_add_u32 m0, s54, 81920
    s_add_u32 s32, s50, 491520
    buffer_load_dwordx4 v24, s[12:15], s32 offen nt lds
    s_add_u32 m0, s54, 86016
    s_add_u32 s32, s50, 491648
    buffer_load_dwordx4 v24, s[12:15], s32 offen nt lds
    s_add_u32 m0, s54, 90112
    s_add_u32 s32, s50, 491520
    buffer_load_dwordx4 v24, s[16:19], s32 offen nt lds
    s_add_u32 m0, s54, 94208
    s_add_u32 s32, s50, 491648
    buffer_load_dwordx4 v24, s[16:19], s32 offen nt lds
    s_add_u32 m0, s54, 98304
    s_add_u32 s32, s50, 589824
    buffer_load_dwordx4 v24, s[12:15], s32 offen nt lds
    s_add_u32 m0, s54, 102400
    s_add_u32 s32, s50, 589952
    buffer_load_dwordx4 v24, s[12:15], s32 offen nt lds
    s_add_u32 m0, s54, 106496
    s_add_u32 s32, s50, 589824
    buffer_load_dwordx4 v24, s[16:19], s32 offen nt lds
    s_add_u32 m0, s54, 110592
    s_add_u32 s32, s50, 589952
    buffer_load_dwordx4 v24, s[16:19], s32 offen nt lds
    s_add_u32 m0, s54, 114688
    s_add_u32 s32, s50, 688128
    buffer_load_dwordx4 v24, s[12:15], s32 offen nt lds
    s_add_u32 m0, s54, 118784
    s_add_u32 s32, s50, 688256
    buffer_load_dwordx4 v24, s[12:15], s32 offen nt lds
    s_add_u32 m0, s54, 122880
    s_add_u32 s32, s50, 688128
    buffer_load_dwordx4 v24, s[16:19], s32 offen nt lds
    s_add_u32 m0, s54, 126976
    s_add_u32 s32, s50, 688256
    buffer_load_dwordx4 v24, s[16:19], s32 offen nt lds
    s_add_u32 m0, s54, 131072
    s_add_u32 s32, s50, 786432
    buffer_load_dwordx4 v24, s[12:15], s32 offen nt lds
    s_add_u32 m0, s54, 135168
    s_add_u32 s32, s50, 786560
    buffer_load_dwordx4 v24, s[12:15], s32 offen nt lds
    s_add_u32 m0, s54, 139264
    s_add_u32 s32, s50, 786432
    buffer_load_dwordx4 v24, s[16:19], s32 offen nt lds
    s_add_u32 m0, s54, 143360
    s_add_u32 s32, s50, 786560
    buffer_load_dwordx4 v24, s[16:19], s32 offen nt lds
    s_add_u32 m0, s54, 147456
    s_add_u32 s32, s50, 884736
    buffer_load_dwordx4 v24, s[12:15], s32 offen nt lds
    s_add_u32 m0, s54, 151552
    s_add_u32 s32, s50, 884864
    buffer_load_dwordx4 v24, s[12:15], s32 offen nt lds
    s_add_u32 m0, s54, 155648
    s_add_u32 s32, s50, 884736
    buffer_load_dwordx4 v24, s[16:19], s32 offen nt lds
    s_add_u32 m0, s54, 159744
    s_add_u32 s32, s50, 884864
    buffer_load_dwordx4 v24, s[16:19], s32 offen nt lds
    s_waitcnt vmcnt(36)
    s_barrier
    ds_read_b64_tr_b16 a[0:1], v16 offset:0
    ds_read_b64_tr_b16 a[2:3], v16 offset:2048
    ds_read_b64_tr_b16 a[4:5], v17 offset:0
    ds_read_b64_tr_b16 a[6:7], v17 offset:2048
    ds_read_b64_tr_b16 a[8:9], v16 offset:8192
    ds_read_b64_tr_b16 a[10:11], v16 offset:10240
    ds_read_b64_tr_b16 a[12:13], v17 offset:8192
    ds_read_b64_tr_b16 a[14:15], v17 offset:10240
    s_waitcnt lgkmcnt(0)
    s_waitcnt vmcnt(32)
    s_barrier
    s_add_u32 m0, s54, 0
    s_add_u32 s32, s50, 983040
    buffer_load_dwordx4 v24, s[12:15], s32 offen nt lds
    s_add_u32 m0, s54, 4096
    s_add_u32 s32, s50, 983168
    buffer_load_dwordx4 v24, s[12:15], s32 offen nt lds
    s_add_u32 m0, s54, 8192
    s_add_u32 s32, s50, 983040
    buffer_load_dwordx4 v24, s[16:19], s32 offen nt lds
    s_add_u32 m0, s54, 12288
    s_add_u32 s32, s50, 983168
    buffer_load_dwordx4 v24, s[16:19], s32 offen nt lds
    ds_read_b64_tr_b16 a[16:17], v16 offset:16384
    ds_read_b64_tr_b16 a[18:19], v16 offset:18432
    ds_read_b64_tr_b16 a[20:21], v17 offset:16384
    ds_read_b64_tr_b16 a[22:23], v17 offset:18432
    ds_read_b64_tr_b16 a[24:25], v16 offset:24576
    ds_read_b64_tr_b16 a[26:27], v16 offset:26624
    ds_read_b64_tr_b16 a[28:29], v17 offset:24576
    ds_read_b64_tr_b16 a[30:31], v17 offset:26624
    s_waitcnt lgkmcnt(0)
    s_waitcnt vmcnt(32)
    s_barrier
    s_add_u32 m0, s54, 16384
    s_add_u32 s32, s50, 1081344
    buffer_load_dwordx4 v24, s[12:15], s32 offen nt lds
    s_add_u32 m0, s54, 20480
    s_add_u32 s32, s50, 1081472
    buffer_load_dwordx4 v24, s[12:15], s32 offen nt lds
    s_add_u32 m0, s54, 24576
    s_add_u32 s32, s50, 1081344
    buffer_load_dwordx4 v24, s[16:19], s32 offen nt lds
    s_add_u32 m0, s54, 28672
    s_add_u32 s32, s50, 1081472
    buffer_load_dwordx4 v24, s[16:19], s32 offen nt lds
    ds_read_b64_tr_b16 a[32:33], v16 offset:32768
    ds_read_b64_tr_b16 a[34:35], v16 offset:34816
    ds_read_b64_tr_b16 a[36:37], v17 offset:32768
    ds_read_b64_tr_b16 a[38:39], v17 offset:34816
    ds_read_b64_tr_b16 a[40:41], v16 offset:40960
    ds_read_b64_tr_b16 a[42:43], v16 offset:43008
    ds_read_b64_tr_b16 a[44:45], v17 offset:40960
    ds_read_b64_tr_b16 a[46:47], v17 offset:43008
    s_waitcnt lgkmcnt(0)
    s_waitcnt vmcnt(32)
    s_barrier
    s_add_u32 m0, s54, 32768
    s_add_u32 s32, s50, 1179648
    buffer_load_dwordx4 v24, s[12:15], s32 offen nt lds
    s_add_u32 m0, s54, 36864
    s_add_u32 s32, s50, 1179776
    buffer_load_dwordx4 v24, s[12:15], s32 offen nt lds
    s_add_u32 m0, s54, 40960
    s_add_u32 s32, s50, 1179648
    buffer_load_dwordx4 v24, s[16:19], s32 offen nt lds
    s_add_u32 m0, s54, 45056
    s_add_u32 s32, s50, 1179776
    buffer_load_dwordx4 v24, s[16:19], s32 offen nt lds
    ds_read_b64_tr_b16 a[48:49], v16 offset:49152
    ds_read_b64_tr_b16 a[50:51], v16 offset:51200
    ds_read_b64_tr_b16 a[52:53], v17 offset:49152
    ds_read_b64_tr_b16 a[54:55], v17 offset:51200
    ds_read_b64_tr_b16 a[56:57], v16 offset:57344
    ds_read_b64_tr_b16 a[58:59], v16 offset:59392
    ds_read_b64_tr_b16 a[60:61], v17 offset:57344
    ds_read_b64_tr_b16 a[62:63], v17 offset:59392
    s_waitcnt lgkmcnt(0)
    s_waitcnt vmcnt(32)
    s_barrier
    s_add_u32 m0, s54, 49152
    s_add_u32 s32, s50, 1277952
    buffer_load_dwordx4 v24, s[12:15], s32 offen nt lds
    s_add_u32 m0, s54, 53248
    s_add_u32 s32, s50, 1278080
    buffer_load_dwordx4 v24, s[12:15], s32 offen nt lds
    s_add_u32 m0, s54, 57344
    s_add_u32 s32, s50, 1277952
    buffer_load_dwordx4 v24, s[16:19], s32 offen nt lds
    s_add_u32 m0, s54, 61440
    s_add_u32 s32, s50, 1278080
    buffer_load_dwordx4 v24, s[16:19], s32 offen nt lds
    v_add_u32 v10, 0x10000, v16
    ds_read_b64_tr_b16 a[64:65], v10 offset:0
    ds_read_b64_tr_b16 a[66:67], v10 offset:2048
    v_add_u32 v11, 0x10000, v17
    ds_read_b64_tr_b16 a[68:69], v11 offset:0
    ds_read_b64_tr_b16 a[70:71], v11 offset:2048
    ds_read_b64_tr_b16 a[72:73], v10 offset:8192
    ds_read_b64_tr_b16 a[74:75], v10 offset:10240
    ds_read_b64_tr_b16 a[76:77], v11 offset:8192
    ds_read_b64_tr_b16 a[78:79], v11 offset:10240
    s_waitcnt lgkmcnt(0)
    s_waitcnt vmcnt(32)
    s_barrier
    s_add_u32 m0, s54, 65536
    s_add_u32 s32, s50, 1376256
    buffer_load_dwordx4 v24, s[12:15], s32 offen nt lds
    s_add_u32 m0, s54, 69632
    s_add_u32 s32, s50, 1376384
    buffer_load_dwordx4 v24, s[12:15], s32 offen nt lds
    s_add_u32 m0, s54, 73728
    s_add_u32 s32, s50, 1376256
    buffer_load_dwordx4 v24, s[16:19], s32 offen nt lds
    s_add_u32 m0, s54, 77824
    s_add_u32 s32, s50, 1376384
    buffer_load_dwordx4 v24, s[16:19], s32 offen nt lds
    v_add_u32 v10, 0x10000, v16
    ds_read_b64_tr_b16 a[80:81], v10 offset:16384
    ds_read_b64_tr_b16 a[82:83], v10 offset:18432
    v_add_u32 v11, 0x10000, v17
    ds_read_b64_tr_b16 a[84:85], v11 offset:16384
    ds_read_b64_tr_b16 a[86:87], v11 offset:18432
    ds_read_b64_tr_b16 a[88:89], v10 offset:24576
    ds_read_b64_tr_b16 a[90:91], v10 offset:26624
    ds_read_b64_tr_b16 a[92:93], v11 offset:24576
    ds_read_b64_tr_b16 a[94:95], v11 offset:26624
    s_waitcnt lgkmcnt(0)
    s_waitcnt vmcnt(32)
    s_barrier
    s_add_u32 m0, s54, 81920
    s_add_u32 s32, s50, 1474560
    buffer_load_dwordx4 v24, s[12:15], s32 offen nt lds
    s_add_u32 m0, s54, 86016
    s_add_u32 s32, s50, 1474688
    buffer_load_dwordx4 v24, s[12:15], s32 offen nt lds
    s_add_u32 m0, s54, 90112
    s_add_u32 s32, s50, 1474560
    buffer_load_dwordx4 v24, s[16:19], s32 offen nt lds
    s_add_u32 m0, s54, 94208
    s_add_u32 s32, s50, 1474688
    buffer_load_dwordx4 v24, s[16:19], s32 offen nt lds
    v_add_u32 v10, 0x18000, v16
    ds_read_b64_tr_b16 a[96:97], v10 offset:0
    ds_read_b64_tr_b16 a[98:99], v10 offset:2048
    v_add_u32 v11, 0x18000, v17
    ds_read_b64_tr_b16 a[100:101], v11 offset:0
    ds_read_b64_tr_b16 a[102:103], v11 offset:2048
    ds_read_b64_tr_b16 a[104:105], v10 offset:8192
    ds_read_b64_tr_b16 a[106:107], v10 offset:10240
    ds_read_b64_tr_b16 a[108:109], v11 offset:8192
    ds_read_b64_tr_b16 a[110:111], v11 offset:10240
    s_waitcnt lgkmcnt(0)
    s_waitcnt vmcnt(32)
    s_barrier
    s_add_u32 m0, s54, 98304
    s_add_u32 s32, s50, 1572864
    buffer_load_dwordx4 v24, s[12:15], s32 offen nt lds
    s_add_u32 m0, s54, 102400
    s_add_u32 s32, s50, 1572992
    buffer_load_dwordx4 v24, s[12:15], s32 offen nt lds
    s_add_u32 m0, s54, 106496
    s_add_u32 s32, s50, 1572864
    buffer_load_dwordx4 v24, s[16:19], s32 offen nt lds
    s_add_u32 m0, s54, 110592
    s_add_u32 s32, s50, 1572992
    buffer_load_dwordx4 v24, s[16:19], s32 offen nt lds
    v_add_u32 v10, 0x18000, v16
    ds_read_b64_tr_b16 a[112:113], v10 offset:16384
    ds_read_b64_tr_b16 a[114:115], v10 offset:18432
    v_add_u32 v11, 0x18000, v17
    ds_read_b64_tr_b16 a[116:117], v11 offset:16384
    ds_read_b64_tr_b16 a[118:119], v11 offset:18432
    ds_read_b64_tr_b16 a[120:121], v10 offset:24576
    ds_read_b64_tr_b16 a[122:123], v10 offset:26624
    ds_read_b64_tr_b16 a[124:125], v11 offset:24576
    ds_read_b64_tr_b16 a[126:127], v11 offset:26624
    s_waitcnt lgkmcnt(0)
    s_waitcnt vmcnt(32)
    s_barrier
    s_add_u32 m0, s54, 114688
    s_add_u32 s32, s50, 1671168
    buffer_load_dwordx4 v24, s[12:15], s32 offen nt lds
    s_add_u32 m0, s54, 118784
    s_add_u32 s32, s50, 1671296
    buffer_load_dwordx4 v24, s[12:15], s32 offen nt lds
    s_add_u32 m0, s54, 122880
    s_add_u32 s32, s50, 1671168
    buffer_load_dwordx4 v24, s[16:19], s32 offen nt lds
    s_add_u32 m0, s54, 126976
    s_add_u32 s32, s50, 1671296
    buffer_load_dwordx4 v24, s[16:19], s32 offen nt lds
    v_add_u32 v10, 0x20000, v16
    ds_read_b64_tr_b16 a[128:129], v10 offset:0
    ds_read_b64_tr_b16 a[130:131], v10 offset:2048
    v_add_u32 v11, 0x20000, v17
    ds_read_b64_tr_b16 a[132:133], v11 offset:0
    ds_read_b64_tr_b16 a[134:135], v11 offset:2048
    ds_read_b64_tr_b16 a[136:137], v10 offset:8192
    ds_read_b64_tr_b16 a[138:139], v10 offset:10240
    ds_read_b64_tr_b16 a[140:141], v11 offset:8192
    ds_read_b64_tr_b16 a[142:143], v11 offset:10240
    s_waitcnt lgkmcnt(0)
    s_waitcnt vmcnt(32)
    s_barrier
    s_add_u32 m0, s54, 131072
    s_add_u32 s32, s50, 1769472
    buffer_load_dwordx4 v24, s[12:15], s32 offen nt lds
    s_add_u32 m0, s54, 135168
    s_add_u32 s32, s50, 1769600
    buffer_load_dwordx4 v24, s[12:15], s32 offen nt lds
    s_add_u32 m0, s54, 139264
    s_add_u32 s32, s50, 1769472
    buffer_load_dwordx4 v24, s[16:19], s32 offen nt lds
    s_add_u32 m0, s54, 143360
    s_add_u32 s32, s50, 1769600
    buffer_load_dwordx4 v24, s[16:19], s32 offen nt lds
    v_add_u32 v10, 0x20000, v16
    ds_read_b64_tr_b16 v[28:29], v10 offset:16384
    ds_read_b64_tr_b16 v[30:31], v10 offset:18432
    v_add_u32 v11, 0x20000, v17
    ds_read_b64_tr_b16 v[32:33], v11 offset:16384
    ds_read_b64_tr_b16 v[34:35], v11 offset:18432
    ds_read_b64_tr_b16 v[36:37], v10 offset:24576
    ds_read_b64_tr_b16 v[38:39], v10 offset:26624
    ds_read_b64_tr_b16 v[40:41], v11 offset:24576
    ds_read_b64_tr_b16 v[42:43], v11 offset:26624
    s_waitcnt lgkmcnt(0)
    s_waitcnt vmcnt(32)
    s_barrier
    s_add_u32 m0, s54, 147456
    s_add_u32 s32, s50, 1867776
    buffer_load_dwordx4 v24, s[12:15], s32 offen nt lds
    s_add_u32 m0, s54, 151552
    s_add_u32 s32, s50, 1867904
    buffer_load_dwordx4 v24, s[12:15], s32 offen nt lds
    s_add_u32 m0, s54, 155648
    s_add_u32 s32, s50, 1867776
    buffer_load_dwordx4 v24, s[16:19], s32 offen nt lds
    s_add_u32 m0, s54, 159744
    s_add_u32 s32, s50, 1867904
    buffer_load_dwordx4 v24, s[16:19], s32 offen nt lds
    ds_read_b64_tr_b16 a[144:145], v16 offset:0
    ds_read_b64_tr_b16 a[146:147], v16 offset:2048
    ds_read_b64_tr_b16 a[148:149], v17 offset:0
    ds_read_b64_tr_b16 a[150:151], v17 offset:2048
    ds_read_b64_tr_b16 a[152:153], v16 offset:8192
    ds_read_b64_tr_b16 a[154:155], v16 offset:10240
    ds_read_b64_tr_b16 a[156:157], v17 offset:8192
    ds_read_b64_tr_b16 a[158:159], v17 offset:10240
    s_waitcnt lgkmcnt(0)
    s_waitcnt vmcnt(32)
    s_barrier
    ds_read_b64_tr_b16 a[160:161], v16 offset:16384
    ds_read_b64_tr_b16 a[162:163], v16 offset:18432
    ds_read_b64_tr_b16 a[164:165], v17 offset:16384
    ds_read_b64_tr_b16 a[166:167], v17 offset:18432
    ds_read_b64_tr_b16 a[168:169], v16 offset:24576
    ds_read_b64_tr_b16 a[170:171], v16 offset:26624
    ds_read_b64_tr_b16 a[172:173], v17 offset:24576
    ds_read_b64_tr_b16 a[174:175], v17 offset:26624
    s_waitcnt lgkmcnt(0)
    s_waitcnt vmcnt(28)
    s_barrier
    ds_read_b64_tr_b16 a[176:177], v16 offset:32768
    ds_read_b64_tr_b16 a[178:179], v16 offset:34816
    ds_read_b64_tr_b16 a[180:181], v17 offset:32768
    ds_read_b64_tr_b16 a[182:183], v17 offset:34816
    ds_read_b64_tr_b16 a[184:185], v16 offset:40960
    ds_read_b64_tr_b16 a[186:187], v16 offset:43008
    ds_read_b64_tr_b16 a[188:189], v17 offset:40960
    ds_read_b64_tr_b16 a[190:191], v17 offset:43008
    s_waitcnt lgkmcnt(0)
    s_waitcnt vmcnt(24)
    s_barrier
    s_add_u32 m0, s54, 0
    s_add_u32 s32, s51, 0
    buffer_load_dwordx4 v25, s[20:23], s32 offen nt lds
    s_add_u32 m0, s54, 4096
    s_add_u32 s32, s51, 128
    buffer_load_dwordx4 v25, s[20:23], s32 offen nt lds
    s_add_u32 m0, s54, 8192
    s_add_u32 s32, s51, 256
    buffer_load_dwordx4 v25, s[20:23], s32 offen nt lds
    s_add_u32 m0, s54, 12288
    s_add_u32 s32, s51, 384
    buffer_load_dwordx4 v25, s[20:23], s32 offen nt lds
    s_add_u32 m0, s54, 16384
    s_add_u32 s32, s51, 512
    buffer_load_dwordx4 v25, s[20:23], s32 offen nt lds
    s_add_u32 m0, s54, 20480
    s_add_u32 s32, s51, 640
    buffer_load_dwordx4 v25, s[20:23], s32 offen nt lds
    s_add_u32 m0, s54, 24576
    s_add_u32 s32, s51, 768
    buffer_load_dwordx4 v25, s[20:23], s32 offen nt lds
    s_add_u32 m0, s54, 28672
    s_add_u32 s32, s51, 896
    buffer_load_dwordx4 v25, s[20:23], s32 offen nt lds
    s_add_u32 m0, s54, 32768
    s_add_u32 s32, s51, 1024
    buffer_load_dwordx4 v25, s[20:23], s32 offen nt lds
    s_add_u32 m0, s54, 36864
    s_add_u32 s32, s51, 1152
    buffer_load_dwordx4 v25, s[20:23], s32 offen nt lds
    ds_read_b64_tr_b16 a[192:193], v16 offset:49152
    ds_read_b64_tr_b16 a[194:195], v16 offset:51200
    ds_read_b64_tr_b16 a[196:197], v17 offset:49152
    ds_read_b64_tr_b16 a[198:199], v17 offset:51200
    ds_read_b64_tr_b16 a[200:201], v16 offset:57344
    ds_read_b64_tr_b16 a[202:203], v16 offset:59392
    ds_read_b64_tr_b16 a[204:205], v17 offset:57344
    ds_read_b64_tr_b16 a[206:207], v17 offset:59392
    s_waitcnt lgkmcnt(0)
    s_waitcnt vmcnt(30)
    s_barrier
    v_add_u32 v10, 0x10000, v16
    ds_read_b64_tr_b16 a[208:209], v10 offset:0
    ds_read_b64_tr_b16 a[210:211], v10 offset:2048
    v_add_u32 v11, 0x10000, v17
    ds_read_b64_tr_b16 a[212:213], v11 offset:0
    ds_read_b64_tr_b16 a[214:215], v11 offset:2048
    ds_read_b64_tr_b16 a[216:217], v10 offset:8192
    ds_read_b64_tr_b16 a[218:219], v10 offset:10240
    ds_read_b64_tr_b16 a[220:221], v11 offset:8192
    ds_read_b64_tr_b16 a[222:223], v11 offset:10240
    s_waitcnt lgkmcnt(0)
    s_waitcnt vmcnt(26)
    s_barrier
    s_add_u32 m0, s54, 40960
    s_add_u32 s32, s51, 40960
    buffer_load_dwordx4 v25, s[20:23], s32 offen nt lds
    s_add_u32 m0, s54, 45056
    s_add_u32 s32, s51, 41088
    buffer_load_dwordx4 v25, s[20:23], s32 offen nt lds
    s_add_u32 m0, s54, 49152
    s_add_u32 s32, s51, 41216
    buffer_load_dwordx4 v25, s[20:23], s32 offen nt lds
    s_add_u32 m0, s54, 53248
    s_add_u32 s32, s51, 41344
    buffer_load_dwordx4 v25, s[20:23], s32 offen nt lds
    s_add_u32 m0, s54, 57344
    s_add_u32 s32, s51, 41472
    buffer_load_dwordx4 v25, s[20:23], s32 offen nt lds
    s_add_u32 m0, s54, 61440
    s_add_u32 s32, s51, 41600
    buffer_load_dwordx4 v25, s[20:23], s32 offen nt lds
    s_add_u32 m0, s54, 65536
    s_add_u32 s32, s51, 41728
    buffer_load_dwordx4 v25, s[20:23], s32 offen nt lds
    s_add_u32 m0, s54, 69632
    s_add_u32 s32, s51, 41856
    buffer_load_dwordx4 v25, s[20:23], s32 offen nt lds
    s_add_u32 m0, s54, 73728
    s_add_u32 s32, s51, 41984
    buffer_load_dwordx4 v25, s[20:23], s32 offen nt lds
    s_add_u32 m0, s54, 77824
    s_add_u32 s32, s51, 42112
    buffer_load_dwordx4 v25, s[20:23], s32 offen nt lds
    v_add_u32 v10, 0x10000, v16
    ds_read_b64_tr_b16 a[224:225], v10 offset:16384
    ds_read_b64_tr_b16 a[226:227], v10 offset:18432
    v_add_u32 v11, 0x10000, v17
    ds_read_b64_tr_b16 a[228:229], v11 offset:16384
    ds_read_b64_tr_b16 a[230:231], v11 offset:18432
    ds_read_b64_tr_b16 a[232:233], v10 offset:24576
    ds_read_b64_tr_b16 a[234:235], v10 offset:26624
    ds_read_b64_tr_b16 a[236:237], v11 offset:24576
    ds_read_b64_tr_b16 a[238:239], v11 offset:26624
    s_waitcnt lgkmcnt(0)
    s_waitcnt vmcnt(32)
    s_barrier
    v_add_u32 v10, 0x18000, v16
    ds_read_b64_tr_b16 a[240:241], v10 offset:0
    ds_read_b64_tr_b16 a[242:243], v10 offset:2048
    v_add_u32 v11, 0x18000, v17
    ds_read_b64_tr_b16 a[244:245], v11 offset:0
    ds_read_b64_tr_b16 a[246:247], v11 offset:2048
    ds_read_b64_tr_b16 a[248:249], v10 offset:8192
    ds_read_b64_tr_b16 a[250:251], v10 offset:10240
    ds_read_b64_tr_b16 a[252:253], v11 offset:8192
    ds_read_b64_tr_b16 a[254:255], v11 offset:10240
    s_waitcnt lgkmcnt(0)
    s_waitcnt vmcnt(28)
    s_barrier
    v_add_u32 v10, 0x18000, v16
    ds_read_b64_tr_b16 v[144:145], v10 offset:16384
    ds_read_b64_tr_b16 v[146:147], v10 offset:18432
    v_add_u32 v11, 0x18000, v17
    ds_read_b64_tr_b16 v[148:149], v11 offset:16384
    ds_read_b64_tr_b16 v[150:151], v11 offset:18432
    ds_read_b64_tr_b16 v[152:153], v10 offset:24576
    ds_read_b64_tr_b16 v[154:155], v10 offset:26624
    ds_read_b64_tr_b16 v[156:157], v11 offset:24576
    ds_read_b64_tr_b16 v[158:159], v11 offset:26624
    s_waitcnt lgkmcnt(0)
    s_waitcnt vmcnt(24)
    s_barrier
    s_add_u32 m0, s54, 81920
    s_add_u32 s32, s51, 81920
    buffer_load_dwordx4 v25, s[20:23], s32 offen nt lds
    s_add_u32 m0, s54, 86016
    s_add_u32 s32, s51, 82048
    buffer_load_dwordx4 v25, s[20:23], s32 offen nt lds
    s_add_u32 m0, s54, 90112
    s_add_u32 s32, s51, 82176
    buffer_load_dwordx4 v25, s[20:23], s32 offen nt lds
    s_add_u32 m0, s54, 94208
    s_add_u32 s32, s51, 82304
    buffer_load_dwordx4 v25, s[20:23], s32 offen nt lds
    s_add_u32 m0, s54, 98304
    s_add_u32 s32, s51, 82432
    buffer_load_dwordx4 v25, s[20:23], s32 offen nt lds
    s_add_u32 m0, s54, 102400
    s_add_u32 s32, s51, 82560
    buffer_load_dwordx4 v25, s[20:23], s32 offen nt lds
    s_add_u32 m0, s54, 106496
    s_add_u32 s32, s51, 82688
    buffer_load_dwordx4 v25, s[20:23], s32 offen nt lds
    s_add_u32 m0, s54, 110592
    s_add_u32 s32, s51, 82816
    buffer_load_dwordx4 v25, s[20:23], s32 offen nt lds
    s_add_u32 m0, s54, 114688
    s_add_u32 s32, s51, 82944
    buffer_load_dwordx4 v25, s[20:23], s32 offen nt lds
    s_add_u32 m0, s54, 118784
    s_add_u32 s32, s51, 83072
    buffer_load_dwordx4 v25, s[20:23], s32 offen nt lds
    v_add_u32 v10, 0x20000, v16
    ds_read_b64_tr_b16 v[160:161], v10 offset:0
    ds_read_b64_tr_b16 v[162:163], v10 offset:2048
    v_add_u32 v11, 0x20000, v17
    ds_read_b64_tr_b16 v[164:165], v11 offset:0
    ds_read_b64_tr_b16 v[166:167], v11 offset:2048
    ds_read_b64_tr_b16 v[168:169], v10 offset:8192
    ds_read_b64_tr_b16 v[170:171], v10 offset:10240
    ds_read_b64_tr_b16 v[172:173], v11 offset:8192
    ds_read_b64_tr_b16 v[174:175], v11 offset:10240
    s_waitcnt lgkmcnt(0)
    s_waitcnt vmcnt(30)
    s_barrier
    v_add_u32 v10, 0x20000, v16
    ds_read_b64_tr_b16 v[44:45], v10 offset:16384
    ds_read_b64_tr_b16 v[46:47], v10 offset:18432
    v_add_u32 v11, 0x20000, v17
    ds_read_b64_tr_b16 v[48:49], v11 offset:16384
    ds_read_b64_tr_b16 v[50:51], v11 offset:18432
    ds_read_b64_tr_b16 v[52:53], v10 offset:24576
    ds_read_b64_tr_b16 v[54:55], v10 offset:26624
    ds_read_b64_tr_b16 v[56:57], v11 offset:24576
    ds_read_b64_tr_b16 v[58:59], v11 offset:26624
    s_waitcnt lgkmcnt(0)
    s_waitcnt vmcnt(20)
    s_barrier
    s_add_u32 m0, s54, 122880
    s_add_u32 s32, s51, 122880
    buffer_load_dwordx4 v25, s[20:23], s32 offen nt lds
    s_add_u32 m0, s54, 126976
    s_add_u32 s32, s51, 123008
    buffer_load_dwordx4 v25, s[20:23], s32 offen nt lds
    s_add_u32 m0, s54, 131072
    s_add_u32 s32, s51, 123136
    buffer_load_dwordx4 v25, s[20:23], s32 offen nt lds
    s_add_u32 m0, s54, 135168
    s_add_u32 s32, s51, 123264
    buffer_load_dwordx4 v25, s[20:23], s32 offen nt lds
    s_add_u32 m0, s54, 139264
    s_add_u32 s32, s51, 123392
    buffer_load_dwordx4 v25, s[20:23], s32 offen nt lds
    s_add_u32 m0, s54, 143360
    s_add_u32 s32, s51, 123520
    buffer_load_dwordx4 v25, s[20:23], s32 offen nt lds
    s_add_u32 m0, s54, 147456
    s_add_u32 s32, s51, 123648
    buffer_load_dwordx4 v25, s[20:23], s32 offen nt lds
    s_add_u32 m0, s54, 151552
    s_add_u32 s32, s51, 123776
    buffer_load_dwordx4 v25, s[20:23], s32 offen nt lds
    s_add_u32 m0, s54, 155648
    s_add_u32 s32, s51, 123904
    buffer_load_dwordx4 v25, s[20:23], s32 offen nt lds
    s_add_u32 m0, s54, 159744
    s_add_u32 s32, s51, 124032
    buffer_load_dwordx4 v25, s[20:23], s32 offen nt lds
    s_mov_b32 s28, s88
    s_and_b32 s29, s89, 0xffff
    s_mov_b32 s30, 0x100
    s_mov_b32 s31, 0x20000
    v_mov_b32 v2, 0
    buffer_load_dword v3, v2, s[28:31], 0 offen offset:60 sc1
    ds_read_b64_tr_b16 v[176:177], v20 offset:0
    ds_read_b64_tr_b16 v[178:179], v20 offset:2048
    ds_read_b64_tr_b16 v[180:181], v21 offset:0
    ds_read_b64_tr_b16 v[182:183], v21 offset:2048
    ds_read_b64_tr_b16 v[184:185], v22 offset:0
    ds_read_b64_tr_b16 v[186:187], v22 offset:2048
    ds_read_b64_tr_b16 v[188:189], v23 offset:0
    ds_read_b64_tr_b16 v[190:191], v23 offset:2048
    ds_read_b64_tr_b16 v[192:193], v20 offset:4096
    ds_read_b64_tr_b16 v[194:195], v20 offset:6144
    ds_read_b64_tr_b16 v[196:197], v21 offset:4096
    ds_read_b64_tr_b16 v[198:199], v21 offset:6144
    s_waitcnt lgkmcnt(4)
    ds_read_b64_tr_b16 v[200:201], v22 offset:4096
    ds_read_b64_tr_b16 v[202:203], v22 offset:6144
    ds_read_b64_tr_b16 v[204:205], v23 offset:4096
    ds_read_b64_tr_b16 v[206:207], v23 offset:6144
    ds_read_b64_tr_b16 v[208:209], v20 offset:8192
    ds_read_b64_tr_b16 v[210:211], v20 offset:10240
    ds_read_b64_tr_b16 v[212:213], v21 offset:8192
    ds_read_b64_tr_b16 v[214:215], v21 offset:10240
    s_waitcnt lgkmcnt(4)
    s_waitcnt lgkmcnt(0)
    s_waitcnt vmcnt(21)
    s_barrier
    ds_read_b64_tr_b16 v[216:217], v20 offset:40960
    ds_read_b64_tr_b16 v[218:219], v20 offset:43008
    ds_read_b64_tr_b16 v[220:221], v21 offset:40960
    ds_read_b64_tr_b16 v[222:223], v21 offset:43008
    ds_read_b64_tr_b16 v[224:225], v22 offset:40960
    ds_read_b64_tr_b16 v[226:227], v22 offset:43008
    ds_read_b64_tr_b16 v[228:229], v23 offset:40960
    ds_read_b64_tr_b16 v[230:231], v23 offset:43008
    ds_read_b64_tr_b16 v[232:233], v20 offset:45056
    ds_read_b64_tr_b16 v[234:235], v20 offset:47104
    ds_read_b64_tr_b16 v[236:237], v21 offset:45056
    ds_read_b64_tr_b16 v[238:239], v21 offset:47104
    s_waitcnt lgkmcnt(4)
    ds_read_b64_tr_b16 v[240:241], v22 offset:45056
    ds_read_b64_tr_b16 v[242:243], v22 offset:47104
    ds_read_b64_tr_b16 v[244:245], v23 offset:45056
    ds_read_b64_tr_b16 v[246:247], v23 offset:47104
    ds_read_b64_tr_b16 v[248:249], v20 offset:49152
    ds_read_b64_tr_b16 v[250:251], v20 offset:51200
    ds_read_b64_tr_b16 v[252:253], v21 offset:49152
    ds_read_b64_tr_b16 v[254:255], v21 offset:51200
    s_waitcnt lgkmcnt(4)
    s_waitcnt lgkmcnt(0)
    s_waitcnt vmcnt(11)
    s_barrier
    v_add_u32 v10, 0x10000, v20
    ds_read_b64_tr_b16 v[60:61], v10 offset:16384
    ds_read_b64_tr_b16 v[62:63], v10 offset:18432
    v_add_u32 v11, 0x10000, v21
    ds_read_b64_tr_b16 v[64:65], v11 offset:16384
    ds_read_b64_tr_b16 v[66:67], v11 offset:18432
    v_add_u32 v10, 0x10000, v22
    ds_read_b64_tr_b16 v[68:69], v10 offset:16384
    ds_read_b64_tr_b16 v[70:71], v10 offset:18432
    v_add_u32 v11, 0x10000, v23
    ds_read_b64_tr_b16 v[72:73], v11 offset:16384
    ds_read_b64_tr_b16 v[74:75], v11 offset:18432
    v_add_u32 v10, 0x10000, v20
    ds_read_b64_tr_b16 v[76:77], v10 offset:20480
    ds_read_b64_tr_b16 v[78:79], v10 offset:22528
    v_add_u32 v11, 0x10000, v21
    ds_read_b64_tr_b16 v[80:81], v11 offset:20480
    ds_read_b64_tr_b16 v[82:83], v11 offset:22528
    s_waitcnt lgkmcnt(4)
    v_add_u32 v10, 0x10000, v22
    ds_read_b64_tr_b16 v[84:85], v10 offset:20480
    ds_read_b64_tr_b16 v[86:87], v10 offset:22528
    v_add_u32 v11, 0x10000, v23
    ds_read_b64_tr_b16 v[88:89], v11 offset:20480
    ds_read_b64_tr_b16 v[90:91], v11 offset:22528
    v_add_u32 v10, 0x10000, v20
    ds_read_b64_tr_b16 v[92:93], v10 offset:24576
    ds_read_b64_tr_b16 v[94:95], v10 offset:26624
    v_add_u32 v11, 0x10000, v21
    ds_read_b64_tr_b16 v[96:97], v11 offset:24576
    ds_read_b64_tr_b16 v[98:99], v11 offset:26624
    s_waitcnt lgkmcnt(4)
    s_waitcnt lgkmcnt(0)
    s_waitcnt vmcnt(1)
    s_barrier
    v_add_u32 v10, 0x18000, v20
    ds_read_b64_tr_b16 v[100:101], v10 offset:24576
    ds_read_b64_tr_b16 v[102:103], v10 offset:26624
    v_add_u32 v11, 0x18000, v21
    ds_read_b64_tr_b16 v[104:105], v11 offset:24576
    ds_read_b64_tr_b16 v[106:107], v11 offset:26624
    v_add_u32 v10, 0x18000, v22
    ds_read_b64_tr_b16 v[108:109], v10 offset:24576
    ds_read_b64_tr_b16 v[110:111], v10 offset:26624
    v_add_u32 v11, 0x18000, v23
    ds_read_b64_tr_b16 v[112:113], v11 offset:24576
    ds_read_b64_tr_b16 v[114:115], v11 offset:26624
    v_add_u32 v10, 0x18000, v20
    ds_read_b64_tr_b16 v[116:117], v10 offset:28672
    ds_read_b64_tr_b16 v[118:119], v10 offset:30720
    v_add_u32 v11, 0x18000, v21
    ds_read_b64_tr_b16 v[120:121], v11 offset:28672
    ds_read_b64_tr_b16 v[122:123], v11 offset:30720
    s_waitcnt lgkmcnt(4)
    v_add_u32 v10, 0x18000, v22
    ds_read_b64_tr_b16 v[124:125], v10 offset:28672
    ds_read_b64_tr_b16 v[126:127], v10 offset:30720
    v_add_u32 v11, 0x18000, v23
    ds_read_b64_tr_b16 v[128:129], v11 offset:28672
    ds_read_b64_tr_b16 v[130:131], v11 offset:30720
    v_add_u32 v10, 0x20000, v20
    ds_read_b64_tr_b16 v[132:133], v10 offset:0
    ds_read_b64_tr_b16 v[134:135], v10 offset:2048
    v_add_u32 v11, 0x20000, v21
    ds_read_b64_tr_b16 v[136:137], v11 offset:0
    ds_read_b64_tr_b16 v[138:139], v11 offset:2048
    s_waitcnt lgkmcnt(4)
    s_waitcnt lgkmcnt(0)
    s_barrier
    s_mov_b32 s52, 1048576
    s_branch prepw_ck_143
prepw_141:
    buffer_load_dword v3, v2, s[28:31], 0 offen offset:60 sc1
prepw_ck_143:
    s_waitcnt vmcnt(0)
    v_readfirstlane_b32 s32, v3
    s_nop 1
    s_and_b32 s33, s32, 255
    s_cmp_ge_u32 s33, 56
    s_cbranch_scc1 prepw_ok_142
    s_cmp_eq_u32 s52, 0
    s_cbranch_scc1 prepw_ok_142
    s_sub_u32 s52, s52, 1
    s_sleep 4
    s_branch prepw_141
prepw_ok_142:
    s_barrier
    v_mov_b32 v2, 0x40000000
    v_cmp_eq_u32 vcc, 0, v0
    s_nop 1
    v_cndmask_b32 v2, v2, v0, vcc
    v_mov_b32 v3, 1
    buffer_atomic_add v3, v2, s[28:31], 0 offen offset:248
    s_bfe_u32 s33, s32, 0x80008
    s_bfe_u32 s34, s32, 0x80018
    s_add_u32 s33, s33, s34
    s_bfe_u32 s34, s32, 0x80010
    s_sub_u32 s33, s33, s34
    s_cmp_ge_i32 s33, 28
    s_cselect_b32 s96, 0, 8192
    s_mov_b32 s98, s96
    s_xor_b32 s97, s96, 8192
    s_add_u32 s99, s96, 0xa20d000
    v_lshlrev_b32 v7, 4, v0
    s_mov_b32 s48, s7
    s_mul_i32 s55, s48, 40960
    s_add_u32 s55, s55, 0
    s_add_u32 m0, s54, 0
    s_nop 0
    buffer_load_dwordx4 v7, s[8:11], s55 offen sc1 lds
    s_add_u32 s55, s55, 4096
    s_add_u32 m0, s54, 4096
    s_nop 0
    buffer_load_dwordx4 v7, s[8:11], s55 offen sc1 lds
    s_add_u32 s55, s55, 4096
    s_add_u32 m0, s54, 8192
    s_nop 0
    buffer_load_dwordx4 v7, s[8:11], s55 offen sc1 lds
    s_add_u32 s55, s55, 4096
    s_add_u32 m0, s54, 12288
    s_nop 0
    buffer_load_dwordx4 v7, s[8:11], s55 offen sc1 lds
    s_add_u32 s55, s55, 4096
    s_add_u32 m0, s54, 16384
    s_nop 0
    buffer_load_dwordx4 v7, s[8:11], s55 offen sc1 lds
    ds_write_b128 v14, v[28:31] offset:0
    ds_write_b128 v14, v[32:35] offset:1024
    ds_write_b128 v14, v[36:39] offset:2048
    ds_write_b128 v14, v[40:43] offset:3072
    ds_write_b128 v14, v[44:47] offset:4096
    ds_write_b128 v14, v[48:51] offset:5120
    ds_write_b128 v14, v[52:55] offset:6144
    ds_write_b128 v14, v[56:59] offset:7168
    ds_write_b128 v14, v[60:63] offset:8192
    ds_write_b128 v14, v[64:67] offset:9216
    ds_write_b128 v14, v[68:71] offset:10240
    ds_write_b128 v14, v[72:75] offset:11264
    s_waitcnt lgkmcnt(4)
    ds_write_b128 v14, v[76:79] offset:12288
    ds_write_b128 v14, v[80:83] offset:13312
    ds_write_b128 v14, v[84:87] offset:14336
    ds_write_b128 v14, v[88:91] offset:15360
    ds_write_b128 v14, v[92:95] offset:16384
    ds_write_b128 v14, v[96:99] offset:17408
    ds_write_b128 v14, v[100:103] offset:18432
    ds_write_b128 v14, v[104:107] offset:19456
    s_waitcnt lgkmcnt(4)
    ds_write_b128 v14, v[108:111] offset:20480
    ds_write_b128 v14, v[112:115] offset:21504
    ds_write_b128 v14, v[116:119] offset:22528
    ds_write_b128 v14, v[120:123] offset:23552
    ds_write_b128 v14, v[124:127] offset:24576
    ds_write_b128 v14, v[128:131] offset:25600
    ds_write_b128 v14, v[132:135] offset:26624
    ds_write_b128 v14, v[136:139] offset:27648
    s_waitcnt lgkmcnt(4)
    s_waitcnt lgkmcnt(0)
    v_lshrrev_b32 v2, 4, v1
    v_and_b32 v3, 15, v1
    v_lshlrev_b32 v6, 9, v2
    v_lshl_add_u32 v6, v3, 4, v6
    v_mov_b32 v4, 0x40000000
    v_cmp_eq_u32 vcc, 0, v0
    s_nop 1
    v_cndmask_b32 v8, v4, v0, vcc
    v_mov_b32 v13, 64
    v_lshlrev_b32 v9, 4, v1
    s_mul_i32 s32, s4, 450560
    v_add_u32 v24, s32, v9
    v_lshrrev_b32 v4, 1, v2
    v_lshlrev_b32 v4, 8, v4
    v_lshl_add_u32 v4, v3, 4, v4
    v_and_b32 v5, 1, v2
    v_lshl_add_u32 v4, v5, 3, v4
    s_mul_i32 s32, s4, 1024
    v_add_u32 v12, s32, v4
    s_mov_b32 s49, 0x40000000
    s_mov_b32 s58, 0xc0135761
    s_mov_b32 s59, 0xbdd2d3e8
    v_mov_b32 v15, -1
    v_mov_b32 v26, 0
    s_mov_b32 s52, 1048576
    s_waitcnt vmcnt(0)
FFN_loop:
    s_waitcnt vmcnt(10) lgkmcnt(0)
    s_barrier
    ds_read_b128 v[60:63], v6 offset:0
    ds_read_b128 v[64:67], v6 offset:256
    s_waitcnt lgkmcnt(1)
    v_mfma_f32_16x16x32_bf16 v[28:31], a[0:3], v[60:63], 0
    ds_read_b128 v[68:71], v6 offset:2048
    s_waitcnt lgkmcnt(1)
    v_mfma_f32_16x16x32_bf16 v[32:35], a[0:3], v[64:67], 0
    ds_read_b128 v[72:75], v6 offset:2304
    v_mfma_f32_16x16x32_bf16 v[36:39], a[4:7], v[60:63], 0
    s_mul_i32 s55, s48, 40960
    s_add_u32 s55, s55, 20480
    s_add_u32 m0, s54, 20480
    s_nop 0
    buffer_load_dwordx4 v7, s[8:11], s55 offen sc1 lds
    v_mfma_f32_16x16x32_bf16 v[40:43], a[4:7], v[64:67], 0
    v_mfma_f32_16x16x32_bf16 v[44:47], a[8:11], v[60:63], 0
    v_mfma_f32_16x16x32_bf16 v[48:51], a[8:11], v[64:67], 0
    s_add_u32 s55, s55, 4096
    s_add_u32 m0, s54, 24576
    s_nop 0
    buffer_load_dwordx4 v7, s[8:11], s55 offen sc1 lds
    v_mfma_f32_16x16x32_bf16 v[52:55], a[12:15], v[60:63], 0
    v_mfma_f32_16x16x32_bf16 v[56:59], a[12:15], v[64:67], 0
    s_waitcnt lgkmcnt(1)
    v_mfma_f32_16x16x32_bf16 v[28:31], a[16:19], v[68:71], v[28:31]
    ds_read_b128 v[60:63], v6 offset:4096
    s_waitcnt lgkmcnt(1)
    v_mfma_f32_16x16x32_bf16 v[32:35], a[16:19], v[72:75], v[32:35]
    ds_read_b128 v[64:67], v6 offset:4352
    v_mfma_f32_16x16x32_bf16 v[36:39], a[20:23], v[68:71], v[36:39]
    s_add_u32 s55, s55, 4096
    s_add_u32 m0, s54, 28672
    s_nop 0
    buffer_load_dwordx4 v7, s[8:11], s55 offen sc1 lds
    v_mfma_f32_16x16x32_bf16 v[40:43], a[20:23], v[72:75], v[40:43]
    v_mfma_f32_16x16x32_bf16 v[44:47], a[24:27], v[68:71], v[44:47]
    v_mfma_f32_16x16x32_bf16 v[48:51], a[24:27], v[72:75], v[48:51]
    s_add_u32 s55, s55, 4096
    s_add_u32 m0, s54, 32768
    s_nop 0
    buffer_load_dwordx4 v7, s[8:11], s55 offen sc1 lds
    v_mfma_f32_16x16x32_bf16 v[52:55], a[28:31], v[68:71], v[52:55]
    v_mfma_f32_16x16x32_bf16 v[56:59], a[28:31], v[72:75], v[56:59]
    s_waitcnt lgkmcnt(1)
    v_mfma_f32_16x16x32_bf16 v[28:31], a[32:35], v[60:63], v[28:31]
    ds_read_b128 v[68:71], v6 offset:6144
    s_waitcnt lgkmcnt(1)
    v_mfma_f32_16x16x32_bf16 v[32:35], a[32:35], v[64:67], v[32:35]
    ds_read_b128 v[72:75], v6 offset:6400
    v_mfma_f32_16x16x32_bf16 v[36:39], a[36:39], v[60:63], v[36:39]
    s_add_u32 s55, s55, 4096
    s_add_u32 m0, s54, 36864
    s_nop 0
    buffer_load_dwordx4 v7, s[8:11], s55 offen sc1 lds
    v_mfma_f32_16x16x32_bf16 v[40:43], a[36:39], v[64:67], v[40:43]
    v_mfma_f32_16x16x32_bf16 v[44:47], a[40:43], v[60:63], v[44:47]
    v_mfma_f32_16x16x32_bf16 v[48:51], a[40:43], v[64:67], v[48:51]
    v_mfma_f32_16x16x32_bf16 v[52:55], a[44:47], v[60:63], v[52:55]
    v_mfma_f32_16x16x32_bf16 v[56:59], a[44:47], v[64:67], v[56:59]
    s_waitcnt lgkmcnt(1)
    v_mfma_f32_16x16x32_bf16 v[28:31], a[48:51], v[68:71], v[28:31]
    ds_read_b128 v[60:63], v6 offset:8192
    s_waitcnt lgkmcnt(1)
    v_mfma_f32_16x16x32_bf16 v[32:35], a[48:51], v[72:75], v[32:35]
    ds_read_b128 v[64:67], v6 offset:8448
    v_mfma_f32_16x16x32_bf16 v[36:39], a[52:55], v[68:71], v[36:39]
    v_mfma_f32_16x16x32_bf16 v[40:43], a[52:55], v[72:75], v[40:43]
    v_mfma_f32_16x16x32_bf16 v[44:47], a[56:59], v[68:71], v[44:47]
    v_mfma_f32_16x16x32_bf16 v[48:51], a[56:59], v[72:75], v[48:51]
    v_mfma_f32_16x16x32_bf16 v[52:55], a[60:63], v[68:71], v[52:55]
    v_mfma_f32_16x16x32_bf16 v[56:59], a[60:63], v[72:75], v[56:59]
    s_waitcnt lgkmcnt(1)
    v_mfma_f32_16x16x32_bf16 v[28:31], a[64:67], v[60:63], v[28:31]
    ds_read_b128 v[68:71], v6 offset:10240
    s_waitcnt lgkmcnt(1)
    v_mfma_f32_16x16x32_bf16 v[32:35], a[64:67], v[64:67], v[32:35]
    ds_read_b128 v[72:75], v6 offset:10496
    v_mfma_f32_16x16x32_bf16 v[36:39], a[68:71], v[60:63], v[36:39]
    v_mfma_f32_16x16x32_bf16 v[40:43], a[68:71], v[64:67], v[40:43]
    v_mfma_f32_16x16x32_bf16 v[44:47], a[72:75], v[60:63], v[44:47]
    v_mfma_f32_16x16x32_bf16 v[48:51], a[72:75], v[64:67], v[48:51]
    v_mfma_f32_16x16x32_bf16 v[52:55], a[76:79], v[60:63], v[52:55]
    v_mfma_f32_16x16x32_bf16 v[56:59], a[76:79], v[64:67], v[56:59]
    s_waitcnt lgkmcnt(1)
    v_mfma_f32_16x16x32_bf16 v[28:31], a[80:83], v[68:71], v[28:31]
    ds_read_b128 v[60:63], v6 offset:12288
    s_waitcnt lgkmcnt(1)
    v_mfma_f32_16x16x32_bf16 v[32:35], a[80:83], v[72:75], v[32:35]
    ds_read_b128 v[64:67], v6 offset:12544
    v_mfma_f32_16x16x32_bf16 v[36:39], a[84:87], v[68:71], v[36:39]
    v_mfma_f32_16x16x32_bf16 v[40:43], a[84:87], v[72:75], v[40:43]
    v_mfma_f32_16x16x32_bf16 v[44:47], a[88:91], v[68:71], v[44:47]
    v_mfma_f32_16x16x32_bf16 v[48:51], a[88:91], v[72:75], v[48:51]
    v_mfma_f32_16x16x32_bf16 v[52:55], a[92:95], v[68:71], v[52:55]
    v_mfma_f32_16x16x32_bf16 v[56:59], a[92:95], v[72:75], v[56:59]
    s_waitcnt lgkmcnt(1)
    v_mfma_f32_16x16x32_bf16 v[28:31], a[96:99], v[60:63], v[28:31]
    ds_read_b128 v[68:71], v6 offset:14336
    s_waitcnt lgkmcnt(1)
    v_mfma_f32_16x16x32_bf16 v[32:35], a[96:99], v[64:67], v[32:35]
    ds_read_b128 v[72:75], v6 offset:14592
    v_mfma_f32_16x16x32_bf16 v[36:39], a[100:103], v[60:63], v[36:39]
    v_mfma_f32_16x16x32_bf16 v[40:43], a[100:103], v[64:67], v[40:43]
    v_mfma_f32_16x16x32_bf16 v[44:47], a[104:107], v[60:63], v[44:47]
    v_mfma_f32_16x16x32_bf16 v[48:51], a[104:107], v[64:67], v[48:51]
    v_mfma_f32_16x16x32_bf16 v[52:55], a[108:111], v[60:63], v[52:55]
    v_mfma_f32_16x16x32_bf16 v[56:59], a[108:111], v[64:67], v[56:59]
    s_waitcnt lgkmcnt(1)
    v_mfma_f32_16x16x32_bf16 v[28:31], a[112:115], v[68:71], v[28:31]
    ds_read_b128 v[60:63], v6 offset:16384
    s_waitcnt lgkmcnt(1)
    v_mfma_f32_16x16x32_bf16 v[32:35], a[112:115], v[72:75], v[32:35]
    ds_read_b128 v[64:67], v6 offset:16640
    v_mfma_f32_16x16x32_bf16 v[36:39], a[116:119], v[68:71], v[36:39]
    ds_read_b128 v[76:79], v14 offset:0
    v_mfma_f32_16x16x32_bf16 v[40:43], a[116:119], v[72:75], v[40:43]
    ds_read_b128 v[80:83], v14 offset:1024
    v_mfma_f32_16x16x32_bf16 v[44:47], a[120:123], v[68:71], v[44:47]
    ds_read_b128 v[84:87], v14 offset:2048
    v_mfma_f32_16x16x32_bf16 v[48:51], a[120:123], v[72:75], v[48:51]
    ds_read_b128 v[88:91], v14 offset:3072
    v_mfma_f32_16x16x32_bf16 v[52:55], a[124:127], v[68:71], v[52:55]
    v_mfma_f32_16x16x32_bf16 v[56:59], a[124:127], v[72:75], v[56:59]
    s_waitcnt lgkmcnt(5)
    v_mfma_f32_16x16x32_bf16 v[28:31], a[128:131], v[60:63], v[28:31]
    ds_read_b128 v[68:71], v6 offset:18432
    s_waitcnt lgkmcnt(5)
    v_mfma_f32_16x16x32_bf16 v[32:35], a[128:131], v[64:67], v[32:35]
    ds_read_b128 v[72:75], v6 offset:18688
    v_mfma_f32_16x16x32_bf16 v[36:39], a[132:135], v[60:63], v[36:39]
    v_mfma_f32_16x16x32_bf16 v[40:43], a[132:135], v[64:67], v[40:43]
    v_mfma_f32_16x16x32_bf16 v[44:47], a[136:139], v[60:63], v[44:47]
    v_mfma_f32_16x16x32_bf16 v[48:51], a[136:139], v[64:67], v[48:51]
    v_mfma_f32_16x16x32_bf16 v[52:55], a[140:143], v[60:63], v[52:55]
    v_mfma_f32_16x16x32_bf16 v[56:59], a[140:143], v[64:67], v[56:59]
    s_waitcnt lgkmcnt(5)
    s_waitcnt lgkmcnt(1)
    v_mfma_f32_16x16x32_bf16 v[28:31], v[76:79], v[68:71], v[28:31]
    s_waitcnt lgkmcnt(0)
    v_mfma_f32_16x16x32_bf16 v[32:35], v[76:79], v[72:75], v[32:35]
    v_mfma_f32_16x16x32_bf16 v[36:39], v[80:83], v[68:71], v[36:39]
    v_mfma_f32_16x16x32_bf16 v[40:43], v[80:83], v[72:75], v[40:43]
    v_mfma_f32_16x16x32_bf16 v[44:47], v[84:87], v[68:71], v[44:47]
    v_mfma_f32_16x16x32_bf16 v[48:51], v[84:87], v[72:75], v[48:51]
    v_mfma_f32_16x16x32_bf16 v[52:55], v[88:91], v[68:71], v[52:55]
    v_mfma_f32_16x16x32_bf16 v[56:59], v[88:91], v[72:75], v[56:59]
    s_waitcnt vmcnt(0) lgkmcnt(0)
    s_barrier
    ds_read_b128 v[60:63], v6 offset:20480
    ds_read_b128 v[64:67], v6 offset:20736
    buffer_store_dword v13, v8, s[8:11], s49 offen sc1
    s_add_u32 s34, s48, 2
    s_min_u32 s34, s34, 63
    s_waitcnt lgkmcnt(1)
    v_mfma_f32_16x16x32_bf16 v[28:31], a[144:147], v[60:63], v[28:31]
    ds_read_b128 v[68:71], v6 offset:22528
    s_waitcnt lgkmcnt(1)
    v_mfma_f32_16x16x32_bf16 v[32:35], a[144:147], v[64:67], v[32:35]
    ds_read_b128 v[72:75], v6 offset:22784
    v_mfma_f32_16x16x32_bf16 v[36:39], a[148:151], v[60:63], v[36:39]
    s_mul_i32 s55, s34, 40960
    s_add_u32 s55, s55, 0
    s_add_u32 m0, s54, 0
    s_nop 0
    buffer_load_dwordx4 v7, s[8:11], s55 offen sc1 lds
    v_mfma_f32_16x16x32_bf16 v[40:43], a[148:151], v[64:67], v[40:43]
    v_mfma_f32_16x16x32_bf16 v[44:47], a[152:155], v[60:63], v[44:47]
    v_mfma_f32_16x16x32_bf16 v[48:51], a[152:155], v[64:67], v[48:51]
    s_add_u32 s55, s55, 4096
    s_add_u32 m0, s54, 4096
    s_nop 0
    buffer_load_dwordx4 v7, s[8:11], s55 offen sc1 lds
    v_mfma_f32_16x16x32_bf16 v[52:55], a[156:159], v[60:63], v[52:55]
    v_mfma_f32_16x16x32_bf16 v[56:59], a[156:159], v[64:67], v[56:59]
    s_waitcnt lgkmcnt(1)
    v_mfma_f32_16x16x32_bf16 v[28:31], a[160:163], v[68:71], v[28:31]
    ds_read_b128 v[60:63], v6 offset:24576
    s_waitcnt lgkmcnt(1)
    v_mfma_f32_16x16x32_bf16 v[32:35], a[160:163], v[72:75], v[32:35]
    ds_read_b128 v[64:67], v6 offset:24832
    v_mfma_f32_16x16x32_bf16 v[36:39], a[164:167], v[68:71], v[36:39]
    s_add_u32 s55, s55, 4096
    s_add_u32 m0, s54, 8192
    s_nop 0
    buffer_load_dwordx4 v7, s[8:11], s55 offen sc1 lds
    v_mfma_f32_16x16x32_bf16 v[40:43], a[164:167], v[72:75], v[40:43]
    v_mfma_f32_16x16x32_bf16 v[44:47], a[168:171], v[68:71], v[44:47]
    v_mfma_f32_16x16x32_bf16 v[48:51], a[168:171], v[72:75], v[48:51]
    s_add_u32 s55, s55, 4096
    s_add_u32 m0, s54, 12288
    s_nop 0
    buffer_load_dwordx4 v7, s[8:11], s55 offen sc1 lds
    v_mfma_f32_16x16x32_bf16 v[52:55], a[172:175], v[68:71], v[52:55]
    v_mfma_f32_16x16x32_bf16 v[56:59], a[172:175], v[72:75], v[56:59]
    s_waitcnt lgkmcnt(1)
    v_mfma_f32_16x16x32_bf16 v[28:31], a[176:179], v[60:63], v[28:31]
    ds_read_b128 v[68:71], v6 offset:26624
    s_waitcnt lgkmcnt(1)
    v_mfma_f32_16x16x32_bf16 v[32:35], a[176:179], v[64:67], v[32:35]
    ds_read_b128 v[72:75], v6 offset:26880
    v_mfma_f32_16x16x32_bf16 v[36:39], a[180:183], v[60:63], v[36:39]
    s_add_u32 s55, s55, 4096
    s_add_u32 m0, s54, 16384
    s_nop 0
    buffer_load_dwordx4 v7, s[8:11], s55 offen sc1 lds
    v_mfma_f32_16x16x32_bf16 v[40:43], a[180:183], v[64:67], v[40:43]
    v_mfma_f32_16x16x32_bf16 v[44:47], a[184:187], v[60:63], v[44:47]
    v_mfma_f32_16x16x32_bf16 v[48:51], a[184:187], v[64:67], v[48:51]
    v_mfma_f32_16x16x32_bf16 v[52:55], a[188:191], v[60:63], v[52:55]
    v_mfma_f32_16x16x32_bf16 v[56:59], a[188:191], v[64:67], v[56:59]
    s_waitcnt lgkmcnt(1)
    v_mfma_f32_16x16x32_bf16 v[28:31], a[192:195], v[68:71], v[28:31]
    ds_read_b128 v[60:63], v6 offset:28672
    s_waitcnt lgkmcnt(1)
    v_mfma_f32_16x16x32_bf16 v[32:35], a[192:195], v[72:75], v[32:35]
    ds_read_b128 v[64:67], v6 offset:28928
    v_mfma_f32_16x16x32_bf16 v[36:39], a[196:199], v[68:71], v[36:39]
    v_mfma_f32_16x16x32_bf16 v[40:43], a[196:199], v[72:75], v[40:43]
    v_mfma_f32_16x16x32_bf16 v[44:47], a[200:203], v[68:71], v[44:47]
    v_mfma_f32_16x16x32_bf16 v[48:51], a[200:203], v[72:75], v[48:51]
    v_mfma_f32_16x16x32_bf16 v[52:55], a[204:207], v[68:71], v[52:55]
    v_mfma_f32_16x16x32_bf16 v[56:59], a[204:207], v[72:75], v[56:59]
    s_waitcnt lgkmcnt(1)
    v_mfma_f32_16x16x32_bf16 v[28:31], a[208:211], v[60:63], v[28:31]
    ds_read_b128 v[68:71], v6 offset:30720
    s_waitcnt lgkmcnt(1)
    v_mfma_f32_16x16x32_bf16 v[32:35], a[208:211], v[64:67], v[32:35]
    ds_read_b128 v[72:75], v6 offset:30976
    v_mfma_f32_16x16x32_bf16 v[36:39], a[212:215], v[60:63], v[36:39]
    v_mfma_f32_16x16x32_bf16 v[40:43], a[212:215], v[64:67], v[40:43]
    v_mfma_f32_16x16x32_bf16 v[44:47], a[216:219], v[60:63], v[44:47]
    v_mfma_f32_16x16x32_bf16 v[48:51], a[216:219], v[64:67], v[48:51]
    v_mfma_f32_16x16x32_bf16 v[52:55], a[220:223], v[60:63], v[52:55]
    v_mfma_f32_16x16x32_bf16 v[56:59], a[220:223], v[64:67], v[56:59]
    s_waitcnt lgkmcnt(1)
    v_mfma_f32_16x16x32_bf16 v[28:31], a[224:227], v[68:71], v[28:31]
    ds_read_b128 v[60:63], v6 offset:32768
    s_waitcnt lgkmcnt(1)
    v_mfma_f32_16x16x32_bf16 v[32:35], a[224:227], v[72:75], v[32:35]
    ds_read_b128 v[64:67], v6 offset:33024
    v_mfma_f32_16x16x32_bf16 v[36:39], a[228:231], v[68:71], v[36:39]
    v_mfma_f32_16x16x32_bf16 v[40:43], a[228:231], v[72:75], v[40:43]
    v_mfma_f32_16x16x32_bf16 v[44:47], a[232:235], v[68:71], v[44:47]
    v_mfma_f32_16x16x32_bf16 v[48:51], a[232:235], v[72:75], v[48:51]
    v_mfma_f32_16x16x32_bf16 v[52:55], a[236:239], v[68:71], v[52:55]
    v_mfma_f32_16x16x32_bf16 v[56:59], a[236:239], v[72:75], v[56:59]
    s_waitcnt lgkmcnt(1)
    v_mfma_f32_16x16x32_bf16 v[28:31], a[240:243], v[60:63], v[28:31]
    ds_read_b128 v[68:71], v6 offset:34816
    s_waitcnt lgkmcnt(1)
    v_mfma_f32_16x16x32_bf16 v[32:35], a[240:243], v[64:67], v[32:35]
    ds_read_b128 v[72:75], v6 offset:35072
    v_mfma_f32_16x16x32_bf16 v[36:39], a[244:247], v[60:63], v[36:39]
    v_mfma_f32_16x16x32_bf16 v[40:43], a[244:247], v[64:67], v[40:43]
    v_mfma_f32_16x16x32_bf16 v[44:47], a[248:251], v[60:63], v[44:47]
    v_mfma_f32_16x16x32_bf16 v[48:51], a[248:251], v[64:67], v[48:51]
    v_mfma_f32_16x16x32_bf16 v[52:55], a[252:255], v[60:63], v[52:55]
    v_mfma_f32_16x16x32_bf16 v[56:59], a[252:255], v[64:67], v[56:59]
    s_waitcnt lgkmcnt(1)
    v_mfma_f32_16x16x32_bf16 v[28:31], v[144:147], v[68:71], v[28:31]
    ds_read_b128 v[60:63], v6 offset:36864
    s_waitcnt lgkmcnt(1)
    v_mfma_f32_16x16x32_bf16 v[32:35], v[144:147], v[72:75], v[32:35]
    ds_read_b128 v[64:67], v6 offset:37120
    v_mfma_f32_16x16x32_bf16 v[36:39], v[148:151], v[68:71], v[36:39]
    ds_read_b128 v[76:79], v14 offset:4096
    v_mfma_f32_16x16x32_bf16 v[40:43], v[148:151], v[72:75], v[40:43]
    ds_read_b128 v[80:83], v14 offset:5120
    v_mfma_f32_16x16x32_bf16 v[44:47], v[152:155], v[68:71], v[44:47]
    ds_read_b128 v[84:87], v14 offset:6144
    v_mfma_f32_16x16x32_bf16 v[48:51], v[152:155], v[72:75], v[48:51]
    ds_read_b128 v[88:91], v14 offset:7168
    v_mfma_f32_16x16x32_bf16 v[52:55], v[156:159], v[68:71], v[52:55]
    v_mfma_f32_16x16x32_bf16 v[56:59], v[156:159], v[72:75], v[56:59]
    s_waitcnt lgkmcnt(5)
    v_mfma_f32_16x16x32_bf16 v[28:31], v[160:163], v[60:63], v[28:31]
    ds_read_b128 v[68:71], v6 offset:38912
    s_waitcnt lgkmcnt(5)
    v_mfma_f32_16x16x32_bf16 v[32:35], v[160:163], v[64:67], v[32:35]
    ds_read_b128 v[72:75], v6 offset:39168
    v_mfma_f32_16x16x32_bf16 v[36:39], v[164:167], v[60:63], v[36:39]
    v_mfma_f32_16x16x32_bf16 v[40:43], v[164:167], v[64:67], v[40:43]
    v_mfma_f32_16x16x32_bf16 v[44:47], v[168:171], v[60:63], v[44:47]
    v_mfma_f32_16x16x32_bf16 v[48:51], v[168:171], v[64:67], v[48:51]
    v_mfma_f32_16x16x32_bf16 v[52:55], v[172:175], v[60:63], v[52:55]
    v_mfma_f32_16x16x32_bf16 v[56:59], v[172:175], v[64:67], v[56:59]
    s_waitcnt lgkmcnt(5)
    s_waitcnt lgkmcnt(1)
    v_mfma_f32_16x16x32_bf16 v[28:31], v[76:79], v[68:71], v[28:31]
    s_waitcnt lgkmcnt(0)
    v_mfma_f32_16x16x32_bf16 v[32:35], v[76:79], v[72:75], v[32:35]
    v_mfma_f32_16x16x32_bf16 v[36:39], v[80:83], v[68:71], v[36:39]
    v_mfma_f32_16x16x32_bf16 v[40:43], v[80:83], v[72:75], v[40:43]
    v_mfma_f32_16x16x32_bf16 v[44:47], v[84:87], v[68:71], v[44:47]
    v_mfma_f32_16x16x32_bf16 v[48:51], v[84:87], v[72:75], v[48:51]
    v_mfma_f32_16x16x32_bf16 v[52:55], v[88:91], v[68:71], v[52:55]
    v_mfma_f32_16x16x32_bf16 v[56:59], v[88:91], v[72:75], v[56:59]
    ds_read_b128 v[60:63], v14 offset:8192
    ds_read_b128 v[64:67], v14 offset:18432
    v_pk_mul_f32 v[16:17], v[28:29], v[28:29]
    v_pk_mul_f32 v[18:19], v[30:31], v[30:31]
    v_pk_mul_f32 v[20:21], v[32:33], v[32:33]
    v_pk_mul_f32 v[22:23], v[34:35], v[34:35]
    v_mul_f32 v16, s59, v16
    v_mul_f32 v17, s59, v17
    v_mul_f32 v18, s59, v18
    v_mul_f32 v19, s59, v19
    v_mul_f32 v20, s59, v20
    v_mul_f32 v21, s59, v21
    v_mul_f32 v22, s59, v22
    v_mul_f32 v23, s59, v23
    v_add_f32 v16, s58, v16
    v_add_f32 v17, s58, v17
    v_add_f32 v18, s58, v18
    v_add_f32 v19, s58, v19
    v_add_f32 v20, s58, v20
    v_add_f32 v21, s58, v21
    v_add_f32 v22, s58, v22
    v_add_f32 v23, s58, v23
    v_pk_mul_f32 v[16:17], v[16:17], v[28:29]
    v_pk_mul_f32 v[18:19], v[18:19], v[30:31]
    v_pk_mul_f32 v[20:21], v[20:21], v[32:33]
    v_pk_mul_f32 v[22:23], v[22:23], v[34:35]
    v_exp_f32 v16, v16
    v_exp_f32 v17, v17
    v_exp_f32 v18, v18
    v_exp_f32 v19, v19
    v_exp_f32 v20, v20
    v_exp_f32 v21, v21
    v_exp_f32 v22, v22
    v_exp_f32 v23, v23
    v_pk_mul_f32 v[28:29], v[28:29], v[44:45]
    v_pk_mul_f32 v[30:31], v[30:31], v[46:47]
    v_pk_mul_f32 v[32:33], v[32:33], v[48:49]
    v_pk_mul_f32 v[34:35], v[34:35], v[50:51]
    v_pk_add_f32 v[16:17], v[16:17], 1.0 op_sel_hi:[1,0]
    v_pk_add_f32 v[18:19], v[18:19], 1.0 op_sel_hi:[1,0]
    v_pk_add_f32 v[20:21], v[20:21], 1.0 op_sel_hi:[1,0]
    v_pk_add_f32 v[22:23], v[22:23], 1.0 op_sel_hi:[1,0]
    v_rcp_f32 v16, v16
    v_rcp_f32 v17, v17
    v_rcp_f32 v18, v18
    v_rcp_f32 v19, v19
    v_rcp_f32 v20, v20
    v_rcp_f32 v21, v21
    v_rcp_f32 v22, v22
    v_rcp_f32 v23, v23
    v_pk_mul_f32 v[28:29], v[28:29], v[16:17]
    v_pk_mul_f32 v[30:31], v[30:31], v[18:19]
    v_pk_mul_f32 v[32:33], v[32:33], v[20:21]
    v_pk_mul_f32 v[34:35], v[34:35], v[22:23]
    v_cvt_pk_bf16_f32 v92, v28, v29
    v_cvt_pk_bf16_f32 v93, v30, v31
    ds_write_b64 v12, v[92:93] offset:40960
    v_cvt_pk_bf16_f32 v94, v32, v33
    v_cvt_pk_bf16_f32 v95, v34, v35
    ds_write_b64 v12, v[94:95] offset:45056
    v_pk_mul_f32 v[16:17], v[36:37], v[36:37]
    v_pk_mul_f32 v[18:19], v[38:39], v[38:39]
    v_pk_mul_f32 v[20:21], v[40:41], v[40:41]
    v_pk_mul_f32 v[22:23], v[42:43], v[42:43]
    v_mul_f32 v16, s59, v16
    v_mul_f32 v17, s59, v17
    v_mul_f32 v18, s59, v18
    v_mul_f32 v19, s59, v19
    v_mul_f32 v20, s59, v20
    v_mul_f32 v21, s59, v21
    v_mul_f32 v22, s59, v22
    v_mul_f32 v23, s59, v23
    v_add_f32 v16, s58, v16
    v_add_f32 v17, s58, v17
    v_add_f32 v18, s58, v18
    v_add_f32 v19, s58, v19
    v_add_f32 v20, s58, v20
    v_add_f32 v21, s58, v21
    v_add_f32 v22, s58, v22
    v_add_f32 v23, s58, v23
    v_pk_mul_f32 v[16:17], v[16:17], v[36:37]
    v_pk_mul_f32 v[18:19], v[18:19], v[38:39]
    v_pk_mul_f32 v[20:21], v[20:21], v[40:41]
    v_pk_mul_f32 v[22:23], v[22:23], v[42:43]
    v_exp_f32 v16, v16
    v_exp_f32 v17, v17
    v_exp_f32 v18, v18
    v_exp_f32 v19, v19
    v_exp_f32 v20, v20
    v_exp_f32 v21, v21
    v_exp_f32 v22, v22
    v_exp_f32 v23, v23
    v_pk_mul_f32 v[36:37], v[36:37], v[52:53]
    v_pk_mul_f32 v[38:39], v[38:39], v[54:55]
    v_pk_mul_f32 v[40:41], v[40:41], v[56:57]
    v_pk_mul_f32 v[42:43], v[42:43], v[58:59]
    v_pk_add_f32 v[16:17], v[16:17], 1.0 op_sel_hi:[1,0]
    v_pk_add_f32 v[18:19], v[18:19], 1.0 op_sel_hi:[1,0]
    v_pk_add_f32 v[20:21], v[20:21], 1.0 op_sel_hi:[1,0]
    v_pk_add_f32 v[22:23], v[22:23], 1.0 op_sel_hi:[1,0]
    v_rcp_f32 v16, v16
    v_rcp_f32 v17, v17
    v_rcp_f32 v18, v18
    v_rcp_f32 v19, v19
    v_rcp_f32 v20, v20
    v_rcp_f32 v21, v21
    v_rcp_f32 v22, v22
    v_rcp_f32 v23, v23
    v_pk_mul_f32 v[36:37], v[36:37], v[16:17]
    v_pk_mul_f32 v[38:39], v[38:39], v[18:19]
    v_pk_mul_f32 v[40:41], v[40:41], v[20:21]
    v_pk_mul_f32 v[42:43], v[42:43], v[22:23]
    v_cvt_pk_bf16_f32 v96, v36, v37
    v_cvt_pk_bf16_f32 v97, v38, v39
    ds_write_b64 v12, v[96:97] offset:41472
    v_cvt_pk_bf16_f32 v98, v40, v41
    v_cvt_pk_bf16_f32 v99, v42, v43
    ds_write_b64 v12, v[98:99] offset:45568
    s_mul_i32 s32, s48, 1802240
    s_lshl_b32 s33, s6, 10
    s_add_u32 s32, s32, s33
    s_add_u32 s32, s32, 0x3408000
    s_waitcnt lgkmcnt(0)
    s_barrier
    ds_read_b128 v[100:103], v9 offset:40960
    ds_read_b128 v[104:107], v9 offset:45056
    ds_read_b128 v[108:111], v9 offset:41984
    ds_read_b128 v[112:115], v9 offset:46080
    ds_read_b128 v[116:119], v9 offset:43008
    ds_read_b128 v[120:123], v9 offset:47104
    s_waitcnt lgkmcnt(5)
    v_mfma_f32_16x16x32_bf16 v[28:31], v[100:103], v[176:179], 0
    ds_read_b128 v[124:127], v9 offset:44032
    s_waitcnt lgkmcnt(5)
    v_mfma_f32_16x16x32_bf16 v[32:35], v[104:107], v[176:179], 0
    ds_read_b128 v[128:131], v9 offset:48128
    s_waitcnt lgkmcnt(5)
    v_mfma_f32_16x16x32_bf16 v[28:31], v[108:111], v[216:219], v[28:31]
    ds_read_b128 v[68:71], v14 offset:9216
    s_waitcnt lgkmcnt(5)
    v_mfma_f32_16x16x32_bf16 v[32:35], v[112:115], v[216:219], v[32:35]
    ds_read_b128 v[72:75], v14 offset:19456
    s_waitcnt lgkmcnt(5)
    v_mfma_f32_16x16x32_bf16 v[28:31], v[116:119], v[60:63], v[28:31]
    s_waitcnt lgkmcnt(4)
    v_mfma_f32_16x16x32_bf16 v[32:35], v[120:123], v[60:63], v[32:35]
    s_waitcnt lgkmcnt(3)
    v_mfma_f32_16x16x32_bf16 v[28:31], v[124:127], v[64:67], v[28:31]
    s_waitcnt lgkmcnt(2)
    v_mfma_f32_16x16x32_bf16 v[32:35], v[128:131], v[64:67], v[32:35]
    v_mfma_f32_16x16x32_bf16 v[36:39], v[100:103], v[180:183], 0
    v_mfma_f32_16x16x32_bf16 v[40:43], v[104:107], v[180:183], 0
    v_mfma_f32_16x16x32_bf16 v[36:39], v[108:111], v[220:223], v[36:39]
    ds_read_b128 v[60:63], v14 offset:10240
    v_mfma_f32_16x16x32_bf16 v[40:43], v[112:115], v[220:223], v[40:43]
    ds_read_b128 v[64:67], v14 offset:20480
    v_cvt_pk_bf16_f32 v92, v28, v29
    s_waitcnt lgkmcnt(3)
    v_mfma_f32_16x16x32_bf16 v[36:39], v[116:119], v[68:71], v[36:39]
    v_cvt_pk_bf16_f32 v93, v30, v31
    v_mfma_f32_16x16x32_bf16 v[40:43], v[120:123], v[68:71], v[40:43]
    v_cvt_pk_bf16_f32 v94, v32, v33
    s_waitcnt lgkmcnt(2)
    v_mfma_f32_16x16x32_bf16 v[36:39], v[124:127], v[72:75], v[36:39]
    v_cvt_pk_bf16_f32 v95, v34, v35
    v_mfma_f32_16x16x32_bf16 v[40:43], v[128:131], v[72:75], v[40:43]
    buffer_store_dwordx4 v[92:95], v24, s[8:11], s32 offen sc1
    s_add_u32 s32, s32, 45056
    v_mfma_f32_16x16x32_bf16 v[28:31], v[100:103], v[184:187], 0
    v_mfma_f32_16x16x32_bf16 v[32:35], v[104:107], v[184:187], 0
    v_mfma_f32_16x16x32_bf16 v[28:31], v[108:111], v[224:227], v[28:31]
    ds_read_b128 v[68:71], v14 offset:11264
    v_mfma_f32_16x16x32_bf16 v[32:35], v[112:115], v[224:227], v[32:35]
    ds_read_b128 v[72:75], v14 offset:21504
    v_cvt_pk_bf16_f32 v96, v36, v37
    s_waitcnt lgkmcnt(3)
    v_mfma_f32_16x16x32_bf16 v[28:31], v[116:119], v[60:63], v[28:31]
    v_cvt_pk_bf16_f32 v97, v38, v39
    v_mfma_f32_16x16x32_bf16 v[32:35], v[120:123], v[60:63], v[32:35]
    v_cvt_pk_bf16_f32 v98, v40, v41
    s_waitcnt lgkmcnt(2)
    v_mfma_f32_16x16x32_bf16 v[28:31], v[124:127], v[64:67], v[28:31]
    v_cvt_pk_bf16_f32 v99, v42, v43
    v_mfma_f32_16x16x32_bf16 v[32:35], v[128:131], v[64:67], v[32:35]
    buffer_store_dwordx4 v[96:99], v24, s[8:11], s32 offen sc1
    s_add_u32 s32, s32, 45056
    v_mfma_f32_16x16x32_bf16 v[36:39], v[100:103], v[188:191], 0
    v_mfma_f32_16x16x32_bf16 v[40:43], v[104:107], v[188:191], 0
    v_mfma_f32_16x16x32_bf16 v[36:39], v[108:111], v[228:231], v[36:39]
    ds_read_b128 v[60:63], v14 offset:12288
    v_mfma_f32_16x16x32_bf16 v[40:43], v[112:115], v[228:231], v[40:43]
    ds_read_b128 v[64:67], v14 offset:22528
    v_cvt_pk_bf16_f32 v92, v28, v29
    s_waitcnt lgkmcnt(3)
    v_mfma_f32_16x16x32_bf16 v[36:39], v[116:119], v[68:71], v[36:39]
    v_cvt_pk_bf16_f32 v93, v30, v31
    v_mfma_f32_16x16x32_bf16 v[40:43], v[120:123], v[68:71], v[40:43]
    v_cvt_pk_bf16_f32 v94, v32, v33
    s_waitcnt lgkmcnt(2)
    v_mfma_f32_16x16x32_bf16 v[36:39], v[124:127], v[72:75], v[36:39]
    v_cvt_pk_bf16_f32 v95, v34, v35
    v_mfma_f32_16x16x32_bf16 v[40:43], v[128:131], v[72:75], v[40:43]
    buffer_store_dwordx4 v[92:95], v24, s[8:11], s32 offen sc1
    s_add_u32 s32, s32, 45056
    v_mfma_f32_16x16x32_bf16 v[28:31], v[100:103], v[192:195], 0
    v_mfma_f32_16x16x32_bf16 v[32:35], v[104:107], v[192:195], 0
    v_mfma_f32_16x16x32_bf16 v[28:31], v[108:111], v[232:235], v[28:31]
    ds_read_b128 v[68:71], v14 offset:13312
    v_mfma_f32_16x16x32_bf16 v[32:35], v[112:115], v[232:235], v[32:35]
    ds_read_b128 v[72:75], v14 offset:23552
    v_cvt_pk_bf16_f32 v96, v36, v37
    s_waitcnt lgkmcnt(3)
    v_mfma_f32_16x16x32_bf16 v[28:31], v[116:119], v[60:63], v[28:31]
    v_cvt_pk_bf16_f32 v97, v38, v39
    v_mfma_f32_16x16x32_bf16 v[32:35], v[120:123], v[60:63], v[32:35]
    v_cvt_pk_bf16_f32 v98, v40, v41
    s_waitcnt lgkmcnt(2)
    v_mfma_f32_16x16x32_bf16 v[28:31], v[124:127], v[64:67], v[28:31]
    v_cvt_pk_bf16_f32 v99, v42, v43
    v_mfma_f32_16x16x32_bf16 v[32:35], v[128:131], v[64:67], v[32:35]
    buffer_store_dwordx4 v[96:99], v24, s[8:11], s32 offen sc1
    s_add_u32 s32, s32, 45056
    v_mfma_f32_16x16x32_bf16 v[36:39], v[100:103], v[196:199], 0
    v_mfma_f32_16x16x32_bf16 v[40:43], v[104:107], v[196:199], 0
    v_mfma_f32_16x16x32_bf16 v[36:39], v[108:111], v[236:239], v[36:39]
    ds_read_b128 v[60:63], v14 offset:14336
    v_mfma_f32_16x16x32_bf16 v[40:43], v[112:115], v[236:239], v[40:43]
    ds_read_b128 v[64:67], v14 offset:24576
    v_cvt_pk_bf16_f32 v92, v28, v29
    s_waitcnt lgkmcnt(3)
    v_mfma_f32_16x16x32_bf16 v[36:39], v[116:119], v[68:71], v[36:39]
    v_cvt_pk_bf16_f32 v93, v30, v31
    v_mfma_f32_16x16x32_bf16 v[40:43], v[120:123], v[68:71], v[40:43]
    v_cvt_pk_bf16_f32 v94, v32, v33
    s_waitcnt lgkmcnt(2)
    v_mfma_f32_16x16x32_bf16 v[36:39], v[124:127], v[72:75], v[36:39]
    v_cvt_pk_bf16_f32 v95, v34, v35
    v_mfma_f32_16x16x32_bf16 v[40:43], v[128:131], v[72:75], v[40:43]
    buffer_store_dwordx4 v[92:95], v24, s[8:11], s32 offen sc1
    s_add_u32 s32, s32, 45056
    v_mfma_f32_16x16x32_bf16 v[28:31], v[100:103], v[200:203], 0
    v_mfma_f32_16x16x32_bf16 v[32:35], v[104:107], v[200:203], 0
    v_mfma_f32_16x16x32_bf16 v[28:31], v[108:111], v[240:243], v[28:31]
    ds_read_b128 v[68:71], v14 offset:15360
    v_mfma_f32_16x16x32_bf16 v[32:35], v[112:115], v[240:243], v[32:35]
    ds_read_b128 v[72:75], v14 offset:25600
    v_cvt_pk_bf16_f32 v96, v36, v37
    s_waitcnt lgkmcnt(3)
    v_mfma_f32_16x16x32_bf16 v[28:31], v[116:119], v[60:63], v[28:31]
    v_cvt_pk_bf16_f32 v97, v38, v39
    v_mfma_f32_16x16x32_bf16 v[32:35], v[120:123], v[60:63], v[32:35]
    v_cvt_pk_bf16_f32 v98, v40, v41
    s_waitcnt lgkmcnt(2)
    v_mfma_f32_16x16x32_bf16 v[28:31], v[124:127], v[64:67], v[28:31]
    v_cvt_pk_bf16_f32 v99, v42, v43
    v_mfma_f32_16x16x32_bf16 v[32:35], v[128:131], v[64:67], v[32:35]
    buffer_store_dwordx4 v[96:99], v24, s[8:11], s32 offen sc1
    s_add_u32 s32, s32, 45056
    v_mfma_f32_16x16x32_bf16 v[36:39], v[100:103], v[204:207], 0
    v_mfma_f32_16x16x32_bf16 v[40:43], v[104:107], v[204:207], 0
    v_mfma_f32_16x16x32_bf16 v[36:39], v[108:111], v[244:247], v[36:39]
    ds_read_b128 v[60:63], v14 offset:16384
    v_mfma_f32_16x16x32_bf16 v[40:43], v[112:115], v[244:247], v[40:43]
    ds_read_b128 v[64:67], v14 offset:26624
    v_cvt_pk_bf16_f32 v92, v28, v29
    s_waitcnt lgkmcnt(3)
    v_mfma_f32_16x16x32_bf16 v[36:39], v[116:119], v[68:71], v[36:39]
    v_cvt_pk_bf16_f32 v93, v30, v31
    v_mfma_f32_16x16x32_bf16 v[40:43], v[120:123], v[68:71], v[40:43]
    v_cvt_pk_bf16_f32 v94, v32, v33
    s_waitcnt lgkmcnt(2)
    v_mfma_f32_16x16x32_bf16 v[36:39], v[124:127], v[72:75], v[36:39]
    v_cvt_pk_bf16_f32 v95, v34, v35
    v_mfma_f32_16x16x32_bf16 v[40:43], v[128:131], v[72:75], v[40:43]
    buffer_store_dwordx4 v[92:95], v24, s[8:11], s32 offen sc1
    s_add_u32 s32, s32, 45056
    v_mfma_f32_16x16x32_bf16 v[28:31], v[100:103], v[208:211], 0
    v_mfma_f32_16x16x32_bf16 v[32:35], v[104:107], v[208:211], 0
    v_mfma_f32_16x16x32_bf16 v[28:31], v[108:111], v[248:251], v[28:31]
    ds_read_b128 v[68:71], v14 offset:17408
    v_mfma_f32_16x16x32_bf16 v[32:35], v[112:115], v[248:251], v[32:35]
    ds_read_b128 v[72:75], v14 offset:27648
    v_cvt_pk_bf16_f32 v96, v36, v37
    s_waitcnt lgkmcnt(3)
    v_mfma_f32_16x16x32_bf16 v[28:31], v[116:119], v[60:63], v[28:31]
    v_cvt_pk_bf16_f32 v97, v38, v39
    v_mfma_f32_16x16x32_bf16 v[32:35], v[120:123], v[60:63], v[32:35]
    v_cvt_pk_bf16_f32 v98, v40, v41
    s_waitcnt lgkmcnt(2)
    v_mfma_f32_16x16x32_bf16 v[28:31], v[124:127], v[64:67], v[28:31]
    v_cvt_pk_bf16_f32 v99, v42, v43
    v_mfma_f32_16x16x32_bf16 v[32:35], v[128:131], v[64:67], v[32:35]
    buffer_store_dwordx4 v[96:99], v24, s[8:11], s32 offen sc1
    s_add_u32 s32, s32, 45056
    v_mfma_f32_16x16x32_bf16 v[36:39], v[100:103], v[212:215], 0
    v_mfma_f32_16x16x32_bf16 v[40:43], v[104:107], v[212:215], 0
    v_mfma_f32_16x16x32_bf16 v[36:39], v[108:111], v[252:255], v[36:39]
    v_mfma_f32_16x16x32_bf16 v[40:43], v[112:115], v[252:255], v[40:43]
    v_cvt_pk_bf16_f32 v92, v28, v29
    s_waitcnt lgkmcnt(1)
    v_mfma_f32_16x16x32_bf16 v[36:39], v[116:119], v[68:71], v[36:39]
    v_cvt_pk_bf16_f32 v93, v30, v31
    v_mfma_f32_16x16x32_bf16 v[40:43], v[120:123], v[68:71], v[40:43]
    v_cvt_pk_bf16_f32 v94, v32, v33
    s_waitcnt lgkmcnt(0)
    v_mfma_f32_16x16x32_bf16 v[36:39], v[124:127], v[72:75], v[36:39]
    v_cvt_pk_bf16_f32 v95, v34, v35
    v_mfma_f32_16x16x32_bf16 v[40:43], v[128:131], v[72:75], v[40:43]
    buffer_store_dwordx4 v[92:95], v24, s[8:11], s32 offen sc1
    s_add_u32 s32, s32, 45056
    s_nop 3
    v_cvt_pk_bf16_f32 v96, v36, v37
    v_cvt_pk_bf16_f32 v97, v38, v39
    v_cvt_pk_bf16_f32 v98, v40, v41
    v_cvt_pk_bf16_f32 v99, v42, v43
    buffer_store_dwordx4 v[96:99], v24, s[8:11], s32 offen sc1
    s_mul_i32 s49, s48, 2048
    s_lshl_b32 s32, s6, 4
    s_add_u32 s49, s49, s32
    s_add_u32 s49, s49, 0xa800600
    s_cmp_ge_u32 s48, 2
    s_cbranch_scc1 nf_144
    s_waitcnt vmcnt(0)
    s_barrier
    buffer_store_dword v13, v8, s[8:11], s49 offen sc1
nf_144:
    s_add_u32 s48, s48, 2
    s_cmp_lt_u32 s48, 64
    s_cbranch_scc1 FFN_loop
    s_waitcnt vmcnt(0) lgkmcnt(0)
    s_barrier
    buffer_store_dword v13, v8, s[8:11], s49 offen sc1
    s_endpgm
code_end:
    s_endpgm
.section .rodata,"a"
.p2align 6
.amdhsa_kernel parallel_sum__memory_aug_recurrent_mem_tr__glu_gated_geglu__prompt_kernel
  .amdhsa_next_free_vgpr 512
  .amdhsa_next_free_sgpr 102
  .amdhsa_accum_offset 256
  .amdhsa_group_segment_fixed_size 0
  .amdhsa_kernarg_size 112
  .amdhsa_user_sgpr_count 2
  .amdhsa_user_sgpr_kernarg_segment_ptr 1
  .amdhsa_system_sgpr_workgroup_id_x 1
.end_amdhsa_kernel
```
